```python
import torch

def _softmax(x, axis=-1):
    return torch.softmax(x, dim=axis)
def _gelu(x):
    return torch.nn.functional.gelu(x, approximate="tanh")
def _silu(x):
    return torch.nn.functional.silu(x)
def _sigmoid(x):
    return torch.sigmoid(x)
def _layernorm(x, axis=-1, eps=1e-5):
    m = x.mean(dim=axis, keepdim=True)
    v = x.var(dim=axis, keepdim=True, unbiased=False)
    return (x - m) / torch.sqrt(v + eps)
def _scatter_add(tgt, idx, src, axis=0):
    return tgt.clone().index_add_(axis, idx, src)
def _segment_sum(src, seg, n):
    out = torch.zeros((n,) + src.shape[1:], dtype=src.dtype)
    return out.index_add_(0, seg, src)
def _pad(x, pw):
    flat = tuple(v for pair in reversed(pw) for v in pair)
    return torch.nn.functional.pad(x, flat)

kernel_name = 'standalone__qk_norm__prompt'

def setup_inputs():

    _w = (lambda a: (lambda t: t.to(torch.bfloat16) if t.is_floating_point() else t)(torch.as_tensor(a)))
    B, H, S, D = 2, 32, 2048, 1024
    Dh = D // H
    return {
        "q": _w((lambda *s: torch.randn(*s, dtype=torch.bfloat16) * 0.05)(B, H, S, Dh)),
        "k": _w((lambda *s: torch.randn(*s, dtype=torch.bfloat16) * 0.05)(B, H, S, Dh)),
        "v": _w((lambda *s: torch.randn(*s, dtype=torch.bfloat16) * 0.8)(B, H, S, Dh)),
        "t": _w(torch.abs((lambda *s: torch.randn(*s, dtype=torch.bfloat16) * 0.8)(H)) + 1.0),
    }

def reference(q, k, v, t):
    eps = 1e-6
    qn = q / (torch.sqrt((q * q).sum(axis=-1, keepdims=True)) + eps)
    kn = k / (torch.sqrt((k * k).sum(axis=-1, keepdims=True)) + eps)
    logits = torch.einsum('bhqd,bhkd->bhqk', qn, kn) * t[None, :, None, None]
    attn = _softmax(logits, axis=-1)
    return torch.einsum('bhqk,bhkd->bhqd', attn, v)
```

```asm
; @launch grid=(256,1,1) block=(256,1,1) lds=131136
.amdgcn_target "amdgcn-amd-amdhsa--gfx950"
.macro exph d, s
    v_exp_f16_sdwa v\d, v\s dst_sel:WORD_1 dst_unused:UNUSED_PRESERVE src0_sel:WORD_0
.endm
.text
.globl standalone__qk_norm__prompt_kernel
.p2align 8
.type standalone__qk_norm__prompt_kernel,@function
standalone__qk_norm__prompt_kernel:
    s_cmp_ge_u32 s2, 256
    s_cbranch_scc1 L_end
    s_load_dwordx8 s[4:11], s[0:1], 0
    s_load_dwordx2 s[12:13], s[0:1], 32
    s_load_dwordx2 s[96:97], s[0:1], 48
    s_getpc_b64 s[62:63]
L_pc:
    v_lshrrev_b32 v40, 2, v0
    s_bfe_u32 s42, s2, 0x40003
    s_lshl_b32 s42, s42, 13
    v_lshl_add_u32 v40, v40, 7, s42
    v_min_u32 v40, L_end - L_mainF - 0, v40
    s_add_u32 s62, s62, L_mainF - L_pc - 0
    s_addc_u32 s63, s63, 0
    v_mov_b32 v41, s63
    v_add_co_u32 v40, vcc, s62, v40
    v_readfirstlane_b32 s32, v0
    s_and_b32 s33, s2, 7
    v_addc_co_u32 v41, vcc, 0, v41, vcc
    global_load_dword v248, v[40:41], off
    s_lshr_b32 s42, s2, 5
    s_lshl_b32 s42, s42, 3
    s_or_b32 s33, s33, s42
    s_bfe_u32 s34, s2, 0x20003
    s_lshr_b32 s32, s32, 6
    v_and_b32 v225, 63, v0
    v_lshlrev_b32 v225, 4, v225
    v_and_b32 v249, 48, v0
    v_xor_b32 v249, v249, v225
    s_lshl_b32 s44, s32, 12
    s_add_u32 s56, s44, 0x4000
    s_lshl_b32 s58, s32, 14
    s_add_u32 s58, s58, 0x10000
    s_lshl_b32 s47, s32, 11
    s_lshl_b32 s98, s34, 13
    s_add_u32 s98, s98, s47
    s_lshl_b32 s42, s33, 17
    s_lshl_b32 s43, s34, 15
    s_add_u32 s43, s43, s42
    s_and_b32 s36, s33, 30
    s_lshl_b32 s36, s36, 1
    s_mov_b32 s22, 0x20000
    s_mov_b32 s23, 0x20000
    s_mov_b32 s26, 0x20000
    s_mov_b32 s27, 0x20000
    s_mov_b32 s18, 0x8000
    s_mov_b32 s19, 0x20000
    s_mov_b32 s30, 0x8000
    s_mov_b32 s31, 0x20000
    s_mov_b32 s50, 0x20000
    s_mov_b32 s51, 0x20000
    s_mov_b32 s54, 64
    s_mov_b32 s55, 0x20000
    s_mov_b64 s[66:67], s[50:51]
    s_lshl2_add_u32 s3, s33, s32
    s_lshl_b32 s3, s3, 7
    s_bitset1_b32 s3, 23
    s_add_u32 s38, s47, 0x2000
    s_cmp_eq_u32 s32, 3
    s_cselect_b32 s41, 0x100000, 0
    s_add_u32 s99, s98, 0x2000
    s_and_b32 s99, s99, 0x7fff
    s_add_u32 s100, s99, 0x2000
    s_and_b32 s100, s100, 0x7fff
    s_add_u32 s101, s100, 0x2000
    s_and_b32 s101, s101, 0x7fff
    v_lshlrev_b32 v36, 2, v225
    v_and_b32 v37, 12, v0
    v_lshl_add_u32 v36, v37, 2, v36
    v_add_u32 v252, s58, v36
    v_xor_b32 v253, 16, v252
    v_xor_b32 v254, 32, v252
    v_xor_b32 v255, 48, v252
    v_and_b32 v36, 0x7ff, v36
    v_and_b32 v37, 32, v0
    v_lshrrev_b32 v37, 1, v37
    v_xor_b32 v36, v36, v37
    v_add_u32 v250, s58, v36
    v_xor_b32 v251, 32, v250
    v_and_b32 v37, 1, v0
    v_lshlrev_b32 v37, 4, v37
    v_mov_b32 v36, 0x3f80
    v_lshlrev_b32 v36, v37, v36
    v_mov_b32 v38, 0x4380
    v_lshlrev_b32 v38, v37, v38
    v_and_b32 v37, 2, v0
    v_cmp_eq_u32 vcc, 0, v37
    v_lshrrev_b32 v37, 5, v0
    v_lshlrev_b32 v37, 11, v37
    v_cndmask_b32 v230, 0, v36, vcc
    v_cndmask_b32 v231, v36, 0, vcc
    v_cndmask_b32 v36, 0, v38, vcc
    v_cndmask_b32 v38, v38, 0, vcc
    v_and_b32 v227, 31, v0
    v_lshl_add_u32 v227, v227, 4, v37
    v_accvgpr_write_b32 a60, v36
    v_accvgpr_write_b32 a61, v38
    v_and_b32 v37, 32, v0
    v_lshlrev_b32 v234, 3, v37
    v_and_b32 v37, 12, v0
    v_lshl_add_u32 v234, v37, 4, v234
    v_and_b32 v37, 1, v0
    v_lshl_add_u32 v234, v37, 5, v234
    v_and_b32 v37, 16, v0
    v_add_u32 v234, v234, v37
    v_and_b32 v37, 2, v0
    v_lshl_add_u32 v234, v37, 2, v234
    s_add_u32 s62, s47, 0x4000
    v_add_u32 v234, s62, v234
    s_waitcnt lgkmcnt(0)
    s_add_u32 m0, s47, 16384
    s_add_u32 s24, s8, s42
    s_addc_u32 s25, s9, 0
    buffer_load_dwordx4 v225, s[24:27], s47 offen offset:0 nt lds
    buffer_load_dwordx4 v225, s[24:27], s47 offen offset:1024 nt lds
    s_load_dword s35, s[10:11], s36
    s_add_u32 m0, s58, 0
    s_add_u32 s20, s6, s42
    s_addc_u32 s21, s7, 0
    buffer_load_dwordx4 v249, s[20:23], s47 offen offset:0 nt lds
    buffer_load_dwordx4 v249, s[20:23], s47 offen offset:1024 nt lds
    s_add_u32 m0, s58, 2048
    s_add_u32 s16, s4, s43
    s_addc_u32 s17, s5, 0
    buffer_load_dwordx4 v249, s[16:19], s98 offen offset:0 nt lds
    buffer_load_dwordx4 v249, s[16:19], s98 offen offset:1024 nt lds
    s_add_u32 s28, s12, s43
    s_addc_u32 s29, s13, 0
    s_add_u32 s48, s96, s42
    s_addc_u32 s49, s97, 0
    s_add_u32 s52, s96, s3
    s_addc_u32 s53, s97, 0
    s_add_u32 s64, s48, 0x1000000
    s_addc_u32 s65, s49, 0
    v_and_b32 v37, 6, v0
    v_cmp_eq_u32 vcc, 0, v37
    v_mov_b32 v36, 0x5c005c00
    v_and_b32 v229, 15, v0
    v_cndmask_b32 v38, 0, v36, vcc
    v_cmp_eq_u32 vcc, 4, v37
    v_accvgpr_write_b32 a56, v38
    v_accvgpr_write_b32 a57, v38
    v_cndmask_b32 v38, 0, v36, vcc
    v_and_b32 v37, 1, v0
    v_mul_u32_u24 v244, 0xaaaa, v37
    v_accvgpr_write_b32 a58, v38
    v_accvgpr_write_b32 a59, v38
    v_add_u32 v244, 0x4444, v244
    v_lshlrev_b32 v229, 6, v229
    v_and_b32 v37, 48, v0
    v_or_b32 v229, v229, v37
    v_and_b32 v37, 63, v0
    v_cmp_eq_u32 vcc, s34, v37
    v_mov_b32 v235, 131072
    v_add_u32 v245, s47, v225
    v_cndmask_b32 v228, 64, v225, vcc
    v_add_u32 v247, 0x800, v227
    v_and_b32 v247, 0x4000, v247
    v_lshl_add_u32 v247, v247, 6, v227
    v_accvgpr_write_b32 a40, 0
    v_accvgpr_write_b32 a41, 0
    v_accvgpr_write_b32 a44, 0
    v_accvgpr_write_b32 a45, 0
    v_accvgpr_write_b32 a48, 0
    v_accvgpr_write_b32 a49, 0
    v_accvgpr_write_b32 a52, 0
    v_accvgpr_write_b32 a53, 0
    v_mov_b32 v36, 0x3d803d80
    v_pk_mul_f32 v[240:241], 0, 0
    v_pk_mul_f32 v[242:243], 0, 0
    v_accvgpr_write_b32 a36, v36
    v_accvgpr_write_b32 a37, v36
    v_accvgpr_write_b32 a38, v36
    v_accvgpr_write_b32 a39, v36
    s_mov_b64 vcc, -1
    s_cmp_eq_u32 s32, 0
    s_cbranch_scc1 L_pad0F
    s_cmp_eq_u32 s32, 1
    s_cbranch_scc1 L_pad1F
    s_cmp_eq_u32 s32, 2
    s_cbranch_scc1 L_pad2F
    s_branch L_pad3F
L_t:
    s_waitcnt lgkmcnt(0)
    s_and_b32 s42, s33, 1
    s_lshl_b32 s42, s42, 4
    s_lshr_b32 s35, s35, s42
    s_lshl_b32 s35, s35, 16
    v_mov_b32 v238, 0x3fb8aa3b
    v_mul_f32 v238, s35, v238
    s_and_b32 s42, s35, 0x7fffffff
    s_cmp_ge_u32 s42, 0x40400001
    s_cbranch_scc1 L_notf
    s_branch L_goF
L_notf:
    s_cmp_ge_u32 s42, 0x41300001
    s_cbranch_scc1 L_slow
    s_cmp_eq_u32 s32, 0
    s_cbranch_scc1 L_pad0B
    s_cmp_eq_u32 s32, 1
    s_cbranch_scc1 L_pad1B
    s_cmp_eq_u32 s32, 2
    s_cbranch_scc1 L_pad2B
    s_branch L_pad3B
.p2align 12
L_mainF:
L_pad0F:
    s_cbranch_vccnz L_pad4F
L_goF:
    s_mov_b64 vcc, 0
    ds_write_b32 v235, v241
    s_waitcnt vmcnt(4)
    ds_read_b64_tr_b16 v[208:209], v234 offset:0
    ds_read_b64_tr_b16 v[210:211], v234 offset:512
    ds_read_b64_tr_b16 v[212:213], v234 offset:1024
    ds_read_b64_tr_b16 v[214:215], v234 offset:1536
    v_and_b32 v48, 0x7fffffff, v238
    v_mov_b32 v49, 0x3f80a3d7
    v_fmaak_f32 v48, v48, v49, 0x3cc00000
    v_add_f32 v49, 0.5, v48
    v_floor_f32 v49, v49
    v_add_f32 v49, 0.5, v49
    v_min_f32 v49, 0x40600000, v49
    v_max_f32 v48, v48, v49
    v_add_f32 v48, 0x47804800, v48
    v_mov_b32 v49, v48
    v_pk_add_f32 v[50:51], v[48:49], 0
    v_pk_add_f32 v[52:53], v[48:49], 0
    v_pk_add_f32 v[54:55], v[48:49], 0
    v_pk_add_f32 v[56:57], v[48:49], 0
    v_pk_add_f32 v[58:59], v[48:49], 0
    v_pk_add_f32 v[60:61], v[48:49], 0
    v_pk_add_f32 v[62:63], v[48:49], 0
    s_add_u32 m0, s58, 4096
    s_nop 0
    buffer_load_dwordx4 v249, s[20:23], s38 offen offset:0 nt lds
    buffer_load_dwordx4 v249, s[20:23], s38 offen offset:1024 nt lds
    s_add_u32 m0, s58, 6144
    s_nop 0
    buffer_load_dwordx4 v249, s[16:19], s99 offen offset:0 nt lds
    buffer_load_dwordx4 v249, s[16:19], s99 offen offset:1024 nt lds
    s_add_u32 m0, s47, 24576
    s_nop 0
    buffer_load_dwordx4 v225, s[24:27], s38 offen offset:0 nt lds
    buffer_load_dwordx4 v225, s[24:27], s38 offen offset:1024 nt lds
    buffer_load_dwordx2 v[232:233], v225, s[52:55], 0 offen sc1
    s_waitcnt lgkmcnt(3)
    v_mfma_f32_4x4x4_16b_bf16 v[160:163], a[60:61], v[208:209], 0
    s_waitcnt lgkmcnt(2)
    v_mfma_f32_4x4x4_16b_bf16 v[164:167], a[60:61], v[210:211], 0
    s_waitcnt lgkmcnt(1)
    v_mfma_f32_4x4x4_16b_bf16 v[168:171], a[60:61], v[212:213], 0
    s_waitcnt lgkmcnt(0)
    v_mfma_f32_4x4x4_16b_bf16 v[172:175], a[60:61], v[214:215], 0
    s_nop 1
    v_cvt_pk_f16_f32 v208, v160, v161
    v_cvt_pk_f16_f32 v209, v162, v163
    v_cvt_pk_f16_f32 v210, v164, v165
    v_cvt_pk_f16_f32 v211, v166, v167
    v_cvt_pk_f16_f32 v212, v168, v169
    v_cvt_pk_f16_f32 v213, v170, v171
    v_cvt_pk_f16_f32 v214, v172, v173
    v_cvt_pk_f16_f32 v215, v174, v175
    v_and_b32 v200, 0x7fff7fff, v208
    v_and_b32 v201, 0x7fff7fff, v209
    v_and_b32 v202, 0x7fff7fff, v210
    v_and_b32 v203, 0x7fff7fff, v211
    ds_write_b128 v245, v[208:211] offset:16384
    ds_write_b128 v245, v[212:215] offset:17408
    v_mfma_f32_32x32x16_f16 v[96:111], v[200:203], a[36:39], 0
    s_waitcnt vmcnt(7)
    ds_read_b128 v[16:19], v250 offset:0
    ds_read_b128 v[128:131], v250 offset:2048
    ds_read_b128 v[20:23], v251 offset:0
    ds_read_b128 v[132:135], v251 offset:2048
    v_pk_mul_f32 v[236:237], 0, 0
    s_waitcnt lgkmcnt(3)
    v_dot2c_f32_bf16 v236, v16, v16
    s_waitcnt lgkmcnt(2)
    v_dot2c_f32_bf16 v237, v128, v128
    v_dot2c_f32_bf16 v236, v17, v17
    v_dot2c_f32_bf16 v237, v129, v129
    v_dot2c_f32_bf16 v236, v18, v18
    v_dot2c_f32_bf16 v237, v130, v130
    v_dot2c_f32_bf16 v236, v19, v19
    v_dot2c_f32_bf16 v237, v131, v131
    s_waitcnt lgkmcnt(1)
    v_dot2c_f32_bf16 v236, v20, v20
    s_waitcnt lgkmcnt(0)
    v_dot2c_f32_bf16 v237, v132, v132
    v_dot2c_f32_bf16 v236, v21, v21
    v_dot2c_f32_bf16 v237, v133, v133
    v_dot2c_f32_bf16 v236, v22, v22
    v_dot2c_f32_bf16 v237, v134, v134
    v_dot2c_f32_bf16 v236, v23, v23
    v_dot2c_f32_bf16 v237, v135, v135
    v_mfma_f32_4x4x4_16b_bf16 v[160:163], v[230:231], v[16:17], 0
    v_mfma_f32_4x4x4_16b_bf16 v[164:167], v[230:231], v[18:19], 0
    v_mfma_f32_4x4x4_16b_bf16 v[168:171], v[230:231], v[20:21], 0
    v_permlane32_swap_b32 v236, v237
    v_add_f32 v236, v236, v237
    v_mfma_f32_4x4x4_16b_bf16 v[172:175], v[230:231], v[22:23], 0
    v_sqrt_f32 v236, v236
    v_mfma_f32_4x4x4_16b_bf16 v[176:179], v[230:231], v[128:129], 0
    v_add_f32 v236, 0x358637bd, v236
    v_rcp_f32 v236, v236
    v_mfma_f32_4x4x4_16b_bf16 v[180:183], v[230:231], v[130:131], 0
    v_mov_b32 v237, v236
    v_mfma_f32_4x4x4_16b_bf16 v[184:187], v[230:231], v[132:133], 0
    v_mfma_f32_4x4x4_16b_bf16 v[188:191], v[230:231], v[134:135], 0
    v_permlane32_swap_b32 v236, v237
    v_mul_f32 v237, v238, v237
    v_pk_mul_f32 v[160:161], v[160:161], v[236:237] op_sel_hi:[1,0]
    v_pk_mul_f32 v[162:163], v[162:163], v[236:237] op_sel_hi:[1,0]
    v_pk_mul_f32 v[164:165], v[164:165], v[236:237] op_sel_hi:[1,0]
    v_pk_mul_f32 v[166:167], v[166:167], v[236:237] op_sel_hi:[1,0]
    v_pk_mul_f32 v[168:169], v[168:169], v[236:237] op_sel_hi:[1,0]
    v_pk_mul_f32 v[170:171], v[170:171], v[236:237] op_sel_hi:[1,0]
    v_pk_mul_f32 v[172:173], v[172:173], v[236:237] op_sel_hi:[1,0]
    v_pk_mul_f32 v[174:175], v[174:175], v[236:237] op_sel_hi:[1,0]
    v_pk_mul_f32 v[176:177], v[176:177], v[236:237] op_sel:[0,1]
    v_pk_mul_f32 v[178:179], v[178:179], v[236:237] op_sel:[0,1]
    v_pk_mul_f32 v[180:181], v[180:181], v[236:237] op_sel:[0,1]
    v_pk_mul_f32 v[182:183], v[182:183], v[236:237] op_sel:[0,1]
    v_pk_mul_f32 v[184:185], v[184:185], v[236:237] op_sel:[0,1]
    v_pk_mul_f32 v[186:187], v[186:187], v[236:237] op_sel:[0,1]
    v_pk_mul_f32 v[188:189], v[188:189], v[236:237] op_sel:[0,1]
    v_pk_mul_f32 v[190:191], v[190:191], v[236:237] op_sel:[0,1]
    v_cvt_pk_bf16_f32 v16, v160, v161
    v_cvt_pk_bf16_f32 v17, v162, v163
    v_cvt_pk_bf16_f32 v18, v164, v165
    v_cvt_pk_bf16_f32 v19, v166, v167
    v_cvt_pk_bf16_f32 v20, v168, v169
    v_cvt_pk_bf16_f32 v21, v170, v171
    v_cvt_pk_bf16_f32 v22, v172, v173
    v_cvt_pk_bf16_f32 v23, v174, v175
    ds_write_b128 v245, v[16:19] offset:0
    ds_write_b128 v245, v[20:23] offset:1024
    v_cvt_pk_bf16_f32 v128, v176, v177
    v_cvt_pk_bf16_f32 v129, v178, v179
    v_cvt_pk_bf16_f32 v130, v180, v181
    v_cvt_pk_bf16_f32 v131, v182, v183
    v_cvt_pk_bf16_f32 v132, v184, v185
    v_cvt_pk_bf16_f32 v133, v186, v187
    v_cvt_pk_bf16_f32 v134, v188, v189
    v_cvt_pk_bf16_f32 v135, v190, v191
    s_waitcnt lgkmcnt(0)
    s_barrier
    ds_read_b128 a[0:3], v225 offset:0
    ds_read_b128 a[4:7], v225 offset:1024
    ds_read_b128 a[8:11], v225 offset:2048
    ds_read_b128 a[12:15], v225 offset:3072
    ds_read_b128 a[16:19], v225 offset:16384
    ds_read_b128 a[20:23], v225 offset:17408
    v_min3_f32 v200, v96, v97, v98
    v_min3_f32 v200, v99, v100, v200
    v_min3_f32 v200, v101, v102, v200
    v_min3_f32 v200, v103, v104, v200
    v_min3_f32 v200, v105, v106, v200
    v_min3_f32 v200, v107, v108, v200
    v_min3_f32 v200, v109, v110, v200
    v_min_f32 v200, v111, v200
    v_mov_b32 v201, v200
    v_mov_b32 v202, 0x42800000
    s_nop 0
    v_permlane32_swap_b32 v200, v201
    v_min_f32 v200, v200, v201
    v_cmp_nge_f32 s[62:63], v200, v202
    v_and_b32 v200, 0x7f800000, v200
    v_add_u32 v240, 0xa400000, v200
    v_mul_f32 v246, 0xbe000000, v240
    s_cmp_lg_u32 s62, 0
    s_cbranch_scc1 L_vbad
L_vback:
    s_waitcnt lgkmcnt(5)
    v_mfma_f32_32x32x16_bf16 v[0:15], a[0:3], v[128:131], v[48:63]
    s_waitcnt lgkmcnt(4)
    v_mfma_f32_32x32x16_bf16 v[0:15], a[4:7], v[132:135], v[0:15]
    s_lshl_b32 s45, s34, 1
    s_mul_i32 s37, s45, 14336
    s_add_u32 s37, s37, s56
    s_add_u32 s13, s37, s41
    s_add_u32 s57, s56, 0x8000
    s_lshl_b32 s39, s34, 15
    s_add_u32 s61, s44, 0x8000
    s_add_u32 s68, s39, s44
    s_add_u32 s69, s68, s41
    s_sub_u32 s36, s58, s47
    s_sub_u32 s36, s36, 0x3000
    s_waitcnt lgkmcnt(3)
    v_mfma_f32_32x32x16_bf16 v[16:31], a[8:11], v[128:131], v[48:63]
    s_waitcnt lgkmcnt(2)
    ds_read_b128 a[0:3], v225 offset:4096
    v_exp_f16 v32, v0
    v_exp_f16 v33, v2
    v_exp_f16 v34, v4
    v_mfma_f32_32x32x16_bf16 v[16:31], a[12:15], v[132:135], v[16:31]
    s_waitcnt lgkmcnt(0)
    ds_read_b128 a[4:7], v225 offset:5120
    v_exp_f16 v35, v6
    exph 32, 1
    exph 33, 3
    v_mfma_f32_32x32x16_bf16 v[64:79], v[240:243], a[36:39], 0
    ds_read_b128 a[24:27], v225 offset:18432
    exph 34, 5
    exph 35, 7
    v_exp_f16 v36, v8
    v_mfma_f32_32x32x16_bf16 v[80:95], v[240:243], a[36:39], 0
    s_add_u32 m0, s58, 8192
    v_exp_f16 v37, v10
    v_exp_f16 v38, v12
    v_exp_f16 v39, v14
    v_mfma_f32_32x32x16_bf16 v[112:127], v[240:243], a[36:39], 0
    ds_read_b128 a[28:31], v225 offset:19456
    buffer_load_dwordx4 v249, s[16:19], s100 offen offset:0 nt lds
    buffer_load_dwordx4 v249, s[16:19], s100 offen offset:1024 nt lds
    exph 36, 9
    exph 37, 11
    exph 38, 13
    exph 39, 15
    v_mfma_f32_32x32x16_bf16 v[0:15], a[0:3], v[128:131], v[48:63]
    s_waitcnt lgkmcnt(2)
    ds_read_b128 a[8:11], v225 offset:6144
    v_exp_f16 v40, v16
    v_exp_f16 v41, v18
    v_exp_f16 v42, v20
    v_mfma_f32_32x32x16_bf16 v[0:15], a[4:7], v[132:135], v[0:15]
    ds_read_b128 a[12:15], v225 offset:7168
    v_exp_f16 v43, v22
    exph 40, 17
    exph 41, 19
    v_mfma_f32_32x32x16_f16 v[64:79], a[16:19], v[32:35], v[64:79]
    ds_read_b128 a[16:19], v225 offset:20480
    exph 42, 21
    exph 43, 23
    v_exp_f16 v44, v24
    v_mfma_f32_32x32x16_f16 v[64:79], a[20:23], v[36:39], v[64:79]
    s_add_u32 m0, s58, 10240
    v_exp_f16 v45, v26
    v_exp_f16 v46, v28
    v_exp_f16 v47, v30
    v_smfmac_f32_16x16x64_f16 a[40:43], a[56:59], v[32:39], v244
    s_waitcnt lgkmcnt(2)
    ds_read_b128 a[20:23], v225 offset:21504
    buffer_load_dwordx4 v249, s[16:19], s101 offen offset:0 nt lds
    buffer_load_dwordx4 v249, s[16:19], s101 offen offset:1024 nt lds
    exph 44, 25
    v_mfma_f32_32x32x16_bf16 v[96:111], v[240:243], a[36:39], 0
    exph 45, 27
    exph 46, 29
    exph 47, 31
    v_mfma_f32_32x32x16_bf16 v[16:31], a[8:11], v[128:131], v[48:63]
    s_waitcnt lgkmcnt(2)
    ds_read_b128 a[0:3], v225 offset:0
    v_exp_f16 v32, v0
    v_exp_f16 v33, v2
    v_exp_f16 v34, v4
    v_mfma_f32_32x32x16_bf16 v[16:31], a[12:15], v[132:135], v[16:31]
    ds_read_b128 a[4:7], v225 offset:1024
    v_exp_f16 v35, v6
    exph 32, 1
    exph 33, 3
    v_mfma_f32_32x32x16_f16 v[64:79], a[24:27], v[40:43], v[64:79]
    s_waitcnt vmcnt(7)
    ds_read_b128 a[24:27], v225 offset:22528
    ds_read_b128 v[192:195], v250 offset:4096
    ds_read_b128 v[136:139], v250 offset:6144
    exph 34, 5
    exph 35, 7
    v_exp_f16 v36, v8
    v_mfma_f32_32x32x16_f16 v[64:79], a[28:31], v[44:47], v[64:79]
    ds_read_b128 v[196:199], v251 offset:4096
    ds_read_b128 v[140:143], v251 offset:6144
    v_exp_f16 v37, v10
    v_exp_f16 v38, v12
    v_exp_f16 v39, v14
    v_smfmac_f32_16x16x64_f16 a[40:43], a[56:59], v[40:47], v244
    s_waitcnt lgkmcnt(0)
    ds_read_b128 a[28:31], v225 offset:23552
    exph 36, 9
    exph 37, 11
    exph 38, 13
    exph 39, 15
    v_pk_mul_f32 v[236:237], 0, 0
    v_dot2c_f32_bf16 v236, v192, v192
    v_dot2c_f32_bf16 v237, v136, v136
    v_dot2c_f32_bf16 v236, v193, v193
    v_dot2c_f32_bf16 v237, v137, v137
    v_dot2c_f32_bf16 v236, v194, v194
    v_dot2c_f32_bf16 v237, v138, v138
    v_dot2c_f32_bf16 v236, v195, v195
    v_dot2c_f32_bf16 v237, v139, v139
    v_dot2c_f32_bf16 v236, v196, v196
    v_dot2c_f32_bf16 v237, v140, v140
    v_dot2c_f32_bf16 v236, v197, v197
    v_dot2c_f32_bf16 v237, v141, v141
    v_dot2c_f32_bf16 v236, v198, v198
    v_dot2c_f32_bf16 v237, v142, v142
    v_dot2c_f32_bf16 v236, v199, v199
    v_dot2c_f32_bf16 v237, v143, v143
    v_mfma_f32_4x4x4_16b_bf16 v[160:163], v[230:231], v[192:193], 0
    v_mfma_f32_4x4x4_16b_bf16 v[164:167], v[230:231], v[194:195], 0
    v_mfma_f32_4x4x4_16b_bf16 v[168:171], v[230:231], v[196:197], 0
    v_permlane32_swap_b32 v236, v237
    v_add_f32 v236, v236, v237
    v_mfma_f32_4x4x4_16b_bf16 v[172:175], v[230:231], v[198:199], 0
    v_sqrt_f32 v236, v236
    v_mfma_f32_4x4x4_16b_bf16 v[176:179], v[230:231], v[136:137], 0
    v_add_f32 v236, 0x358637bd, v236
    v_rcp_f32 v236, v236
    v_mfma_f32_4x4x4_16b_bf16 v[180:183], v[230:231], v[138:139], 0
    v_mov_b32 v237, v236
    v_mfma_f32_4x4x4_16b_bf16 v[184:187], v[230:231], v[140:141], 0
    v_mfma_f32_4x4x4_16b_bf16 v[188:191], v[230:231], v[142:143], 0
    v_permlane32_swap_b32 v236, v237
    v_mul_f32 v237, v238, v237
    v_pk_mul_f32 v[160:161], v[160:161], v[236:237] op_sel_hi:[1,0]
    v_pk_mul_f32 v[162:163], v[162:163], v[236:237] op_sel_hi:[1,0]
    v_pk_mul_f32 v[164:165], v[164:165], v[236:237] op_sel_hi:[1,0]
    v_pk_mul_f32 v[166:167], v[166:167], v[236:237] op_sel_hi:[1,0]
    v_pk_mul_f32 v[168:169], v[168:169], v[236:237] op_sel_hi:[1,0]
    v_pk_mul_f32 v[170:171], v[170:171], v[236:237] op_sel_hi:[1,0]
    v_pk_mul_f32 v[172:173], v[172:173], v[236:237] op_sel_hi:[1,0]
    v_pk_mul_f32 v[174:175], v[174:175], v[236:237] op_sel_hi:[1,0]
    v_pk_mul_f32 v[176:177], v[176:177], v[236:237] op_sel:[0,1]
    v_pk_mul_f32 v[178:179], v[178:179], v[236:237] op_sel:[0,1]
    v_pk_mul_f32 v[180:181], v[180:181], v[236:237] op_sel:[0,1]
    v_pk_mul_f32 v[182:183], v[182:183], v[236:237] op_sel:[0,1]
    v_pk_mul_f32 v[184:185], v[184:185], v[236:237] op_sel:[0,1]
    v_pk_mul_f32 v[186:187], v[186:187], v[236:237] op_sel:[0,1]
    v_pk_mul_f32 v[188:189], v[188:189], v[236:237] op_sel:[0,1]
    v_pk_mul_f32 v[190:191], v[190:191], v[236:237] op_sel:[0,1]
    v_cvt_pk_bf16_f32 v136, v176, v177
    v_cvt_pk_bf16_f32 v137, v178, v179
    v_cvt_pk_bf16_f32 v138, v180, v181
    v_cvt_pk_bf16_f32 v139, v182, v183
    v_cvt_pk_bf16_f32 v140, v184, v185
    v_cvt_pk_bf16_f32 v141, v186, v187
    v_cvt_pk_bf16_f32 v142, v188, v189
    v_cvt_pk_bf16_f32 v143, v190, v191
    v_cvt_pk_bf16_f32 v192, v160, v161
    v_cvt_pk_bf16_f32 v193, v162, v163
    v_cvt_pk_bf16_f32 v194, v164, v165
    v_cvt_pk_bf16_f32 v195, v166, v167
    v_cvt_pk_bf16_f32 v196, v168, v169
    v_cvt_pk_bf16_f32 v197, v170, v171
    v_cvt_pk_bf16_f32 v198, v172, v173
    v_cvt_pk_bf16_f32 v199, v174, v175
    v_mfma_f32_32x32x16_bf16 v[0:15], a[0:3], v[136:139], v[48:63]
    s_waitcnt vmcnt(5)
    ds_read_b128 a[8:11], v225 offset:2048
    ds_read_b64_tr_b16 v[208:209], v234 offset:8192
    v_exp_f16 v40, v16
    v_exp_f16 v41, v18
    v_exp_f16 v42, v20
    v_mfma_f32_32x32x16_bf16 v[0:15], a[4:7], v[140:143], v[0:15]
    ds_read_b128 a[12:15], v225 offset:3072
    ds_read_b64_tr_b16 v[210:211], v234 offset:8704
    ds_read_b64_tr_b16 v[212:213], v234 offset:9216
    v_exp_f16 v43, v22
    exph 40, 17
    exph 41, 19
    v_mfma_f32_32x32x16_f16 v[64:79], a[16:19], v[32:35], v[64:79]
    ds_read_b128 a[16:19], v225 offset:16384
    ds_read_b64_tr_b16 v[214:215], v234 offset:9728
    exph 42, 21
    exph 43, 23
    v_exp_f16 v44, v24
    v_mfma_f32_32x32x16_f16 v[64:79], a[20:23], v[36:39], v[64:79]
    ds_read_b128 a[20:23], v225 offset:17408
    v_exp_f16 v45, v26
    v_exp_f16 v46, v28
    v_exp_f16 v47, v30
    v_smfmac_f32_16x16x64_f16 a[40:43], a[56:59], v[32:39], v244
    s_waitcnt lgkmcnt(1)
    ds_write_b128 v245, v[192:195] offset:8192
    ds_write_b128 v245, v[196:199] offset:9216
    exph 44, 25
    v_mfma_f32_4x4x4_16b_bf16 v[160:163], a[60:61], v[208:209], 0
    exph 45, 27
    v_mfma_f32_4x4x4_16b_bf16 v[164:167], a[60:61], v[210:211], 0
    exph 46, 29
    exph 47, 31
    v_mfma_f32_4x4x4_16b_bf16 v[168:171], a[60:61], v[212:213], 0
    v_cvt_pk_f16_f32 v208, v160, v161
    v_cvt_pk_f16_f32 v209, v162, v163
    v_mfma_f32_4x4x4_16b_bf16 v[172:175], a[60:61], v[214:215], 0
    v_cvt_pk_f16_f32 v210, v164, v165
    v_cvt_pk_f16_f32 v211, v166, v167
    v_cvt_pk_f16_f32 v212, v168, v169
    v_cvt_pk_f16_f32 v213, v170, v171
    s_nop 0
    v_cvt_pk_f16_f32 v214, v172, v173
    v_cvt_pk_f16_f32 v215, v174, v175
    v_mfma_f32_32x32x16_bf16 v[16:31], a[8:11], v[136:139], v[48:63]
    ds_read_b128 a[0:3], v225 offset:4096
    v_exp_f16 v32, v0
    v_exp_f16 v33, v2
    v_exp_f16 v34, v4
    v_mfma_f32_32x32x16_bf16 v[16:31], a[12:15], v[140:143], v[16:31]
    ds_read_b128 a[4:7], v225 offset:5120
    v_exp_f16 v35, v6
    exph 32, 1
    exph 33, 3
    v_mfma_f32_32x32x16_f16 v[64:79], a[24:27], v[40:43], v[64:79]
    ds_read_b128 a[24:27], v225 offset:18432
    exph 34, 5
    exph 35, 7
    v_exp_f16 v36, v8
    v_mfma_f32_32x32x16_f16 v[64:79], a[28:31], v[44:47], v[64:79]
    ds_read_b128 a[28:31], v225 offset:19456
    v_exp_f16 v37, v10
    v_exp_f16 v38, v12
    v_exp_f16 v39, v14
    v_smfmac_f32_16x16x64_f16 a[40:43], a[56:59], v[40:47], v244
    s_waitcnt lgkmcnt(3)
    ds_write_b128 v245, v[208:211] offset:24576
    ds_write_b128 v245, v[212:215] offset:25600
    exph 36, 9
    exph 37, 11
    exph 38, 13
    exph 39, 15
    v_mfma_f32_32x32x16_bf16 v[0:15], a[0:3], v[136:139], v[48:63]
    s_waitcnt lgkmcnt(4)
    ds_read_b128 a[8:11], v225 offset:6144
    v_exp_f16 v40, v16
    v_exp_f16 v41, v18
    v_exp_f16 v42, v20
    v_mfma_f32_32x32x16_bf16 v[0:15], a[4:7], v[140:143], v[0:15]
    ds_read_b128 a[12:15], v225 offset:7168
    v_exp_f16 v43, v22
    exph 40, 17
    exph 41, 19
    v_mfma_f32_32x32x16_f16 v[80:95], a[16:19], v[32:35], v[80:95]
    s_waitcnt lgkmcnt(2)
    ds_read_b128 a[16:19], v225 offset:20480
    exph 42, 21
    exph 43, 23
    v_exp_f16 v44, v24
    v_mfma_f32_32x32x16_f16 v[80:95], a[20:23], v[36:39], v[80:95]
    s_barrier
    v_exp_f16 v45, v26
    v_exp_f16 v46, v28
    v_exp_f16 v47, v30
    v_smfmac_f32_16x16x64_f16 a[44:47], a[56:59], v[32:39], v244
    s_waitcnt lgkmcnt(2)
    ds_read_b128 a[20:23], v225 offset:21504
    exph 44, 25
    exph 45, 27
    exph 46, 29
    exph 47, 31
    v_mfma_f32_32x32x16_bf16 v[16:31], a[8:11], v[136:139], v[48:63]
    s_waitcnt lgkmcnt(2)
    ds_read_b128 a[0:3], v225 offset:8192
    v_exp_f16 v32, v0
    v_exp_f16 v33, v2
    v_add_u32 v245, s47, v245
    v_exp_f16 v34, v4
    v_mfma_f32_32x32x16_bf16 v[16:31], a[12:15], v[140:143], v[16:31]
    ds_read_b128 a[4:7], v225 offset:9216
    v_exp_f16 v35, v6
    exph 32, 1
    v_add_u32 v234, s36, v234
    exph 33, 3
    v_mfma_f32_32x32x16_f16 v[80:95], a[24:27], v[40:43], v[80:95]
    ds_read_b128 a[24:27], v225 offset:22528
    exph 34, 5
    exph 35, 7
    v_exp_f16 v36, v8
    v_mfma_f32_32x32x16_f16 v[80:95], a[28:31], v[44:47], v[80:95]
    s_mov_b32 m0, s58
    v_exp_f16 v37, v10
    v_exp_f16 v38, v12
    v_exp_f16 v39, v14
    v_smfmac_f32_16x16x64_f16 a[44:47], a[56:59], v[40:47], v244
    s_waitcnt lgkmcnt(2)
    ds_read_b128 a[28:31], v225 offset:23552
    exph 36, 9
    exph 37, 11
    exph 38, 13
    exph 39, 15
    v_mfma_f32_32x32x16_bf16 v[0:15], a[0:3], v[128:131], v[48:63]
    s_waitcnt lgkmcnt(2)
    buffer_load_dwordx4 v249, s[20:23], s37 offen offset:0 nt lds
    v_exp_f16 v40, v16
    v_exp_f16 v41, v18
    v_exp_f16 v42, v20
    v_mfma_f32_32x32x16_bf16 v[0:15], a[4:7], v[132:135], v[0:15]
    buffer_load_dwordx4 v249, s[20:23], s37 offen offset:1024 nt lds
    v_exp_f16 v43, v22
    exph 40, 17
    exph 41, 19
    v_mfma_f32_32x32x16_f16 v[80:95], a[16:19], v[32:35], v[80:95]
    ds_read_b128 a[16:19], v225 offset:24576
    exph 42, 21
    exph 43, 23
    v_exp_f16 v44, v24
    v_mfma_f32_32x32x16_f16 v[80:95], a[20:23], v[36:39], v[80:95]
    buffer_load_dwordx4 v249, s[20:23], s13 offen offset:2048 nt lds
    v_exp_f16 v45, v26
    v_exp_f16 v46, v28
    v_exp_f16 v47, v30
    v_smfmac_f32_16x16x64_f16 a[44:47], a[56:59], v[32:39], v244
    ds_read_b128 a[20:23], v225 offset:25600
    exph 44, 25
    exph 45, 27
    exph 46, 29
    exph 47, 31
    s_mov_b64 vcc, -1
    s_cmp_eq_u32 s32, 0
    s_cbranch_scc1 L_pad8F
    s_cmp_eq_u32 s32, 1
    s_cbranch_scc1 L_pad9F
    s_cmp_eq_u32 s32, 2
    s_cbranch_scc1 L_pad10F
    s_branch L_ret
L_ret:
    s_mov_b64 vcc, 0
    v_mfma_f32_32x32x16_bf16 v[16:31], a[0:3], v[136:139], v[48:63]
    ds_read_b128 a[8:11], v225 offset:10240
    v_exp_f16 v32, v0
    v_exp_f16 v33, v2
    v_exp_f16 v34, v4
    v_mfma_f32_32x32x16_bf16 v[16:31], a[4:7], v[140:143], v[16:31]
    s_waitcnt lgkmcnt(4)
    ds_read_b128 a[12:15], v225 offset:11264
    v_exp_f16 v35, v6
    exph 32, 1
    exph 33, 3
    v_mfma_f32_32x32x16_f16 v[80:95], a[24:27], v[40:43], v[80:95]
    s_waitcnt lgkmcnt(4)
    buffer_load_dwordx4 v249, s[20:23], s13 offen offset:3072 nt lds
    exph 34, 5
    exph 35, 7
    v_exp_f16 v36, v8
    v_mfma_f32_32x32x16_f16 v[80:95], a[28:31], v[44:47], v[80:95]
    s_add_u32 m0, s58, 0x1000
    v_exp_f16 v37, v10
    v_exp_f16 v38, v12
    v_exp_f16 v39, v14
    v_smfmac_f32_16x16x64_f16 a[44:47], a[56:59], v[40:47], v244
    s_waitcnt lgkmcnt(1)
    ds_read_b128 a[24:27], v225 offset:26624
    exph 36, 9
    exph 37, 11
    exph 38, 13
    exph 39, 15
    v_mfma_f32_32x32x16_bf16 v[0:15], a[8:11], v[128:131], v[48:63]
    s_waitcnt vmcnt(4) lgkmcnt(1)
    ds_read_b128 v[144:147], v250 offset:8192
    v_exp_f16 v40, v16
    v_exp_f16 v41, v18
    v_exp_f16 v42, v20
    v_mfma_f32_32x32x16_bf16 v[0:15], a[12:15], v[132:135], v[0:15]
    ds_read_b128 v[152:155], v250 offset:10240
    v_exp_f16 v43, v22
    exph 40, 17
    exph 41, 19
    v_mfma_f32_32x32x16_f16 v[64:79], a[16:19], v[32:35], v[64:79]
    ds_read_b128 v[148:151], v251 offset:8192
    exph 42, 21
    exph 43, 23
    v_exp_f16 v44, v24
    v_mfma_f32_32x32x16_f16 v[64:79], a[20:23], v[36:39], v[64:79]
    ds_read_b128 v[156:159], v251 offset:10240
    v_exp_f16 v45, v26
    v_exp_f16 v46, v28
    v_exp_f16 v47, v30
    v_smfmac_f32_16x16x64_f16 a[40:43], a[56:59], v[32:39], v244
    ds_read_b128 a[28:31], v225 offset:27648
    exph 44, 25
    exph 45, 27
    exph 46, 29
    exph 47, 31
    v_mfma_f32_32x32x16_bf16 v[16:31], a[8:11], v[136:139], v[48:63]
    ds_read_b128 a[0:3], v225 offset:0
    v_exp_f16 v32, v0
    v_exp_f16 v33, v2
    v_exp_f16 v34, v4
    v_mfma_f32_32x32x16_bf16 v[16:31], a[12:15], v[140:143], v[16:31]
    ds_read_b128 a[4:7], v225 offset:1024
    v_exp_f16 v35, v6
    exph 32, 1
    exph 33, 3
    v_mfma_f32_32x32x16_f16 v[80:95], a[16:19], v[40:43], v[80:95]
    buffer_load_dwordx4 v225, s[24:27], s37 offen offset:0 nt lds
    exph 34, 5
    exph 35, 7
    v_exp_f16 v36, v8
    v_mfma_f32_32x32x16_f16 v[80:95], a[20:23], v[44:47], v[80:95]
    buffer_load_dwordx4 v225, s[24:27], s37 offen offset:1024 nt lds
    v_exp_f16 v37, v10
    v_exp_f16 v38, v12
    v_exp_f16 v39, v14
    v_smfmac_f32_16x16x64_f16 a[44:47], a[56:59], v[40:47], v244
    s_waitcnt lgkmcnt(1)
    ds_read_b128 a[16:19], v225 offset:16384
    exph 36, 9
    exph 37, 11
    exph 38, 13
    exph 39, 15
    v_pk_mul_f32 v[236:237], 0, 0
    v_dot2c_f32_bf16 v236, v144, v144
    v_dot2c_f32_bf16 v237, v152, v152
    v_dot2c_f32_bf16 v236, v145, v145
    v_dot2c_f32_bf16 v237, v153, v153
    v_dot2c_f32_bf16 v236, v146, v146
    v_dot2c_f32_bf16 v237, v154, v154
    v_dot2c_f32_bf16 v236, v147, v147
    v_dot2c_f32_bf16 v237, v155, v155
    v_dot2c_f32_bf16 v236, v148, v148
    v_dot2c_f32_bf16 v237, v156, v156
    v_dot2c_f32_bf16 v236, v149, v149
    v_dot2c_f32_bf16 v237, v157, v157
    v_dot2c_f32_bf16 v236, v150, v150
    v_dot2c_f32_bf16 v237, v158, v158
    v_dot2c_f32_bf16 v236, v151, v151
    v_dot2c_f32_bf16 v237, v159, v159
    v_mfma_f32_4x4x4_16b_bf16 v[160:163], v[230:231], v[144:145], 0
    v_mfma_f32_4x4x4_16b_bf16 v[164:167], v[230:231], v[146:147], 0
    v_mfma_f32_4x4x4_16b_bf16 v[168:171], v[230:231], v[148:149], 0
    v_permlane32_swap_b32 v236, v237
    v_add_f32 v236, v236, v237
    v_mfma_f32_4x4x4_16b_bf16 v[172:175], v[230:231], v[150:151], 0
    v_sqrt_f32 v236, v236
    v_mfma_f32_4x4x4_16b_bf16 v[176:179], v[230:231], v[152:153], 0
    v_add_f32 v236, 0x358637bd, v236
    v_rcp_f32 v236, v236
    v_mfma_f32_4x4x4_16b_bf16 v[180:183], v[230:231], v[154:155], 0
    v_mul_f32 v237, v238, v236
    v_mul_f32 v236, v238, v236
    v_mfma_f32_4x4x4_16b_bf16 v[184:187], v[230:231], v[156:157], 0
    v_mfma_f32_4x4x4_16b_bf16 v[188:191], v[230:231], v[158:159], 0
    v_permlane32_swap_b32 v236, v237
    v_pk_mul_f32 v[160:161], v[160:161], v[236:237] op_sel_hi:[1,0]
    v_pk_mul_f32 v[162:163], v[162:163], v[236:237] op_sel_hi:[1,0]
    v_pk_mul_f32 v[164:165], v[164:165], v[236:237] op_sel_hi:[1,0]
    v_pk_mul_f32 v[166:167], v[166:167], v[236:237] op_sel_hi:[1,0]
    v_pk_mul_f32 v[168:169], v[168:169], v[236:237] op_sel_hi:[1,0]
    v_pk_mul_f32 v[170:171], v[170:171], v[236:237] op_sel_hi:[1,0]
    v_pk_mul_f32 v[172:173], v[172:173], v[236:237] op_sel_hi:[1,0]
    v_pk_mul_f32 v[174:175], v[174:175], v[236:237] op_sel_hi:[1,0]
    v_pk_mul_f32 v[176:177], v[176:177], v[236:237] op_sel:[0,1]
    v_pk_mul_f32 v[178:179], v[178:179], v[236:237] op_sel:[0,1]
    v_pk_mul_f32 v[180:181], v[180:181], v[236:237] op_sel:[0,1]
L_pad1F:
    s_cbranch_vccnz L_pad5F
    v_pk_mul_f32 v[182:183], v[182:183], v[236:237] op_sel:[0,1]
    v_pk_mul_f32 v[184:185], v[184:185], v[236:237] op_sel:[0,1]
    v_pk_mul_f32 v[186:187], v[186:187], v[236:237] op_sel:[0,1]
    v_pk_mul_f32 v[188:189], v[188:189], v[236:237] op_sel:[0,1]
    v_pk_mul_f32 v[190:191], v[190:191], v[236:237] op_sel:[0,1]
    v_cvt_pk_bf16_f32 v144, v160, v161
    v_cvt_pk_bf16_f32 v145, v162, v163
    v_cvt_pk_bf16_f32 v146, v164, v165
    v_cvt_pk_bf16_f32 v147, v166, v167
    v_cvt_pk_bf16_f32 v148, v168, v169
    v_cvt_pk_bf16_f32 v149, v170, v171
    v_cvt_pk_bf16_f32 v150, v172, v173
    v_cvt_pk_bf16_f32 v151, v174, v175
    v_cvt_pk_bf16_f32 v152, v176, v177
    v_cvt_pk_bf16_f32 v153, v178, v179
    v_cvt_pk_bf16_f32 v154, v180, v181
    v_cvt_pk_bf16_f32 v155, v182, v183
    v_cvt_pk_bf16_f32 v156, v184, v185
    v_cvt_pk_bf16_f32 v157, v186, v187
    v_cvt_pk_bf16_f32 v158, v188, v189
    v_cvt_pk_bf16_f32 v159, v190, v191
    s_nop 0
    v_mfma_f32_32x32x16_bf16 v[0:15], a[0:3], v[144:147], v[48:63]
    s_waitcnt lgkmcnt(1)
    buffer_load_dwordx4 v225, s[24:27], s13 offen offset:2048 nt lds
    v_exp_f16 v40, v16
    v_exp_f16 v41, v18
    v_exp_f16 v42, v20
    v_mfma_f32_32x32x16_bf16 v[0:15], a[4:7], v[148:151], v[0:15]
    buffer_load_dwordx4 v225, s[24:27], s13 offen offset:3072 nt lds
    v_exp_f16 v43, v22
    exph 40, 17
    exph 41, 19
    v_mfma_f32_32x32x16_f16 v[64:79], a[24:27], v[32:35], v[64:79]
    exph 42, 21
    exph 43, 23
    v_exp_f16 v44, v24
    v_mfma_f32_32x32x16_f16 v[64:79], a[28:31], v[36:39], v[64:79]
    v_exp_f16 v45, v26
    v_exp_f16 v46, v28
    v_exp_f16 v47, v30
    v_smfmac_f32_16x16x64_f16 a[40:43], a[56:59], v[32:39], v244
    ds_read_b128 a[20:23], v225 offset:17408
    exph 44, 25
    exph 45, 27
    exph 46, 29
    exph 47, 31
    v_mfma_f32_32x32x16_bf16 v[16:31], a[0:3], v[152:155], v[48:63]
    s_add_u32 s37, s37, 14336
    ds_read_b128 a[8:11], v225 offset:2048
    v_exp_f16 v32, v0
    v_exp_f16 v33, v2
    v_exp_f16 v34, v4
    v_mfma_f32_32x32x16_bf16 v[16:31], a[4:7], v[156:159], v[16:31]
    s_add_u32 s13, s37, s41
    ds_read_b128 a[12:15], v225 offset:3072
    v_exp_f16 v35, v6
    exph 32, 1
    exph 33, 3
    v_mfma_f32_32x32x16_f16 v[80:95], a[24:27], v[40:43], v[80:95]
    exph 34, 5
    exph 35, 7
    v_exp_f16 v36, v8
    v_mfma_f32_32x32x16_f16 v[80:95], a[28:31], v[44:47], v[80:95]
    v_exp_f16 v37, v10
    v_exp_f16 v38, v12
    v_exp_f16 v39, v14
    v_smfmac_f32_16x16x64_f16 a[44:47], a[56:59], v[40:47], v244
    s_waitcnt lgkmcnt(1)
    ds_read_b128 a[24:27], v225 offset:18432
    exph 36, 9
    exph 37, 11
    exph 38, 13
    exph 39, 15
    v_mfma_f32_32x32x16_bf16 v[0:15], a[8:11], v[144:147], v[48:63]
    s_waitcnt lgkmcnt(1)
    v_exp_f16 v40, v16
    v_exp_f16 v41, v18
    v_exp_f16 v42, v20
    v_mfma_f32_32x32x16_bf16 v[0:15], a[12:15], v[148:151], v[0:15]
    s_add_u32 s45, s45, 1
    v_exp_f16 v43, v22
    exph 40, 17
    exph 41, 19
    v_mfma_f32_32x32x16_f16 v[96:111], a[16:19], v[32:35], v[96:111]
    s_and_b32 s45, s45, 7
    exph 42, 21
    exph 43, 23
    v_exp_f16 v44, v24
    v_mfma_f32_32x32x16_f16 v[96:111], a[20:23], v[36:39], v[96:111]
    v_exp_f16 v45, v26
    v_exp_f16 v46, v28
    v_exp_f16 v47, v30
    v_smfmac_f32_16x16x64_f16 a[48:51], a[56:59], v[32:39], v244
    ds_read_b128 a[28:31], v225 offset:19456
    exph 44, 25
    exph 45, 27
    exph 46, 29
    exph 47, 31
    v_mfma_f32_32x32x16_bf16 v[16:31], a[8:11], v[152:155], v[48:63]
    ds_read_b128 a[0:3], v225 offset:4096
    v_exp_f16 v32, v0
    v_exp_f16 v33, v2
    v_exp_f16 v34, v4
    v_mfma_f32_32x32x16_bf16 v[16:31], a[12:15], v[156:159], v[16:31]
    ds_read_b128 a[4:7], v225 offset:5120
    v_exp_f16 v35, v6
    exph 32, 1
    exph 33, 3
    v_mfma_f32_32x32x16_f16 v[112:127], a[16:19], v[40:43], v[112:127]
    exph 34, 5
    exph 35, 7
    v_exp_f16 v36, v8
    v_mfma_f32_32x32x16_f16 v[112:127], a[20:23], v[44:47], v[112:127]
    v_exp_f16 v37, v10
    v_exp_f16 v38, v12
    v_exp_f16 v39, v14
    v_smfmac_f32_16x16x64_f16 a[52:55], a[56:59], v[40:47], v244
    s_waitcnt lgkmcnt(1)
    ds_read_b128 a[16:19], v225 offset:20480
    exph 36, 9
    exph 37, 11
    exph 38, 13
    exph 39, 15
    v_mfma_f32_32x32x16_bf16 v[0:15], a[0:3], v[144:147], v[48:63]
    s_waitcnt vmcnt(4) lgkmcnt(1)
    ds_read_b128 v[192:195], v252 offset:0
    v_exp_f16 v40, v16
    v_exp_f16 v41, v18
    v_exp_f16 v42, v20
    v_mfma_f32_32x32x16_bf16 v[0:15], a[4:7], v[148:151], v[0:15]
    ds_read_b128 v[196:199], v253 offset:0
    v_exp_f16 v43, v22
    exph 40, 17
    exph 41, 19
    v_mfma_f32_32x32x16_f16 v[96:111], a[24:27], v[32:35], v[96:111]
    ds_read_b128 v[200:203], v254 offset:0
    exph 42, 21
    exph 43, 23
    v_exp_f16 v44, v24
    v_mfma_f32_32x32x16_f16 v[96:111], a[28:31], v[36:39], v[96:111]
    ds_read_b128 v[204:207], v255 offset:0
    v_exp_f16 v45, v26
    v_exp_f16 v46, v28
    v_exp_f16 v47, v30
    v_smfmac_f32_16x16x64_f16 a[48:51], a[56:59], v[32:39], v244
    ds_read_b128 a[20:23], v225 offset:21504
    exph 44, 25
    exph 45, 27
    exph 46, 29
    exph 47, 31
    v_mfma_f32_32x32x16_bf16 v[16:31], a[0:3], v[152:155], v[48:63]
    ds_read_b128 a[8:11], v225 offset:6144
    v_exp_f16 v32, v0
    v_exp_f16 v33, v2
    v_exp_f16 v34, v4
    v_mfma_f32_32x32x16_bf16 v[16:31], a[4:7], v[156:159], v[16:31]
    ds_read_b128 a[12:15], v225 offset:7168
    v_exp_f16 v35, v6
    exph 32, 1
    exph 33, 3
    v_mfma_f32_32x32x16_f16 v[112:127], a[24:27], v[40:43], v[112:127]
    exph 34, 5
    exph 35, 7
    v_exp_f16 v36, v8
    v_mfma_f32_32x32x16_f16 v[112:127], a[28:31], v[44:47], v[112:127]
    v_exp_f16 v37, v10
    v_exp_f16 v38, v12
    v_exp_f16 v39, v14
    v_smfmac_f32_16x16x64_f16 a[52:55], a[56:59], v[40:47], v244
    s_waitcnt lgkmcnt(1)
    ds_read_b128 a[24:27], v225 offset:22528
    exph 36, 9
    exph 37, 11
    exph 38, 13
    exph 39, 15
    v_pk_mul_f32 v[236:237], 0, 0
    v_dot2c_f32_bf16 v236, v192, v192
    v_dot2c_f32_bf16 v237, v193, v193
    v_dot2c_f32_bf16 v236, v194, v194
    v_dot2c_f32_bf16 v237, v195, v195
    v_dot2c_f32_bf16 v236, v196, v196
    v_dot2c_f32_bf16 v237, v197, v197
    v_dot2c_f32_bf16 v236, v198, v198
    v_dot2c_f32_bf16 v237, v199, v199
    v_dot2c_f32_bf16 v236, v200, v200
    v_dot2c_f32_bf16 v237, v201, v201
    v_dot2c_f32_bf16 v236, v202, v202
    v_dot2c_f32_bf16 v237, v203, v203
    v_dot2c_f32_bf16 v236, v204, v204
    v_dot2c_f32_bf16 v237, v205, v205
    v_dot2c_f32_bf16 v236, v206, v206
    v_dot2c_f32_bf16 v237, v207, v207
    v_mfma_f32_32x32x16_bf16 v[0:15], a[8:11], v[144:147], v[48:63]
    s_waitcnt lgkmcnt(1)
    v_exp_f16 v40, v16
    v_exp_f16 v41, v18
    v_exp_f16 v42, v20
    v_mfma_f32_32x32x16_bf16 v[0:15], a[12:15], v[148:151], v[0:15]
    v_exp_f16 v43, v22
    exph 40, 17
    exph 41, 19
    v_mfma_f32_32x32x16_f16 v[96:111], a[16:19], v[32:35], v[96:111]
    exph 42, 21
    exph 43, 23
    v_exp_f16 v44, v24
    v_mfma_f32_32x32x16_f16 v[96:111], a[20:23], v[36:39], v[96:111]
    v_exp_f16 v45, v26
    v_exp_f16 v46, v28
    v_exp_f16 v47, v30
    v_smfmac_f32_16x16x64_f16 a[48:51], a[56:59], v[32:39], v244
    ds_read_b128 a[28:31], v225 offset:23552
    exph 44, 25
    v_mfma_f32_4x4x4_16b_bf16 v[160:163], v[230:231], v[192:193], 0
    exph 45, 27
    v_mfma_f32_4x4x4_16b_bf16 v[164:167], v[230:231], v[194:195], 0
    exph 46, 29
    exph 47, 31
    v_mfma_f32_32x32x16_bf16 v[16:31], a[8:11], v[152:155], v[48:63]
    ds_read_b128 a[0:3], v225 offset:8192
    v_exp_f16 v32, v0
    v_exp_f16 v33, v2
    v_add_f32 v236, v236, v237
    v_exp_f16 v34, v4
    v_mfma_f32_32x32x16_bf16 v[16:31], a[12:15], v[156:159], v[16:31]
    ds_read_b128 a[4:7], v225 offset:9216
    v_exp_f16 v35, v6
    exph 32, 1
    v_sqrt_f32 v236, v236
    exph 33, 3
    v_mfma_f32_32x32x16_f16 v[112:127], a[16:19], v[40:43], v[112:127]
    exph 34, 5
    exph 35, 7
    v_add_f32 v236, 0x358637bd, v236
    v_exp_f16 v36, v8
    v_mfma_f32_32x32x16_f16 v[112:127], a[20:23], v[44:47], v[112:127]
    v_exp_f16 v37, v10
    v_exp_f16 v38, v12
    v_rcp_f32 v236, v236
    v_exp_f16 v39, v14
    v_smfmac_f32_16x16x64_f16 a[52:55], a[56:59], v[40:47], v244
    s_waitcnt lgkmcnt(1)
    ds_read_b128 a[16:19], v225 offset:24576
    exph 36, 9
    v_mfma_f32_4x4x4_16b_bf16 v[168:171], v[230:231], v[196:197], 0
    exph 37, 11
    v_mfma_f32_4x4x4_16b_bf16 v[172:175], v[230:231], v[198:199], 0
    exph 38, 13
    exph 39, 15
    v_mfma_f32_32x32x16_bf16 v[0:15], a[0:3], v[144:147], v[48:63]
    s_waitcnt vmcnt(0) lgkmcnt(1)
    ds_read_b64_tr_b16 v[208:209], v234 offset:0
    v_exp_f16 v40, v16
    v_exp_f16 v41, v18
    v_exp_f16 v42, v20
    v_mfma_f32_32x32x16_bf16 v[0:15], a[4:7], v[148:151], v[0:15]
    ds_read_b64_tr_b16 v[210:211], v234 offset:512
    v_exp_f16 v43, v22
    exph 40, 17
    exph 41, 19
    v_mfma_f32_32x32x16_f16 v[96:111], a[24:27], v[32:35], v[96:111]
    ds_read_b64_tr_b16 v[212:213], v234 offset:1024
    exph 42, 21
    exph 43, 23
    v_exp_f16 v44, v24
    v_mfma_f32_32x32x16_f16 v[96:111], a[28:31], v[36:39], v[96:111]
    ds_read_b64_tr_b16 v[214:215], v234 offset:1536
    v_exp_f16 v45, v26
    v_exp_f16 v46, v28
    v_exp_f16 v47, v30
    v_smfmac_f32_16x16x64_f16 a[48:51], a[56:59], v[32:39], v244
    ds_read_b128 a[20:23], v225 offset:25600
    exph 44, 25
    v_mfma_f32_4x4x4_16b_bf16 v[176:179], v[230:231], v[200:201], 0
    exph 45, 27
    v_mfma_f32_4x4x4_16b_bf16 v[180:183], v[230:231], v[202:203], 0
    exph 46, 29
    exph 47, 31
    v_mfma_f32_32x32x16_bf16 v[16:31], a[0:3], v[152:155], v[48:63]
    ds_read_b128 a[8:11], v225 offset:10240
    v_exp_f16 v32, v0
    v_exp_f16 v33, v2
    v_exp_f16 v34, v4
    v_mfma_f32_32x32x16_bf16 v[16:31], a[4:7], v[156:159], v[16:31]
    ds_read_b128 a[12:15], v225 offset:11264
    v_exp_f16 v35, v6
    exph 32, 1
    exph 33, 3
    v_mfma_f32_32x32x16_f16 v[112:127], a[24:27], v[40:43], v[112:127]
    ds_read_b64_tr_b16 v[216:217], v234 offset:2048
    exph 34, 5
    exph 35, 7
    v_exp_f16 v36, v8
    v_mfma_f32_32x32x16_f16 v[112:127], a[28:31], v[44:47], v[112:127]
    ds_read_b64_tr_b16 v[218:219], v234 offset:2560
    v_exp_f16 v37, v10
    v_exp_f16 v38, v12
    v_exp_f16 v39, v14
    v_smfmac_f32_16x16x64_f16 a[52:55], a[56:59], v[40:47], v244
    s_waitcnt lgkmcnt(3)
    ds_read_b128 a[24:27], v225 offset:26624
    exph 36, 9
    v_mfma_f32_4x4x4_16b_bf16 v[184:187], v[230:231], v[204:205], 0
    exph 37, 11
    v_mfma_f32_4x4x4_16b_bf16 v[188:191], v[230:231], v[206:207], 0
    exph 38, 13
    exph 39, 15
    v_pk_mul_f32 v[160:161], v[160:161], v[236:237] op_sel_hi:[1,0]
    v_pk_mul_f32 v[162:163], v[162:163], v[236:237] op_sel_hi:[1,0]
    v_pk_mul_f32 v[164:165], v[164:165], v[236:237] op_sel_hi:[1,0]
    v_pk_mul_f32 v[166:167], v[166:167], v[236:237] op_sel_hi:[1,0]
    v_pk_mul_f32 v[168:169], v[168:169], v[236:237] op_sel_hi:[1,0]
    v_pk_mul_f32 v[170:171], v[170:171], v[236:237] op_sel_hi:[1,0]
    v_pk_mul_f32 v[172:173], v[172:173], v[236:237] op_sel_hi:[1,0]
    v_pk_mul_f32 v[174:175], v[174:175], v[236:237] op_sel_hi:[1,0]
    v_mfma_f32_32x32x16_bf16 v[0:15], a[8:11], v[144:147], v[48:63]
    s_waitcnt lgkmcnt(3)
    ds_read_b64_tr_b16 v[220:221], v234 offset:3072
    v_exp_f16 v40, v16
    v_cvt_pk_bf16_f32 v192, v160, v161
    v_exp_f16 v41, v18
    v_cvt_pk_bf16_f32 v193, v162, v163
    v_exp_f16 v42, v20
    v_mfma_f32_32x32x16_bf16 v[0:15], a[12:15], v[148:151], v[0:15]
    ds_read_b64_tr_b16 v[222:223], v234 offset:3584
    v_exp_f16 v43, v22
    v_cvt_pk_bf16_f32 v194, v164, v165
    exph 40, 17
    v_cvt_pk_bf16_f32 v195, v166, v167
    exph 41, 19
    v_mfma_f32_32x32x16_f16 v[96:111], a[16:19], v[32:35], v[96:111]
    exph 42, 21
    v_cvt_pk_bf16_f32 v196, v168, v169
    exph 43, 23
    v_cvt_pk_bf16_f32 v197, v170, v171
    v_exp_f16 v44, v24
    v_mfma_f32_32x32x16_f16 v[96:111], a[20:23], v[36:39], v[96:111]
    v_exp_f16 v45, v26
    v_cvt_pk_bf16_f32 v198, v172, v173
    v_exp_f16 v46, v28
    v_cvt_pk_bf16_f32 v199, v174, v175
    v_exp_f16 v47, v30
    v_smfmac_f32_16x16x64_f16 a[48:51], a[56:59], v[32:39], v244
    ds_read_b128 a[28:31], v225 offset:27648
    exph 44, 25
    exph 45, 27
    exph 46, 29
    exph 47, 31
    v_pk_mul_f32 v[176:177], v[176:177], v[236:237] op_sel_hi:[1,0]
    v_pk_mul_f32 v[178:179], v[178:179], v[236:237] op_sel_hi:[1,0]
    v_pk_mul_f32 v[180:181], v[180:181], v[236:237] op_sel_hi:[1,0]
    v_pk_mul_f32 v[182:183], v[182:183], v[236:237] op_sel_hi:[1,0]
    v_pk_mul_f32 v[184:185], v[184:185], v[236:237] op_sel_hi:[1,0]
    v_pk_mul_f32 v[186:187], v[186:187], v[236:237] op_sel_hi:[1,0]
    v_pk_mul_f32 v[188:189], v[188:189], v[236:237] op_sel_hi:[1,0]
    v_pk_mul_f32 v[190:191], v[190:191], v[236:237] op_sel_hi:[1,0]
    v_mfma_f32_32x32x16_bf16 v[16:31], a[8:11], v[152:155], v[48:63]
    ds_read_b128 a[0:3], v225 offset:12288
    v_exp_f16 v32, v0
    v_cvt_pk_bf16_f32 v200, v176, v177
    v_exp_f16 v33, v2
    v_cvt_pk_bf16_f32 v201, v178, v179
    v_exp_f16 v34, v4
    v_mfma_f32_32x32x16_bf16 v[16:31], a[12:15], v[156:159], v[16:31]
    s_add_u32 m0, s58, 0x3000
    ds_read_b128 a[4:7], v225 offset:13312
    v_exp_f16 v35, v6
    v_cvt_pk_bf16_f32 v202, v180, v181
    exph 32, 1
    v_cvt_pk_bf16_f32 v203, v182, v183
    exph 33, 3
    v_mfma_f32_32x32x16_f16 v[112:127], a[16:19], v[40:43], v[112:127]
    buffer_load_dwordx4 v249, s[20:23], s37 offen offset:0 nt lds
    exph 34, 5
    v_cvt_pk_bf16_f32 v204, v184, v185
    exph 35, 7
    v_cvt_pk_bf16_f32 v205, v186, v187
    v_exp_f16 v36, v8
    v_mfma_f32_32x32x16_f16 v[112:127], a[20:23], v[44:47], v[112:127]
    buffer_load_dwordx4 v249, s[20:23], s37 offen offset:1024 nt lds
    v_exp_f16 v37, v10
    v_cvt_pk_bf16_f32 v206, v188, v189
    v_exp_f16 v38, v12
    v_cvt_pk_bf16_f32 v207, v190, v191
    v_exp_f16 v39, v14
    v_smfmac_f32_16x16x64_f16 a[52:55], a[56:59], v[40:47], v244
    s_waitcnt lgkmcnt(1)
    ds_read_b128 a[16:19], v225 offset:28672
    exph 36, 9
    v_mfma_f32_4x4x4_16b_bf16 v[160:163], a[60:61], v[208:209], 0
    exph 37, 11
    v_mfma_f32_4x4x4_16b_bf16 v[164:167], a[60:61], v[210:211], 0
    exph 38, 13
    exph 39, 15
    v_mfma_f32_4x4x4_16b_bf16 v[168:171], a[60:61], v[212:213], 0
    v_cvt_pk_f16_f32 v208, v160, v161
    v_cvt_pk_f16_f32 v209, v162, v163
    v_mfma_f32_4x4x4_16b_bf16 v[172:175], a[60:61], v[214:215], 0
    v_cvt_pk_f16_f32 v210, v164, v165
    v_cvt_pk_f16_f32 v211, v166, v167
    v_mfma_f32_4x4x4_16b_bf16 v[176:179], a[60:61], v[216:217], 0
    v_cvt_pk_f16_f32 v212, v168, v169
    v_cvt_pk_f16_f32 v213, v170, v171
    v_mfma_f32_4x4x4_16b_bf16 v[180:183], a[60:61], v[218:219], 0
    v_cvt_pk_f16_f32 v214, v172, v173
    v_cvt_pk_f16_f32 v215, v174, v175
    v_mfma_f32_4x4x4_16b_bf16 v[184:187], a[60:61], v[220:221], 0
    v_cvt_pk_f16_f32 v216, v176, v177
    v_cvt_pk_f16_f32 v217, v178, v179
    v_mfma_f32_4x4x4_16b_bf16 v[188:191], a[60:61], v[222:223], 0
    v_cvt_pk_f16_f32 v218, v180, v181
    v_cvt_pk_f16_f32 v219, v182, v183
    v_cvt_pk_f16_f32 v220, v184, v185
    v_cvt_pk_f16_f32 v221, v186, v187
    s_nop 0
    v_cvt_pk_f16_f32 v222, v188, v189
    v_cvt_pk_f16_f32 v223, v190, v191
    v_mfma_f32_32x32x16_bf16 v[0:15], a[0:3], v[128:131], v[48:63]
    s_waitcnt lgkmcnt(1)
    ds_write_b128 v227, v[192:195] offset:32768
    v_exp_f16 v40, v16
    v_exp_f16 v41, v18
    v_exp_f16 v42, v20
    v_mfma_f32_32x32x16_bf16 v[0:15], a[4:7], v[132:135], v[0:15]
    ds_write_b128 v227, v[196:199] offset:33280
    v_exp_f16 v43, v22
    exph 40, 17
    exph 41, 19
    v_mfma_f32_32x32x16_f16 v[96:111], a[24:27], v[32:35], v[96:111]
    buffer_load_dwordx4 v249, s[20:23], s13 offen offset:2048 nt lds
    exph 42, 21
    exph 43, 23
    v_exp_f16 v44, v24
    v_mfma_f32_32x32x16_f16 v[96:111], a[28:31], v[36:39], v[96:111]
    buffer_load_dwordx4 v249, s[20:23], s13 offen offset:3072 nt lds
    v_exp_f16 v45, v26
    v_exp_f16 v46, v28
    v_exp_f16 v47, v30
    v_smfmac_f32_16x16x64_f16 a[48:51], a[56:59], v[32:39], v244
    ds_read_b128 a[20:23], v225 offset:29696
    exph 44, 25
    exph 45, 27
    exph 46, 29
    exph 47, 31
    v_mfma_f32_32x32x16_bf16 v[16:31], a[0:3], v[136:139], v[48:63]
    ds_write_b128 v227, v[200:203] offset:33792
    v_exp_f16 v32, v0
    v_exp_f16 v33, v2
    v_exp_f16 v34, v4
    v_mfma_f32_32x32x16_bf16 v[16:31], a[4:7], v[140:143], v[16:31]
    s_add_u32 m0, s58, 0x2000
    ds_write_b128 v227, v[204:207] offset:34304
    v_exp_f16 v35, v6
    exph 32, 1
    exph 33, 3
    v_mfma_f32_32x32x16_f16 v[112:127], a[24:27], v[40:43], v[112:127]
    buffer_load_dwordx4 v225, s[24:27], s37 offen offset:0 nt lds
    exph 34, 5
    exph 35, 7
    v_exp_f16 v36, v8
    v_mfma_f32_32x32x16_f16 v[112:127], a[28:31], v[44:47], v[112:127]
    buffer_load_dwordx4 v225, s[24:27], s37 offen offset:1024 nt lds
    v_exp_f16 v37, v10
    v_exp_f16 v38, v12
    v_exp_f16 v39, v14
    v_smfmac_f32_16x16x64_f16 a[52:55], a[56:59], v[40:47], v244
    ds_read_b128 a[8:11], v225 offset:14336
    exph 36, 9
    exph 37, 11
    exph 38, 13
    exph 39, 15
    v_mfma_f32_32x32x16_bf16 v[0:15], a[0:3], v[144:147], v[48:63]
    ds_write_b128 v245, v[208:211] offset:49152
    v_exp_f16 v40, v16
    v_exp_f16 v41, v18
    v_exp_f16 v42, v20
    v_mfma_f32_32x32x16_bf16 v[0:15], a[4:7], v[148:151], v[0:15]
    s_waitcnt lgkmcnt(7)
    ds_write_b128 v245, v[212:215] offset:50176
    v_exp_f16 v43, v22
    exph 40, 17
    exph 41, 19
    v_mfma_f32_32x32x16_f16 v[64:79], a[16:19], v[32:35], v[64:79]
    s_waitcnt lgkmcnt(5)
    buffer_load_dwordx4 v225, s[24:27], s13 offen offset:2048 nt lds
    exph 42, 21
    exph 43, 23
    v_exp_f16 v44, v24
    v_mfma_f32_32x32x16_f16 v[64:79], a[20:23], v[36:39], v[64:79]
    buffer_load_dwordx4 v225, s[24:27], s13 offen offset:3072 nt lds
    v_exp_f16 v45, v26
    v_exp_f16 v46, v28
    v_exp_f16 v47, v30
    v_smfmac_f32_16x16x64_f16 a[40:43], a[56:59], v[32:39], v244
    ds_read_b128 a[12:15], v225 offset:15360
    exph 44, 25
    exph 45, 27
    exph 46, 29
    exph 47, 31
    v_mfma_f32_32x32x16_bf16 v[16:31], a[0:3], v[152:155], v[48:63]
    ds_write_b128 v245, v[216:219] offset:51200
    v_exp_f16 v32, v0
    v_exp_f16 v33, v2
    v_exp_f16 v34, v4
    v_mfma_f32_32x32x16_bf16 v[16:31], a[4:7], v[156:159], v[16:31]
    ds_write_b128 v245, v[220:223] offset:52224
    v_exp_f16 v35, v6
    exph 32, 1
    exph 33, 3
    v_mfma_f32_32x32x16_f16 v[80:95], a[16:19], v[40:43], v[80:95]
    exph 34, 5
    exph 35, 7
    v_exp_f16 v36, v8
    v_mfma_f32_32x32x16_f16 v[80:95], a[20:23], v[44:47], v[80:95]
    v_exp_f16 v37, v10
    v_exp_f16 v38, v12
    v_exp_f16 v39, v14
    v_smfmac_f32_16x16x64_f16 a[44:47], a[56:59], v[40:47], v244
    s_waitcnt lgkmcnt(5)
    ds_read_b128 a[24:27], v225 offset:30720
    exph 36, 9
    exph 37, 11
    exph 38, 13
    exph 39, 15
    v_mfma_f32_32x32x16_bf16 v[0:15], a[8:11], v[128:131], v[48:63]
    s_waitcnt lgkmcnt(3)
    v_exp_f16 v40, v16
    v_exp_f16 v41, v18
    v_exp_f16 v42, v20
    v_mfma_f32_32x32x16_bf16 v[0:15], a[12:15], v[132:135], v[0:15]
    v_exp_f16 v43, v22
    exph 40, 17
    exph 41, 19
    v_mfma_f32_32x32x16_f16 v[96:111], a[16:19], v[32:35], v[96:111]
    exph 42, 21
    exph 43, 23
    v_exp_f16 v44, v24
    v_mfma_f32_32x32x16_f16 v[96:111], a[20:23], v[36:39], v[96:111]
    v_exp_f16 v45, v26
    v_exp_f16 v46, v28
    v_exp_f16 v47, v30
    v_smfmac_f32_16x16x64_f16 a[48:51], a[56:59], v[32:39], v244
    ds_read_b128 a[28:31], v225 offset:31744
    exph 44, 25
    exph 45, 27
    exph 46, 29
    exph 47, 31
    v_mfma_f32_32x32x16_bf16 v[16:31], a[8:11], v[136:139], v[48:63]
    v_exp_f16 v32, v0
    v_exp_f16 v33, v2
    v_exp_f16 v34, v4
    v_mfma_f32_32x32x16_bf16 v[16:31], a[12:15], v[140:143], v[16:31]
    v_exp_f16 v35, v6
    exph 32, 1
    exph 33, 3
    v_mfma_f32_32x32x16_f16 v[112:127], a[16:19], v[40:43], v[112:127]
    s_waitcnt lgkmcnt(0)
    exph 34, 5
    exph 35, 7
    v_exp_f16 v36, v8
    v_mfma_f32_32x32x16_f16 v[112:127], a[20:23], v[44:47], v[112:127]
    s_barrier
    v_exp_f16 v37, v10
    v_exp_f16 v38, v12
    v_exp_f16 v39, v14
    v_smfmac_f32_16x16x64_f16 a[52:55], a[56:59], v[40:47], v244
    ds_read_b128 a[0:3], v225 offset:32768
    exph 36, 9
    exph 37, 11
    exph 38, 13
    exph 39, 15
    v_mfma_f32_32x32x16_bf16 v[0:15], a[8:11], v[144:147], v[48:63]
    v_exp_f16 v40, v16
    v_exp_f16 v41, v18
    v_exp_f16 v42, v20
    v_mfma_f32_32x32x16_bf16 v[0:15], a[12:15], v[148:151], v[0:15]
    v_exp_f16 v43, v22
    exph 40, 17
    exph 41, 19
    v_mfma_f32_32x32x16_f16 v[64:79], a[24:27], v[32:35], v[64:79]
    exph 42, 21
    exph 43, 23
    v_exp_f16 v44, v24
    v_mfma_f32_32x32x16_f16 v[64:79], a[28:31], v[36:39], v[64:79]
    v_exp_f16 v45, v26
    v_exp_f16 v46, v28
    v_exp_f16 v47, v30
    v_smfmac_f32_16x16x64_f16 a[40:43], a[56:59], v[32:39], v244
    ds_read_b128 a[4:7], v225 offset:33792
    exph 44, 25
    exph 45, 27
    exph 46, 29
    exph 47, 31
    v_mfma_f32_32x32x16_bf16 v[16:31], a[8:11], v[152:155], v[48:63]
    v_exp_f16 v32, v0
    v_exp_f16 v33, v2
    v_exp_f16 v34, v4
    v_mfma_f32_32x32x16_bf16 v[16:31], a[12:15], v[156:159], v[16:31]
    v_exp_f16 v35, v6
    exph 32, 1
    exph 33, 3
    v_mfma_f32_32x32x16_f16 v[80:95], a[24:27], v[40:43], v[80:95]
    exph 34, 5
    exph 35, 7
    v_exp_f16 v36, v8
    v_mfma_f32_32x32x16_f16 v[80:95], a[28:31], v[44:47], v[80:95]
L_pad2F:
    s_cbranch_vccnz L_pad6F
    v_exp_f16 v37, v10
    v_exp_f16 v38, v12
    v_exp_f16 v39, v14
    v_smfmac_f32_16x16x64_f16 a[44:47], a[56:59], v[40:47], v244
    s_waitcnt lgkmcnt(1)
    ds_read_b128 a[16:19], v225 offset:49152
    exph 36, 9
    exph 37, 11
    exph 38, 13
    exph 39, 15
    v_mfma_f32_32x32x16_bf16 v[0:15], a[0:3], v[128:131], v[48:63]
    s_waitcnt lgkmcnt(1)
    v_exp_f16 v40, v16
    v_exp_f16 v41, v18
    v_exp_f16 v42, v20
    v_mfma_f32_32x32x16_bf16 v[0:15], a[4:7], v[132:135], v[0:15]
    v_exp_f16 v43, v22
    exph 40, 17
    exph 41, 19
    v_mfma_f32_32x32x16_f16 v[96:111], a[24:27], v[32:35], v[96:111]
    exph 42, 21
    exph 43, 23
    v_exp_f16 v44, v24
    v_mfma_f32_32x32x16_f16 v[96:111], a[28:31], v[36:39], v[96:111]
    v_exp_f16 v45, v26
    v_exp_f16 v46, v28
    v_exp_f16 v47, v30
    v_smfmac_f32_16x16x64_f16 a[48:51], a[56:59], v[32:39], v244
    ds_read_b128 a[20:23], v225 offset:50176
    exph 44, 25
    exph 45, 27
    exph 46, 29
    exph 47, 31
    v_mfma_f32_32x32x16_bf16 v[16:31], a[0:3], v[136:139], v[48:63]
    v_exp_f16 v32, v0
    v_exp_f16 v33, v2
    v_exp_f16 v34, v4
    v_mfma_f32_32x32x16_bf16 v[16:31], a[4:7], v[140:143], v[16:31]
    v_exp_f16 v35, v6
    exph 32, 1
    exph 33, 3
    v_mfma_f32_32x32x16_f16 v[112:127], a[24:27], v[40:43], v[112:127]
    exph 34, 5
    exph 35, 7
    v_exp_f16 v36, v8
    v_mfma_f32_32x32x16_f16 v[112:127], a[28:31], v[44:47], v[112:127]
    v_exp_f16 v37, v10
    v_exp_f16 v38, v12
    v_exp_f16 v39, v14
    v_smfmac_f32_16x16x64_f16 a[52:55], a[56:59], v[40:47], v244
    ds_read_b128 a[8:11], v225 offset:34816
    exph 36, 9
    exph 37, 11
    exph 38, 13
    exph 39, 15
    v_mfma_f32_32x32x16_bf16 v[0:15], a[0:3], v[144:147], v[48:63]
    v_exp_f16 v40, v16
    v_exp_f16 v41, v18
    v_exp_f16 v42, v20
    v_mfma_f32_32x32x16_bf16 v[0:15], a[4:7], v[148:151], v[0:15]
    s_waitcnt lgkmcnt(2)
    v_exp_f16 v43, v22
    exph 40, 17
    exph 41, 19
    v_mfma_f32_32x32x16_f16 v[64:79], a[16:19], v[32:35], v[64:79]
    s_waitcnt lgkmcnt(1)
    exph 42, 21
    exph 43, 23
    v_exp_f16 v44, v24
    v_mfma_f32_32x32x16_f16 v[64:79], a[20:23], v[36:39], v[64:79]
    v_exp_f16 v45, v26
    v_exp_f16 v46, v28
    v_exp_f16 v47, v30
    v_smfmac_f32_16x16x64_f16 a[40:43], a[56:59], v[32:39], v244
    ds_read_b128 a[12:15], v225 offset:35840
    exph 44, 25
    exph 45, 27
    exph 46, 29
    exph 47, 31
    v_mfma_f32_32x32x16_bf16 v[16:31], a[0:3], v[152:155], v[48:63]
    v_exp_f16 v32, v0
    v_exp_f16 v33, v2
    v_exp_f16 v34, v4
    v_mfma_f32_32x32x16_bf16 v[16:31], a[4:7], v[156:159], v[16:31]
    v_exp_f16 v35, v6
    exph 32, 1
    exph 33, 3
    v_mfma_f32_32x32x16_f16 v[80:95], a[16:19], v[40:43], v[80:95]
    exph 34, 5
    exph 35, 7
    v_exp_f16 v36, v8
    v_mfma_f32_32x32x16_f16 v[80:95], a[20:23], v[44:47], v[80:95]
    ds_read_b128 a[24:27], v225 offset:51200
    v_exp_f16 v37, v10
    v_exp_f16 v38, v12
    v_exp_f16 v39, v14
    v_smfmac_f32_16x16x64_f16 a[44:47], a[56:59], v[40:47], v244
    s_waitcnt lgkmcnt(2)
    buffer_store_dwordx4 v[192:195], v247, s[48:51], s39 offen offset:0 sc1
    exph 36, 9
    exph 37, 11
    exph 38, 13
    exph 39, 15
    v_mfma_f32_32x32x16_bf16 v[0:15], a[8:11], v[128:131], v[48:63]
    s_waitcnt lgkmcnt(1)
    v_exp_f16 v40, v16
    v_exp_f16 v41, v18
    v_exp_f16 v42, v20
    v_mfma_f32_32x32x16_bf16 v[0:15], a[12:15], v[132:135], v[0:15]
    v_exp_f16 v43, v22
    exph 40, 17
    exph 41, 19
    v_mfma_f32_32x32x16_f16 v[96:111], a[16:19], v[32:35], v[96:111]
    exph 42, 21
    exph 43, 23
    v_exp_f16 v44, v24
    v_mfma_f32_32x32x16_f16 v[96:111], a[20:23], v[36:39], v[96:111]
    ds_read_b128 a[28:31], v225 offset:52224
    v_exp_f16 v45, v26
    v_exp_f16 v46, v28
    v_exp_f16 v47, v30
    v_smfmac_f32_16x16x64_f16 a[48:51], a[56:59], v[32:39], v244
    buffer_store_dwordx4 v[196:199], v247, s[48:51], s39 offen offset:512 sc1
    exph 44, 25
    exph 45, 27
    exph 46, 29
    exph 47, 31
    v_mfma_f32_32x32x16_bf16 v[16:31], a[8:11], v[136:139], v[48:63]
    v_exp_f16 v32, v0
    v_exp_f16 v33, v2
    v_exp_f16 v34, v4
    v_mfma_f32_32x32x16_bf16 v[16:31], a[12:15], v[140:143], v[16:31]
    v_exp_f16 v35, v6
    exph 32, 1
    exph 33, 3
    v_mfma_f32_32x32x16_f16 v[112:127], a[16:19], v[40:43], v[112:127]
    exph 34, 5
    exph 35, 7
    v_exp_f16 v36, v8
    v_mfma_f32_32x32x16_f16 v[112:127], a[20:23], v[44:47], v[112:127]
    ds_read_b128 a[0:3], v225 offset:36864
    v_exp_f16 v37, v10
    v_exp_f16 v38, v12
    v_exp_f16 v39, v14
    v_smfmac_f32_16x16x64_f16 a[52:55], a[56:59], v[40:47], v244
    buffer_store_dwordx4 v[200:203], v247, s[48:51], s39 offen offset:1024 sc1
    exph 36, 9
    exph 37, 11
    exph 38, 13
    exph 39, 15
    v_mfma_f32_32x32x16_bf16 v[0:15], a[8:11], v[144:147], v[48:63]
    v_exp_f16 v40, v16
    v_exp_f16 v41, v18
    v_exp_f16 v42, v20
    v_mfma_f32_32x32x16_bf16 v[0:15], a[12:15], v[148:151], v[0:15]
    s_waitcnt lgkmcnt(2)
    v_exp_f16 v43, v22
    exph 40, 17
    exph 41, 19
    v_mfma_f32_32x32x16_f16 v[64:79], a[24:27], v[32:35], v[64:79]
    s_waitcnt lgkmcnt(1)
    exph 42, 21
    exph 43, 23
    v_exp_f16 v44, v24
    v_mfma_f32_32x32x16_f16 v[64:79], a[28:31], v[36:39], v[64:79]
    ds_read_b128 a[4:7], v225 offset:37888
    v_exp_f16 v45, v26
    v_exp_f16 v46, v28
    v_exp_f16 v47, v30
    v_smfmac_f32_16x16x64_f16 a[40:43], a[56:59], v[32:39], v244
    buffer_store_dwordx4 v[204:207], v247, s[48:51], s39 offen offset:1536 sc1
    exph 44, 25
    exph 45, 27
    exph 46, 29
    exph 47, 31
    v_mfma_f32_32x32x16_bf16 v[16:31], a[8:11], v[152:155], v[48:63]
    s_waitcnt vmcnt(8)
    ds_read_b128 v[192:195], v252 offset:12288
    v_exp_f16 v32, v0
    v_exp_f16 v33, v2
    v_exp_f16 v34, v4
    v_mfma_f32_32x32x16_bf16 v[16:31], a[12:15], v[156:159], v[16:31]
    ds_read_b128 v[196:199], v253 offset:12288
    v_exp_f16 v35, v6
    exph 32, 1
    exph 33, 3
    v_mfma_f32_32x32x16_f16 v[80:95], a[24:27], v[40:43], v[80:95]
    ds_read_b128 v[200:203], v254 offset:12288
    exph 34, 5
    exph 35, 7
    v_exp_f16 v36, v8
    v_mfma_f32_32x32x16_f16 v[80:95], a[28:31], v[44:47], v[80:95]
    ds_read_b128 a[16:19], v225 offset:53248
    v_exp_f16 v37, v10
    v_exp_f16 v38, v12
    v_exp_f16 v39, v14
    v_smfmac_f32_16x16x64_f16 a[44:47], a[56:59], v[40:47], v244
    s_waitcnt lgkmcnt(5)
    buffer_store_dwordx4 v[208:211], v225, s[64:67], s68 offen offset:0 sc1
    exph 36, 9
    exph 37, 11
    exph 38, 13
    exph 39, 15
    v_mfma_f32_32x32x16_bf16 v[0:15], a[0:3], v[128:131], v[48:63]
    s_waitcnt lgkmcnt(4)
    ds_read_b128 v[204:207], v255 offset:12288
    v_exp_f16 v40, v16
    v_exp_f16 v41, v18
    v_exp_f16 v42, v20
    v_mfma_f32_32x32x16_bf16 v[0:15], a[4:7], v[132:135], v[0:15]
    v_exp_f16 v43, v22
    exph 40, 17
    exph 41, 19
    v_mfma_f32_32x32x16_f16 v[96:111], a[24:27], v[32:35], v[96:111]
    exph 42, 21
    exph 43, 23
    v_exp_f16 v44, v24
    v_mfma_f32_32x32x16_f16 v[96:111], a[28:31], v[36:39], v[96:111]
    ds_read_b128 a[20:23], v225 offset:54272
    v_exp_f16 v45, v26
    v_exp_f16 v46, v28
    v_exp_f16 v47, v30
    v_smfmac_f32_16x16x64_f16 a[48:51], a[56:59], v[32:39], v244
    buffer_store_dwordx4 v[212:215], v225, s[64:67], s68 offen offset:1024 sc1
    exph 44, 25
    exph 45, 27
    exph 46, 29
    exph 47, 31
    v_mfma_f32_32x32x16_bf16 v[16:31], a[0:3], v[136:139], v[48:63]
    v_exp_f16 v32, v0
    v_exp_f16 v33, v2
    v_exp_f16 v34, v4
    v_mfma_f32_32x32x16_bf16 v[16:31], a[4:7], v[140:143], v[16:31]
    v_exp_f16 v35, v6
    exph 32, 1
    exph 33, 3
    v_mfma_f32_32x32x16_f16 v[112:127], a[24:27], v[40:43], v[112:127]
    exph 34, 5
    exph 35, 7
    v_exp_f16 v36, v8
    v_mfma_f32_32x32x16_f16 v[112:127], a[28:31], v[44:47], v[112:127]
    ds_read_b128 a[8:11], v225 offset:38912
    v_exp_f16 v37, v10
    v_exp_f16 v38, v12
    v_exp_f16 v39, v14
    v_smfmac_f32_16x16x64_f16 a[52:55], a[56:59], v[40:47], v244
    s_waitcnt lgkmcnt(2)
    buffer_store_dwordx4 v[216:219], v225, s[64:67], s69 offen offset:2048 sc1
    exph 36, 9
    exph 37, 11
    exph 38, 13
    exph 39, 15
    v_pk_mul_f32 v[236:237], 0, 0
    v_dot2c_f32_bf16 v236, v192, v192
    v_dot2c_f32_bf16 v237, v193, v193
    v_dot2c_f32_bf16 v236, v194, v194
    v_dot2c_f32_bf16 v237, v195, v195
    v_dot2c_f32_bf16 v236, v196, v196
    v_dot2c_f32_bf16 v237, v197, v197
    v_dot2c_f32_bf16 v236, v198, v198
    v_dot2c_f32_bf16 v237, v199, v199
    v_dot2c_f32_bf16 v236, v200, v200
    v_dot2c_f32_bf16 v237, v201, v201
    v_dot2c_f32_bf16 v236, v202, v202
    v_dot2c_f32_bf16 v237, v203, v203
    v_dot2c_f32_bf16 v236, v204, v204
    v_dot2c_f32_bf16 v237, v205, v205
    v_dot2c_f32_bf16 v236, v206, v206
    v_dot2c_f32_bf16 v237, v207, v207
    v_mfma_f32_32x32x16_bf16 v[0:15], a[0:3], v[144:147], v[48:63]
    v_exp_f16 v40, v16
    v_exp_f16 v41, v18
    v_exp_f16 v42, v20
    v_mfma_f32_32x32x16_bf16 v[0:15], a[4:7], v[148:151], v[0:15]
    v_exp_f16 v43, v22
    exph 40, 17
    exph 41, 19
    v_mfma_f32_32x32x16_f16 v[64:79], a[16:19], v[32:35], v[64:79]
    s_waitcnt lgkmcnt(1)
    exph 42, 21
    exph 43, 23
    v_exp_f16 v44, v24
    v_mfma_f32_32x32x16_f16 v[64:79], a[20:23], v[36:39], v[64:79]
    ds_read_b128 a[12:15], v225 offset:39936
    v_exp_f16 v45, v26
    v_exp_f16 v46, v28
    v_exp_f16 v47, v30
    v_smfmac_f32_16x16x64_f16 a[40:43], a[56:59], v[32:39], v244
    buffer_store_dwordx4 v[220:223], v225, s[64:67], s69 offen offset:3072 sc1
    exph 44, 25
    v_mfma_f32_4x4x4_16b_bf16 v[160:163], v[230:231], v[192:193], 0
    exph 45, 27
    v_mfma_f32_4x4x4_16b_bf16 v[164:167], v[230:231], v[194:195], 0
    exph 46, 29
    exph 47, 31
    v_mfma_f32_32x32x16_bf16 v[16:31], a[0:3], v[152:155], v[48:63]
    s_add_u32 s39, s39, 0x4000
    s_waitcnt vmcnt(8)
    ds_read_b64_tr_b16 v[208:209], v234 offset:4096
    v_exp_f16 v32, v0
    v_exp_f16 v33, v2
    v_add_f32 v236, v236, v237
    v_exp_f16 v34, v4
    v_mfma_f32_32x32x16_bf16 v[16:31], a[4:7], v[156:159], v[16:31]
    s_add_u32 s68, s68, 0x4000
    ds_read_b64_tr_b16 v[210:211], v234 offset:4608
    v_exp_f16 v35, v6
    exph 32, 1
    v_sqrt_f32 v236, v236
    exph 33, 3
    v_mfma_f32_32x32x16_f16 v[80:95], a[16:19], v[40:43], v[80:95]
    s_add_u32 s69, s69, 0x4000
    ds_read_b64_tr_b16 v[212:213], v234 offset:5120
    exph 34, 5
    exph 35, 7
    v_add_f32 v236, 0x358637bd, v236
    v_exp_f16 v36, v8
    v_mfma_f32_32x32x16_f16 v[80:95], a[20:23], v[44:47], v[80:95]
    ds_read_b64_tr_b16 v[214:215], v234 offset:5632
    v_exp_f16 v37, v10
    v_exp_f16 v38, v12
    v_rcp_f32 v236, v236
    v_exp_f16 v39, v14
    v_smfmac_f32_16x16x64_f16 a[44:47], a[56:59], v[40:47], v244
    s_waitcnt lgkmcnt(5)
    ds_read_b128 a[24:27], v225 offset:55296
    exph 36, 9
    v_mfma_f32_4x4x4_16b_bf16 v[168:171], v[230:231], v[196:197], 0
    exph 37, 11
    v_mfma_f32_4x4x4_16b_bf16 v[172:175], v[230:231], v[198:199], 0
    exph 38, 13
    exph 39, 15
    v_mfma_f32_32x32x16_bf16 v[0:15], a[8:11], v[128:131], v[48:63]
    s_waitcnt lgkmcnt(5)
    ds_read_b64_tr_b16 v[216:217], v234 offset:6144
    v_exp_f16 v40, v16
    v_exp_f16 v41, v18
    v_exp_f16 v42, v20
    v_mfma_f32_32x32x16_bf16 v[0:15], a[12:15], v[132:135], v[0:15]
    ds_read_b64_tr_b16 v[218:219], v234 offset:6656
    v_exp_f16 v43, v22
    exph 40, 17
    exph 41, 19
    v_mfma_f32_32x32x16_f16 v[96:111], a[16:19], v[32:35], v[96:111]
    ds_read_b64_tr_b16 v[220:221], v234 offset:7168
    exph 42, 21
    exph 43, 23
    v_exp_f16 v44, v24
    v_mfma_f32_32x32x16_f16 v[96:111], a[20:23], v[36:39], v[96:111]
    ds_read_b64_tr_b16 v[222:223], v234 offset:7680
    v_exp_f16 v45, v26
    v_exp_f16 v46, v28
    v_exp_f16 v47, v30
    v_smfmac_f32_16x16x64_f16 a[48:51], a[56:59], v[32:39], v244
    ds_read_b128 a[28:31], v225 offset:56320
    exph 44, 25
    v_mfma_f32_4x4x4_16b_bf16 v[176:179], v[230:231], v[200:201], 0
    exph 45, 27
    v_mfma_f32_4x4x4_16b_bf16 v[180:183], v[230:231], v[202:203], 0
    exph 46, 29
    exph 47, 31
    v_mfma_f32_32x32x16_bf16 v[16:31], a[8:11], v[136:139], v[48:63]
    s_add_u32 s45, s45, 1
    v_exp_f16 v32, v0
    v_exp_f16 v33, v2
    v_exp_f16 v34, v4
    v_mfma_f32_32x32x16_bf16 v[16:31], a[12:15], v[140:143], v[16:31]
    s_and_b32 s45, s45, 7
    v_exp_f16 v35, v6
    exph 32, 1
    exph 33, 3
    v_mfma_f32_32x32x16_f16 v[112:127], a[16:19], v[40:43], v[112:127]
    s_lshl_b32 s46, s45, 14
    exph 34, 5
    exph 35, 7
    v_exp_f16 v36, v8
    v_mfma_f32_32x32x16_f16 v[112:127], a[20:23], v[44:47], v[112:127]
    v_exp_f16 v37, v10
    v_exp_f16 v38, v12
    v_exp_f16 v39, v14
    v_smfmac_f32_16x16x64_f16 a[52:55], a[56:59], v[40:47], v244
    ds_read_b128 a[0:3], v225 offset:40960
    exph 36, 9
    v_mfma_f32_4x4x4_16b_bf16 v[184:187], v[230:231], v[204:205], 0
    exph 37, 11
    v_mfma_f32_4x4x4_16b_bf16 v[188:191], v[230:231], v[206:207], 0
    exph 38, 13
    exph 39, 15
    v_pk_mul_f32 v[160:161], v[160:161], v[236:237] op_sel_hi:[1,0]
    v_pk_mul_f32 v[162:163], v[162:163], v[236:237] op_sel_hi:[1,0]
    v_pk_mul_f32 v[164:165], v[164:165], v[236:237] op_sel_hi:[1,0]
    v_pk_mul_f32 v[166:167], v[166:167], v[236:237] op_sel_hi:[1,0]
    v_pk_mul_f32 v[168:169], v[168:169], v[236:237] op_sel_hi:[1,0]
    v_pk_mul_f32 v[170:171], v[170:171], v[236:237] op_sel_hi:[1,0]
    v_pk_mul_f32 v[172:173], v[172:173], v[236:237] op_sel_hi:[1,0]
    v_pk_mul_f32 v[174:175], v[174:175], v[236:237] op_sel_hi:[1,0]
    v_mfma_f32_32x32x16_bf16 v[0:15], a[8:11], v[144:147], v[48:63]
    s_add_u32 s46, s46, s44
    v_exp_f16 v40, v16
    v_cvt_pk_bf16_f32 v192, v160, v161
    v_exp_f16 v41, v18
    v_cvt_pk_bf16_f32 v193, v162, v163
    v_exp_f16 v42, v20
    v_mfma_f32_32x32x16_bf16 v[0:15], a[12:15], v[148:151], v[0:15]
    s_waitcnt lgkmcnt(6)
    v_exp_f16 v43, v22
    v_cvt_pk_bf16_f32 v194, v164, v165
    exph 40, 17
    v_cvt_pk_bf16_f32 v195, v166, v167
    exph 41, 19
    v_mfma_f32_32x32x16_f16 v[64:79], a[24:27], v[32:35], v[64:79]
    s_waitcnt lgkmcnt(1)
    exph 42, 21
    v_cvt_pk_bf16_f32 v196, v168, v169
    exph 43, 23
    v_cvt_pk_bf16_f32 v197, v170, v171
    v_exp_f16 v44, v24
    v_mfma_f32_32x32x16_f16 v[64:79], a[28:31], v[36:39], v[64:79]
    v_exp_f16 v45, v26
    v_cvt_pk_bf16_f32 v198, v172, v173
    v_exp_f16 v46, v28
    v_cvt_pk_bf16_f32 v199, v174, v175
    v_exp_f16 v47, v30
    v_smfmac_f32_16x16x64_f16 a[40:43], a[56:59], v[32:39], v244
    ds_read_b128 a[4:7], v225 offset:41984
    exph 44, 25
    exph 45, 27
    exph 46, 29
    exph 47, 31
    v_pk_mul_f32 v[176:177], v[176:177], v[236:237] op_sel_hi:[1,0]
    v_pk_mul_f32 v[178:179], v[178:179], v[236:237] op_sel_hi:[1,0]
    v_pk_mul_f32 v[180:181], v[180:181], v[236:237] op_sel_hi:[1,0]
    v_pk_mul_f32 v[182:183], v[182:183], v[236:237] op_sel_hi:[1,0]
    v_pk_mul_f32 v[184:185], v[184:185], v[236:237] op_sel_hi:[1,0]
    v_pk_mul_f32 v[186:187], v[186:187], v[236:237] op_sel_hi:[1,0]
    v_pk_mul_f32 v[188:189], v[188:189], v[236:237] op_sel_hi:[1,0]
    v_pk_mul_f32 v[190:191], v[190:191], v[236:237] op_sel_hi:[1,0]
    v_mfma_f32_32x32x16_bf16 v[16:31], a[8:11], v[152:155], v[48:63]
    s_add_u32 s14, s46, s41
    ds_write_b128 v227, v[192:195] offset:0
    v_exp_f16 v32, v0
    v_cvt_pk_bf16_f32 v200, v176, v177
    v_exp_f16 v33, v2
    v_cvt_pk_bf16_f32 v201, v178, v179
    v_exp_f16 v34, v4
    v_mfma_f32_32x32x16_bf16 v[16:31], a[12:15], v[156:159], v[16:31]
    ds_write_b128 v227, v[196:199] offset:512
    v_exp_f16 v35, v6
    v_cvt_pk_bf16_f32 v202, v180, v181
    exph 32, 1
    v_cvt_pk_bf16_f32 v203, v182, v183
    exph 33, 3
    v_mfma_f32_32x32x16_f16 v[80:95], a[24:27], v[40:43], v[80:95]
    exph 34, 5
    v_cvt_pk_bf16_f32 v204, v184, v185
    exph 35, 7
    v_cvt_pk_bf16_f32 v205, v186, v187
    v_exp_f16 v36, v8
    v_mfma_f32_32x32x16_f16 v[80:95], a[28:31], v[44:47], v[80:95]
    v_exp_f16 v37, v10
    v_cvt_pk_bf16_f32 v206, v188, v189
    v_exp_f16 v38, v12
    v_cvt_pk_bf16_f32 v207, v190, v191
    v_exp_f16 v39, v14
    v_smfmac_f32_16x16x64_f16 a[44:47], a[56:59], v[40:47], v244
    s_waitcnt lgkmcnt(3)
    ds_read_b128 a[16:19], v225 offset:57344
    exph 36, 9
    v_mfma_f32_4x4x4_16b_bf16 v[160:163], a[60:61], v[208:209], 0
    exph 37, 11
    v_mfma_f32_4x4x4_16b_bf16 v[164:167], a[60:61], v[210:211], 0
    exph 38, 13
    exph 39, 15
    v_mfma_f32_4x4x4_16b_bf16 v[168:171], a[60:61], v[212:213], 0
    v_cvt_pk_f16_f32 v208, v160, v161
    v_cvt_pk_f16_f32 v209, v162, v163
    v_mfma_f32_4x4x4_16b_bf16 v[172:175], a[60:61], v[214:215], 0
    v_cvt_pk_f16_f32 v210, v164, v165
    v_cvt_pk_f16_f32 v211, v166, v167
    v_mfma_f32_4x4x4_16b_bf16 v[176:179], a[60:61], v[216:217], 0
    v_cvt_pk_f16_f32 v212, v168, v169
    v_cvt_pk_f16_f32 v213, v170, v171
    v_mfma_f32_4x4x4_16b_bf16 v[180:183], a[60:61], v[218:219], 0
    v_cvt_pk_f16_f32 v214, v172, v173
    v_cvt_pk_f16_f32 v215, v174, v175
    v_mfma_f32_4x4x4_16b_bf16 v[184:187], a[60:61], v[220:221], 0
    v_cvt_pk_f16_f32 v216, v176, v177
    v_cvt_pk_f16_f32 v217, v178, v179
    v_mfma_f32_4x4x4_16b_bf16 v[188:191], a[60:61], v[222:223], 0
    v_cvt_pk_f16_f32 v218, v180, v181
    v_cvt_pk_f16_f32 v219, v182, v183
    v_cvt_pk_f16_f32 v220, v184, v185
    v_cvt_pk_f16_f32 v221, v186, v187
    s_nop 0
    v_cvt_pk_f16_f32 v222, v188, v189
    v_cvt_pk_f16_f32 v223, v190, v191
    v_mfma_f32_32x32x16_bf16 v[0:15], a[0:3], v[128:131], v[48:63]
    s_waitcnt lgkmcnt(3)
    ds_write_b128 v227, v[200:203] offset:1024
    v_exp_f16 v40, v16
    v_exp_f16 v41, v18
    v_exp_f16 v42, v20
    v_mfma_f32_32x32x16_bf16 v[0:15], a[4:7], v[132:135], v[0:15]
    ds_write_b128 v227, v[204:207] offset:1536
    v_exp_f16 v43, v22
    exph 40, 17
    exph 41, 19
    v_mfma_f32_32x32x16_f16 v[96:111], a[24:27], v[32:35], v[96:111]
    exph 42, 21
    exph 43, 23
    v_exp_f16 v44, v24
    v_mfma_f32_32x32x16_f16 v[96:111], a[28:31], v[36:39], v[96:111]
    v_exp_f16 v45, v26
    v_exp_f16 v46, v28
    v_exp_f16 v47, v30
    v_smfmac_f32_16x16x64_f16 a[48:51], a[56:59], v[32:39], v244
    ds_read_b128 a[20:23], v225 offset:58368
    exph 44, 25
    exph 45, 27
    exph 46, 29
    exph 47, 31
    v_mfma_f32_32x32x16_bf16 v[16:31], a[0:3], v[136:139], v[48:63]
    ds_write_b128 v245, v[208:211] offset:16384
    v_exp_f16 v32, v0
    v_exp_f16 v33, v2
    v_exp_f16 v34, v4
    v_mfma_f32_32x32x16_bf16 v[16:31], a[4:7], v[140:143], v[16:31]
    ds_write_b128 v245, v[212:215] offset:17408
    v_exp_f16 v35, v6
    exph 32, 1
    exph 33, 3
    v_mfma_f32_32x32x16_f16 v[112:127], a[24:27], v[40:43], v[112:127]
    exph 34, 5
    exph 35, 7
    v_exp_f16 v36, v8
    v_mfma_f32_32x32x16_f16 v[112:127], a[28:31], v[44:47], v[112:127]
    v_exp_f16 v37, v10
    v_exp_f16 v38, v12
    v_exp_f16 v39, v14
    v_smfmac_f32_16x16x64_f16 a[52:55], a[56:59], v[40:47], v244
    ds_read_b128 a[8:11], v225 offset:43008
    exph 36, 9
    exph 37, 11
    exph 38, 13
    exph 39, 15
    v_mfma_f32_32x32x16_bf16 v[0:15], a[0:3], v[144:147], v[48:63]
    ds_write_b128 v245, v[216:219] offset:18432
    v_exp_f16 v40, v16
    v_exp_f16 v41, v18
    v_exp_f16 v42, v20
    v_mfma_f32_32x32x16_bf16 v[0:15], a[4:7], v[148:151], v[0:15]
    s_waitcnt lgkmcnt(7)
    ds_write_b128 v245, v[220:223] offset:19456
    v_exp_f16 v43, v22
    exph 40, 17
    exph 41, 19
    v_mfma_f32_32x32x16_f16 v[64:79], a[16:19], v[32:35], v[64:79]
    s_waitcnt lgkmcnt(5)
    exph 42, 21
    exph 43, 23
    v_exp_f16 v44, v24
    v_mfma_f32_32x32x16_f16 v[64:79], a[20:23], v[36:39], v[64:79]
    v_exp_f16 v45, v26
    v_exp_f16 v46, v28
    v_exp_f16 v47, v30
    v_smfmac_f32_16x16x64_f16 a[40:43], a[56:59], v[32:39], v244
    ds_read_b128 a[12:15], v225 offset:44032
    exph 44, 25
    exph 45, 27
    exph 46, 29
    exph 47, 31
    v_mfma_f32_32x32x16_bf16 v[16:31], a[0:3], v[152:155], v[48:63]
    v_exp_f16 v32, v0
    v_exp_f16 v33, v2
    v_exp_f16 v34, v4
    v_mfma_f32_32x32x16_bf16 v[16:31], a[4:7], v[156:159], v[16:31]
    v_exp_f16 v35, v6
    exph 32, 1
    exph 33, 3
    v_mfma_f32_32x32x16_f16 v[80:95], a[16:19], v[40:43], v[80:95]
    exph 34, 5
    exph 35, 7
    v_exp_f16 v36, v8
    v_mfma_f32_32x32x16_f16 v[80:95], a[20:23], v[44:47], v[80:95]
    v_exp_f16 v37, v10
    v_exp_f16 v38, v12
    v_exp_f16 v39, v14
    v_smfmac_f32_16x16x64_f16 a[44:47], a[56:59], v[40:47], v244
    s_waitcnt lgkmcnt(3)
    ds_read_b128 a[24:27], v225 offset:59392
    exph 36, 9
    exph 37, 11
    exph 38, 13
    exph 39, 15
    v_mfma_f32_32x32x16_bf16 v[0:15], a[8:11], v[128:131], v[48:63]
    s_waitcnt lgkmcnt(1)
    v_exp_f16 v40, v16
    v_exp_f16 v41, v18
    v_exp_f16 v42, v20
    v_mfma_f32_32x32x16_bf16 v[0:15], a[12:15], v[132:135], v[0:15]
    v_exp_f16 v43, v22
    exph 40, 17
    exph 41, 19
    v_mfma_f32_32x32x16_f16 v[96:111], a[16:19], v[32:35], v[96:111]
    exph 42, 21
    exph 43, 23
    v_exp_f16 v44, v24
    v_mfma_f32_32x32x16_f16 v[96:111], a[20:23], v[36:39], v[96:111]
    v_exp_f16 v45, v26
    v_exp_f16 v46, v28
    v_exp_f16 v47, v30
    v_smfmac_f32_16x16x64_f16 a[48:51], a[56:59], v[32:39], v244
    ds_read_b128 a[28:31], v225 offset:60416
    exph 44, 25
    exph 45, 27
    exph 46, 29
    exph 47, 31
    v_mfma_f32_32x32x16_bf16 v[16:31], a[8:11], v[136:139], v[48:63]
    v_exp_f16 v32, v0
    v_exp_f16 v33, v2
    v_exp_f16 v34, v4
    v_mfma_f32_32x32x16_bf16 v[16:31], a[12:15], v[140:143], v[16:31]
L_pad3F:
    s_cbranch_vccnz L_pad7F
    v_exp_f16 v35, v6
    exph 32, 1
    exph 33, 3
    v_mfma_f32_32x32x16_f16 v[112:127], a[16:19], v[40:43], v[112:127]
    exph 34, 5
    exph 35, 7
    v_exp_f16 v36, v8
    v_mfma_f32_32x32x16_f16 v[112:127], a[20:23], v[44:47], v[112:127]
    v_exp_f16 v37, v10
    v_exp_f16 v38, v12
    v_exp_f16 v39, v14
    v_smfmac_f32_16x16x64_f16 a[52:55], a[56:59], v[40:47], v244
    ds_read_b128 a[0:3], v225 offset:45056
    exph 36, 9
    exph 37, 11
    exph 38, 13
    exph 39, 15
    v_mfma_f32_32x32x16_bf16 v[0:15], a[8:11], v[144:147], v[48:63]
    v_exp_f16 v40, v16
    v_exp_f16 v41, v18
    v_exp_f16 v42, v20
    v_not_b32 v248, v232
    v_mfma_f32_32x32x16_bf16 v[0:15], a[12:15], v[148:151], v[0:15]
    s_waitcnt lgkmcnt(2)
    v_exp_f16 v43, v22
    exph 40, 17
    exph 41, 19
    v_mfma_f32_32x32x16_f16 v[64:79], a[24:27], v[32:35], v[64:79]
    s_waitcnt lgkmcnt(1)
    exph 42, 21
    exph 43, 23
    v_exp_f16 v44, v24
    v_mfma_f32_32x32x16_f16 v[64:79], a[28:31], v[36:39], v[64:79]
    v_exp_f16 v45, v26
    v_exp_f16 v46, v28
    v_exp_f16 v47, v30
    v_smfmac_f32_16x16x64_f16 a[40:43], a[56:59], v[32:39], v244
    ds_read_b128 a[4:7], v225 offset:46080
    exph 44, 25
    exph 45, 27
    exph 46, 29
    exph 47, 31
    v_mfma_f32_32x32x16_bf16 v[16:31], a[8:11], v[152:155], v[48:63]
    s_waitcnt vmcnt(0)
    buffer_store_dword v248, v228, s[52:55], 0 offen offset:0 sc1
    v_exp_f16 v32, v0
    v_exp_f16 v33, v2
    v_exp_f16 v34, v4
    v_mfma_f32_32x32x16_bf16 v[16:31], a[12:15], v[156:159], v[16:31]
    v_exp_f16 v35, v6
    exph 32, 1
    exph 33, 3
    v_mfma_f32_32x32x16_f16 v[80:95], a[24:27], v[40:43], v[80:95]
    exph 34, 5
    exph 35, 7
    v_exp_f16 v36, v8
    v_mfma_f32_32x32x16_f16 v[80:95], a[28:31], v[44:47], v[80:95]
    v_exp_f16 v37, v10
    v_exp_f16 v38, v12
    v_exp_f16 v39, v14
    v_smfmac_f32_16x16x64_f16 a[44:47], a[56:59], v[40:47], v244
    s_waitcnt lgkmcnt(1)
    ds_read_b128 a[16:19], v225 offset:61440
    exph 36, 9
    exph 37, 11
    exph 38, 13
    exph 39, 15
    v_mfma_f32_32x32x16_bf16 v[0:15], a[0:3], v[128:131], v[48:63]
    s_waitcnt lgkmcnt(1)
    v_exp_f16 v40, v16
    v_exp_f16 v41, v18
    v_exp_f16 v42, v20
    v_mfma_f32_32x32x16_bf16 v[0:15], a[4:7], v[132:135], v[0:15]
    v_exp_f16 v43, v22
    exph 40, 17
    exph 41, 19
    v_mfma_f32_32x32x16_f16 v[96:111], a[24:27], v[32:35], v[96:111]
    exph 42, 21
    exph 43, 23
    v_exp_f16 v44, v24
    v_mfma_f32_32x32x16_f16 v[96:111], a[28:31], v[36:39], v[96:111]
    v_exp_f16 v45, v26
    v_exp_f16 v46, v28
    v_exp_f16 v47, v30
    v_smfmac_f32_16x16x64_f16 a[48:51], a[56:59], v[32:39], v244
    ds_read_b128 a[20:23], v225 offset:62464
    exph 44, 25
    exph 45, 27
    exph 46, 29
    exph 47, 31
    v_mfma_f32_32x32x16_bf16 v[16:31], a[0:3], v[136:139], v[48:63]
    v_exp_f16 v32, v0
    v_exp_f16 v33, v2
    v_exp_f16 v34, v4
    v_mfma_f32_32x32x16_bf16 v[16:31], a[4:7], v[140:143], v[16:31]
    v_exp_f16 v35, v6
    exph 32, 1
    exph 33, 3
    v_mfma_f32_32x32x16_f16 v[112:127], a[24:27], v[40:43], v[112:127]
    s_waitcnt lgkmcnt(0)
    exph 34, 5
    exph 35, 7
    v_exp_f16 v36, v8
    v_mfma_f32_32x32x16_f16 v[112:127], a[28:31], v[44:47], v[112:127]
    s_barrier
    v_exp_f16 v37, v10
    v_exp_f16 v38, v12
    v_exp_f16 v39, v14
    v_smfmac_f32_16x16x64_f16 a[52:55], a[56:59], v[40:47], v244
    ds_read_b128 a[8:11], v225 offset:0
    exph 36, 9
    exph 37, 11
    exph 38, 13
    exph 39, 15
    v_mfma_f32_32x32x16_bf16 v[0:15], a[0:3], v[144:147], v[48:63]
    v_exp_f16 v40, v16
    v_exp_f16 v41, v18
    v_exp_f16 v42, v20
    v_mfma_f32_32x32x16_bf16 v[0:15], a[4:7], v[148:151], v[0:15]
    v_exp_f16 v43, v22
    exph 40, 17
    exph 41, 19
    v_mfma_f32_32x32x16_f16 v[64:79], a[16:19], v[32:35], v[64:79]
    exph 42, 21
    exph 43, 23
    v_exp_f16 v44, v24
    v_mfma_f32_32x32x16_f16 v[64:79], a[20:23], v[36:39], v[64:79]
    v_exp_f16 v45, v26
    v_exp_f16 v46, v28
    v_exp_f16 v47, v30
    v_smfmac_f32_16x16x64_f16 a[40:43], a[56:59], v[32:39], v244
    ds_read_b128 a[12:15], v225 offset:1024
    exph 44, 25
    exph 45, 27
    exph 46, 29
    exph 47, 31
    v_mfma_f32_32x32x16_bf16 v[16:31], a[0:3], v[152:155], v[48:63]
    v_exp_f16 v32, v0
    v_exp_f16 v33, v2
    v_exp_f16 v34, v4
    v_mfma_f32_32x32x16_bf16 v[16:31], a[4:7], v[156:159], v[16:31]
    v_exp_f16 v35, v6
    exph 32, 1
    exph 33, 3
    v_mfma_f32_32x32x16_f16 v[80:95], a[16:19], v[40:43], v[80:95]
    exph 34, 5
    exph 35, 7
    v_exp_f16 v36, v8
    v_mfma_f32_32x32x16_f16 v[80:95], a[20:23], v[44:47], v[80:95]
    v_exp_f16 v37, v10
    v_exp_f16 v38, v12
    v_exp_f16 v39, v14
    v_smfmac_f32_16x16x64_f16 a[44:47], a[56:59], v[40:47], v244
    s_waitcnt lgkmcnt(1)
    ds_read_b128 a[24:27], v225 offset:16384
    exph 36, 9
    exph 37, 11
    exph 38, 13
    exph 39, 15
    v_mfma_f32_32x32x16_bf16 v[0:15], a[8:11], v[128:131], v[48:63]
    s_waitcnt lgkmcnt(1)
    buffer_load_dword v239, v225, s[52:55], 0 offen offset:0 sc1
    v_exp_f16 v40, v16
    v_exp_f16 v41, v18
    v_exp_f16 v42, v20
    v_mfma_f32_32x32x16_bf16 v[0:15], a[12:15], v[132:135], v[0:15]
    v_exp_f16 v43, v22
    exph 40, 17
    exph 41, 19
    v_mfma_f32_32x32x16_f16 v[96:111], a[16:19], v[32:35], v[96:111]
    exph 42, 21
    exph 43, 23
    v_exp_f16 v44, v24
    v_mfma_f32_32x32x16_f16 v[96:111], a[20:23], v[36:39], v[96:111]
    v_exp_f16 v45, v26
    v_exp_f16 v46, v28
    v_exp_f16 v47, v30
    v_smfmac_f32_16x16x64_f16 a[48:51], a[56:59], v[32:39], v244
    ds_read_b128 a[28:31], v225 offset:17408
    exph 44, 25
    exph 45, 27
    exph 46, 29
    exph 47, 31
    v_mfma_f32_32x32x16_bf16 v[16:31], a[8:11], v[136:139], v[48:63]
    v_exp_f16 v32, v0
    v_exp_f16 v33, v2
    v_exp_f16 v34, v4
    v_mfma_f32_32x32x16_bf16 v[16:31], a[12:15], v[140:143], v[16:31]
    v_exp_f16 v35, v6
    exph 32, 1
    exph 33, 3
    v_mfma_f32_32x32x16_f16 v[112:127], a[16:19], v[40:43], v[112:127]
    exph 34, 5
    exph 35, 7
    v_exp_f16 v36, v8
    v_mfma_f32_32x32x16_f16 v[112:127], a[20:23], v[44:47], v[112:127]
    v_exp_f16 v37, v10
    v_exp_f16 v38, v12
    v_exp_f16 v39, v14
    v_smfmac_f32_16x16x64_f16 a[52:55], a[56:59], v[40:47], v244
    ds_read_b128 a[0:3], v225 offset:2048
    exph 36, 9
    exph 37, 11
    exph 38, 13
    exph 39, 15
    v_mfma_f32_32x32x16_bf16 v[0:15], a[8:11], v[144:147], v[48:63]
    v_exp_f16 v40, v16
    v_exp_f16 v41, v18
    v_exp_f16 v42, v20
    v_mfma_f32_32x32x16_bf16 v[0:15], a[12:15], v[148:151], v[0:15]
    s_waitcnt lgkmcnt(2)
    v_exp_f16 v43, v22
    exph 40, 17
    exph 41, 19
    v_mfma_f32_32x32x16_f16 v[64:79], a[24:27], v[32:35], v[64:79]
    s_waitcnt lgkmcnt(1)
    exph 42, 21
    exph 43, 23
    v_exp_f16 v44, v24
    v_mfma_f32_32x32x16_f16 v[64:79], a[28:31], v[36:39], v[64:79]
    v_exp_f16 v45, v26
    v_exp_f16 v46, v28
    v_exp_f16 v47, v30
    v_smfmac_f32_16x16x64_f16 a[40:43], a[56:59], v[32:39], v244
    ds_read_b128 a[4:7], v225 offset:3072
    exph 44, 25
    exph 45, 27
    exph 46, 29
    exph 47, 31
    v_mfma_f32_32x32x16_bf16 v[16:31], a[8:11], v[152:155], v[48:63]
    v_exp_f16 v32, v0
    v_exp_f16 v33, v2
    v_exp_f16 v34, v4
    v_mfma_f32_32x32x16_bf16 v[16:31], a[12:15], v[156:159], v[16:31]
    v_exp_f16 v35, v6
    exph 32, 1
    exph 33, 3
    v_mfma_f32_32x32x16_f16 v[80:95], a[24:27], v[40:43], v[80:95]
    exph 34, 5
    exph 35, 7
    v_exp_f16 v36, v8
    v_mfma_f32_32x32x16_f16 v[80:95], a[28:31], v[44:47], v[80:95]
    v_exp_f16 v37, v10
    v_exp_f16 v38, v12
    v_exp_f16 v39, v14
    v_smfmac_f32_16x16x64_f16 a[44:47], a[56:59], v[40:47], v244
    s_waitcnt lgkmcnt(1)
    ds_read_b128 a[16:19], v225 offset:18432
    exph 36, 9
    exph 37, 11
    exph 38, 13
    exph 39, 15
    v_mfma_f32_32x32x16_bf16 v[0:15], a[0:3], v[128:131], v[48:63]
    s_waitcnt lgkmcnt(1)
    v_exp_f16 v40, v16
    v_exp_f16 v41, v18
    v_exp_f16 v42, v20
    v_mfma_f32_32x32x16_bf16 v[0:15], a[4:7], v[132:135], v[0:15]
    s_waitcnt vmcnt(0)
    v_exp_f16 v43, v22
    exph 40, 17
    v_cmp_ne_u32 s[62:63], v239, v232
    exph 41, 19
    v_mfma_f32_32x32x16_f16 v[96:111], a[24:27], v[32:35], v[96:111]
    s_cmp_eq_u32 s62, 15
    exph 42, 21
    exph 43, 23
    v_exp_f16 v44, v24
    v_mfma_f32_32x32x16_f16 v[96:111], a[28:31], v[36:39], v[96:111]
    s_cbranch_scc0 L_spin0F
L_back0F:
    v_exp_f16 v45, v26
    v_exp_f16 v46, v28
    v_exp_f16 v47, v30
    v_smfmac_f32_16x16x64_f16 a[48:51], a[56:59], v[32:39], v244
    ds_read_b128 a[20:23], v225 offset:19456
    exph 44, 25
    exph 45, 27
    exph 46, 29
    exph 47, 31
    v_mfma_f32_32x32x16_bf16 v[16:31], a[0:3], v[136:139], v[48:63]
    v_exp_f16 v32, v0
    v_exp_f16 v33, v2
    v_exp_f16 v34, v4
    v_mfma_f32_32x32x16_bf16 v[16:31], a[4:7], v[140:143], v[16:31]
    v_exp_f16 v35, v6
    exph 32, 1
    exph 33, 3
    v_mfma_f32_32x32x16_f16 v[112:127], a[24:27], v[40:43], v[112:127]
    exph 34, 5
    exph 35, 7
    v_exp_f16 v36, v8
    v_mfma_f32_32x32x16_f16 v[112:127], a[28:31], v[44:47], v[112:127]
    s_mov_b32 m0, s61
    v_exp_f16 v37, v10
    v_exp_f16 v38, v12
    v_exp_f16 v39, v14
    v_smfmac_f32_16x16x64_f16 a[52:55], a[56:59], v[40:47], v244
    ds_read_b128 a[8:11], v225 offset:4096
    exph 36, 9
    exph 37, 11
    exph 38, 13
    exph 39, 15
    v_mfma_f32_32x32x16_bf16 v[0:15], a[0:3], v[144:147], v[48:63]
    buffer_load_dwordx4 v225, s[48:51], s46 offen offset:0 sc1 lds
    v_exp_f16 v40, v16
    v_exp_f16 v41, v18
    v_exp_f16 v42, v20
    v_mfma_f32_32x32x16_bf16 v[0:15], a[4:7], v[148:151], v[0:15]
    s_waitcnt lgkmcnt(2)
    buffer_load_dwordx4 v225, s[48:51], s46 offen offset:1024 sc1 lds
    v_exp_f16 v43, v22
    exph 40, 17
    exph 41, 19
    v_mfma_f32_32x32x16_f16 v[64:79], a[16:19], v[32:35], v[64:79]
    s_waitcnt lgkmcnt(1)
    buffer_load_dwordx4 v225, s[48:51], s14 offen offset:2048 sc1 lds
    exph 42, 21
    exph 43, 23
    v_exp_f16 v44, v24
    v_mfma_f32_32x32x16_f16 v[64:79], a[20:23], v[36:39], v[64:79]
    buffer_load_dwordx4 v225, s[48:51], s14 offen offset:3072 sc1 lds
    v_exp_f16 v45, v26
    v_exp_f16 v46, v28
    v_exp_f16 v47, v30
    v_smfmac_f32_16x16x64_f16 a[40:43], a[56:59], v[32:39], v244
    ds_read_b128 a[12:15], v225 offset:5120
    exph 44, 25
    exph 45, 27
    exph 46, 29
    exph 47, 31
    v_mfma_f32_32x32x16_bf16 v[16:31], a[0:3], v[152:155], v[48:63]
    v_exp_f16 v32, v0
    v_exp_f16 v33, v2
    v_exp_f16 v34, v4
    v_mfma_f32_32x32x16_bf16 v[16:31], a[4:7], v[156:159], v[16:31]
    v_exp_f16 v35, v6
    exph 32, 1
    exph 33, 3
    v_mfma_f32_32x32x16_f16 v[80:95], a[16:19], v[40:43], v[80:95]
    exph 34, 5
    exph 35, 7
    v_exp_f16 v36, v8
    v_mfma_f32_32x32x16_f16 v[80:95], a[20:23], v[44:47], v[80:95]
    s_mov_b32 m0, s57
    v_exp_f16 v37, v10
    v_exp_f16 v38, v12
    v_exp_f16 v39, v14
    v_smfmac_f32_16x16x64_f16 a[44:47], a[56:59], v[40:47], v244
    s_waitcnt lgkmcnt(1)
    ds_read_b128 a[24:27], v225 offset:20480
    exph 36, 9
    exph 37, 11
    exph 38, 13
    exph 39, 15
    v_mfma_f32_32x32x16_bf16 v[0:15], a[8:11], v[128:131], v[48:63]
    s_waitcnt lgkmcnt(1)
    buffer_load_dwordx4 v225, s[64:67], s46 offen offset:0 sc1 lds
    v_exp_f16 v40, v16
    v_exp_f16 v41, v18
    v_exp_f16 v42, v20
    v_mfma_f32_32x32x16_bf16 v[0:15], a[12:15], v[132:135], v[0:15]
    buffer_load_dwordx4 v225, s[64:67], s46 offen offset:1024 sc1 lds
    v_exp_f16 v43, v22
    exph 40, 17
    exph 41, 19
    v_mfma_f32_32x32x16_f16 v[96:111], a[16:19], v[32:35], v[96:111]
    buffer_load_dwordx4 v225, s[64:67], s14 offen offset:2048 sc1 lds
    exph 42, 21
    exph 43, 23
    v_exp_f16 v44, v24
    v_mfma_f32_32x32x16_f16 v[96:111], a[20:23], v[36:39], v[96:111]
    buffer_load_dwordx4 v225, s[64:67], s14 offen offset:3072 sc1 lds
    v_exp_f16 v45, v26
    v_exp_f16 v46, v28
    v_exp_f16 v47, v30
    v_smfmac_f32_16x16x64_f16 a[48:51], a[56:59], v[32:39], v244
    ds_read_b128 a[28:31], v225 offset:21504
    exph 44, 25
    exph 45, 27
    exph 46, 29
    exph 47, 31
    v_mfma_f32_32x32x16_bf16 v[16:31], a[8:11], v[136:139], v[48:63]
    s_add_u32 s45, s45, 2
    v_exp_f16 v32, v0
    v_exp_f16 v33, v2
    v_exp_f16 v34, v4
    v_mfma_f32_32x32x16_bf16 v[16:31], a[12:15], v[140:143], v[16:31]
    s_and_b32 s45, s45, 7
    v_exp_f16 v35, v6
    exph 32, 1
    exph 33, 3
    v_mfma_f32_32x32x16_f16 v[112:127], a[16:19], v[40:43], v[112:127]
    s_lshl_b32 s46, s45, 14
    exph 34, 5
    exph 35, 7
    v_exp_f16 v36, v8
    v_mfma_f32_32x32x16_f16 v[112:127], a[20:23], v[44:47], v[112:127]
    v_exp_f16 v37, v10
    v_exp_f16 v38, v12
    v_exp_f16 v39, v14
    v_smfmac_f32_16x16x64_f16 a[52:55], a[56:59], v[40:47], v244
    ds_read_b128 a[0:3], v225 offset:6144
    exph 36, 9
    exph 37, 11
    exph 38, 13
    exph 39, 15
    v_mfma_f32_32x32x16_bf16 v[0:15], a[8:11], v[144:147], v[48:63]
    s_add_u32 s46, s46, s44
    v_exp_f16 v40, v16
    v_exp_f16 v41, v18
    v_exp_f16 v42, v20
    v_mfma_f32_32x32x16_bf16 v[0:15], a[12:15], v[148:151], v[0:15]
    s_waitcnt lgkmcnt(2)
    v_exp_f16 v43, v22
    exph 40, 17
    exph 41, 19
    v_mfma_f32_32x32x16_f16 v[64:79], a[24:27], v[32:35], v[64:79]
    s_waitcnt lgkmcnt(1)
    exph 42, 21
    exph 43, 23
    v_exp_f16 v44, v24
    v_mfma_f32_32x32x16_f16 v[64:79], a[28:31], v[36:39], v[64:79]
    v_exp_f16 v45, v26
    v_exp_f16 v46, v28
    v_exp_f16 v47, v30
    v_smfmac_f32_16x16x64_f16 a[40:43], a[56:59], v[32:39], v244
    ds_read_b128 a[4:7], v225 offset:7168
    exph 44, 25
    exph 45, 27
    exph 46, 29
    exph 47, 31
    v_mfma_f32_32x32x16_bf16 v[16:31], a[8:11], v[152:155], v[48:63]
    s_add_u32 s14, s46, s41
    v_exp_f16 v32, v0
    v_exp_f16 v33, v2
    v_exp_f16 v34, v4
    v_mfma_f32_32x32x16_bf16 v[16:31], a[12:15], v[156:159], v[16:31]
    v_exp_f16 v35, v6
    exph 32, 1
    exph 33, 3
    v_mfma_f32_32x32x16_f16 v[80:95], a[24:27], v[40:43], v[80:95]
    exph 34, 5
    exph 35, 7
    v_exp_f16 v36, v8
    v_mfma_f32_32x32x16_f16 v[80:95], a[28:31], v[44:47], v[80:95]
    v_exp_f16 v37, v10
    v_exp_f16 v38, v12
    v_exp_f16 v39, v14
    v_smfmac_f32_16x16x64_f16 a[44:47], a[56:59], v[40:47], v244
    s_waitcnt lgkmcnt(1)
    ds_read_b128 a[16:19], v225 offset:22528
    exph 36, 9
    exph 37, 11
    exph 38, 13
    exph 39, 15
    v_mfma_f32_32x32x16_bf16 v[0:15], a[0:3], v[128:131], v[48:63]
    s_waitcnt lgkmcnt(1)
    v_exp_f16 v40, v16
    v_exp_f16 v41, v18
    v_exp_f16 v42, v20
    v_mfma_f32_32x32x16_bf16 v[0:15], a[4:7], v[132:135], v[0:15]
    v_exp_f16 v43, v22
    exph 40, 17
    exph 41, 19
    v_mfma_f32_32x32x16_f16 v[96:111], a[24:27], v[32:35], v[96:111]
    exph 42, 21
    exph 43, 23
    v_exp_f16 v44, v24
    v_mfma_f32_32x32x16_f16 v[96:111], a[28:31], v[36:39], v[96:111]
    v_exp_f16 v45, v26
    v_exp_f16 v46, v28
    v_exp_f16 v47, v30
    v_smfmac_f32_16x16x64_f16 a[48:51], a[56:59], v[32:39], v244
    ds_read_b128 a[20:23], v225 offset:23552
    exph 44, 25
    exph 45, 27
    exph 46, 29
    exph 47, 31
    v_mfma_f32_32x32x16_bf16 v[16:31], a[0:3], v[136:139], v[48:63]
    v_exp_f16 v32, v0
    v_exp_f16 v33, v2
    v_exp_f16 v34, v4
    v_mfma_f32_32x32x16_bf16 v[16:31], a[4:7], v[140:143], v[16:31]
    v_exp_f16 v35, v6
    exph 32, 1
    exph 33, 3
    v_mfma_f32_32x32x16_f16 v[112:127], a[24:27], v[40:43], v[112:127]
    exph 34, 5
    exph 35, 7
    v_exp_f16 v36, v8
    v_mfma_f32_32x32x16_f16 v[112:127], a[28:31], v[44:47], v[112:127]
    v_exp_f16 v37, v10
    v_exp_f16 v38, v12
    v_exp_f16 v39, v14
    v_smfmac_f32_16x16x64_f16 a[52:55], a[56:59], v[40:47], v244
    ds_read_b128 a[8:11], v225 offset:8192
    exph 36, 9
    exph 37, 11
    exph 38, 13
    exph 39, 15
    v_mfma_f32_32x32x16_bf16 v[0:15], a[0:3], v[144:147], v[48:63]
    v_exp_f16 v40, v16
    v_exp_f16 v41, v18
    v_exp_f16 v42, v20
    v_mfma_f32_32x32x16_bf16 v[0:15], a[4:7], v[148:151], v[0:15]
    s_waitcnt lgkmcnt(2)
    v_exp_f16 v43, v22
    exph 40, 17
    exph 41, 19
    v_mfma_f32_32x32x16_f16 v[64:79], a[16:19], v[32:35], v[64:79]
    s_waitcnt lgkmcnt(1)
    exph 42, 21
    exph 43, 23
    v_exp_f16 v44, v24
    v_mfma_f32_32x32x16_f16 v[64:79], a[20:23], v[36:39], v[64:79]
    v_exp_f16 v45, v26
    v_exp_f16 v46, v28
    v_exp_f16 v47, v30
    v_smfmac_f32_16x16x64_f16 a[40:43], a[56:59], v[32:39], v244
    ds_read_b128 a[12:15], v225 offset:9216
    exph 44, 25
    exph 45, 27
    exph 46, 29
    exph 47, 31
    v_mfma_f32_32x32x16_bf16 v[16:31], a[0:3], v[152:155], v[48:63]
    v_exp_f16 v32, v0
    v_exp_f16 v33, v2
    v_exp_f16 v34, v4
    v_mfma_f32_32x32x16_bf16 v[16:31], a[4:7], v[156:159], v[16:31]
    v_exp_f16 v35, v6
    exph 32, 1
    exph 33, 3
    v_mfma_f32_32x32x16_f16 v[80:95], a[16:19], v[40:43], v[80:95]
    exph 34, 5
    exph 35, 7
    v_exp_f16 v36, v8
    v_mfma_f32_32x32x16_f16 v[80:95], a[20:23], v[44:47], v[80:95]
    v_exp_f16 v37, v10
    v_exp_f16 v38, v12
    v_exp_f16 v39, v14
    v_smfmac_f32_16x16x64_f16 a[44:47], a[56:59], v[40:47], v244
    s_waitcnt lgkmcnt(1)
    ds_read_b128 a[24:27], v225 offset:24576
    exph 36, 9
    exph 37, 11
    exph 38, 13
    exph 39, 15
    v_mfma_f32_32x32x16_bf16 v[0:15], a[8:11], v[128:131], v[48:63]
    s_waitcnt lgkmcnt(1)
    v_exp_f16 v40, v16
    v_exp_f16 v41, v18
    v_exp_f16 v42, v20
    v_mfma_f32_32x32x16_bf16 v[0:15], a[12:15], v[132:135], v[0:15]
    v_exp_f16 v43, v22
    exph 40, 17
    exph 41, 19
    v_mfma_f32_32x32x16_f16 v[96:111], a[16:19], v[32:35], v[96:111]
    exph 42, 21
    exph 43, 23
    v_exp_f16 v44, v24
    v_mfma_f32_32x32x16_f16 v[96:111], a[20:23], v[36:39], v[96:111]
    v_exp_f16 v45, v26
    v_exp_f16 v46, v28
    v_exp_f16 v47, v30
    v_smfmac_f32_16x16x64_f16 a[48:51], a[56:59], v[32:39], v244
    ds_read_b128 a[28:31], v225 offset:25600
    exph 44, 25
    exph 45, 27
    exph 46, 29
    exph 47, 31
    v_mfma_f32_32x32x16_bf16 v[16:31], a[8:11], v[136:139], v[48:63]
    v_exp_f16 v32, v0
    v_exp_f16 v33, v2
    v_exp_f16 v34, v4
    v_mfma_f32_32x32x16_bf16 v[16:31], a[12:15], v[140:143], v[16:31]
    v_exp_f16 v35, v6
    exph 32, 1
    exph 33, 3
    v_mfma_f32_32x32x16_f16 v[112:127], a[16:19], v[40:43], v[112:127]
    exph 34, 5
    exph 35, 7
    v_exp_f16 v36, v8
    v_mfma_f32_32x32x16_f16 v[112:127], a[20:23], v[44:47], v[112:127]
    v_exp_f16 v37, v10
    v_exp_f16 v38, v12
    v_exp_f16 v39, v14
    v_smfmac_f32_16x16x64_f16 a[52:55], a[56:59], v[40:47], v244
    ds_read_b128 a[0:3], v225 offset:10240
    exph 36, 9
    exph 37, 11
    exph 38, 13
    exph 39, 15
    v_mfma_f32_32x32x16_bf16 v[0:15], a[8:11], v[144:147], v[48:63]
    v_exp_f16 v40, v16
    v_exp_f16 v41, v18
    v_exp_f16 v42, v20
    v_mfma_f32_32x32x16_bf16 v[0:15], a[12:15], v[148:151], v[0:15]
    s_waitcnt lgkmcnt(2)
    v_exp_f16 v43, v22
    exph 40, 17
    exph 41, 19
    v_mfma_f32_32x32x16_f16 v[64:79], a[24:27], v[32:35], v[64:79]
    s_waitcnt lgkmcnt(1)
    exph 42, 21
    exph 43, 23
    v_exp_f16 v44, v24
    v_mfma_f32_32x32x16_f16 v[64:79], a[28:31], v[36:39], v[64:79]
    v_exp_f16 v45, v26
    v_exp_f16 v46, v28
    v_exp_f16 v47, v30
    v_smfmac_f32_16x16x64_f16 a[40:43], a[56:59], v[32:39], v244
    ds_read_b128 a[4:7], v225 offset:11264
    exph 44, 25
    exph 45, 27
    exph 46, 29
    exph 47, 31
    v_mfma_f32_32x32x16_bf16 v[16:31], a[8:11], v[152:155], v[48:63]
    v_exp_f16 v32, v0
    v_exp_f16 v33, v2
    v_exp_f16 v34, v4
    v_mfma_f32_32x32x16_bf16 v[16:31], a[12:15], v[156:159], v[16:31]
    v_exp_f16 v35, v6
    exph 32, 1
    exph 33, 3
    v_mfma_f32_32x32x16_f16 v[80:95], a[24:27], v[40:43], v[80:95]
    exph 34, 5
    exph 35, 7
    v_exp_f16 v36, v8
    v_mfma_f32_32x32x16_f16 v[80:95], a[28:31], v[44:47], v[80:95]
    v_exp_f16 v37, v10
    v_exp_f16 v38, v12
    v_exp_f16 v39, v14
    v_smfmac_f32_16x16x64_f16 a[44:47], a[56:59], v[40:47], v244
    s_waitcnt lgkmcnt(1)
    ds_read_b128 a[16:19], v225 offset:26624
    exph 36, 9
    exph 37, 11
    exph 38, 13
    exph 39, 15
    v_mfma_f32_32x32x16_bf16 v[0:15], a[0:3], v[128:131], v[48:63]
    s_waitcnt lgkmcnt(1)
    v_exp_f16 v40, v16
    v_exp_f16 v41, v18
    v_exp_f16 v42, v20
    v_mfma_f32_32x32x16_bf16 v[0:15], a[4:7], v[132:135], v[0:15]
L_pad4F:
    s_cbranch_vccnz L_t
    v_exp_f16 v43, v22
    exph 40, 17
    exph 41, 19
    v_mfma_f32_32x32x16_f16 v[96:111], a[24:27], v[32:35], v[96:111]
    exph 42, 21
    exph 43, 23
    v_exp_f16 v44, v24
    v_mfma_f32_32x32x16_f16 v[96:111], a[28:31], v[36:39], v[96:111]
    v_exp_f16 v45, v26
    v_exp_f16 v46, v28
    v_exp_f16 v47, v30
    v_smfmac_f32_16x16x64_f16 a[48:51], a[56:59], v[32:39], v244
    ds_read_b128 a[20:23], v225 offset:27648
    exph 44, 25
    exph 45, 27
    exph 46, 29
    exph 47, 31
    v_mfma_f32_32x32x16_bf16 v[16:31], a[0:3], v[136:139], v[48:63]
    v_exp_f16 v32, v0
    v_exp_f16 v33, v2
    v_exp_f16 v34, v4
    v_mfma_f32_32x32x16_bf16 v[16:31], a[4:7], v[140:143], v[16:31]
    v_exp_f16 v35, v6
    exph 32, 1
    exph 33, 3
    v_mfma_f32_32x32x16_f16 v[112:127], a[24:27], v[40:43], v[112:127]
    exph 34, 5
    exph 35, 7
    v_exp_f16 v36, v8
    v_mfma_f32_32x32x16_f16 v[112:127], a[28:31], v[44:47], v[112:127]
    v_exp_f16 v37, v10
    v_exp_f16 v38, v12
    v_exp_f16 v39, v14
    v_smfmac_f32_16x16x64_f16 a[52:55], a[56:59], v[40:47], v244
    ds_read_b128 a[8:11], v225 offset:12288
    exph 36, 9
    exph 37, 11
    exph 38, 13
    exph 39, 15
    v_mfma_f32_32x32x16_bf16 v[0:15], a[0:3], v[144:147], v[48:63]
    v_exp_f16 v40, v16
    v_exp_f16 v41, v18
    v_exp_f16 v42, v20
    v_mfma_f32_32x32x16_bf16 v[0:15], a[4:7], v[148:151], v[0:15]
    s_waitcnt lgkmcnt(2)
    v_exp_f16 v43, v22
    exph 40, 17
    exph 41, 19
    v_mfma_f32_32x32x16_f16 v[64:79], a[16:19], v[32:35], v[64:79]
    s_waitcnt lgkmcnt(1)
    exph 42, 21
    exph 43, 23
    v_exp_f16 v44, v24
    v_mfma_f32_32x32x16_f16 v[64:79], a[20:23], v[36:39], v[64:79]
    v_exp_f16 v45, v26
    v_exp_f16 v46, v28
    v_exp_f16 v47, v30
    v_smfmac_f32_16x16x64_f16 a[40:43], a[56:59], v[32:39], v244
    ds_read_b128 a[12:15], v225 offset:13312
    exph 44, 25
    exph 45, 27
    exph 46, 29
    exph 47, 31
    v_mfma_f32_32x32x16_bf16 v[16:31], a[0:3], v[152:155], v[48:63]
    v_exp_f16 v32, v0
    v_exp_f16 v33, v2
    v_exp_f16 v34, v4
    v_mfma_f32_32x32x16_bf16 v[16:31], a[4:7], v[156:159], v[16:31]
    v_exp_f16 v35, v6
    exph 32, 1
    exph 33, 3
    v_mfma_f32_32x32x16_f16 v[80:95], a[16:19], v[40:43], v[80:95]
    exph 34, 5
    exph 35, 7
    v_exp_f16 v36, v8
    v_mfma_f32_32x32x16_f16 v[80:95], a[20:23], v[44:47], v[80:95]
    v_exp_f16 v37, v10
    v_exp_f16 v38, v12
    v_exp_f16 v39, v14
    v_smfmac_f32_16x16x64_f16 a[44:47], a[56:59], v[40:47], v244
    s_waitcnt lgkmcnt(1)
    ds_read_b128 a[24:27], v225 offset:28672
    exph 36, 9
    exph 37, 11
    exph 38, 13
    exph 39, 15
    v_mfma_f32_32x32x16_bf16 v[0:15], a[8:11], v[128:131], v[48:63]
    s_waitcnt lgkmcnt(1)
    v_exp_f16 v40, v16
    v_exp_f16 v41, v18
    v_exp_f16 v42, v20
    v_mfma_f32_32x32x16_bf16 v[0:15], a[12:15], v[132:135], v[0:15]
    v_exp_f16 v43, v22
    exph 40, 17
    exph 41, 19
    v_mfma_f32_32x32x16_f16 v[96:111], a[16:19], v[32:35], v[96:111]
    exph 42, 21
    exph 43, 23
    v_exp_f16 v44, v24
    v_mfma_f32_32x32x16_f16 v[96:111], a[20:23], v[36:39], v[96:111]
    v_exp_f16 v45, v26
    v_exp_f16 v46, v28
    v_exp_f16 v47, v30
    v_smfmac_f32_16x16x64_f16 a[48:51], a[56:59], v[32:39], v244
    ds_read_b128 a[28:31], v225 offset:29696
    exph 44, 25
    exph 45, 27
    exph 46, 29
    exph 47, 31
    v_mfma_f32_32x32x16_bf16 v[16:31], a[8:11], v[136:139], v[48:63]
    v_exp_f16 v32, v0
    v_exp_f16 v33, v2
    v_exp_f16 v34, v4
    v_mfma_f32_32x32x16_bf16 v[16:31], a[12:15], v[140:143], v[16:31]
    v_exp_f16 v35, v6
    exph 32, 1
    exph 33, 3
    v_mfma_f32_32x32x16_f16 v[112:127], a[16:19], v[40:43], v[112:127]
    s_waitcnt vmcnt(0) lgkmcnt(0)
    exph 34, 5
    exph 35, 7
    v_exp_f16 v36, v8
    v_mfma_f32_32x32x16_f16 v[112:127], a[20:23], v[44:47], v[112:127]
    s_barrier
    v_exp_f16 v37, v10
    v_exp_f16 v38, v12
    v_exp_f16 v39, v14
    v_smfmac_f32_16x16x64_f16 a[52:55], a[56:59], v[40:47], v244
    ds_read_b128 a[0:3], v225 offset:32768
    exph 36, 9
    exph 37, 11
    exph 38, 13
    exph 39, 15
    v_mfma_f32_32x32x16_bf16 v[0:15], a[8:11], v[144:147], v[48:63]
    v_exp_f16 v40, v16
    v_exp_f16 v41, v18
    v_exp_f16 v42, v20
    v_mfma_f32_32x32x16_bf16 v[0:15], a[12:15], v[148:151], v[0:15]
    v_exp_f16 v43, v22
    exph 40, 17
    exph 41, 19
    v_mfma_f32_32x32x16_f16 v[64:79], a[24:27], v[32:35], v[64:79]
    exph 42, 21
    exph 43, 23
    v_exp_f16 v44, v24
    v_mfma_f32_32x32x16_f16 v[64:79], a[28:31], v[36:39], v[64:79]
    s_mov_b32 m0, s44
    v_exp_f16 v45, v26
    v_exp_f16 v46, v28
    v_exp_f16 v47, v30
    v_smfmac_f32_16x16x64_f16 a[40:43], a[56:59], v[32:39], v244
    ds_read_b128 a[4:7], v225 offset:33792
    exph 44, 25
    exph 45, 27
    exph 46, 29
    exph 47, 31
    v_mfma_f32_32x32x16_bf16 v[16:31], a[8:11], v[152:155], v[48:63]
    buffer_load_dwordx4 v225, s[48:51], s46 offen offset:0 sc1 lds
    v_exp_f16 v32, v0
    v_exp_f16 v33, v2
    v_exp_f16 v34, v4
    v_mfma_f32_32x32x16_bf16 v[16:31], a[12:15], v[156:159], v[16:31]
    buffer_load_dwordx4 v225, s[48:51], s46 offen offset:1024 sc1 lds
    v_exp_f16 v35, v6
    exph 32, 1
    exph 33, 3
    v_mfma_f32_32x32x16_f16 v[80:95], a[24:27], v[40:43], v[80:95]
    buffer_load_dwordx4 v225, s[48:51], s14 offen offset:2048 sc1 lds
    exph 34, 5
    exph 35, 7
    v_exp_f16 v36, v8
    v_mfma_f32_32x32x16_f16 v[80:95], a[28:31], v[44:47], v[80:95]
    buffer_load_dwordx4 v225, s[48:51], s14 offen offset:3072 sc1 lds
    v_exp_f16 v37, v10
    v_exp_f16 v38, v12
    v_exp_f16 v39, v14
    v_smfmac_f32_16x16x64_f16 a[44:47], a[56:59], v[40:47], v244
    s_waitcnt lgkmcnt(1)
    ds_read_b128 a[16:19], v225 offset:49152
    exph 36, 9
    exph 37, 11
    exph 38, 13
    exph 39, 15
    v_mfma_f32_32x32x16_bf16 v[0:15], a[0:3], v[128:131], v[48:63]
    s_waitcnt lgkmcnt(1)
    v_exp_f16 v40, v16
    v_exp_f16 v41, v18
    v_exp_f16 v42, v20
    v_mfma_f32_32x32x16_bf16 v[0:15], a[4:7], v[132:135], v[0:15]
    v_exp_f16 v43, v22
    exph 40, 17
    exph 41, 19
    v_mfma_f32_32x32x16_f16 v[96:111], a[24:27], v[32:35], v[96:111]
    exph 42, 21
    exph 43, 23
    v_exp_f16 v44, v24
    v_mfma_f32_32x32x16_f16 v[96:111], a[28:31], v[36:39], v[96:111]
    s_mov_b32 m0, s56
    v_exp_f16 v45, v26
    v_exp_f16 v46, v28
    v_exp_f16 v47, v30
    v_smfmac_f32_16x16x64_f16 a[48:51], a[56:59], v[32:39], v244
    ds_read_b128 a[20:23], v225 offset:50176
    exph 44, 25
    exph 45, 27
    exph 46, 29
    exph 47, 31
    v_mfma_f32_32x32x16_bf16 v[16:31], a[0:3], v[136:139], v[48:63]
    buffer_load_dwordx4 v225, s[64:67], s46 offen offset:0 sc1 lds
    v_exp_f16 v32, v0
    v_exp_f16 v33, v2
    v_exp_f16 v34, v4
    v_mfma_f32_32x32x16_bf16 v[16:31], a[4:7], v[140:143], v[16:31]
    buffer_load_dwordx4 v225, s[64:67], s46 offen offset:1024 sc1 lds
    v_exp_f16 v35, v6
    exph 32, 1
    exph 33, 3
    v_mfma_f32_32x32x16_f16 v[112:127], a[24:27], v[40:43], v[112:127]
    buffer_load_dwordx4 v225, s[64:67], s14 offen offset:2048 sc1 lds
    exph 34, 5
    exph 35, 7
    v_exp_f16 v36, v8
    v_mfma_f32_32x32x16_f16 v[112:127], a[28:31], v[44:47], v[112:127]
    buffer_load_dwordx4 v225, s[64:67], s14 offen offset:3072 sc1 lds
    v_exp_f16 v37, v10
    v_exp_f16 v38, v12
    v_exp_f16 v39, v14
    v_smfmac_f32_16x16x64_f16 a[52:55], a[56:59], v[40:47], v244
    ds_read_b128 a[8:11], v225 offset:34816
    exph 36, 9
    exph 37, 11
    exph 38, 13
    exph 39, 15
    v_mfma_f32_32x32x16_bf16 v[0:15], a[0:3], v[144:147], v[48:63]
    s_add_u32 s45, s45, 2
    v_exp_f16 v40, v16
    v_exp_f16 v41, v18
    v_exp_f16 v42, v20
    v_mfma_f32_32x32x16_bf16 v[0:15], a[4:7], v[148:151], v[0:15]
    s_waitcnt lgkmcnt(2)
    v_exp_f16 v43, v22
    exph 40, 17
    exph 41, 19
    v_mfma_f32_32x32x16_f16 v[64:79], a[16:19], v[32:35], v[64:79]
    s_waitcnt lgkmcnt(1)
    exph 42, 21
    exph 43, 23
    v_exp_f16 v44, v24
    v_mfma_f32_32x32x16_f16 v[64:79], a[20:23], v[36:39], v[64:79]
    ds_read_b128 a[12:15], v225 offset:35840
    v_exp_f16 v45, v26
    v_exp_f16 v46, v28
    v_exp_f16 v47, v30
    v_smfmac_f32_16x16x64_f16 a[40:43], a[56:59], v[32:39], v244
    buffer_store_dwordx4 v[192:195], v247, s[48:51], s39 offen offset:0 sc1
    exph 44, 25
    exph 45, 27
    exph 46, 29
    exph 47, 31
    v_mfma_f32_32x32x16_bf16 v[16:31], a[0:3], v[152:155], v[48:63]
    s_and_b32 s45, s45, 7
    v_exp_f16 v32, v0
    v_exp_f16 v33, v2
    v_exp_f16 v34, v4
    v_mfma_f32_32x32x16_bf16 v[16:31], a[4:7], v[156:159], v[16:31]
    s_lshl_b32 s46, s45, 14
    v_exp_f16 v35, v6
    exph 32, 1
    exph 33, 3
    v_mfma_f32_32x32x16_f16 v[80:95], a[16:19], v[40:43], v[80:95]
    s_add_u32 s46, s46, s44
    exph 34, 5
    exph 35, 7
    v_exp_f16 v36, v8
    v_mfma_f32_32x32x16_f16 v[80:95], a[20:23], v[44:47], v[80:95]
    ds_read_b128 a[24:27], v225 offset:51200
    v_exp_f16 v37, v10
    v_exp_f16 v38, v12
    v_exp_f16 v39, v14
    v_smfmac_f32_16x16x64_f16 a[44:47], a[56:59], v[40:47], v244
    s_waitcnt lgkmcnt(2)
    buffer_store_dwordx4 v[196:199], v247, s[48:51], s39 offen offset:512 sc1
    exph 36, 9
    exph 37, 11
    exph 38, 13
    exph 39, 15
    v_mfma_f32_32x32x16_bf16 v[0:15], a[8:11], v[128:131], v[48:63]
    s_waitcnt lgkmcnt(1)
    v_exp_f16 v40, v16
    v_exp_f16 v41, v18
    v_exp_f16 v42, v20
    v_mfma_f32_32x32x16_bf16 v[0:15], a[12:15], v[132:135], v[0:15]
    s_add_u32 s14, s46, s41
    v_exp_f16 v43, v22
    exph 40, 17
    exph 41, 19
    v_mfma_f32_32x32x16_f16 v[96:111], a[16:19], v[32:35], v[96:111]
    exph 42, 21
    exph 43, 23
    v_exp_f16 v44, v24
    v_mfma_f32_32x32x16_f16 v[96:111], a[20:23], v[36:39], v[96:111]
    ds_read_b128 a[28:31], v225 offset:52224
    v_exp_f16 v45, v26
    v_exp_f16 v46, v28
    v_exp_f16 v47, v30
    v_smfmac_f32_16x16x64_f16 a[48:51], a[56:59], v[32:39], v244
    buffer_store_dwordx4 v[200:203], v247, s[48:51], s39 offen offset:1024 sc1
    exph 44, 25
    exph 45, 27
    exph 46, 29
    exph 47, 31
    v_mfma_f32_32x32x16_bf16 v[16:31], a[8:11], v[136:139], v[48:63]
    v_exp_f16 v32, v0
    v_exp_f16 v33, v2
    v_exp_f16 v34, v4
    v_mfma_f32_32x32x16_bf16 v[16:31], a[12:15], v[140:143], v[16:31]
    v_exp_f16 v35, v6
    exph 32, 1
    exph 33, 3
    v_mfma_f32_32x32x16_f16 v[112:127], a[16:19], v[40:43], v[112:127]
    exph 34, 5
    exph 35, 7
    v_exp_f16 v36, v8
    v_mfma_f32_32x32x16_f16 v[112:127], a[20:23], v[44:47], v[112:127]
    ds_read_b128 a[0:3], v225 offset:36864
    v_exp_f16 v37, v10
    v_exp_f16 v38, v12
    v_exp_f16 v39, v14
    v_smfmac_f32_16x16x64_f16 a[52:55], a[56:59], v[40:47], v244
    buffer_store_dwordx4 v[204:207], v247, s[48:51], s39 offen offset:1536 sc1
    exph 36, 9
    exph 37, 11
    exph 38, 13
    exph 39, 15
    v_mfma_f32_32x32x16_bf16 v[0:15], a[8:11], v[144:147], v[48:63]
    v_exp_f16 v40, v16
    v_exp_f16 v41, v18
    v_exp_f16 v42, v20
    v_mfma_f32_32x32x16_bf16 v[0:15], a[12:15], v[148:151], v[0:15]
    s_waitcnt lgkmcnt(2)
    v_exp_f16 v43, v22
    exph 40, 17
    exph 41, 19
    v_mfma_f32_32x32x16_f16 v[64:79], a[24:27], v[32:35], v[64:79]
    s_waitcnt lgkmcnt(1)
    exph 42, 21
    exph 43, 23
    v_exp_f16 v44, v24
    v_mfma_f32_32x32x16_f16 v[64:79], a[28:31], v[36:39], v[64:79]
    ds_read_b128 a[4:7], v225 offset:37888
    v_exp_f16 v45, v26
    v_exp_f16 v46, v28
    v_exp_f16 v47, v30
    v_smfmac_f32_16x16x64_f16 a[40:43], a[56:59], v[32:39], v244
    buffer_store_dwordx4 v[208:211], v225, s[64:67], s68 offen offset:0 sc1
    exph 44, 25
    exph 45, 27
    exph 46, 29
    exph 47, 31
    v_mfma_f32_32x32x16_bf16 v[16:31], a[8:11], v[152:155], v[48:63]
    v_exp_f16 v32, v0
    v_exp_f16 v33, v2
    v_exp_f16 v34, v4
    v_mfma_f32_32x32x16_bf16 v[16:31], a[12:15], v[156:159], v[16:31]
    v_exp_f16 v35, v6
    exph 32, 1
    exph 33, 3
    v_mfma_f32_32x32x16_f16 v[80:95], a[24:27], v[40:43], v[80:95]
    exph 34, 5
    exph 35, 7
    v_exp_f16 v36, v8
    v_mfma_f32_32x32x16_f16 v[80:95], a[28:31], v[44:47], v[80:95]
    ds_read_b128 a[16:19], v225 offset:53248
    v_exp_f16 v37, v10
    v_exp_f16 v38, v12
    v_exp_f16 v39, v14
    v_smfmac_f32_16x16x64_f16 a[44:47], a[56:59], v[40:47], v244
    s_waitcnt lgkmcnt(2)
    buffer_store_dwordx4 v[212:215], v225, s[64:67], s68 offen offset:1024 sc1
    exph 36, 9
    exph 37, 11
    exph 38, 13
    exph 39, 15
    v_mfma_f32_32x32x16_bf16 v[0:15], a[0:3], v[128:131], v[48:63]
    s_waitcnt lgkmcnt(1)
    v_exp_f16 v40, v16
    v_exp_f16 v41, v18
    v_exp_f16 v42, v20
    v_mfma_f32_32x32x16_bf16 v[0:15], a[4:7], v[132:135], v[0:15]
    v_exp_f16 v43, v22
    exph 40, 17
    exph 41, 19
    v_mfma_f32_32x32x16_f16 v[96:111], a[24:27], v[32:35], v[96:111]
    exph 42, 21
    exph 43, 23
    v_exp_f16 v44, v24
    v_mfma_f32_32x32x16_f16 v[96:111], a[28:31], v[36:39], v[96:111]
    ds_read_b128 a[20:23], v225 offset:54272
    v_exp_f16 v45, v26
    v_exp_f16 v46, v28
    v_exp_f16 v47, v30
    v_smfmac_f32_16x16x64_f16 a[48:51], a[56:59], v[32:39], v244
    buffer_store_dwordx4 v[216:219], v225, s[64:67], s69 offen offset:2048 sc1
    exph 44, 25
    exph 45, 27
    exph 46, 29
    exph 47, 31
    v_mfma_f32_32x32x16_bf16 v[16:31], a[0:3], v[136:139], v[48:63]
    v_exp_f16 v32, v0
    v_exp_f16 v33, v2
    v_exp_f16 v34, v4
    v_mfma_f32_32x32x16_bf16 v[16:31], a[4:7], v[140:143], v[16:31]
    v_exp_f16 v35, v6
    exph 32, 1
    exph 33, 3
    v_mfma_f32_32x32x16_f16 v[112:127], a[24:27], v[40:43], v[112:127]
    exph 34, 5
    exph 35, 7
    v_exp_f16 v36, v8
    v_mfma_f32_32x32x16_f16 v[112:127], a[28:31], v[44:47], v[112:127]
    ds_read_b128 a[8:11], v225 offset:38912
    v_exp_f16 v37, v10
    v_exp_f16 v38, v12
    v_exp_f16 v39, v14
    v_smfmac_f32_16x16x64_f16 a[52:55], a[56:59], v[40:47], v244
    buffer_store_dwordx4 v[220:223], v225, s[64:67], s69 offen offset:3072 sc1
    exph 36, 9
    exph 37, 11
    exph 38, 13
    exph 39, 15
    v_mfma_f32_32x32x16_bf16 v[0:15], a[0:3], v[144:147], v[48:63]
    v_exp_f16 v40, v16
    v_exp_f16 v41, v18
    v_exp_f16 v42, v20
    v_mfma_f32_32x32x16_bf16 v[0:15], a[4:7], v[148:151], v[0:15]
    s_waitcnt lgkmcnt(2)
    v_exp_f16 v43, v22
    exph 40, 17
    exph 41, 19
    v_mfma_f32_32x32x16_f16 v[64:79], a[16:19], v[32:35], v[64:79]
    s_waitcnt lgkmcnt(1)
    exph 42, 21
    exph 43, 23
    v_exp_f16 v44, v24
    v_mfma_f32_32x32x16_f16 v[64:79], a[20:23], v[36:39], v[64:79]
    v_exp_f16 v45, v26
    v_exp_f16 v46, v28
    v_exp_f16 v47, v30
    v_smfmac_f32_16x16x64_f16 a[40:43], a[56:59], v[32:39], v244
    ds_read_b128 a[12:15], v225 offset:39936
    exph 44, 25
    exph 45, 27
    exph 46, 29
    exph 47, 31
    v_mfma_f32_32x32x16_bf16 v[16:31], a[0:3], v[152:155], v[48:63]
    v_exp_f16 v32, v0
    v_exp_f16 v33, v2
    v_exp_f16 v34, v4
    v_mfma_f32_32x32x16_bf16 v[16:31], a[4:7], v[156:159], v[16:31]
    v_exp_f16 v35, v6
    exph 32, 1
    exph 33, 3
    v_mfma_f32_32x32x16_f16 v[80:95], a[16:19], v[40:43], v[80:95]
    exph 34, 5
    exph 35, 7
    v_exp_f16 v36, v8
    v_mfma_f32_32x32x16_f16 v[80:95], a[20:23], v[44:47], v[80:95]
    v_exp_f16 v37, v10
    v_exp_f16 v38, v12
    v_exp_f16 v39, v14
    v_smfmac_f32_16x16x64_f16 a[44:47], a[56:59], v[40:47], v244
    s_waitcnt lgkmcnt(1)
    ds_read_b128 a[24:27], v225 offset:55296
    exph 36, 9
    exph 37, 11
    exph 38, 13
    exph 39, 15
    v_mfma_f32_32x32x16_bf16 v[0:15], a[8:11], v[128:131], v[48:63]
    s_waitcnt lgkmcnt(1)
    v_exp_f16 v40, v16
    v_exp_f16 v41, v18
    v_exp_f16 v42, v20
    v_mfma_f32_32x32x16_bf16 v[0:15], a[12:15], v[132:135], v[0:15]
    v_exp_f16 v43, v22
    exph 40, 17
    exph 41, 19
    v_mfma_f32_32x32x16_f16 v[96:111], a[16:19], v[32:35], v[96:111]
    exph 42, 21
    exph 43, 23
    v_exp_f16 v44, v24
    v_mfma_f32_32x32x16_f16 v[96:111], a[20:23], v[36:39], v[96:111]
    v_exp_f16 v45, v26
    v_exp_f16 v46, v28
    v_exp_f16 v47, v30
    v_smfmac_f32_16x16x64_f16 a[48:51], a[56:59], v[32:39], v244
    ds_read_b128 a[28:31], v225 offset:56320
    exph 44, 25
    exph 45, 27
    exph 46, 29
    exph 47, 31
    v_mfma_f32_32x32x16_bf16 v[16:31], a[8:11], v[136:139], v[48:63]
    v_exp_f16 v32, v0
    v_exp_f16 v33, v2
    v_exp_f16 v34, v4
    v_mfma_f32_32x32x16_bf16 v[16:31], a[12:15], v[140:143], v[16:31]
    v_exp_f16 v35, v6
    exph 32, 1
    exph 33, 3
    v_mfma_f32_32x32x16_f16 v[112:127], a[16:19], v[40:43], v[112:127]
    exph 34, 5
    exph 35, 7
    v_exp_f16 v36, v8
    v_mfma_f32_32x32x16_f16 v[112:127], a[20:23], v[44:47], v[112:127]
    v_exp_f16 v37, v10
    v_exp_f16 v38, v12
    v_exp_f16 v39, v14
    v_smfmac_f32_16x16x64_f16 a[52:55], a[56:59], v[40:47], v244
    ds_read_b128 a[0:3], v225 offset:40960
    exph 36, 9
    exph 37, 11
    exph 38, 13
    exph 39, 15
    v_mfma_f32_32x32x16_bf16 v[0:15], a[8:11], v[144:147], v[48:63]
    v_exp_f16 v40, v16
    v_exp_f16 v41, v18
    v_exp_f16 v42, v20
    v_mfma_f32_32x32x16_bf16 v[0:15], a[12:15], v[148:151], v[0:15]
    s_waitcnt lgkmcnt(2)
    v_exp_f16 v43, v22
    exph 40, 17
    exph 41, 19
    v_mfma_f32_32x32x16_f16 v[64:79], a[24:27], v[32:35], v[64:79]
    s_waitcnt lgkmcnt(1)
    exph 42, 21
    exph 43, 23
    v_exp_f16 v44, v24
    v_mfma_f32_32x32x16_f16 v[64:79], a[28:31], v[36:39], v[64:79]
    v_exp_f16 v45, v26
    v_exp_f16 v46, v28
    v_exp_f16 v47, v30
    v_smfmac_f32_16x16x64_f16 a[40:43], a[56:59], v[32:39], v244
    ds_read_b128 a[4:7], v225 offset:41984
    exph 44, 25
    exph 45, 27
    exph 46, 29
    exph 47, 31
    v_mfma_f32_32x32x16_bf16 v[16:31], a[8:11], v[152:155], v[48:63]
    v_exp_f16 v32, v0
    v_exp_f16 v33, v2
    v_exp_f16 v34, v4
    v_mfma_f32_32x32x16_bf16 v[16:31], a[12:15], v[156:159], v[16:31]
    v_exp_f16 v35, v6
    exph 32, 1
    exph 33, 3
    v_mfma_f32_32x32x16_f16 v[80:95], a[24:27], v[40:43], v[80:95]
    exph 34, 5
    exph 35, 7
    v_exp_f16 v36, v8
    v_mfma_f32_32x32x16_f16 v[80:95], a[28:31], v[44:47], v[80:95]
    v_exp_f16 v37, v10
    v_exp_f16 v38, v12
    v_exp_f16 v39, v14
    v_smfmac_f32_16x16x64_f16 a[44:47], a[56:59], v[40:47], v244
    s_waitcnt lgkmcnt(1)
    ds_read_b128 a[16:19], v225 offset:57344
    exph 36, 9
    exph 37, 11
    exph 38, 13
    exph 39, 15
    v_mfma_f32_32x32x16_bf16 v[0:15], a[0:3], v[128:131], v[48:63]
    s_waitcnt lgkmcnt(1)
    v_exp_f16 v40, v16
    v_exp_f16 v41, v18
    v_exp_f16 v42, v20
    v_mfma_f32_32x32x16_bf16 v[0:15], a[4:7], v[132:135], v[0:15]
    v_exp_f16 v43, v22
    exph 40, 17
    exph 41, 19
    v_mfma_f32_32x32x16_f16 v[96:111], a[24:27], v[32:35], v[96:111]
    exph 42, 21
    exph 43, 23
    v_exp_f16 v44, v24
    v_mfma_f32_32x32x16_f16 v[96:111], a[28:31], v[36:39], v[96:111]
    v_exp_f16 v45, v26
    v_exp_f16 v46, v28
    v_exp_f16 v47, v30
    v_smfmac_f32_16x16x64_f16 a[48:51], a[56:59], v[32:39], v244
    ds_read_b128 a[20:23], v225 offset:58368
    exph 44, 25
    exph 45, 27
    exph 46, 29
    exph 47, 31
    v_mfma_f32_32x32x16_bf16 v[16:31], a[0:3], v[136:139], v[48:63]
    v_exp_f16 v32, v0
    v_exp_f16 v33, v2
    v_exp_f16 v34, v4
    v_mfma_f32_32x32x16_bf16 v[16:31], a[4:7], v[140:143], v[16:31]
    v_exp_f16 v35, v6
    exph 32, 1
    exph 33, 3
    v_mfma_f32_32x32x16_f16 v[112:127], a[24:27], v[40:43], v[112:127]
    exph 34, 5
    exph 35, 7
    v_exp_f16 v36, v8
    v_mfma_f32_32x32x16_f16 v[112:127], a[28:31], v[44:47], v[112:127]
    v_exp_f16 v37, v10
    v_exp_f16 v38, v12
    v_exp_f16 v39, v14
    v_smfmac_f32_16x16x64_f16 a[52:55], a[56:59], v[40:47], v244
    ds_read_b128 a[8:11], v225 offset:43008
    exph 36, 9
    exph 37, 11
    exph 38, 13
    exph 39, 15
    v_mfma_f32_32x32x16_bf16 v[0:15], a[0:3], v[144:147], v[48:63]
    v_exp_f16 v40, v16
    v_exp_f16 v41, v18
    v_exp_f16 v42, v20
    v_mfma_f32_32x32x16_bf16 v[0:15], a[4:7], v[148:151], v[0:15]
    s_waitcnt lgkmcnt(2)
    v_exp_f16 v43, v22
    exph 40, 17
    exph 41, 19
    v_mfma_f32_32x32x16_f16 v[64:79], a[16:19], v[32:35], v[64:79]
    s_waitcnt lgkmcnt(1)
    exph 42, 21
    exph 43, 23
    v_exp_f16 v44, v24
    v_mfma_f32_32x32x16_f16 v[64:79], a[20:23], v[36:39], v[64:79]
L_pad5F:
    s_cbranch_vccnz L_t
    v_exp_f16 v45, v26
    v_exp_f16 v46, v28
    v_exp_f16 v47, v30
    v_smfmac_f32_16x16x64_f16 a[40:43], a[56:59], v[32:39], v244
    ds_read_b128 a[12:15], v225 offset:44032
    exph 44, 25
    exph 45, 27
    exph 46, 29
    exph 47, 31
    v_mfma_f32_32x32x16_bf16 v[16:31], a[0:3], v[152:155], v[48:63]
    v_exp_f16 v32, v0
    v_exp_f16 v33, v2
    v_exp_f16 v34, v4
    v_mfma_f32_32x32x16_bf16 v[16:31], a[4:7], v[156:159], v[16:31]
    v_exp_f16 v35, v6
    exph 32, 1
    exph 33, 3
    v_mfma_f32_32x32x16_f16 v[80:95], a[16:19], v[40:43], v[80:95]
    exph 34, 5
    exph 35, 7
    v_exp_f16 v36, v8
    v_mfma_f32_32x32x16_f16 v[80:95], a[20:23], v[44:47], v[80:95]
    v_exp_f16 v37, v10
    v_exp_f16 v38, v12
    v_exp_f16 v39, v14
    v_smfmac_f32_16x16x64_f16 a[44:47], a[56:59], v[40:47], v244
    s_waitcnt lgkmcnt(1)
    ds_read_b128 a[24:27], v225 offset:59392
    exph 36, 9
    exph 37, 11
    exph 38, 13
    exph 39, 15
    v_mfma_f32_32x32x16_bf16 v[0:15], a[8:11], v[128:131], v[48:63]
    s_waitcnt lgkmcnt(1)
    v_exp_f16 v40, v16
    v_exp_f16 v41, v18
    v_exp_f16 v42, v20
    v_mfma_f32_32x32x16_bf16 v[0:15], a[12:15], v[132:135], v[0:15]
    v_exp_f16 v43, v22
    exph 40, 17
    exph 41, 19
    v_mfma_f32_32x32x16_f16 v[96:111], a[16:19], v[32:35], v[96:111]
    exph 42, 21
    exph 43, 23
    v_exp_f16 v44, v24
    v_mfma_f32_32x32x16_f16 v[96:111], a[20:23], v[36:39], v[96:111]
    v_exp_f16 v45, v26
    v_exp_f16 v46, v28
    v_exp_f16 v47, v30
    v_smfmac_f32_16x16x64_f16 a[48:51], a[56:59], v[32:39], v244
    ds_read_b128 a[28:31], v225 offset:60416
    exph 44, 25
    exph 45, 27
    exph 46, 29
    exph 47, 31
    v_mfma_f32_32x32x16_bf16 v[16:31], a[8:11], v[136:139], v[48:63]
    v_exp_f16 v32, v0
    v_exp_f16 v33, v2
    v_exp_f16 v34, v4
    v_mfma_f32_32x32x16_bf16 v[16:31], a[12:15], v[140:143], v[16:31]
    v_exp_f16 v35, v6
    exph 32, 1
    exph 33, 3
    v_mfma_f32_32x32x16_f16 v[112:127], a[16:19], v[40:43], v[112:127]
    exph 34, 5
    exph 35, 7
    v_exp_f16 v36, v8
    v_mfma_f32_32x32x16_f16 v[112:127], a[20:23], v[44:47], v[112:127]
    v_exp_f16 v37, v10
    v_exp_f16 v38, v12
    v_exp_f16 v39, v14
    v_smfmac_f32_16x16x64_f16 a[52:55], a[56:59], v[40:47], v244
    ds_read_b128 a[0:3], v225 offset:45056
    exph 36, 9
    exph 37, 11
    exph 38, 13
    exph 39, 15
    v_mfma_f32_32x32x16_bf16 v[0:15], a[8:11], v[144:147], v[48:63]
    v_exp_f16 v40, v16
    v_exp_f16 v41, v18
    v_exp_f16 v42, v20
    v_mfma_f32_32x32x16_bf16 v[0:15], a[12:15], v[148:151], v[0:15]
    s_waitcnt lgkmcnt(2)
    v_exp_f16 v43, v22
    exph 40, 17
    exph 41, 19
    v_mfma_f32_32x32x16_f16 v[64:79], a[24:27], v[32:35], v[64:79]
    s_waitcnt lgkmcnt(1)
    exph 42, 21
    exph 43, 23
    v_exp_f16 v44, v24
    v_mfma_f32_32x32x16_f16 v[64:79], a[28:31], v[36:39], v[64:79]
    v_exp_f16 v45, v26
    v_exp_f16 v46, v28
    v_exp_f16 v47, v30
    v_smfmac_f32_16x16x64_f16 a[40:43], a[56:59], v[32:39], v244
    ds_read_b128 a[4:7], v225 offset:46080
    exph 44, 25
    exph 45, 27
    exph 46, 29
    exph 47, 31
    v_mfma_f32_32x32x16_bf16 v[16:31], a[8:11], v[152:155], v[48:63]
    v_exp_f16 v32, v0
    v_exp_f16 v33, v2
    v_exp_f16 v34, v4
    v_not_b32 v248, v233
    v_mfma_f32_32x32x16_bf16 v[16:31], a[12:15], v[156:159], v[16:31]
    v_exp_f16 v35, v6
    exph 32, 1
    exph 33, 3
    v_mfma_f32_32x32x16_f16 v[80:95], a[24:27], v[40:43], v[80:95]
    exph 34, 5
    exph 35, 7
    v_exp_f16 v36, v8
    v_mfma_f32_32x32x16_f16 v[80:95], a[28:31], v[44:47], v[80:95]
    v_exp_f16 v37, v10
    v_exp_f16 v38, v12
    v_exp_f16 v39, v14
    v_smfmac_f32_16x16x64_f16 a[44:47], a[56:59], v[40:47], v244
    s_waitcnt lgkmcnt(1)
    ds_read_b128 a[16:19], v225 offset:61440
    exph 36, 9
    exph 37, 11
    exph 38, 13
    exph 39, 15
    v_mfma_f32_32x32x16_bf16 v[0:15], a[0:3], v[128:131], v[48:63]
    s_waitcnt vmcnt(0)
    buffer_store_dword v248, v228, s[52:55], 0 offen offset:4 sc1
    v_exp_f16 v40, v16
    v_exp_f16 v41, v18
    v_exp_f16 v42, v20
    s_waitcnt lgkmcnt(1)
    v_mfma_f32_32x32x16_bf16 v[0:15], a[4:7], v[132:135], v[0:15]
    v_exp_f16 v43, v22
    exph 40, 17
    exph 41, 19
    v_mfma_f32_32x32x16_f16 v[96:111], a[24:27], v[32:35], v[96:111]
    exph 42, 21
    exph 43, 23
    v_exp_f16 v44, v24
    v_mfma_f32_32x32x16_f16 v[96:111], a[28:31], v[36:39], v[96:111]
    v_exp_f16 v45, v26
    v_exp_f16 v46, v28
    v_exp_f16 v47, v30
    v_smfmac_f32_16x16x64_f16 a[48:51], a[56:59], v[32:39], v244
    ds_read_b128 a[20:23], v225 offset:62464
    exph 44, 25
    exph 45, 27
    exph 46, 29
    exph 47, 31
    v_mfma_f32_32x32x16_bf16 v[16:31], a[0:3], v[136:139], v[48:63]
    v_exp_f16 v32, v0
    v_exp_f16 v33, v2
    v_exp_f16 v34, v4
    v_mfma_f32_32x32x16_bf16 v[16:31], a[4:7], v[140:143], v[16:31]
    v_exp_f16 v35, v6
    exph 32, 1
    exph 33, 3
    v_mfma_f32_32x32x16_f16 v[112:127], a[24:27], v[40:43], v[112:127]
    s_waitcnt lgkmcnt(0)
    exph 34, 5
    exph 35, 7
    v_exp_f16 v36, v8
    v_mfma_f32_32x32x16_f16 v[112:127], a[28:31], v[44:47], v[112:127]
    s_barrier
    v_exp_f16 v37, v10
    v_exp_f16 v38, v12
    v_exp_f16 v39, v14
    v_smfmac_f32_16x16x64_f16 a[52:55], a[56:59], v[40:47], v244
    ds_read_b128 a[8:11], v225 offset:0
    exph 36, 9
    exph 37, 11
    exph 38, 13
    exph 39, 15
    v_mfma_f32_32x32x16_bf16 v[0:15], a[0:3], v[144:147], v[48:63]
    v_exp_f16 v40, v16
    v_exp_f16 v41, v18
    v_exp_f16 v42, v20
    v_mfma_f32_32x32x16_bf16 v[0:15], a[4:7], v[148:151], v[0:15]
    v_exp_f16 v43, v22
    exph 40, 17
    exph 41, 19
    v_mfma_f32_32x32x16_f16 v[64:79], a[16:19], v[32:35], v[64:79]
    exph 42, 21
    exph 43, 23
    v_exp_f16 v44, v24
    v_mfma_f32_32x32x16_f16 v[64:79], a[20:23], v[36:39], v[64:79]
    s_mov_b32 m0, s61
    v_exp_f16 v45, v26
    v_exp_f16 v46, v28
    v_exp_f16 v47, v30
    v_smfmac_f32_16x16x64_f16 a[40:43], a[56:59], v[32:39], v244
    ds_read_b128 a[12:15], v225 offset:1024
    exph 44, 25
    exph 45, 27
    exph 46, 29
    exph 47, 31
    v_mfma_f32_32x32x16_bf16 v[16:31], a[0:3], v[152:155], v[48:63]
    buffer_load_dwordx4 v225, s[48:51], s46 offen offset:0 sc1 lds
    v_exp_f16 v32, v0
    v_exp_f16 v33, v2
    v_exp_f16 v34, v4
    v_mfma_f32_32x32x16_bf16 v[16:31], a[4:7], v[156:159], v[16:31]
    buffer_load_dwordx4 v225, s[48:51], s46 offen offset:1024 sc1 lds
    v_exp_f16 v35, v6
    exph 32, 1
    exph 33, 3
    v_mfma_f32_32x32x16_f16 v[80:95], a[16:19], v[40:43], v[80:95]
    buffer_load_dwordx4 v225, s[48:51], s14 offen offset:2048 sc1 lds
    exph 34, 5
    exph 35, 7
    v_exp_f16 v36, v8
    v_mfma_f32_32x32x16_f16 v[80:95], a[20:23], v[44:47], v[80:95]
    buffer_load_dwordx4 v225, s[48:51], s14 offen offset:3072 sc1 lds
    v_exp_f16 v37, v10
    v_exp_f16 v38, v12
    v_exp_f16 v39, v14
    v_smfmac_f32_16x16x64_f16 a[44:47], a[56:59], v[40:47], v244
    s_waitcnt lgkmcnt(1)
    ds_read_b128 a[24:27], v225 offset:16384
    exph 36, 9
    exph 37, 11
    exph 38, 13
    exph 39, 15
    v_mfma_f32_32x32x16_bf16 v[0:15], a[8:11], v[128:131], v[48:63]
    s_waitcnt lgkmcnt(1)
    v_exp_f16 v40, v16
    v_exp_f16 v41, v18
    v_exp_f16 v42, v20
    v_mfma_f32_32x32x16_bf16 v[0:15], a[12:15], v[132:135], v[0:15]
    v_exp_f16 v43, v22
    exph 40, 17
    exph 41, 19
    v_mfma_f32_32x32x16_f16 v[96:111], a[16:19], v[32:35], v[96:111]
    exph 42, 21
    exph 43, 23
    v_exp_f16 v44, v24
    v_mfma_f32_32x32x16_f16 v[96:111], a[20:23], v[36:39], v[96:111]
    s_mov_b32 m0, s57
    v_exp_f16 v45, v26
    v_exp_f16 v46, v28
    v_exp_f16 v47, v30
    v_smfmac_f32_16x16x64_f16 a[48:51], a[56:59], v[32:39], v244
    ds_read_b128 a[28:31], v225 offset:17408
    exph 44, 25
    exph 45, 27
    exph 46, 29
    exph 47, 31
    v_mfma_f32_32x32x16_bf16 v[16:31], a[8:11], v[136:139], v[48:63]
    buffer_load_dwordx4 v225, s[64:67], s46 offen offset:0 sc1 lds
    v_exp_f16 v32, v0
    v_exp_f16 v33, v2
    v_exp_f16 v34, v4
    v_mfma_f32_32x32x16_bf16 v[16:31], a[12:15], v[140:143], v[16:31]
    buffer_load_dwordx4 v225, s[64:67], s46 offen offset:1024 sc1 lds
    v_exp_f16 v35, v6
    exph 32, 1
    exph 33, 3
    v_mfma_f32_32x32x16_f16 v[112:127], a[16:19], v[40:43], v[112:127]
    buffer_load_dwordx4 v225, s[64:67], s14 offen offset:2048 sc1 lds
    exph 34, 5
    exph 35, 7
    v_exp_f16 v36, v8
    v_mfma_f32_32x32x16_f16 v[112:127], a[20:23], v[44:47], v[112:127]
    buffer_load_dwordx4 v225, s[64:67], s14 offen offset:3072 sc1 lds
    v_exp_f16 v37, v10
    v_exp_f16 v38, v12
    v_exp_f16 v39, v14
    v_smfmac_f32_16x16x64_f16 a[52:55], a[56:59], v[40:47], v244
    ds_read_b128 a[0:3], v225 offset:2048
    exph 36, 9
    exph 37, 11
    exph 38, 13
    exph 39, 15
    v_mfma_f32_32x32x16_bf16 v[0:15], a[8:11], v[144:147], v[48:63]
    s_add_u32 s45, s45, 5
    v_exp_f16 v40, v16
    v_exp_f16 v41, v18
    v_exp_f16 v42, v20
    v_mfma_f32_32x32x16_bf16 v[0:15], a[12:15], v[148:151], v[0:15]
    s_waitcnt lgkmcnt(2)
    v_exp_f16 v43, v22
    exph 40, 17
    exph 41, 19
    v_mfma_f32_32x32x16_f16 v[64:79], a[24:27], v[32:35], v[64:79]
    s_waitcnt lgkmcnt(1)
    exph 42, 21
    exph 43, 23
    v_exp_f16 v44, v24
    v_mfma_f32_32x32x16_f16 v[64:79], a[28:31], v[36:39], v[64:79]
    v_exp_f16 v45, v26
    v_exp_f16 v46, v28
    v_exp_f16 v47, v30
    v_smfmac_f32_16x16x64_f16 a[40:43], a[56:59], v[32:39], v244
    ds_read_b128 a[4:7], v225 offset:3072
    exph 44, 25
    exph 45, 27
    exph 46, 29
    exph 47, 31
    v_mfma_f32_32x32x16_bf16 v[16:31], a[8:11], v[152:155], v[48:63]
    s_and_b32 s45, s45, 7
    v_exp_f16 v32, v0
    v_exp_f16 v33, v2
    v_exp_f16 v34, v4
    v_mfma_f32_32x32x16_bf16 v[16:31], a[12:15], v[156:159], v[16:31]
    s_lshl_b32 s46, s45, 14
    v_exp_f16 v35, v6
    exph 32, 1
    exph 33, 3
    v_mfma_f32_32x32x16_f16 v[80:95], a[24:27], v[40:43], v[80:95]
    s_add_u32 s46, s46, s44
    exph 34, 5
    exph 35, 7
    v_exp_f16 v36, v8
    v_mfma_f32_32x32x16_f16 v[80:95], a[28:31], v[44:47], v[80:95]
    v_exp_f16 v37, v10
    v_exp_f16 v38, v12
    v_exp_f16 v39, v14
    v_smfmac_f32_16x16x64_f16 a[44:47], a[56:59], v[40:47], v244
    s_waitcnt lgkmcnt(1)
    ds_read_b128 a[16:19], v225 offset:18432
    exph 36, 9
    exph 37, 11
    exph 38, 13
    exph 39, 15
    v_mfma_f32_32x32x16_bf16 v[0:15], a[0:3], v[128:131], v[48:63]
    s_waitcnt lgkmcnt(1)
    v_exp_f16 v40, v16
    v_exp_f16 v41, v18
    v_exp_f16 v42, v20
    v_mfma_f32_32x32x16_bf16 v[0:15], a[4:7], v[132:135], v[0:15]
    s_add_u32 s14, s46, s41
    v_exp_f16 v43, v22
    exph 40, 17
    exph 41, 19
    v_mfma_f32_32x32x16_f16 v[96:111], a[24:27], v[32:35], v[96:111]
    exph 42, 21
    exph 43, 23
    v_exp_f16 v44, v24
    v_mfma_f32_32x32x16_f16 v[96:111], a[28:31], v[36:39], v[96:111]
    v_exp_f16 v45, v26
    v_exp_f16 v46, v28
    v_exp_f16 v47, v30
    v_smfmac_f32_16x16x64_f16 a[48:51], a[56:59], v[32:39], v244
    ds_read_b128 a[20:23], v225 offset:19456
    exph 44, 25
    exph 45, 27
    exph 46, 29
    exph 47, 31
    v_mfma_f32_32x32x16_bf16 v[16:31], a[0:3], v[136:139], v[48:63]
    v_exp_f16 v32, v0
    v_exp_f16 v33, v2
    v_exp_f16 v34, v4
    v_mfma_f32_32x32x16_bf16 v[16:31], a[4:7], v[140:143], v[16:31]
    v_exp_f16 v35, v6
    exph 32, 1
    exph 33, 3
    v_mfma_f32_32x32x16_f16 v[112:127], a[24:27], v[40:43], v[112:127]
    exph 34, 5
    exph 35, 7
    v_exp_f16 v36, v8
    v_mfma_f32_32x32x16_f16 v[112:127], a[28:31], v[44:47], v[112:127]
    v_exp_f16 v37, v10
    v_exp_f16 v38, v12
    v_exp_f16 v39, v14
    v_smfmac_f32_16x16x64_f16 a[52:55], a[56:59], v[40:47], v244
    ds_read_b128 a[8:11], v225 offset:4096
    exph 36, 9
    exph 37, 11
    exph 38, 13
    exph 39, 15
    v_mfma_f32_32x32x16_bf16 v[0:15], a[0:3], v[144:147], v[48:63]
    v_exp_f16 v40, v16
    v_exp_f16 v41, v18
    v_exp_f16 v42, v20
    v_mfma_f32_32x32x16_bf16 v[0:15], a[4:7], v[148:151], v[0:15]
    s_waitcnt lgkmcnt(2)
    v_exp_f16 v43, v22
    exph 40, 17
    exph 41, 19
    v_mfma_f32_32x32x16_f16 v[64:79], a[16:19], v[32:35], v[64:79]
    s_waitcnt lgkmcnt(1)
    exph 42, 21
    exph 43, 23
    v_exp_f16 v44, v24
    v_mfma_f32_32x32x16_f16 v[64:79], a[20:23], v[36:39], v[64:79]
    v_exp_f16 v45, v26
    v_exp_f16 v46, v28
    v_exp_f16 v47, v30
    v_smfmac_f32_16x16x64_f16 a[40:43], a[56:59], v[32:39], v244
    ds_read_b128 a[12:15], v225 offset:5120
    exph 44, 25
    exph 45, 27
    exph 46, 29
    exph 47, 31
    v_mfma_f32_32x32x16_bf16 v[16:31], a[0:3], v[152:155], v[48:63]
    v_exp_f16 v32, v0
    v_exp_f16 v33, v2
    v_exp_f16 v34, v4
    v_mfma_f32_32x32x16_bf16 v[16:31], a[4:7], v[156:159], v[16:31]
    v_exp_f16 v35, v6
    exph 32, 1
    exph 33, 3
    v_mfma_f32_32x32x16_f16 v[80:95], a[16:19], v[40:43], v[80:95]
    exph 34, 5
    exph 35, 7
    v_exp_f16 v36, v8
    v_mfma_f32_32x32x16_f16 v[80:95], a[20:23], v[44:47], v[80:95]
    v_exp_f16 v37, v10
    v_exp_f16 v38, v12
    v_exp_f16 v39, v14
    v_smfmac_f32_16x16x64_f16 a[44:47], a[56:59], v[40:47], v244
    s_waitcnt lgkmcnt(1)
    ds_read_b128 a[24:27], v225 offset:20480
    exph 36, 9
    exph 37, 11
    exph 38, 13
    exph 39, 15
    v_mfma_f32_32x32x16_bf16 v[0:15], a[8:11], v[128:131], v[48:63]
    s_waitcnt lgkmcnt(1)
    v_exp_f16 v40, v16
    v_exp_f16 v41, v18
    v_exp_f16 v42, v20
    v_mfma_f32_32x32x16_bf16 v[0:15], a[12:15], v[132:135], v[0:15]
    v_exp_f16 v43, v22
    exph 40, 17
    exph 41, 19
    v_mfma_f32_32x32x16_f16 v[96:111], a[16:19], v[32:35], v[96:111]
    exph 42, 21
    exph 43, 23
    v_exp_f16 v44, v24
    v_mfma_f32_32x32x16_f16 v[96:111], a[20:23], v[36:39], v[96:111]
    v_exp_f16 v45, v26
    v_exp_f16 v46, v28
    v_exp_f16 v47, v30
    v_smfmac_f32_16x16x64_f16 a[48:51], a[56:59], v[32:39], v244
    ds_read_b128 a[28:31], v225 offset:21504
    exph 44, 25
    exph 45, 27
    exph 46, 29
    exph 47, 31
    v_mfma_f32_32x32x16_bf16 v[16:31], a[8:11], v[136:139], v[48:63]
    v_exp_f16 v32, v0
    v_exp_f16 v33, v2
    v_exp_f16 v34, v4
    v_mfma_f32_32x32x16_bf16 v[16:31], a[12:15], v[140:143], v[16:31]
    v_exp_f16 v35, v6
    exph 32, 1
    exph 33, 3
    v_mfma_f32_32x32x16_f16 v[112:127], a[16:19], v[40:43], v[112:127]
    exph 34, 5
    exph 35, 7
    v_exp_f16 v36, v8
    v_mfma_f32_32x32x16_f16 v[112:127], a[20:23], v[44:47], v[112:127]
    v_exp_f16 v37, v10
    v_exp_f16 v38, v12
    v_exp_f16 v39, v14
    v_smfmac_f32_16x16x64_f16 a[52:55], a[56:59], v[40:47], v244
    ds_read_b128 a[0:3], v225 offset:6144
    exph 36, 9
    exph 37, 11
    exph 38, 13
    exph 39, 15
    v_mfma_f32_32x32x16_bf16 v[0:15], a[8:11], v[144:147], v[48:63]
    v_exp_f16 v40, v16
    v_exp_f16 v41, v18
    v_exp_f16 v42, v20
    v_mfma_f32_32x32x16_bf16 v[0:15], a[12:15], v[148:151], v[0:15]
    s_waitcnt lgkmcnt(2)
    v_exp_f16 v43, v22
    exph 40, 17
    exph 41, 19
    v_mfma_f32_32x32x16_f16 v[64:79], a[24:27], v[32:35], v[64:79]
    s_waitcnt lgkmcnt(1)
    exph 42, 21
    exph 43, 23
    v_exp_f16 v44, v24
    v_mfma_f32_32x32x16_f16 v[64:79], a[28:31], v[36:39], v[64:79]
    v_exp_f16 v45, v26
    v_exp_f16 v46, v28
    v_exp_f16 v47, v30
    v_smfmac_f32_16x16x64_f16 a[40:43], a[56:59], v[32:39], v244
    ds_read_b128 a[4:7], v225 offset:7168
    exph 44, 25
    exph 45, 27
    exph 46, 29
    exph 47, 31
    v_mfma_f32_32x32x16_bf16 v[16:31], a[8:11], v[152:155], v[48:63]
    v_exp_f16 v32, v0
    v_exp_f16 v33, v2
    v_exp_f16 v34, v4
    v_mfma_f32_32x32x16_bf16 v[16:31], a[12:15], v[156:159], v[16:31]
    v_exp_f16 v35, v6
    exph 32, 1
    exph 33, 3
    v_mfma_f32_32x32x16_f16 v[80:95], a[24:27], v[40:43], v[80:95]
    exph 34, 5
    exph 35, 7
    v_exp_f16 v36, v8
    v_mfma_f32_32x32x16_f16 v[80:95], a[28:31], v[44:47], v[80:95]
    v_exp_f16 v37, v10
    v_exp_f16 v38, v12
    v_exp_f16 v39, v14
    v_smfmac_f32_16x16x64_f16 a[44:47], a[56:59], v[40:47], v244
    s_waitcnt lgkmcnt(1)
    ds_read_b128 a[16:19], v225 offset:22528
    exph 36, 9
    exph 37, 11
    exph 38, 13
    exph 39, 15
    v_mfma_f32_32x32x16_bf16 v[0:15], a[0:3], v[128:131], v[48:63]
    s_waitcnt lgkmcnt(1)
    v_exp_f16 v40, v16
    v_exp_f16 v41, v18
    v_exp_f16 v42, v20
    v_mfma_f32_32x32x16_bf16 v[0:15], a[4:7], v[132:135], v[0:15]
    v_exp_f16 v43, v22
    exph 40, 17
    exph 41, 19
    v_mfma_f32_32x32x16_f16 v[96:111], a[24:27], v[32:35], v[96:111]
    exph 42, 21
    exph 43, 23
    v_exp_f16 v44, v24
    v_mfma_f32_32x32x16_f16 v[96:111], a[28:31], v[36:39], v[96:111]
    v_exp_f16 v45, v26
    v_exp_f16 v46, v28
    v_exp_f16 v47, v30
    v_smfmac_f32_16x16x64_f16 a[48:51], a[56:59], v[32:39], v244
    ds_read_b128 a[20:23], v225 offset:23552
    exph 44, 25
    exph 45, 27
    exph 46, 29
    exph 47, 31
    v_mfma_f32_32x32x16_bf16 v[16:31], a[0:3], v[136:139], v[48:63]
    v_exp_f16 v32, v0
    v_exp_f16 v33, v2
    v_exp_f16 v34, v4
    v_mfma_f32_32x32x16_bf16 v[16:31], a[4:7], v[140:143], v[16:31]
    v_exp_f16 v35, v6
    exph 32, 1
    exph 33, 3
    v_mfma_f32_32x32x16_f16 v[112:127], a[24:27], v[40:43], v[112:127]
    exph 34, 5
    exph 35, 7
    v_exp_f16 v36, v8
    v_mfma_f32_32x32x16_f16 v[112:127], a[28:31], v[44:47], v[112:127]
    v_exp_f16 v37, v10
    v_exp_f16 v38, v12
    v_exp_f16 v39, v14
    v_smfmac_f32_16x16x64_f16 a[52:55], a[56:59], v[40:47], v244
    ds_read_b128 a[8:11], v225 offset:8192
    exph 36, 9
    exph 37, 11
    exph 38, 13
    exph 39, 15
    v_mfma_f32_32x32x16_bf16 v[0:15], a[0:3], v[144:147], v[48:63]
    v_exp_f16 v40, v16
    v_exp_f16 v41, v18
    v_exp_f16 v42, v20
    v_mfma_f32_32x32x16_bf16 v[0:15], a[4:7], v[148:151], v[0:15]
    s_waitcnt lgkmcnt(2)
    v_exp_f16 v43, v22
    exph 40, 17
    exph 41, 19
    v_mfma_f32_32x32x16_f16 v[64:79], a[16:19], v[32:35], v[64:79]
    s_waitcnt lgkmcnt(1)
    exph 42, 21
    exph 43, 23
    v_exp_f16 v44, v24
    v_mfma_f32_32x32x16_f16 v[64:79], a[20:23], v[36:39], v[64:79]
    v_exp_f16 v45, v26
    v_exp_f16 v46, v28
    v_exp_f16 v47, v30
    v_smfmac_f32_16x16x64_f16 a[40:43], a[56:59], v[32:39], v244
    ds_read_b128 a[12:15], v225 offset:9216
    exph 44, 25
    exph 45, 27
    exph 46, 29
    exph 47, 31
    v_mfma_f32_32x32x16_bf16 v[16:31], a[0:3], v[152:155], v[48:63]
    v_exp_f16 v32, v0
    v_exp_f16 v33, v2
    v_exp_f16 v34, v4
    v_mfma_f32_32x32x16_bf16 v[16:31], a[4:7], v[156:159], v[16:31]
    v_exp_f16 v35, v6
    exph 32, 1
    exph 33, 3
    v_mfma_f32_32x32x16_f16 v[80:95], a[16:19], v[40:43], v[80:95]
    exph 34, 5
    exph 35, 7
    v_exp_f16 v36, v8
    v_mfma_f32_32x32x16_f16 v[80:95], a[20:23], v[44:47], v[80:95]
    v_exp_f16 v37, v10
    v_exp_f16 v38, v12
    v_exp_f16 v39, v14
    v_smfmac_f32_16x16x64_f16 a[44:47], a[56:59], v[40:47], v244
    s_waitcnt lgkmcnt(1)
    ds_read_b128 a[24:27], v225 offset:24576
    exph 36, 9
    exph 37, 11
    exph 38, 13
    exph 39, 15
    v_mfma_f32_32x32x16_bf16 v[0:15], a[8:11], v[128:131], v[48:63]
    s_waitcnt lgkmcnt(1)
    v_exp_f16 v40, v16
    v_exp_f16 v41, v18
    v_exp_f16 v42, v20
    v_mfma_f32_32x32x16_bf16 v[0:15], a[12:15], v[132:135], v[0:15]
    v_exp_f16 v43, v22
    exph 40, 17
    exph 41, 19
    v_mfma_f32_32x32x16_f16 v[96:111], a[16:19], v[32:35], v[96:111]
    exph 42, 21
    exph 43, 23
    v_exp_f16 v44, v24
    v_mfma_f32_32x32x16_f16 v[96:111], a[20:23], v[36:39], v[96:111]
    v_exp_f16 v45, v26
    v_exp_f16 v46, v28
    v_exp_f16 v47, v30
    v_smfmac_f32_16x16x64_f16 a[48:51], a[56:59], v[32:39], v244
    ds_read_b128 a[28:31], v225 offset:25600
    exph 44, 25
    exph 45, 27
    exph 46, 29
    exph 47, 31
    v_mfma_f32_32x32x16_bf16 v[16:31], a[8:11], v[136:139], v[48:63]
    v_exp_f16 v32, v0
    v_exp_f16 v33, v2
    v_exp_f16 v34, v4
    v_mfma_f32_32x32x16_bf16 v[16:31], a[12:15], v[140:143], v[16:31]
    v_exp_f16 v35, v6
    exph 32, 1
    exph 33, 3
    v_mfma_f32_32x32x16_f16 v[112:127], a[16:19], v[40:43], v[112:127]
    exph 34, 5
    exph 35, 7
    v_exp_f16 v36, v8
    v_mfma_f32_32x32x16_f16 v[112:127], a[20:23], v[44:47], v[112:127]
L_pad6F:
    s_cbranch_vccnz L_t
    v_exp_f16 v37, v10
    v_exp_f16 v38, v12
    v_exp_f16 v39, v14
    v_smfmac_f32_16x16x64_f16 a[52:55], a[56:59], v[40:47], v244
    ds_read_b128 a[0:3], v225 offset:10240
    exph 36, 9
    exph 37, 11
    exph 38, 13
    exph 39, 15
    v_mfma_f32_32x32x16_bf16 v[0:15], a[8:11], v[144:147], v[48:63]
    v_exp_f16 v40, v16
    v_exp_f16 v41, v18
    v_exp_f16 v42, v20
    v_mfma_f32_32x32x16_bf16 v[0:15], a[12:15], v[148:151], v[0:15]
    s_waitcnt lgkmcnt(2)
    v_exp_f16 v43, v22
    exph 40, 17
    exph 41, 19
    v_mfma_f32_32x32x16_f16 v[64:79], a[24:27], v[32:35], v[64:79]
    s_waitcnt lgkmcnt(1)
    exph 42, 21
    exph 43, 23
    v_exp_f16 v44, v24
    v_mfma_f32_32x32x16_f16 v[64:79], a[28:31], v[36:39], v[64:79]
    v_exp_f16 v45, v26
    v_exp_f16 v46, v28
    v_exp_f16 v47, v30
    v_smfmac_f32_16x16x64_f16 a[40:43], a[56:59], v[32:39], v244
    ds_read_b128 a[4:7], v225 offset:11264
    exph 44, 25
    exph 45, 27
    exph 46, 29
    exph 47, 31
    v_mfma_f32_32x32x16_bf16 v[16:31], a[8:11], v[152:155], v[48:63]
    v_exp_f16 v32, v0
    v_exp_f16 v33, v2
    v_exp_f16 v34, v4
    v_mfma_f32_32x32x16_bf16 v[16:31], a[12:15], v[156:159], v[16:31]
    v_exp_f16 v35, v6
    exph 32, 1
    exph 33, 3
    v_mfma_f32_32x32x16_f16 v[80:95], a[24:27], v[40:43], v[80:95]
    exph 34, 5
    exph 35, 7
    v_exp_f16 v36, v8
    v_mfma_f32_32x32x16_f16 v[80:95], a[28:31], v[44:47], v[80:95]
    v_exp_f16 v37, v10
    v_exp_f16 v38, v12
    v_exp_f16 v39, v14
    v_smfmac_f32_16x16x64_f16 a[44:47], a[56:59], v[40:47], v244
    s_waitcnt lgkmcnt(1)
    ds_read_b128 a[16:19], v225 offset:26624
    exph 36, 9
    exph 37, 11
    exph 38, 13
    exph 39, 15
    v_mfma_f32_32x32x16_bf16 v[0:15], a[0:3], v[128:131], v[48:63]
    s_waitcnt lgkmcnt(1)
    v_exp_f16 v40, v16
    v_exp_f16 v41, v18
    v_exp_f16 v42, v20
    v_mfma_f32_32x32x16_bf16 v[0:15], a[4:7], v[132:135], v[0:15]
    v_exp_f16 v43, v22
    exph 40, 17
    exph 41, 19
    v_mfma_f32_32x32x16_f16 v[96:111], a[24:27], v[32:35], v[96:111]
    exph 42, 21
    exph 43, 23
    v_exp_f16 v44, v24
    v_mfma_f32_32x32x16_f16 v[96:111], a[28:31], v[36:39], v[96:111]
    v_exp_f16 v45, v26
    v_exp_f16 v46, v28
    v_exp_f16 v47, v30
    v_smfmac_f32_16x16x64_f16 a[48:51], a[56:59], v[32:39], v244
    ds_read_b128 a[20:23], v225 offset:27648
    exph 44, 25
    exph 45, 27
    exph 46, 29
    exph 47, 31
    v_mfma_f32_32x32x16_bf16 v[16:31], a[0:3], v[136:139], v[48:63]
    buffer_load_dword v239, v225, s[52:55], 0 offen offset:4 sc1
    v_exp_f16 v32, v0
    v_exp_f16 v33, v2
    v_exp_f16 v34, v4
    v_mfma_f32_32x32x16_bf16 v[16:31], a[4:7], v[140:143], v[16:31]
    v_exp_f16 v35, v6
    exph 32, 1
    exph 33, 3
    v_mfma_f32_32x32x16_f16 v[112:127], a[24:27], v[40:43], v[112:127]
    exph 34, 5
    exph 35, 7
    v_exp_f16 v36, v8
    v_mfma_f32_32x32x16_f16 v[112:127], a[28:31], v[44:47], v[112:127]
    v_exp_f16 v37, v10
    v_exp_f16 v38, v12
    v_exp_f16 v39, v14
    v_smfmac_f32_16x16x64_f16 a[52:55], a[56:59], v[40:47], v244
    ds_read_b128 a[8:11], v225 offset:12288
    exph 36, 9
    exph 37, 11
    exph 38, 13
    exph 39, 15
    v_mfma_f32_32x32x16_bf16 v[0:15], a[0:3], v[144:147], v[48:63]
    v_exp_f16 v40, v16
    v_exp_f16 v41, v18
    v_exp_f16 v42, v20
    v_mfma_f32_32x32x16_bf16 v[0:15], a[4:7], v[148:151], v[0:15]
    s_waitcnt lgkmcnt(2)
    v_exp_f16 v43, v22
    exph 40, 17
    exph 41, 19
    v_mfma_f32_32x32x16_f16 v[64:79], a[16:19], v[32:35], v[64:79]
    s_waitcnt lgkmcnt(1)
    exph 42, 21
    exph 43, 23
    v_exp_f16 v44, v24
    v_mfma_f32_32x32x16_f16 v[64:79], a[20:23], v[36:39], v[64:79]
    v_exp_f16 v45, v26
    v_exp_f16 v46, v28
    v_exp_f16 v47, v30
    v_smfmac_f32_16x16x64_f16 a[40:43], a[56:59], v[32:39], v244
    ds_read_b128 a[12:15], v225 offset:13312
    exph 44, 25
    exph 45, 27
    exph 46, 29
    exph 47, 31
    v_mfma_f32_32x32x16_bf16 v[16:31], a[0:3], v[152:155], v[48:63]
    v_exp_f16 v32, v0
    v_exp_f16 v33, v2
    v_exp_f16 v34, v4
    v_mfma_f32_32x32x16_bf16 v[16:31], a[4:7], v[156:159], v[16:31]
    v_exp_f16 v35, v6
    exph 32, 1
    exph 33, 3
    v_mfma_f32_32x32x16_f16 v[80:95], a[16:19], v[40:43], v[80:95]
    exph 34, 5
    exph 35, 7
    v_exp_f16 v36, v8
    v_mfma_f32_32x32x16_f16 v[80:95], a[20:23], v[44:47], v[80:95]
    v_exp_f16 v37, v10
    v_exp_f16 v38, v12
    v_exp_f16 v39, v14
    v_smfmac_f32_16x16x64_f16 a[44:47], a[56:59], v[40:47], v244
    s_waitcnt lgkmcnt(1)
    ds_read_b128 a[24:27], v225 offset:28672
    exph 36, 9
    exph 37, 11
    exph 38, 13
    exph 39, 15
    v_mfma_f32_32x32x16_bf16 v[0:15], a[8:11], v[128:131], v[48:63]
    s_waitcnt lgkmcnt(1)
    v_exp_f16 v40, v16
    v_exp_f16 v41, v18
    v_exp_f16 v42, v20
    v_mfma_f32_32x32x16_bf16 v[0:15], a[12:15], v[132:135], v[0:15]
    v_exp_f16 v43, v22
    exph 40, 17
    exph 41, 19
    v_mfma_f32_32x32x16_f16 v[96:111], a[16:19], v[32:35], v[96:111]
    exph 42, 21
    exph 43, 23
    v_exp_f16 v44, v24
    v_mfma_f32_32x32x16_f16 v[96:111], a[20:23], v[36:39], v[96:111]
    v_exp_f16 v45, v26
    v_exp_f16 v46, v28
    v_exp_f16 v47, v30
    v_smfmac_f32_16x16x64_f16 a[48:51], a[56:59], v[32:39], v244
    ds_read_b128 a[28:31], v225 offset:29696
    exph 44, 25
    exph 45, 27
    exph 46, 29
    exph 47, 31
    v_mfma_f32_32x32x16_bf16 v[16:31], a[8:11], v[136:139], v[48:63]
    v_exp_f16 v32, v0
    v_exp_f16 v33, v2
    v_exp_f16 v34, v4
    v_mfma_f32_32x32x16_bf16 v[16:31], a[12:15], v[140:143], v[16:31]
    v_exp_f16 v35, v6
    exph 32, 1
    exph 33, 3
    v_mfma_f32_32x32x16_f16 v[112:127], a[16:19], v[40:43], v[112:127]
    s_waitcnt vmcnt(1) lgkmcnt(0)
    exph 34, 5
    exph 35, 7
    v_exp_f16 v36, v8
    v_mfma_f32_32x32x16_f16 v[112:127], a[20:23], v[44:47], v[112:127]
    s_barrier
    v_exp_f16 v37, v10
    v_exp_f16 v38, v12
    v_exp_f16 v39, v14
    v_smfmac_f32_16x16x64_f16 a[52:55], a[56:59], v[40:47], v244
    ds_read_b128 a[0:3], v225 offset:32768
    exph 36, 9
    exph 37, 11
    exph 38, 13
    exph 39, 15
    v_mfma_f32_32x32x16_bf16 v[0:15], a[8:11], v[144:147], v[48:63]
    v_exp_f16 v40, v16
    v_exp_f16 v41, v18
    v_exp_f16 v42, v20
    v_mfma_f32_32x32x16_bf16 v[0:15], a[12:15], v[148:151], v[0:15]
    s_waitcnt vmcnt(0)
    v_exp_f16 v43, v22
    exph 40, 17
    v_cmp_ne_u32 s[62:63], v239, v233
    exph 41, 19
    v_mfma_f32_32x32x16_f16 v[64:79], a[24:27], v[32:35], v[64:79]
    s_cmp_eq_u32 s62, 15
    exph 42, 21
    exph 43, 23
    v_exp_f16 v44, v24
    v_mfma_f32_32x32x16_f16 v[64:79], a[28:31], v[36:39], v[64:79]
    s_cbranch_scc0 L_spin1F
L_back1F:
    v_exp_f16 v45, v26
    v_exp_f16 v46, v28
    v_exp_f16 v47, v30
    v_smfmac_f32_16x16x64_f16 a[40:43], a[56:59], v[32:39], v244
    ds_read_b128 a[4:7], v225 offset:33792
    exph 44, 25
    exph 45, 27
    exph 46, 29
    exph 47, 31
    v_mfma_f32_32x32x16_bf16 v[16:31], a[8:11], v[152:155], v[48:63]
    v_exp_f16 v32, v0
    v_exp_f16 v33, v2
    v_exp_f16 v34, v4
    v_mfma_f32_32x32x16_bf16 v[16:31], a[12:15], v[156:159], v[16:31]
    v_exp_f16 v35, v6
    exph 32, 1
    exph 33, 3
    v_mfma_f32_32x32x16_f16 v[80:95], a[24:27], v[40:43], v[80:95]
    exph 34, 5
    exph 35, 7
    v_exp_f16 v36, v8
    v_mfma_f32_32x32x16_f16 v[80:95], a[28:31], v[44:47], v[80:95]
    s_mov_b32 m0, s44
    v_exp_f16 v37, v10
    v_exp_f16 v38, v12
    v_exp_f16 v39, v14
    v_smfmac_f32_16x16x64_f16 a[44:47], a[56:59], v[40:47], v244
    s_waitcnt lgkmcnt(1)
    ds_read_b128 a[16:19], v225 offset:49152
    exph 36, 9
    exph 37, 11
    exph 38, 13
    exph 39, 15
    v_mfma_f32_32x32x16_bf16 v[0:15], a[0:3], v[128:131], v[48:63]
    s_waitcnt lgkmcnt(1)
    buffer_load_dwordx4 v225, s[48:51], s46 offen offset:0 sc1 lds
    v_exp_f16 v40, v16
    v_exp_f16 v41, v18
    v_exp_f16 v42, v20
    v_mfma_f32_32x32x16_bf16 v[0:15], a[4:7], v[132:135], v[0:15]
    buffer_load_dwordx4 v225, s[48:51], s46 offen offset:1024 sc1 lds
    v_exp_f16 v43, v22
    exph 40, 17
    exph 41, 19
    v_mfma_f32_32x32x16_f16 v[96:111], a[24:27], v[32:35], v[96:111]
    buffer_load_dwordx4 v225, s[48:51], s14 offen offset:2048 sc1 lds
    exph 42, 21
    exph 43, 23
    v_exp_f16 v44, v24
    v_mfma_f32_32x32x16_f16 v[96:111], a[28:31], v[36:39], v[96:111]
    buffer_load_dwordx4 v225, s[48:51], s14 offen offset:3072 sc1 lds
    v_exp_f16 v45, v26
    v_exp_f16 v46, v28
    v_exp_f16 v47, v30
    v_smfmac_f32_16x16x64_f16 a[48:51], a[56:59], v[32:39], v244
    ds_read_b128 a[20:23], v225 offset:50176
    exph 44, 25
    exph 45, 27
    exph 46, 29
    exph 47, 31
    v_mfma_f32_32x32x16_bf16 v[16:31], a[0:3], v[136:139], v[48:63]
    v_exp_f16 v32, v0
    v_exp_f16 v33, v2
    v_exp_f16 v34, v4
    v_mfma_f32_32x32x16_bf16 v[16:31], a[4:7], v[140:143], v[16:31]
    v_exp_f16 v35, v6
    exph 32, 1
    exph 33, 3
    v_mfma_f32_32x32x16_f16 v[112:127], a[24:27], v[40:43], v[112:127]
    exph 34, 5
    exph 35, 7
    v_exp_f16 v36, v8
    v_mfma_f32_32x32x16_f16 v[112:127], a[28:31], v[44:47], v[112:127]
    s_mov_b32 m0, s56
    v_exp_f16 v37, v10
    v_exp_f16 v38, v12
    v_exp_f16 v39, v14
    v_smfmac_f32_16x16x64_f16 a[52:55], a[56:59], v[40:47], v244
    ds_read_b128 a[8:11], v225 offset:34816
    exph 36, 9
    exph 37, 11
    exph 38, 13
    exph 39, 15
    v_mfma_f32_32x32x16_bf16 v[0:15], a[0:3], v[144:147], v[48:63]
    buffer_load_dwordx4 v225, s[64:67], s46 offen offset:0 sc1 lds
    v_exp_f16 v40, v16
    v_exp_f16 v41, v18
    v_exp_f16 v42, v20
    v_mfma_f32_32x32x16_bf16 v[0:15], a[4:7], v[148:151], v[0:15]
    s_waitcnt lgkmcnt(2)
    buffer_load_dwordx4 v225, s[64:67], s46 offen offset:1024 sc1 lds
    v_exp_f16 v43, v22
    exph 40, 17
    exph 41, 19
    v_mfma_f32_32x32x16_f16 v[64:79], a[16:19], v[32:35], v[64:79]
    s_waitcnt lgkmcnt(1)
    buffer_load_dwordx4 v225, s[64:67], s14 offen offset:2048 sc1 lds
    exph 42, 21
    exph 43, 23
    v_exp_f16 v44, v24
    v_mfma_f32_32x32x16_f16 v[64:79], a[20:23], v[36:39], v[64:79]
    buffer_load_dwordx4 v225, s[64:67], s14 offen offset:3072 sc1 lds
    v_exp_f16 v45, v26
    v_exp_f16 v46, v28
    v_exp_f16 v47, v30
    v_smfmac_f32_16x16x64_f16 a[40:43], a[56:59], v[32:39], v244
    ds_read_b128 a[12:15], v225 offset:35840
    exph 44, 25
    exph 45, 27
    exph 46, 29
    exph 47, 31
    v_mfma_f32_32x32x16_bf16 v[16:31], a[0:3], v[152:155], v[48:63]
    s_add_u32 s45, s45, 2
    v_exp_f16 v32, v0
    v_exp_f16 v33, v2
    v_exp_f16 v34, v4
    v_mfma_f32_32x32x16_bf16 v[16:31], a[4:7], v[156:159], v[16:31]
    s_and_b32 s45, s45, 7
    v_exp_f16 v35, v6
    exph 32, 1
    exph 33, 3
    v_mfma_f32_32x32x16_f16 v[80:95], a[16:19], v[40:43], v[80:95]
    s_lshl_b32 s46, s45, 14
    exph 34, 5
    exph 35, 7
    v_exp_f16 v36, v8
    v_mfma_f32_32x32x16_f16 v[80:95], a[20:23], v[44:47], v[80:95]
    v_exp_f16 v37, v10
    v_exp_f16 v38, v12
    v_exp_f16 v39, v14
    v_smfmac_f32_16x16x64_f16 a[44:47], a[56:59], v[40:47], v244
    s_waitcnt lgkmcnt(1)
    ds_read_b128 a[24:27], v225 offset:51200
    exph 36, 9
    exph 37, 11
    exph 38, 13
    exph 39, 15
    v_mfma_f32_32x32x16_bf16 v[0:15], a[8:11], v[128:131], v[48:63]
    s_waitcnt lgkmcnt(1)
    v_exp_f16 v40, v16
    v_exp_f16 v41, v18
    v_exp_f16 v42, v20
    v_mfma_f32_32x32x16_bf16 v[0:15], a[12:15], v[132:135], v[0:15]
    s_add_u32 s46, s46, s44
    v_exp_f16 v43, v22
    exph 40, 17
    exph 41, 19
    v_mfma_f32_32x32x16_f16 v[96:111], a[16:19], v[32:35], v[96:111]
    s_add_u32 s14, s46, s41
    exph 42, 21
    exph 43, 23
    v_exp_f16 v44, v24
    v_mfma_f32_32x32x16_f16 v[96:111], a[20:23], v[36:39], v[96:111]
    v_exp_f16 v45, v26
    v_exp_f16 v46, v28
    v_exp_f16 v47, v30
    v_smfmac_f32_16x16x64_f16 a[48:51], a[56:59], v[32:39], v244
    ds_read_b128 a[28:31], v225 offset:52224
    exph 44, 25
    exph 45, 27
    exph 46, 29
    exph 47, 31
    v_mfma_f32_32x32x16_bf16 v[16:31], a[8:11], v[136:139], v[48:63]
    v_exp_f16 v32, v0
    v_exp_f16 v33, v2
    v_exp_f16 v34, v4
    v_mfma_f32_32x32x16_bf16 v[16:31], a[12:15], v[140:143], v[16:31]
    v_exp_f16 v35, v6
    exph 32, 1
    exph 33, 3
    v_mfma_f32_32x32x16_f16 v[112:127], a[16:19], v[40:43], v[112:127]
    exph 34, 5
    exph 35, 7
    v_exp_f16 v36, v8
    v_mfma_f32_32x32x16_f16 v[112:127], a[20:23], v[44:47], v[112:127]
    v_exp_f16 v37, v10
    v_exp_f16 v38, v12
    v_exp_f16 v39, v14
    v_smfmac_f32_16x16x64_f16 a[52:55], a[56:59], v[40:47], v244
    ds_read_b128 a[0:3], v225 offset:36864
    exph 36, 9
    exph 37, 11
    exph 38, 13
    exph 39, 15
    v_mfma_f32_32x32x16_bf16 v[0:15], a[8:11], v[144:147], v[48:63]
    v_exp_f16 v40, v16
    v_exp_f16 v41, v18
    v_exp_f16 v42, v20
    v_mfma_f32_32x32x16_bf16 v[0:15], a[12:15], v[148:151], v[0:15]
    s_waitcnt lgkmcnt(2)
    v_exp_f16 v43, v22
    exph 40, 17
    exph 41, 19
    v_mfma_f32_32x32x16_f16 v[64:79], a[24:27], v[32:35], v[64:79]
    s_waitcnt lgkmcnt(1)
    exph 42, 21
    exph 43, 23
    v_exp_f16 v44, v24
    v_mfma_f32_32x32x16_f16 v[64:79], a[28:31], v[36:39], v[64:79]
    v_exp_f16 v45, v26
    v_exp_f16 v46, v28
    v_exp_f16 v47, v30
    v_smfmac_f32_16x16x64_f16 a[40:43], a[56:59], v[32:39], v244
    ds_read_b128 a[4:7], v225 offset:37888
    exph 44, 25
    exph 45, 27
    exph 46, 29
    exph 47, 31
    v_mfma_f32_32x32x16_bf16 v[16:31], a[8:11], v[152:155], v[48:63]
    v_exp_f16 v32, v0
    v_exp_f16 v33, v2
    v_exp_f16 v34, v4
    v_mfma_f32_32x32x16_bf16 v[16:31], a[12:15], v[156:159], v[16:31]
    v_exp_f16 v35, v6
    exph 32, 1
    exph 33, 3
    v_mfma_f32_32x32x16_f16 v[80:95], a[24:27], v[40:43], v[80:95]
    exph 34, 5
    exph 35, 7
    v_exp_f16 v36, v8
    v_mfma_f32_32x32x16_f16 v[80:95], a[28:31], v[44:47], v[80:95]
    v_exp_f16 v37, v10
    v_exp_f16 v38, v12
    v_exp_f16 v39, v14
    v_smfmac_f32_16x16x64_f16 a[44:47], a[56:59], v[40:47], v244
    s_waitcnt lgkmcnt(1)
    ds_read_b128 a[16:19], v225 offset:53248
    exph 36, 9
    exph 37, 11
    exph 38, 13
    exph 39, 15
    v_mfma_f32_32x32x16_bf16 v[0:15], a[0:3], v[128:131], v[48:63]
    s_waitcnt lgkmcnt(1)
    v_exp_f16 v40, v16
    v_exp_f16 v41, v18
    v_exp_f16 v42, v20
    v_mfma_f32_32x32x16_bf16 v[0:15], a[4:7], v[132:135], v[0:15]
    v_exp_f16 v43, v22
    exph 40, 17
    exph 41, 19
    v_mfma_f32_32x32x16_f16 v[96:111], a[24:27], v[32:35], v[96:111]
    exph 42, 21
    exph 43, 23
    v_exp_f16 v44, v24
    v_mfma_f32_32x32x16_f16 v[96:111], a[28:31], v[36:39], v[96:111]
    v_exp_f16 v45, v26
    v_exp_f16 v46, v28
    v_exp_f16 v47, v30
    v_smfmac_f32_16x16x64_f16 a[48:51], a[56:59], v[32:39], v244
    ds_read_b128 a[20:23], v225 offset:54272
    exph 44, 25
    exph 45, 27
    exph 46, 29
    exph 47, 31
    v_mfma_f32_32x32x16_bf16 v[16:31], a[0:3], v[136:139], v[48:63]
    v_exp_f16 v32, v0
    v_exp_f16 v33, v2
    v_exp_f16 v34, v4
    v_mfma_f32_32x32x16_bf16 v[16:31], a[4:7], v[140:143], v[16:31]
    v_exp_f16 v35, v6
    exph 32, 1
    exph 33, 3
    v_mfma_f32_32x32x16_f16 v[112:127], a[24:27], v[40:43], v[112:127]
    exph 34, 5
    exph 35, 7
    v_exp_f16 v36, v8
    v_mfma_f32_32x32x16_f16 v[112:127], a[28:31], v[44:47], v[112:127]
    v_exp_f16 v37, v10
    v_exp_f16 v38, v12
    v_exp_f16 v39, v14
    v_smfmac_f32_16x16x64_f16 a[52:55], a[56:59], v[40:47], v244
    ds_read_b128 a[8:11], v225 offset:38912
    exph 36, 9
    exph 37, 11
    exph 38, 13
    exph 39, 15
    v_mfma_f32_32x32x16_bf16 v[0:15], a[0:3], v[144:147], v[48:63]
    v_exp_f16 v40, v16
    v_exp_f16 v41, v18
    v_exp_f16 v42, v20
    v_mfma_f32_32x32x16_bf16 v[0:15], a[4:7], v[148:151], v[0:15]
    s_waitcnt lgkmcnt(2)
    v_exp_f16 v43, v22
    exph 40, 17
    exph 41, 19
    v_mfma_f32_32x32x16_f16 v[64:79], a[16:19], v[32:35], v[64:79]
    s_waitcnt lgkmcnt(1)
    exph 42, 21
    exph 43, 23
    v_exp_f16 v44, v24
    v_mfma_f32_32x32x16_f16 v[64:79], a[20:23], v[36:39], v[64:79]
    v_exp_f16 v45, v26
    v_exp_f16 v46, v28
    v_exp_f16 v47, v30
    v_smfmac_f32_16x16x64_f16 a[40:43], a[56:59], v[32:39], v244
    ds_read_b128 a[12:15], v225 offset:39936
    exph 44, 25
    exph 45, 27
    exph 46, 29
    exph 47, 31
    v_mfma_f32_32x32x16_bf16 v[16:31], a[0:3], v[152:155], v[48:63]
    v_exp_f16 v32, v0
    v_exp_f16 v33, v2
    v_exp_f16 v34, v4
    v_mfma_f32_32x32x16_bf16 v[16:31], a[4:7], v[156:159], v[16:31]
    v_exp_f16 v35, v6
    exph 32, 1
    exph 33, 3
    v_mfma_f32_32x32x16_f16 v[80:95], a[16:19], v[40:43], v[80:95]
    exph 34, 5
    exph 35, 7
    v_exp_f16 v36, v8
    v_mfma_f32_32x32x16_f16 v[80:95], a[20:23], v[44:47], v[80:95]
    v_exp_f16 v37, v10
    v_exp_f16 v38, v12
    v_exp_f16 v39, v14
    v_smfmac_f32_16x16x64_f16 a[44:47], a[56:59], v[40:47], v244
    s_waitcnt lgkmcnt(1)
    ds_read_b128 a[24:27], v225 offset:55296
    exph 36, 9
    exph 37, 11
    exph 38, 13
    exph 39, 15
    v_mfma_f32_32x32x16_bf16 v[0:15], a[8:11], v[128:131], v[48:63]
    s_waitcnt lgkmcnt(1)
    v_exp_f16 v40, v16
    v_exp_f16 v41, v18
    v_exp_f16 v42, v20
    v_mfma_f32_32x32x16_bf16 v[0:15], a[12:15], v[132:135], v[0:15]
    v_exp_f16 v43, v22
    exph 40, 17
    exph 41, 19
    v_mfma_f32_32x32x16_f16 v[96:111], a[16:19], v[32:35], v[96:111]
    exph 42, 21
    exph 43, 23
    v_exp_f16 v44, v24
    v_mfma_f32_32x32x16_f16 v[96:111], a[20:23], v[36:39], v[96:111]
    v_exp_f16 v45, v26
    v_exp_f16 v46, v28
    v_exp_f16 v47, v30
    v_smfmac_f32_16x16x64_f16 a[48:51], a[56:59], v[32:39], v244
    ds_read_b128 a[28:31], v225 offset:56320
    exph 44, 25
    exph 45, 27
    exph 46, 29
    exph 47, 31
    v_mfma_f32_32x32x16_bf16 v[16:31], a[8:11], v[136:139], v[48:63]
    v_exp_f16 v32, v0
    v_exp_f16 v33, v2
    v_exp_f16 v34, v4
    v_mfma_f32_32x32x16_bf16 v[16:31], a[12:15], v[140:143], v[16:31]
    v_exp_f16 v35, v6
    exph 32, 1
    exph 33, 3
    v_mfma_f32_32x32x16_f16 v[112:127], a[16:19], v[40:43], v[112:127]
    exph 34, 5
    exph 35, 7
    v_exp_f16 v36, v8
    v_mfma_f32_32x32x16_f16 v[112:127], a[20:23], v[44:47], v[112:127]
    v_exp_f16 v37, v10
    v_exp_f16 v38, v12
    v_exp_f16 v39, v14
    v_smfmac_f32_16x16x64_f16 a[52:55], a[56:59], v[40:47], v244
    ds_read_b128 a[0:3], v225 offset:40960
    exph 36, 9
    exph 37, 11
    exph 38, 13
    exph 39, 15
    v_mfma_f32_32x32x16_bf16 v[0:15], a[8:11], v[144:147], v[48:63]
    v_exp_f16 v40, v16
    v_exp_f16 v41, v18
    v_exp_f16 v42, v20
    v_mfma_f32_32x32x16_bf16 v[0:15], a[12:15], v[148:151], v[0:15]
    s_waitcnt lgkmcnt(2)
    v_exp_f16 v43, v22
    exph 40, 17
    exph 41, 19
    v_mfma_f32_32x32x16_f16 v[64:79], a[24:27], v[32:35], v[64:79]
    s_waitcnt lgkmcnt(1)
    exph 42, 21
    exph 43, 23
    v_exp_f16 v44, v24
    v_mfma_f32_32x32x16_f16 v[64:79], a[28:31], v[36:39], v[64:79]
    v_exp_f16 v45, v26
    v_exp_f16 v46, v28
    v_exp_f16 v47, v30
    v_smfmac_f32_16x16x64_f16 a[40:43], a[56:59], v[32:39], v244
    ds_read_b128 a[4:7], v225 offset:41984
    exph 44, 25
    exph 45, 27
    exph 46, 29
    exph 47, 31
    v_mfma_f32_32x32x16_bf16 v[16:31], a[8:11], v[152:155], v[48:63]
    v_exp_f16 v32, v0
    v_exp_f16 v33, v2
    v_exp_f16 v34, v4
    v_mfma_f32_32x32x16_bf16 v[16:31], a[12:15], v[156:159], v[16:31]
    v_exp_f16 v35, v6
    exph 32, 1
    exph 33, 3
    v_mfma_f32_32x32x16_f16 v[80:95], a[24:27], v[40:43], v[80:95]
    exph 34, 5
    exph 35, 7
    v_exp_f16 v36, v8
    v_mfma_f32_32x32x16_f16 v[80:95], a[28:31], v[44:47], v[80:95]
    v_exp_f16 v37, v10
    v_exp_f16 v38, v12
    v_exp_f16 v39, v14
    v_smfmac_f32_16x16x64_f16 a[44:47], a[56:59], v[40:47], v244
    s_waitcnt lgkmcnt(1)
    ds_read_b128 a[16:19], v225 offset:57344
    exph 36, 9
    exph 37, 11
    exph 38, 13
    exph 39, 15
    v_mfma_f32_32x32x16_bf16 v[0:15], a[0:3], v[128:131], v[48:63]
    s_waitcnt lgkmcnt(1)
    v_exp_f16 v40, v16
    v_exp_f16 v41, v18
    v_exp_f16 v42, v20
    v_mfma_f32_32x32x16_bf16 v[0:15], a[4:7], v[132:135], v[0:15]
    v_exp_f16 v43, v22
    exph 40, 17
    exph 41, 19
    v_mfma_f32_32x32x16_f16 v[96:111], a[24:27], v[32:35], v[96:111]
L_pad7F:
    s_cbranch_vccnz L_t
    exph 42, 21
    exph 43, 23
    v_exp_f16 v44, v24
    v_mfma_f32_32x32x16_f16 v[96:111], a[28:31], v[36:39], v[96:111]
    v_exp_f16 v45, v26
    v_exp_f16 v46, v28
    v_exp_f16 v47, v30
    v_smfmac_f32_16x16x64_f16 a[48:51], a[56:59], v[32:39], v244
    ds_read_b128 a[20:23], v225 offset:58368
    exph 44, 25
    exph 45, 27
    exph 46, 29
    exph 47, 31
    v_mfma_f32_32x32x16_bf16 v[16:31], a[0:3], v[136:139], v[48:63]
    v_exp_f16 v32, v0
    v_exp_f16 v33, v2
    v_exp_f16 v34, v4
    v_mfma_f32_32x32x16_bf16 v[16:31], a[4:7], v[140:143], v[16:31]
    v_exp_f16 v35, v6
    exph 32, 1
    exph 33, 3
    v_mfma_f32_32x32x16_f16 v[112:127], a[24:27], v[40:43], v[112:127]
    exph 34, 5
    exph 35, 7
    v_exp_f16 v36, v8
    v_mfma_f32_32x32x16_f16 v[112:127], a[28:31], v[44:47], v[112:127]
    v_exp_f16 v37, v10
    v_exp_f16 v38, v12
    v_exp_f16 v39, v14
    v_smfmac_f32_16x16x64_f16 a[52:55], a[56:59], v[40:47], v244
    ds_read_b128 a[8:11], v225 offset:43008
    exph 36, 9
    exph 37, 11
    exph 38, 13
    exph 39, 15
    v_mfma_f32_32x32x16_bf16 v[0:15], a[0:3], v[144:147], v[48:63]
    v_exp_f16 v40, v16
    v_exp_f16 v41, v18
    v_exp_f16 v42, v20
    v_mfma_f32_32x32x16_bf16 v[0:15], a[4:7], v[148:151], v[0:15]
    s_waitcnt lgkmcnt(2)
    v_exp_f16 v43, v22
    exph 40, 17
    exph 41, 19
    v_mfma_f32_32x32x16_f16 v[64:79], a[16:19], v[32:35], v[64:79]
    s_waitcnt lgkmcnt(1)
    exph 42, 21
    exph 43, 23
    v_exp_f16 v44, v24
    v_mfma_f32_32x32x16_f16 v[64:79], a[20:23], v[36:39], v[64:79]
    v_exp_f16 v45, v26
    v_exp_f16 v46, v28
    v_exp_f16 v47, v30
    v_smfmac_f32_16x16x64_f16 a[40:43], a[56:59], v[32:39], v244
    ds_read_b128 a[12:15], v225 offset:44032
    exph 44, 25
    exph 45, 27
    exph 46, 29
    exph 47, 31
    v_mfma_f32_32x32x16_bf16 v[16:31], a[0:3], v[152:155], v[48:63]
    v_exp_f16 v32, v0
    v_exp_f16 v33, v2
    v_exp_f16 v34, v4
    v_mfma_f32_32x32x16_bf16 v[16:31], a[4:7], v[156:159], v[16:31]
    v_exp_f16 v35, v6
    exph 32, 1
    exph 33, 3
    v_mfma_f32_32x32x16_f16 v[80:95], a[16:19], v[40:43], v[80:95]
    exph 34, 5
    exph 35, 7
    v_exp_f16 v36, v8
    v_mfma_f32_32x32x16_f16 v[80:95], a[20:23], v[44:47], v[80:95]
    v_exp_f16 v37, v10
    v_exp_f16 v38, v12
    v_exp_f16 v39, v14
    v_smfmac_f32_16x16x64_f16 a[44:47], a[56:59], v[40:47], v244
    s_waitcnt lgkmcnt(1)
    ds_read_b128 a[24:27], v225 offset:59392
    exph 36, 9
    exph 37, 11
    exph 38, 13
    exph 39, 15
    v_mfma_f32_32x32x16_bf16 v[0:15], a[8:11], v[128:131], v[48:63]
    s_waitcnt lgkmcnt(1)
    v_exp_f16 v40, v16
    v_exp_f16 v41, v18
    v_exp_f16 v42, v20
    v_mfma_f32_32x32x16_bf16 v[0:15], a[12:15], v[132:135], v[0:15]
    v_exp_f16 v43, v22
    exph 40, 17
    exph 41, 19
    v_mfma_f32_32x32x16_f16 v[96:111], a[16:19], v[32:35], v[96:111]
    exph 42, 21
    exph 43, 23
    v_exp_f16 v44, v24
    v_mfma_f32_32x32x16_f16 v[96:111], a[20:23], v[36:39], v[96:111]
    v_exp_f16 v45, v26
    v_exp_f16 v46, v28
    v_exp_f16 v47, v30
    v_smfmac_f32_16x16x64_f16 a[48:51], a[56:59], v[32:39], v244
    ds_read_b128 a[28:31], v225 offset:60416
    exph 44, 25
    exph 45, 27
    exph 46, 29
    exph 47, 31
    v_mfma_f32_32x32x16_bf16 v[16:31], a[8:11], v[136:139], v[48:63]
    v_exp_f16 v32, v0
    v_exp_f16 v33, v2
    v_exp_f16 v34, v4
    v_mfma_f32_32x32x16_bf16 v[16:31], a[12:15], v[140:143], v[16:31]
    v_exp_f16 v35, v6
    exph 32, 1
    exph 33, 3
    v_mfma_f32_32x32x16_f16 v[112:127], a[16:19], v[40:43], v[112:127]
    exph 34, 5
    exph 35, 7
    v_exp_f16 v36, v8
    v_mfma_f32_32x32x16_f16 v[112:127], a[20:23], v[44:47], v[112:127]
    v_exp_f16 v37, v10
    v_exp_f16 v38, v12
    v_exp_f16 v39, v14
    v_smfmac_f32_16x16x64_f16 a[52:55], a[56:59], v[40:47], v244
    ds_read_b128 a[0:3], v225 offset:45056
    exph 36, 9
    exph 37, 11
    exph 38, 13
    exph 39, 15
    v_mfma_f32_32x32x16_bf16 v[0:15], a[8:11], v[144:147], v[48:63]
    v_exp_f16 v40, v16
    v_exp_f16 v41, v18
    v_exp_f16 v42, v20
    v_mfma_f32_32x32x16_bf16 v[0:15], a[12:15], v[148:151], v[0:15]
    s_waitcnt lgkmcnt(2)
    v_exp_f16 v43, v22
    exph 40, 17
    exph 41, 19
    v_mfma_f32_32x32x16_f16 v[64:79], a[24:27], v[32:35], v[64:79]
    s_waitcnt lgkmcnt(1)
    exph 42, 21
    exph 43, 23
    v_exp_f16 v44, v24
    v_mfma_f32_32x32x16_f16 v[64:79], a[28:31], v[36:39], v[64:79]
    v_exp_f16 v45, v26
    v_exp_f16 v46, v28
    v_exp_f16 v47, v30
    v_smfmac_f32_16x16x64_f16 a[40:43], a[56:59], v[32:39], v244
    ds_read_b128 a[4:7], v225 offset:46080
    exph 44, 25
    exph 45, 27
    exph 46, 29
    exph 47, 31
    v_mfma_f32_32x32x16_bf16 v[16:31], a[8:11], v[152:155], v[48:63]
    v_exp_f16 v32, v0
    v_exp_f16 v33, v2
    v_exp_f16 v34, v4
    v_mfma_f32_32x32x16_bf16 v[16:31], a[12:15], v[156:159], v[16:31]
    v_exp_f16 v35, v6
    exph 32, 1
    exph 33, 3
    v_mfma_f32_32x32x16_f16 v[80:95], a[24:27], v[40:43], v[80:95]
    exph 34, 5
    exph 35, 7
    v_exp_f16 v36, v8
    v_mfma_f32_32x32x16_f16 v[80:95], a[28:31], v[44:47], v[80:95]
    v_exp_f16 v37, v10
    v_exp_f16 v38, v12
    v_exp_f16 v39, v14
    v_smfmac_f32_16x16x64_f16 a[44:47], a[56:59], v[40:47], v244
    s_waitcnt lgkmcnt(1)
    ds_read_b128 a[16:19], v225 offset:61440
    exph 36, 9
    exph 37, 11
    exph 38, 13
    exph 39, 15
    v_mfma_f32_32x32x16_bf16 v[0:15], a[0:3], v[128:131], v[48:63]
    s_waitcnt lgkmcnt(1)
    v_exp_f16 v40, v16
    v_exp_f16 v41, v18
    v_exp_f16 v42, v20
    v_mfma_f32_32x32x16_bf16 v[0:15], a[4:7], v[132:135], v[0:15]
    v_exp_f16 v43, v22
    exph 40, 17
    exph 41, 19
    v_mfma_f32_32x32x16_f16 v[96:111], a[24:27], v[32:35], v[96:111]
    exph 42, 21
    exph 43, 23
    v_exp_f16 v44, v24
    v_mfma_f32_32x32x16_f16 v[96:111], a[28:31], v[36:39], v[96:111]
    v_exp_f16 v45, v26
    v_exp_f16 v46, v28
    v_exp_f16 v47, v30
    v_smfmac_f32_16x16x64_f16 a[48:51], a[56:59], v[32:39], v244
    ds_read_b128 a[20:23], v225 offset:62464
    exph 44, 25
    exph 45, 27
    exph 46, 29
    exph 47, 31
    v_mfma_f32_32x32x16_bf16 v[16:31], a[0:3], v[136:139], v[48:63]
    v_exp_f16 v32, v0
    v_exp_f16 v33, v2
    v_exp_f16 v34, v4
    v_mfma_f32_32x32x16_bf16 v[16:31], a[4:7], v[140:143], v[16:31]
    v_exp_f16 v35, v6
    exph 32, 1
    exph 33, 3
    v_mfma_f32_32x32x16_f16 v[112:127], a[24:27], v[40:43], v[112:127]
    s_waitcnt vmcnt(0) lgkmcnt(0)
    exph 34, 5
    exph 35, 7
    v_exp_f16 v36, v8
    v_mfma_f32_32x32x16_f16 v[112:127], a[28:31], v[44:47], v[112:127]
    s_barrier
    v_exp_f16 v37, v10
    v_exp_f16 v38, v12
    v_exp_f16 v39, v14
    v_smfmac_f32_16x16x64_f16 a[52:55], a[56:59], v[40:47], v244
    ds_read_b128 a[8:11], v225 offset:0
    exph 36, 9
    exph 37, 11
    exph 38, 13
    exph 39, 15
    v_mfma_f32_32x32x16_bf16 v[0:15], a[0:3], v[144:147], v[48:63]
    v_exp_f16 v40, v16
    v_exp_f16 v41, v18
    v_exp_f16 v42, v20
    v_mfma_f32_32x32x16_bf16 v[0:15], a[4:7], v[148:151], v[0:15]
    v_exp_f16 v43, v22
    exph 40, 17
    exph 41, 19
    v_mfma_f32_32x32x16_f16 v[64:79], a[16:19], v[32:35], v[64:79]
    exph 42, 21
    exph 43, 23
    v_exp_f16 v44, v24
    v_mfma_f32_32x32x16_f16 v[64:79], a[20:23], v[36:39], v[64:79]
    s_mov_b32 m0, s61
    v_exp_f16 v45, v26
    v_exp_f16 v46, v28
    v_exp_f16 v47, v30
    v_smfmac_f32_16x16x64_f16 a[40:43], a[56:59], v[32:39], v244
    ds_read_b128 a[12:15], v225 offset:1024
    exph 44, 25
    exph 45, 27
    exph 46, 29
    exph 47, 31
    v_mfma_f32_32x32x16_bf16 v[16:31], a[0:3], v[152:155], v[48:63]
    buffer_load_dwordx4 v225, s[48:51], s46 offen offset:0 sc1 lds
    v_exp_f16 v32, v0
    v_exp_f16 v33, v2
    v_exp_f16 v34, v4
    v_mfma_f32_32x32x16_bf16 v[16:31], a[4:7], v[156:159], v[16:31]
    buffer_load_dwordx4 v225, s[48:51], s46 offen offset:1024 sc1 lds
    v_exp_f16 v35, v6
    exph 32, 1
    exph 33, 3
    v_mfma_f32_32x32x16_f16 v[80:95], a[16:19], v[40:43], v[80:95]
    buffer_load_dwordx4 v225, s[48:51], s14 offen offset:2048 sc1 lds
    exph 34, 5
    exph 35, 7
    v_exp_f16 v36, v8
    v_mfma_f32_32x32x16_f16 v[80:95], a[20:23], v[44:47], v[80:95]
    buffer_load_dwordx4 v225, s[48:51], s14 offen offset:3072 sc1 lds
    v_exp_f16 v37, v10
    v_exp_f16 v38, v12
    v_exp_f16 v39, v14
    v_smfmac_f32_16x16x64_f16 a[44:47], a[56:59], v[40:47], v244
    s_waitcnt lgkmcnt(1)
    ds_read_b128 a[24:27], v225 offset:16384
    exph 36, 9
    exph 37, 11
    exph 38, 13
    exph 39, 15
    v_mfma_f32_32x32x16_bf16 v[0:15], a[8:11], v[128:131], v[48:63]
    s_waitcnt lgkmcnt(1)
    v_exp_f16 v40, v16
    v_exp_f16 v41, v18
    v_exp_f16 v42, v20
    v_mfma_f32_32x32x16_bf16 v[0:15], a[12:15], v[132:135], v[0:15]
    v_exp_f16 v43, v22
    exph 40, 17
    exph 41, 19
    v_mfma_f32_32x32x16_f16 v[96:111], a[16:19], v[32:35], v[96:111]
    exph 42, 21
    exph 43, 23
    v_exp_f16 v44, v24
    v_mfma_f32_32x32x16_f16 v[96:111], a[20:23], v[36:39], v[96:111]
    s_mov_b32 m0, s57
    v_exp_f16 v45, v26
    v_exp_f16 v46, v28
    v_exp_f16 v47, v30
    v_smfmac_f32_16x16x64_f16 a[48:51], a[56:59], v[32:39], v244
    ds_read_b128 a[28:31], v225 offset:17408
    exph 44, 25
    exph 45, 27
    exph 46, 29
    exph 47, 31
    v_mfma_f32_32x32x16_bf16 v[16:31], a[8:11], v[136:139], v[48:63]
    buffer_load_dwordx4 v225, s[64:67], s46 offen offset:0 sc1 lds
    v_exp_f16 v32, v0
    v_exp_f16 v33, v2
    v_exp_f16 v34, v4
    v_mfma_f32_32x32x16_bf16 v[16:31], a[12:15], v[140:143], v[16:31]
    buffer_load_dwordx4 v225, s[64:67], s46 offen offset:1024 sc1 lds
    v_exp_f16 v35, v6
    exph 32, 1
    exph 33, 3
    v_mfma_f32_32x32x16_f16 v[112:127], a[16:19], v[40:43], v[112:127]
    buffer_load_dwordx4 v225, s[64:67], s14 offen offset:2048 sc1 lds
    exph 34, 5
    exph 35, 7
    v_exp_f16 v36, v8
    v_mfma_f32_32x32x16_f16 v[112:127], a[20:23], v[44:47], v[112:127]
    buffer_load_dwordx4 v225, s[64:67], s14 offen offset:3072 sc1 lds
    v_exp_f16 v37, v10
    v_exp_f16 v38, v12
    v_exp_f16 v39, v14
    v_smfmac_f32_16x16x64_f16 a[52:55], a[56:59], v[40:47], v244
    ds_read_b128 a[0:3], v225 offset:2048
    exph 36, 9
    exph 37, 11
    exph 38, 13
    exph 39, 15
    v_mfma_f32_32x32x16_bf16 v[0:15], a[8:11], v[144:147], v[48:63]
    s_add_u32 s45, s45, 2
    v_exp_f16 v40, v16
    v_exp_f16 v41, v18
    v_exp_f16 v42, v20
    v_mfma_f32_32x32x16_bf16 v[0:15], a[12:15], v[148:151], v[0:15]
    s_waitcnt lgkmcnt(2)
    v_exp_f16 v43, v22
    exph 40, 17
    exph 41, 19
    v_mfma_f32_32x32x16_f16 v[64:79], a[24:27], v[32:35], v[64:79]
    s_waitcnt lgkmcnt(1)
    exph 42, 21
    exph 43, 23
    v_exp_f16 v44, v24
    v_mfma_f32_32x32x16_f16 v[64:79], a[28:31], v[36:39], v[64:79]
    v_exp_f16 v45, v26
    v_exp_f16 v46, v28
    v_exp_f16 v47, v30
    v_smfmac_f32_16x16x64_f16 a[40:43], a[56:59], v[32:39], v244
    ds_read_b128 a[4:7], v225 offset:3072
    exph 44, 25
    exph 45, 27
    exph 46, 29
    exph 47, 31
    v_mfma_f32_32x32x16_bf16 v[16:31], a[8:11], v[152:155], v[48:63]
    s_and_b32 s45, s45, 7
    v_exp_f16 v32, v0
    v_exp_f16 v33, v2
    v_exp_f16 v34, v4
    v_mfma_f32_32x32x16_bf16 v[16:31], a[12:15], v[156:159], v[16:31]
    s_lshl_b32 s46, s45, 14
    v_exp_f16 v35, v6
    exph 32, 1
    exph 33, 3
    v_mfma_f32_32x32x16_f16 v[80:95], a[24:27], v[40:43], v[80:95]
    s_add_u32 s46, s46, s44
    exph 34, 5
    exph 35, 7
    v_exp_f16 v36, v8
    v_mfma_f32_32x32x16_f16 v[80:95], a[28:31], v[44:47], v[80:95]
    v_exp_f16 v37, v10
    v_exp_f16 v38, v12
    v_exp_f16 v39, v14
    v_smfmac_f32_16x16x64_f16 a[44:47], a[56:59], v[40:47], v244
    s_waitcnt lgkmcnt(1)
    ds_read_b128 a[16:19], v225 offset:18432
    exph 36, 9
    exph 37, 11
    exph 38, 13
    exph 39, 15
    v_mfma_f32_32x32x16_bf16 v[0:15], a[0:3], v[128:131], v[48:63]
    s_waitcnt lgkmcnt(1)
    v_exp_f16 v40, v16
    v_exp_f16 v41, v18
    v_exp_f16 v42, v20
    v_mfma_f32_32x32x16_bf16 v[0:15], a[4:7], v[132:135], v[0:15]
    s_add_u32 s14, s46, s41
    v_exp_f16 v43, v22
    exph 40, 17
    exph 41, 19
    v_mfma_f32_32x32x16_f16 v[96:111], a[24:27], v[32:35], v[96:111]
    exph 42, 21
    exph 43, 23
    v_exp_f16 v44, v24
    v_mfma_f32_32x32x16_f16 v[96:111], a[28:31], v[36:39], v[96:111]
    v_exp_f16 v45, v26
    v_exp_f16 v46, v28
    v_exp_f16 v47, v30
    v_smfmac_f32_16x16x64_f16 a[48:51], a[56:59], v[32:39], v244
    ds_read_b128 a[20:23], v225 offset:19456
    exph 44, 25
    exph 45, 27
    exph 46, 29
    exph 47, 31
    v_mfma_f32_32x32x16_bf16 v[16:31], a[0:3], v[136:139], v[48:63]
    v_exp_f16 v32, v0
    v_exp_f16 v33, v2
    v_exp_f16 v34, v4
    v_mfma_f32_32x32x16_bf16 v[16:31], a[4:7], v[140:143], v[16:31]
    v_exp_f16 v35, v6
    exph 32, 1
    exph 33, 3
    v_mfma_f32_32x32x16_f16 v[112:127], a[24:27], v[40:43], v[112:127]
    exph 34, 5
    exph 35, 7
    v_exp_f16 v36, v8
    v_mfma_f32_32x32x16_f16 v[112:127], a[28:31], v[44:47], v[112:127]
    v_exp_f16 v37, v10
    v_exp_f16 v38, v12
    v_exp_f16 v39, v14
    v_smfmac_f32_16x16x64_f16 a[52:55], a[56:59], v[40:47], v244
    ds_read_b128 a[8:11], v225 offset:4096
    exph 36, 9
    exph 37, 11
    exph 38, 13
    exph 39, 15
    v_mfma_f32_32x32x16_bf16 v[0:15], a[0:3], v[144:147], v[48:63]
    v_exp_f16 v40, v16
    v_exp_f16 v41, v18
    v_exp_f16 v42, v20
    v_mfma_f32_32x32x16_bf16 v[0:15], a[4:7], v[148:151], v[0:15]
    s_waitcnt lgkmcnt(2)
    v_exp_f16 v43, v22
    exph 40, 17
    exph 41, 19
    v_mfma_f32_32x32x16_f16 v[64:79], a[16:19], v[32:35], v[64:79]
    s_waitcnt lgkmcnt(1)
    exph 42, 21
    exph 43, 23
    v_exp_f16 v44, v24
    v_mfma_f32_32x32x16_f16 v[64:79], a[20:23], v[36:39], v[64:79]
    v_exp_f16 v45, v26
    v_exp_f16 v46, v28
    v_exp_f16 v47, v30
    v_smfmac_f32_16x16x64_f16 a[40:43], a[56:59], v[32:39], v244
    ds_read_b128 a[12:15], v225 offset:5120
    exph 44, 25
    exph 45, 27
    exph 46, 29
    exph 47, 31
    v_mfma_f32_32x32x16_bf16 v[16:31], a[0:3], v[152:155], v[48:63]
    v_exp_f16 v32, v0
    v_exp_f16 v33, v2
    v_exp_f16 v34, v4
    v_mfma_f32_32x32x16_bf16 v[16:31], a[4:7], v[156:159], v[16:31]
    v_exp_f16 v35, v6
    exph 32, 1
    exph 33, 3
    v_mfma_f32_32x32x16_f16 v[80:95], a[16:19], v[40:43], v[80:95]
    exph 34, 5
    exph 35, 7
    v_exp_f16 v36, v8
    v_mfma_f32_32x32x16_f16 v[80:95], a[20:23], v[44:47], v[80:95]
    v_exp_f16 v37, v10
    v_exp_f16 v38, v12
    v_exp_f16 v39, v14
    v_smfmac_f32_16x16x64_f16 a[44:47], a[56:59], v[40:47], v244
    s_waitcnt lgkmcnt(1)
    ds_read_b128 a[24:27], v225 offset:20480
    exph 36, 9
    exph 37, 11
    exph 38, 13
    exph 39, 15
    v_mfma_f32_32x32x16_bf16 v[0:15], a[8:11], v[128:131], v[48:63]
    s_waitcnt lgkmcnt(1)
    v_exp_f16 v40, v16
    v_exp_f16 v41, v18
    v_exp_f16 v42, v20
    v_mfma_f32_32x32x16_bf16 v[0:15], a[12:15], v[132:135], v[0:15]
    v_exp_f16 v43, v22
    exph 40, 17
    exph 41, 19
    v_mfma_f32_32x32x16_f16 v[96:111], a[16:19], v[32:35], v[96:111]
    exph 42, 21
    exph 43, 23
    v_exp_f16 v44, v24
    v_mfma_f32_32x32x16_f16 v[96:111], a[20:23], v[36:39], v[96:111]
    v_exp_f16 v45, v26
    v_exp_f16 v46, v28
    v_exp_f16 v47, v30
    v_smfmac_f32_16x16x64_f16 a[48:51], a[56:59], v[32:39], v244
    ds_read_b128 a[28:31], v225 offset:21504
    exph 44, 25
    exph 45, 27
    exph 46, 29
    exph 47, 31
    v_mfma_f32_32x32x16_bf16 v[16:31], a[8:11], v[136:139], v[48:63]
    v_exp_f16 v32, v0
    v_exp_f16 v33, v2
    v_exp_f16 v34, v4
    v_mfma_f32_32x32x16_bf16 v[16:31], a[12:15], v[140:143], v[16:31]
    v_exp_f16 v35, v6
    exph 32, 1
    exph 33, 3
    v_mfma_f32_32x32x16_f16 v[112:127], a[16:19], v[40:43], v[112:127]
    exph 34, 5
    exph 35, 7
    v_exp_f16 v36, v8
    v_mfma_f32_32x32x16_f16 v[112:127], a[20:23], v[44:47], v[112:127]
    v_exp_f16 v37, v10
    v_exp_f16 v38, v12
    v_exp_f16 v39, v14
    v_smfmac_f32_16x16x64_f16 a[52:55], a[56:59], v[40:47], v244
    ds_read_b128 a[0:3], v225 offset:6144
    exph 36, 9
    exph 37, 11
    exph 38, 13
    exph 39, 15
    v_mfma_f32_32x32x16_bf16 v[0:15], a[8:11], v[144:147], v[48:63]
    v_exp_f16 v40, v16
    v_exp_f16 v41, v18
    v_exp_f16 v42, v20
    v_mfma_f32_32x32x16_bf16 v[0:15], a[12:15], v[148:151], v[0:15]
    s_waitcnt lgkmcnt(2)
    v_exp_f16 v43, v22
    exph 40, 17
    exph 41, 19
    v_mfma_f32_32x32x16_f16 v[64:79], a[24:27], v[32:35], v[64:79]
    s_waitcnt lgkmcnt(1)
    exph 42, 21
    exph 43, 23
    v_exp_f16 v44, v24
    v_mfma_f32_32x32x16_f16 v[64:79], a[28:31], v[36:39], v[64:79]
    v_exp_f16 v45, v26
    v_exp_f16 v46, v28
    v_exp_f16 v47, v30
    v_smfmac_f32_16x16x64_f16 a[40:43], a[56:59], v[32:39], v244
    ds_read_b128 a[4:7], v225 offset:7168
    exph 44, 25
    exph 45, 27
    exph 46, 29
    exph 47, 31
    v_mfma_f32_32x32x16_bf16 v[16:31], a[8:11], v[152:155], v[48:63]
    v_exp_f16 v32, v0
    v_exp_f16 v33, v2
    v_exp_f16 v34, v4
    v_mfma_f32_32x32x16_bf16 v[16:31], a[12:15], v[156:159], v[16:31]
    v_exp_f16 v35, v6
    exph 32, 1
    exph 33, 3
    v_mfma_f32_32x32x16_f16 v[80:95], a[24:27], v[40:43], v[80:95]
    exph 34, 5
    exph 35, 7
    v_exp_f16 v36, v8
    v_mfma_f32_32x32x16_f16 v[80:95], a[28:31], v[44:47], v[80:95]
    v_exp_f16 v37, v10
    v_exp_f16 v38, v12
    v_exp_f16 v39, v14
    v_smfmac_f32_16x16x64_f16 a[44:47], a[56:59], v[40:47], v244
    s_waitcnt lgkmcnt(1)
    ds_read_b128 a[16:19], v225 offset:22528
    exph 36, 9
    exph 37, 11
    exph 38, 13
    exph 39, 15
    v_mfma_f32_32x32x16_bf16 v[0:15], a[0:3], v[128:131], v[48:63]
    s_waitcnt lgkmcnt(1)
    v_exp_f16 v40, v16
    v_exp_f16 v41, v18
    v_exp_f16 v42, v20
    v_mfma_f32_32x32x16_bf16 v[0:15], a[4:7], v[132:135], v[0:15]
    v_exp_f16 v43, v22
    exph 40, 17
    exph 41, 19
    v_mfma_f32_32x32x16_f16 v[96:111], a[24:27], v[32:35], v[96:111]
    exph 42, 21
    exph 43, 23
    v_exp_f16 v44, v24
    v_mfma_f32_32x32x16_f16 v[96:111], a[28:31], v[36:39], v[96:111]
    v_exp_f16 v45, v26
    v_exp_f16 v46, v28
    v_exp_f16 v47, v30
    v_smfmac_f32_16x16x64_f16 a[48:51], a[56:59], v[32:39], v244
    ds_read_b128 a[20:23], v225 offset:23552
    exph 44, 25
    exph 45, 27
    exph 46, 29
    exph 47, 31
    v_mfma_f32_32x32x16_bf16 v[16:31], a[0:3], v[136:139], v[48:63]
    v_exp_f16 v32, v0
    v_exp_f16 v33, v2
    v_exp_f16 v34, v4
    v_mfma_f32_32x32x16_bf16 v[16:31], a[4:7], v[140:143], v[16:31]
    v_exp_f16 v35, v6
    exph 32, 1
    exph 33, 3
    v_mfma_f32_32x32x16_f16 v[112:127], a[24:27], v[40:43], v[112:127]
    exph 34, 5
    exph 35, 7
    v_exp_f16 v36, v8
    v_mfma_f32_32x32x16_f16 v[112:127], a[28:31], v[44:47], v[112:127]
    v_exp_f16 v37, v10
    v_exp_f16 v38, v12
    v_exp_f16 v39, v14
    v_smfmac_f32_16x16x64_f16 a[52:55], a[56:59], v[40:47], v244
    ds_read_b128 a[8:11], v225 offset:8192
    exph 36, 9
    exph 37, 11
    exph 38, 13
    exph 39, 15
    v_mfma_f32_32x32x16_bf16 v[0:15], a[0:3], v[144:147], v[48:63]
    v_exp_f16 v40, v16
    v_exp_f16 v41, v18
    v_exp_f16 v42, v20
    v_mfma_f32_32x32x16_bf16 v[0:15], a[4:7], v[148:151], v[0:15]
    s_waitcnt lgkmcnt(2)
    v_exp_f16 v43, v22
    exph 40, 17
    exph 41, 19
    v_mfma_f32_32x32x16_f16 v[64:79], a[16:19], v[32:35], v[64:79]
    s_waitcnt lgkmcnt(1)
    exph 42, 21
    exph 43, 23
    v_exp_f16 v44, v24
    v_mfma_f32_32x32x16_f16 v[64:79], a[20:23], v[36:39], v[64:79]
    v_exp_f16 v45, v26
    v_exp_f16 v46, v28
    v_exp_f16 v47, v30
    v_smfmac_f32_16x16x64_f16 a[40:43], a[56:59], v[32:39], v244
    ds_read_b128 a[12:15], v225 offset:9216
    exph 44, 25
    exph 45, 27
    exph 46, 29
    exph 47, 31
    v_mfma_f32_32x32x16_bf16 v[16:31], a[0:3], v[152:155], v[48:63]
    v_exp_f16 v32, v0
    v_exp_f16 v33, v2
    v_exp_f16 v34, v4
    v_mfma_f32_32x32x16_bf16 v[16:31], a[4:7], v[156:159], v[16:31]
    v_exp_f16 v35, v6
    exph 32, 1
    exph 33, 3
    v_mfma_f32_32x32x16_f16 v[80:95], a[16:19], v[40:43], v[80:95]
L_pad8F:
    s_cbranch_vccnz L_ret
    exph 34, 5
    exph 35, 7
    v_exp_f16 v36, v8
    v_mfma_f32_32x32x16_f16 v[80:95], a[20:23], v[44:47], v[80:95]
    v_exp_f16 v37, v10
    v_exp_f16 v38, v12
    v_exp_f16 v39, v14
    v_smfmac_f32_16x16x64_f16 a[44:47], a[56:59], v[40:47], v244
    s_waitcnt lgkmcnt(1)
    ds_read_b128 a[24:27], v225 offset:24576
    exph 36, 9
    exph 37, 11
    exph 38, 13
    exph 39, 15
    v_mfma_f32_32x32x16_bf16 v[0:15], a[8:11], v[128:131], v[48:63]
    s_waitcnt lgkmcnt(1)
    v_exp_f16 v40, v16
    v_exp_f16 v41, v18
    v_exp_f16 v42, v20
    v_mfma_f32_32x32x16_bf16 v[0:15], a[12:15], v[132:135], v[0:15]
    v_exp_f16 v43, v22
    exph 40, 17
    exph 41, 19
    v_mfma_f32_32x32x16_f16 v[96:111], a[16:19], v[32:35], v[96:111]
    exph 42, 21
    exph 43, 23
    v_exp_f16 v44, v24
    v_mfma_f32_32x32x16_f16 v[96:111], a[20:23], v[36:39], v[96:111]
    v_exp_f16 v45, v26
    v_exp_f16 v46, v28
    v_exp_f16 v47, v30
    v_smfmac_f32_16x16x64_f16 a[48:51], a[56:59], v[32:39], v244
    ds_read_b128 a[28:31], v225 offset:25600
    exph 44, 25
    exph 45, 27
    exph 46, 29
    exph 47, 31
    v_mfma_f32_32x32x16_bf16 v[16:31], a[8:11], v[136:139], v[48:63]
    v_exp_f16 v32, v0
    v_exp_f16 v33, v2
    v_exp_f16 v34, v4
    v_mfma_f32_32x32x16_bf16 v[16:31], a[12:15], v[140:143], v[16:31]
    v_exp_f16 v35, v6
    exph 32, 1
    exph 33, 3
    v_mfma_f32_32x32x16_f16 v[112:127], a[16:19], v[40:43], v[112:127]
    exph 34, 5
    exph 35, 7
    v_exp_f16 v36, v8
    v_mfma_f32_32x32x16_f16 v[112:127], a[20:23], v[44:47], v[112:127]
    v_exp_f16 v37, v10
    v_exp_f16 v38, v12
    v_exp_f16 v39, v14
    v_smfmac_f32_16x16x64_f16 a[52:55], a[56:59], v[40:47], v244
    ds_read_b128 a[0:3], v225 offset:10240
    exph 36, 9
    exph 37, 11
    exph 38, 13
    exph 39, 15
    v_mfma_f32_32x32x16_bf16 v[0:15], a[8:11], v[144:147], v[48:63]
    v_exp_f16 v40, v16
    v_exp_f16 v41, v18
    v_exp_f16 v42, v20
    v_mfma_f32_32x32x16_bf16 v[0:15], a[12:15], v[148:151], v[0:15]
    s_waitcnt lgkmcnt(2)
    v_exp_f16 v43, v22
    exph 40, 17
    exph 41, 19
    v_mfma_f32_32x32x16_f16 v[64:79], a[24:27], v[32:35], v[64:79]
    s_waitcnt lgkmcnt(1)
    exph 42, 21
    exph 43, 23
    v_exp_f16 v44, v24
    v_mfma_f32_32x32x16_f16 v[64:79], a[28:31], v[36:39], v[64:79]
    v_exp_f16 v45, v26
    v_exp_f16 v46, v28
    v_exp_f16 v47, v30
    v_smfmac_f32_16x16x64_f16 a[40:43], a[56:59], v[32:39], v244
    ds_read_b128 a[4:7], v225 offset:11264
    exph 44, 25
    exph 45, 27
    exph 46, 29
    exph 47, 31
    v_mfma_f32_32x32x16_bf16 v[16:31], a[8:11], v[152:155], v[48:63]
    v_exp_f16 v32, v0
    v_exp_f16 v33, v2
    v_exp_f16 v34, v4
    v_mfma_f32_32x32x16_bf16 v[16:31], a[12:15], v[156:159], v[16:31]
    v_exp_f16 v35, v6
    exph 32, 1
    exph 33, 3
    v_mfma_f32_32x32x16_f16 v[80:95], a[24:27], v[40:43], v[80:95]
    exph 34, 5
    exph 35, 7
    v_exp_f16 v36, v8
    v_mfma_f32_32x32x16_f16 v[80:95], a[28:31], v[44:47], v[80:95]
    v_exp_f16 v37, v10
    v_exp_f16 v38, v12
    v_exp_f16 v39, v14
    v_smfmac_f32_16x16x64_f16 a[44:47], a[56:59], v[40:47], v244
    s_waitcnt lgkmcnt(1)
    ds_read_b128 a[16:19], v225 offset:26624
    exph 36, 9
    exph 37, 11
    exph 38, 13
    exph 39, 15
    v_mfma_f32_32x32x16_bf16 v[0:15], a[0:3], v[128:131], v[48:63]
    s_waitcnt lgkmcnt(1)
    v_exp_f16 v40, v16
    v_exp_f16 v41, v18
    v_exp_f16 v42, v20
    v_mfma_f32_32x32x16_bf16 v[0:15], a[4:7], v[132:135], v[0:15]
    v_exp_f16 v43, v22
    exph 40, 17
    exph 41, 19
    v_mfma_f32_32x32x16_f16 v[96:111], a[24:27], v[32:35], v[96:111]
    exph 42, 21
    exph 43, 23
    v_exp_f16 v44, v24
    v_mfma_f32_32x32x16_f16 v[96:111], a[28:31], v[36:39], v[96:111]
    v_exp_f16 v45, v26
    v_exp_f16 v46, v28
    v_exp_f16 v47, v30
    v_smfmac_f32_16x16x64_f16 a[48:51], a[56:59], v[32:39], v244
    ds_read_b128 a[20:23], v225 offset:27648
    exph 44, 25
    exph 45, 27
    exph 46, 29
    exph 47, 31
    v_mfma_f32_32x32x16_bf16 v[16:31], a[0:3], v[136:139], v[48:63]
    v_exp_f16 v32, v0
    v_exp_f16 v33, v2
    v_exp_f16 v34, v4
    v_mfma_f32_32x32x16_bf16 v[16:31], a[4:7], v[140:143], v[16:31]
    v_exp_f16 v35, v6
    exph 32, 1
    exph 33, 3
    v_mfma_f32_32x32x16_f16 v[112:127], a[24:27], v[40:43], v[112:127]
    exph 34, 5
    exph 35, 7
    v_exp_f16 v36, v8
    v_mfma_f32_32x32x16_f16 v[112:127], a[28:31], v[44:47], v[112:127]
    v_exp_f16 v37, v10
    v_exp_f16 v38, v12
    v_exp_f16 v39, v14
    v_smfmac_f32_16x16x64_f16 a[52:55], a[56:59], v[40:47], v244
    ds_read_b128 a[8:11], v225 offset:12288
    exph 36, 9
    exph 37, 11
    exph 38, 13
    exph 39, 15
    v_mfma_f32_32x32x16_bf16 v[0:15], a[0:3], v[144:147], v[48:63]
    v_exp_f16 v40, v16
    v_exp_f16 v41, v18
    v_exp_f16 v42, v20
    v_mfma_f32_32x32x16_bf16 v[0:15], a[4:7], v[148:151], v[0:15]
    s_waitcnt lgkmcnt(2)
    v_exp_f16 v43, v22
    exph 40, 17
    exph 41, 19
    v_mfma_f32_32x32x16_f16 v[64:79], a[16:19], v[32:35], v[64:79]
    s_waitcnt lgkmcnt(1)
    exph 42, 21
    exph 43, 23
    v_exp_f16 v44, v24
    v_mfma_f32_32x32x16_f16 v[64:79], a[20:23], v[36:39], v[64:79]
    v_exp_f16 v45, v26
    v_exp_f16 v46, v28
    v_exp_f16 v47, v30
    v_smfmac_f32_16x16x64_f16 a[40:43], a[56:59], v[32:39], v244
    ds_read_b128 a[12:15], v225 offset:13312
    exph 44, 25
    exph 45, 27
    exph 46, 29
    exph 47, 31
    v_mfma_f32_32x32x16_bf16 v[16:31], a[0:3], v[152:155], v[48:63]
    v_exp_f16 v32, v0
    v_exp_f16 v33, v2
    v_exp_f16 v34, v4
    v_mfma_f32_32x32x16_bf16 v[16:31], a[4:7], v[156:159], v[16:31]
    v_exp_f16 v35, v6
    exph 32, 1
    exph 33, 3
    v_mfma_f32_32x32x16_f16 v[80:95], a[16:19], v[40:43], v[80:95]
    exph 34, 5
    exph 35, 7
    v_exp_f16 v36, v8
    v_mfma_f32_32x32x16_f16 v[80:95], a[20:23], v[44:47], v[80:95]
    v_exp_f16 v37, v10
    v_exp_f16 v38, v12
    v_exp_f16 v39, v14
    v_smfmac_f32_16x16x64_f16 a[44:47], a[56:59], v[40:47], v244
    s_waitcnt lgkmcnt(1)
    ds_read_b128 a[24:27], v225 offset:28672
    exph 36, 9
    exph 37, 11
    exph 38, 13
    exph 39, 15
    v_mfma_f32_32x32x16_bf16 v[0:15], a[8:11], v[128:131], v[48:63]
    s_waitcnt lgkmcnt(1)
    v_exp_f16 v40, v16
    v_exp_f16 v41, v18
    v_exp_f16 v42, v20
    v_mfma_f32_32x32x16_bf16 v[0:15], a[12:15], v[132:135], v[0:15]
    v_exp_f16 v43, v22
    exph 40, 17
    exph 41, 19
    v_mfma_f32_32x32x16_f16 v[96:111], a[16:19], v[32:35], v[96:111]
    exph 42, 21
    exph 43, 23
    v_exp_f16 v44, v24
    v_mfma_f32_32x32x16_f16 v[96:111], a[20:23], v[36:39], v[96:111]
    v_exp_f16 v45, v26
    v_exp_f16 v46, v28
    v_exp_f16 v47, v30
    v_smfmac_f32_16x16x64_f16 a[48:51], a[56:59], v[32:39], v244
    ds_read_b128 a[28:31], v225 offset:29696
    exph 44, 25
    exph 45, 27
    exph 46, 29
    exph 47, 31
    v_mfma_f32_32x32x16_bf16 v[16:31], a[8:11], v[136:139], v[48:63]
    v_exp_f16 v32, v0
    v_exp_f16 v33, v2
    v_exp_f16 v34, v4
    v_mfma_f32_32x32x16_bf16 v[16:31], a[12:15], v[140:143], v[16:31]
    v_exp_f16 v35, v6
    exph 32, 1
    exph 33, 3
    v_mfma_f32_32x32x16_f16 v[112:127], a[16:19], v[40:43], v[112:127]
    s_waitcnt vmcnt(0) lgkmcnt(0)
    exph 34, 5
    exph 35, 7
    v_exp_f16 v36, v8
    v_mfma_f32_32x32x16_f16 v[112:127], a[20:23], v[44:47], v[112:127]
    s_barrier
    v_exp_f16 v37, v10
    v_exp_f16 v38, v12
    v_exp_f16 v39, v14
    v_smfmac_f32_16x16x64_f16 a[52:55], a[56:59], v[40:47], v244
    ds_read_b128 a[0:3], v225 offset:32768
    exph 36, 9
    exph 37, 11
    exph 38, 13
    exph 39, 15
    v_mfma_f32_32x32x16_bf16 v[0:15], a[8:11], v[144:147], v[48:63]
    v_exp_f16 v40, v16
    v_exp_f16 v41, v18
    v_exp_f16 v42, v20
    v_mfma_f32_32x32x16_bf16 v[0:15], a[12:15], v[148:151], v[0:15]
    v_exp_f16 v43, v22
    exph 40, 17
    exph 41, 19
    v_mfma_f32_32x32x16_f16 v[64:79], a[24:27], v[32:35], v[64:79]
    exph 42, 21
    exph 43, 23
    v_exp_f16 v44, v24
    v_mfma_f32_32x32x16_f16 v[64:79], a[28:31], v[36:39], v[64:79]
    s_mov_b32 m0, s44
    v_exp_f16 v45, v26
    v_exp_f16 v46, v28
    v_exp_f16 v47, v30
    v_smfmac_f32_16x16x64_f16 a[40:43], a[56:59], v[32:39], v244
    ds_read_b128 a[4:7], v225 offset:33792
    exph 44, 25
    exph 45, 27
    exph 46, 29
    exph 47, 31
    v_mfma_f32_32x32x16_bf16 v[16:31], a[8:11], v[152:155], v[48:63]
    buffer_load_dwordx4 v225, s[48:51], s46 offen offset:0 sc1 lds
    v_exp_f16 v32, v0
    v_exp_f16 v33, v2
    v_exp_f16 v34, v4
    v_mfma_f32_32x32x16_bf16 v[16:31], a[12:15], v[156:159], v[16:31]
    buffer_load_dwordx4 v225, s[48:51], s46 offen offset:1024 sc1 lds
    v_exp_f16 v35, v6
    exph 32, 1
    exph 33, 3
    v_mfma_f32_32x32x16_f16 v[80:95], a[24:27], v[40:43], v[80:95]
    buffer_load_dwordx4 v225, s[48:51], s14 offen offset:2048 sc1 lds
    exph 34, 5
    exph 35, 7
    v_exp_f16 v36, v8
    v_mfma_f32_32x32x16_f16 v[80:95], a[28:31], v[44:47], v[80:95]
    buffer_load_dwordx4 v225, s[48:51], s14 offen offset:3072 sc1 lds
    v_exp_f16 v37, v10
    v_exp_f16 v38, v12
    v_exp_f16 v39, v14
    v_smfmac_f32_16x16x64_f16 a[44:47], a[56:59], v[40:47], v244
    s_waitcnt lgkmcnt(1)
    ds_read_b128 a[16:19], v225 offset:49152
    exph 36, 9
    exph 37, 11
    exph 38, 13
    exph 39, 15
    v_mfma_f32_32x32x16_bf16 v[0:15], a[0:3], v[128:131], v[48:63]
    s_waitcnt lgkmcnt(1)
    v_exp_f16 v40, v16
    v_exp_f16 v41, v18
    v_exp_f16 v42, v20
    v_mfma_f32_32x32x16_bf16 v[0:15], a[4:7], v[132:135], v[0:15]
    v_exp_f16 v43, v22
    exph 40, 17
    exph 41, 19
    v_mfma_f32_32x32x16_f16 v[96:111], a[24:27], v[32:35], v[96:111]
    exph 42, 21
    exph 43, 23
    v_exp_f16 v44, v24
    v_mfma_f32_32x32x16_f16 v[96:111], a[28:31], v[36:39], v[96:111]
    s_mov_b32 m0, s56
    v_exp_f16 v45, v26
    v_exp_f16 v46, v28
    v_exp_f16 v47, v30
    v_smfmac_f32_16x16x64_f16 a[48:51], a[56:59], v[32:39], v244
    ds_read_b128 a[20:23], v225 offset:50176
    exph 44, 25
    exph 45, 27
    exph 46, 29
    exph 47, 31
    v_mfma_f32_32x32x16_bf16 v[16:31], a[0:3], v[136:139], v[48:63]
    buffer_load_dwordx4 v225, s[64:67], s46 offen offset:0 sc1 lds
    v_exp_f16 v32, v0
    v_exp_f16 v33, v2
    v_exp_f16 v34, v4
    v_mfma_f32_32x32x16_bf16 v[16:31], a[4:7], v[140:143], v[16:31]
    buffer_load_dwordx4 v225, s[64:67], s46 offen offset:1024 sc1 lds
    v_exp_f16 v35, v6
    exph 32, 1
    exph 33, 3
    v_mfma_f32_32x32x16_f16 v[112:127], a[24:27], v[40:43], v[112:127]
    buffer_load_dwordx4 v225, s[64:67], s14 offen offset:2048 sc1 lds
    exph 34, 5
    exph 35, 7
    v_exp_f16 v36, v8
    v_mfma_f32_32x32x16_f16 v[112:127], a[28:31], v[44:47], v[112:127]
    buffer_load_dwordx4 v225, s[64:67], s14 offen offset:3072 sc1 lds
    v_exp_f16 v37, v10
    v_exp_f16 v38, v12
    v_exp_f16 v39, v14
    v_smfmac_f32_16x16x64_f16 a[52:55], a[56:59], v[40:47], v244
    ds_read_b128 a[8:11], v225 offset:34816
    exph 36, 9
    exph 37, 11
    exph 38, 13
    exph 39, 15
    v_mfma_f32_32x32x16_bf16 v[0:15], a[0:3], v[144:147], v[48:63]
    v_exp_f16 v40, v16
    v_exp_f16 v41, v18
    v_exp_f16 v42, v20
    v_mfma_f32_32x32x16_bf16 v[0:15], a[4:7], v[148:151], v[0:15]
    s_waitcnt lgkmcnt(2)
    v_exp_f16 v43, v22
    exph 40, 17
    exph 41, 19
    v_mfma_f32_32x32x16_f16 v[64:79], a[16:19], v[32:35], v[64:79]
    s_waitcnt lgkmcnt(1)
    exph 42, 21
    exph 43, 23
    v_exp_f16 v44, v24
    v_mfma_f32_32x32x16_f16 v[64:79], a[20:23], v[36:39], v[64:79]
    v_exp_f16 v45, v26
    v_exp_f16 v46, v28
    v_exp_f16 v47, v30
    v_smfmac_f32_16x16x64_f16 a[40:43], a[56:59], v[32:39], v244
    ds_read_b128 a[12:15], v225 offset:35840
    exph 44, 25
    exph 45, 27
    exph 46, 29
    exph 47, 31
    v_mfma_f32_32x32x16_bf16 v[16:31], a[0:3], v[152:155], v[48:63]
    v_exp_f16 v32, v0
    v_exp_f16 v33, v2
    v_exp_f16 v34, v4
    v_mfma_f32_32x32x16_bf16 v[16:31], a[4:7], v[156:159], v[16:31]
    v_exp_f16 v35, v6
    exph 32, 1
    exph 33, 3
    v_mfma_f32_32x32x16_f16 v[80:95], a[16:19], v[40:43], v[80:95]
    exph 34, 5
    exph 35, 7
    v_exp_f16 v36, v8
    v_mfma_f32_32x32x16_f16 v[80:95], a[20:23], v[44:47], v[80:95]
    v_exp_f16 v37, v10
    v_exp_f16 v38, v12
    v_exp_f16 v39, v14
    v_smfmac_f32_16x16x64_f16 a[44:47], a[56:59], v[40:47], v244
    s_waitcnt lgkmcnt(1)
    ds_read_b128 a[24:27], v225 offset:51200
    exph 36, 9
    exph 37, 11
    exph 38, 13
    exph 39, 15
    v_mfma_f32_32x32x16_bf16 v[0:15], a[8:11], v[128:131], v[48:63]
    s_waitcnt lgkmcnt(1)
    v_exp_f16 v40, v16
    v_exp_f16 v41, v18
    v_exp_f16 v42, v20
    v_mfma_f32_32x32x16_bf16 v[0:15], a[12:15], v[132:135], v[0:15]
    v_exp_f16 v43, v22
    exph 40, 17
    exph 41, 19
    v_mfma_f32_32x32x16_f16 v[96:111], a[16:19], v[32:35], v[96:111]
    exph 42, 21
    exph 43, 23
    v_exp_f16 v44, v24
    v_mfma_f32_32x32x16_f16 v[96:111], a[20:23], v[36:39], v[96:111]
    v_exp_f16 v45, v26
    v_exp_f16 v46, v28
    v_exp_f16 v47, v30
    v_smfmac_f32_16x16x64_f16 a[48:51], a[56:59], v[32:39], v244
    ds_read_b128 a[28:31], v225 offset:52224
    exph 44, 25
    exph 45, 27
    exph 46, 29
    exph 47, 31
    v_mfma_f32_32x32x16_bf16 v[16:31], a[8:11], v[136:139], v[48:63]
    v_exp_f16 v32, v0
    v_exp_f16 v33, v2
    v_exp_f16 v34, v4
    v_mfma_f32_32x32x16_bf16 v[16:31], a[12:15], v[140:143], v[16:31]
    v_exp_f16 v35, v6
    exph 32, 1
    exph 33, 3
    v_mfma_f32_32x32x16_f16 v[112:127], a[16:19], v[40:43], v[112:127]
    exph 34, 5
    exph 35, 7
    v_exp_f16 v36, v8
    v_mfma_f32_32x32x16_f16 v[112:127], a[20:23], v[44:47], v[112:127]
    v_exp_f16 v37, v10
    v_exp_f16 v38, v12
    v_exp_f16 v39, v14
    v_smfmac_f32_16x16x64_f16 a[52:55], a[56:59], v[40:47], v244
    ds_read_b128 a[0:3], v225 offset:36864
    exph 36, 9
    exph 37, 11
    exph 38, 13
    exph 39, 15
    v_mfma_f32_32x32x16_bf16 v[0:15], a[8:11], v[144:147], v[48:63]
    v_exp_f16 v40, v16
    v_exp_f16 v41, v18
    v_exp_f16 v42, v20
    v_mfma_f32_32x32x16_bf16 v[0:15], a[12:15], v[148:151], v[0:15]
    s_waitcnt lgkmcnt(2)
    v_exp_f16 v43, v22
    exph 40, 17
    exph 41, 19
    v_mfma_f32_32x32x16_f16 v[64:79], a[24:27], v[32:35], v[64:79]
    s_waitcnt lgkmcnt(1)
    exph 42, 21
    exph 43, 23
    v_exp_f16 v44, v24
    v_mfma_f32_32x32x16_f16 v[64:79], a[28:31], v[36:39], v[64:79]
    v_exp_f16 v45, v26
    v_exp_f16 v46, v28
    v_exp_f16 v47, v30
    v_smfmac_f32_16x16x64_f16 a[40:43], a[56:59], v[32:39], v244
    ds_read_b128 a[4:7], v225 offset:37888
    exph 44, 25
    exph 45, 27
    exph 46, 29
    exph 47, 31
    v_mfma_f32_32x32x16_bf16 v[16:31], a[8:11], v[152:155], v[48:63]
    v_exp_f16 v32, v0
    v_exp_f16 v33, v2
    v_exp_f16 v34, v4
    v_mfma_f32_32x32x16_bf16 v[16:31], a[12:15], v[156:159], v[16:31]
    v_exp_f16 v35, v6
    exph 32, 1
    exph 33, 3
    v_mfma_f32_32x32x16_f16 v[80:95], a[24:27], v[40:43], v[80:95]
    exph 34, 5
    exph 35, 7
    v_exp_f16 v36, v8
    v_mfma_f32_32x32x16_f16 v[80:95], a[28:31], v[44:47], v[80:95]
    v_exp_f16 v37, v10
    v_exp_f16 v38, v12
    v_exp_f16 v39, v14
    v_smfmac_f32_16x16x64_f16 a[44:47], a[56:59], v[40:47], v244
    s_waitcnt lgkmcnt(1)
    ds_read_b128 a[16:19], v225 offset:53248
    exph 36, 9
    exph 37, 11
    exph 38, 13
    exph 39, 15
    v_mfma_f32_32x32x16_bf16 v[0:15], a[0:3], v[128:131], v[48:63]
    s_waitcnt lgkmcnt(1)
    v_exp_f16 v40, v16
    v_exp_f16 v41, v18
    v_exp_f16 v42, v20
    v_mfma_f32_32x32x16_bf16 v[0:15], a[4:7], v[132:135], v[0:15]
    v_exp_f16 v43, v22
    exph 40, 17
    exph 41, 19
    v_mfma_f32_32x32x16_f16 v[96:111], a[24:27], v[32:35], v[96:111]
    exph 42, 21
    exph 43, 23
    v_exp_f16 v44, v24
    v_mfma_f32_32x32x16_f16 v[96:111], a[28:31], v[36:39], v[96:111]
    v_exp_f16 v45, v26
    v_exp_f16 v46, v28
    v_exp_f16 v47, v30
    v_smfmac_f32_16x16x64_f16 a[48:51], a[56:59], v[32:39], v244
    ds_read_b128 a[20:23], v225 offset:54272
    exph 44, 25
    exph 45, 27
    exph 46, 29
    exph 47, 31
    v_mfma_f32_32x32x16_bf16 v[16:31], a[0:3], v[136:139], v[48:63]
    v_exp_f16 v32, v0
    v_exp_f16 v33, v2
    v_exp_f16 v34, v4
    v_mfma_f32_32x32x16_bf16 v[16:31], a[4:7], v[140:143], v[16:31]
    v_exp_f16 v35, v6
    exph 32, 1
    exph 33, 3
    v_mfma_f32_32x32x16_f16 v[112:127], a[24:27], v[40:43], v[112:127]
    exph 34, 5
    exph 35, 7
    v_exp_f16 v36, v8
    v_mfma_f32_32x32x16_f16 v[112:127], a[28:31], v[44:47], v[112:127]
    v_exp_f16 v37, v10
    v_exp_f16 v38, v12
    v_exp_f16 v39, v14
    v_smfmac_f32_16x16x64_f16 a[52:55], a[56:59], v[40:47], v244
    ds_read_b128 a[8:11], v225 offset:38912
    exph 36, 9
    exph 37, 11
    exph 38, 13
    exph 39, 15
    v_mfma_f32_32x32x16_bf16 v[0:15], a[0:3], v[144:147], v[48:63]
    v_exp_f16 v40, v16
    v_exp_f16 v41, v18
    v_exp_f16 v42, v20
    v_mfma_f32_32x32x16_bf16 v[0:15], a[4:7], v[148:151], v[0:15]
    s_waitcnt lgkmcnt(2)
    v_exp_f16 v43, v22
    exph 40, 17
    exph 41, 19
    v_mfma_f32_32x32x16_f16 v[64:79], a[16:19], v[32:35], v[64:79]
    s_waitcnt lgkmcnt(1)
    exph 42, 21
    exph 43, 23
    v_exp_f16 v44, v24
    v_mfma_f32_32x32x16_f16 v[64:79], a[20:23], v[36:39], v[64:79]
    v_exp_f16 v45, v26
    v_exp_f16 v46, v28
    v_exp_f16 v47, v30
    v_smfmac_f32_16x16x64_f16 a[40:43], a[56:59], v[32:39], v244
    ds_read_b128 a[12:15], v225 offset:39936
    exph 44, 25
    exph 45, 27
    exph 46, 29
    exph 47, 31
    v_mfma_f32_32x32x16_bf16 v[16:31], a[0:3], v[152:155], v[48:63]
    v_exp_f16 v32, v0
    v_exp_f16 v33, v2
    v_exp_f16 v34, v4
    v_mfma_f32_32x32x16_bf16 v[16:31], a[4:7], v[156:159], v[16:31]
    v_exp_f16 v35, v6
    exph 32, 1
    exph 33, 3
    v_mfma_f32_32x32x16_f16 v[80:95], a[16:19], v[40:43], v[80:95]
    exph 34, 5
    exph 35, 7
    v_exp_f16 v36, v8
    v_mfma_f32_32x32x16_f16 v[80:95], a[20:23], v[44:47], v[80:95]
    v_exp_f16 v37, v10
    v_exp_f16 v38, v12
    v_exp_f16 v39, v14
    v_smfmac_f32_16x16x64_f16 a[44:47], a[56:59], v[40:47], v244
    s_waitcnt lgkmcnt(1)
    ds_read_b128 a[24:27], v225 offset:55296
    exph 36, 9
    exph 37, 11
    exph 38, 13
    exph 39, 15
    v_mfma_f32_32x32x16_bf16 v[0:15], a[8:11], v[128:131], v[48:63]
    s_waitcnt lgkmcnt(1)
    v_exp_f16 v40, v16
    v_exp_f16 v41, v18
    v_exp_f16 v42, v20
    v_mfma_f32_32x32x16_bf16 v[0:15], a[12:15], v[132:135], v[0:15]
    v_exp_f16 v43, v22
    exph 40, 17
    exph 41, 19
    v_mfma_f32_32x32x16_f16 v[96:111], a[16:19], v[32:35], v[96:111]
    exph 42, 21
    exph 43, 23
    v_exp_f16 v44, v24
    v_mfma_f32_32x32x16_f16 v[96:111], a[20:23], v[36:39], v[96:111]
    v_exp_f16 v45, v26
    v_exp_f16 v46, v28
    v_exp_f16 v47, v30
    v_smfmac_f32_16x16x64_f16 a[48:51], a[56:59], v[32:39], v244
    ds_read_b128 a[28:31], v225 offset:56320
    exph 44, 25
    exph 45, 27
    exph 46, 29
    exph 47, 31
    v_mfma_f32_32x32x16_bf16 v[16:31], a[8:11], v[136:139], v[48:63]
    v_exp_f16 v32, v0
    v_exp_f16 v33, v2
    v_exp_f16 v34, v4
    v_mfma_f32_32x32x16_bf16 v[16:31], a[12:15], v[140:143], v[16:31]
    v_exp_f16 v35, v6
    exph 32, 1
    exph 33, 3
    v_mfma_f32_32x32x16_f16 v[112:127], a[16:19], v[40:43], v[112:127]
    exph 34, 5
    exph 35, 7
    v_exp_f16 v36, v8
    v_mfma_f32_32x32x16_f16 v[112:127], a[20:23], v[44:47], v[112:127]
    v_exp_f16 v37, v10
    v_exp_f16 v38, v12
    v_exp_f16 v39, v14
    v_smfmac_f32_16x16x64_f16 a[52:55], a[56:59], v[40:47], v244
    ds_read_b128 a[0:3], v225 offset:40960
    exph 36, 9
    exph 37, 11
    exph 38, 13
    exph 39, 15
    v_mfma_f32_32x32x16_bf16 v[0:15], a[8:11], v[144:147], v[48:63]
    v_exp_f16 v40, v16
    v_exp_f16 v41, v18
    v_exp_f16 v42, v20
    v_mfma_f32_32x32x16_bf16 v[0:15], a[12:15], v[148:151], v[0:15]
    s_waitcnt lgkmcnt(2)
    v_exp_f16 v43, v22
    exph 40, 17
    exph 41, 19
    v_mfma_f32_32x32x16_f16 v[64:79], a[24:27], v[32:35], v[64:79]
    s_waitcnt lgkmcnt(1)
    exph 42, 21
    exph 43, 23
    v_exp_f16 v44, v24
    v_mfma_f32_32x32x16_f16 v[64:79], a[28:31], v[36:39], v[64:79]
L_pad9F:
    s_cbranch_vccnz L_ret
    v_exp_f16 v45, v26
    v_exp_f16 v46, v28
    v_exp_f16 v47, v30
    v_smfmac_f32_16x16x64_f16 a[40:43], a[56:59], v[32:39], v244
    ds_read_b128 a[4:7], v225 offset:41984
    exph 44, 25
    exph 45, 27
    exph 46, 29
    exph 47, 31
    v_mfma_f32_32x32x16_bf16 v[16:31], a[8:11], v[152:155], v[48:63]
    v_exp_f16 v32, v0
    v_exp_f16 v33, v2
    v_exp_f16 v34, v4
    v_mfma_f32_32x32x16_bf16 v[16:31], a[12:15], v[156:159], v[16:31]
    v_exp_f16 v35, v6
    exph 32, 1
    exph 33, 3
    v_mfma_f32_32x32x16_f16 v[80:95], a[24:27], v[40:43], v[80:95]
    exph 34, 5
    exph 35, 7
    v_exp_f16 v36, v8
    v_mfma_f32_32x32x16_f16 v[80:95], a[28:31], v[44:47], v[80:95]
    v_exp_f16 v37, v10
    v_exp_f16 v38, v12
    v_exp_f16 v39, v14
    v_smfmac_f32_16x16x64_f16 a[44:47], a[56:59], v[40:47], v244
    s_waitcnt lgkmcnt(1)
    ds_read_b128 a[16:19], v225 offset:57344
    exph 36, 9
    exph 37, 11
    exph 38, 13
    exph 39, 15
    v_mfma_f32_32x32x16_bf16 v[0:15], a[0:3], v[128:131], v[48:63]
    s_waitcnt lgkmcnt(1)
    v_exp_f16 v40, v16
    v_exp_f16 v41, v18
    v_exp_f16 v42, v20
    v_mfma_f32_32x32x16_bf16 v[0:15], a[4:7], v[132:135], v[0:15]
    v_exp_f16 v43, v22
    exph 40, 17
    exph 41, 19
    v_mfma_f32_32x32x16_f16 v[96:111], a[24:27], v[32:35], v[96:111]
    exph 42, 21
    exph 43, 23
    v_exp_f16 v44, v24
    v_mfma_f32_32x32x16_f16 v[96:111], a[28:31], v[36:39], v[96:111]
    v_exp_f16 v45, v26
    v_exp_f16 v46, v28
    v_exp_f16 v47, v30
    v_smfmac_f32_16x16x64_f16 a[48:51], a[56:59], v[32:39], v244
    ds_read_b128 a[20:23], v225 offset:58368
    exph 44, 25
    exph 45, 27
    exph 46, 29
    exph 47, 31
    v_mfma_f32_32x32x16_bf16 v[16:31], a[0:3], v[136:139], v[48:63]
    v_exp_f16 v32, v0
    v_exp_f16 v33, v2
    v_exp_f16 v34, v4
    v_mfma_f32_32x32x16_bf16 v[16:31], a[4:7], v[140:143], v[16:31]
    v_exp_f16 v35, v6
    exph 32, 1
    exph 33, 3
    v_mfma_f32_32x32x16_f16 v[112:127], a[24:27], v[40:43], v[112:127]
    exph 34, 5
    exph 35, 7
    v_exp_f16 v36, v8
    v_mfma_f32_32x32x16_f16 v[112:127], a[28:31], v[44:47], v[112:127]
    v_exp_f16 v37, v10
    v_exp_f16 v38, v12
    v_exp_f16 v39, v14
    v_smfmac_f32_16x16x64_f16 a[52:55], a[56:59], v[40:47], v244
    ds_read_b128 a[8:11], v225 offset:43008
    exph 36, 9
    exph 37, 11
    exph 38, 13
    exph 39, 15
    v_mfma_f32_32x32x16_bf16 v[0:15], a[0:3], v[144:147], v[48:63]
    v_exp_f16 v40, v16
    v_exp_f16 v41, v18
    v_exp_f16 v42, v20
    v_mfma_f32_32x32x16_bf16 v[0:15], a[4:7], v[148:151], v[0:15]
    s_waitcnt lgkmcnt(2)
    v_exp_f16 v43, v22
    exph 40, 17
    exph 41, 19
    v_mfma_f32_32x32x16_f16 v[64:79], a[16:19], v[32:35], v[64:79]
    s_waitcnt lgkmcnt(1)
    exph 42, 21
    exph 43, 23
    v_exp_f16 v44, v24
    v_mfma_f32_32x32x16_f16 v[64:79], a[20:23], v[36:39], v[64:79]
    v_exp_f16 v45, v26
    v_exp_f16 v46, v28
    v_exp_f16 v47, v30
    v_smfmac_f32_16x16x64_f16 a[40:43], a[56:59], v[32:39], v244
    ds_read_b128 a[12:15], v225 offset:44032
    exph 44, 25
    exph 45, 27
    exph 46, 29
    exph 47, 31
    v_mfma_f32_32x32x16_bf16 v[16:31], a[0:3], v[152:155], v[48:63]
    v_exp_f16 v32, v0
    v_exp_f16 v33, v2
    v_exp_f16 v34, v4
    v_mfma_f32_32x32x16_bf16 v[16:31], a[4:7], v[156:159], v[16:31]
    v_exp_f16 v35, v6
    exph 32, 1
    exph 33, 3
    v_mfma_f32_32x32x16_f16 v[80:95], a[16:19], v[40:43], v[80:95]
    exph 34, 5
    exph 35, 7
    v_exp_f16 v36, v8
    v_mfma_f32_32x32x16_f16 v[80:95], a[20:23], v[44:47], v[80:95]
    v_exp_f16 v37, v10
    v_exp_f16 v38, v12
    v_exp_f16 v39, v14
    v_smfmac_f32_16x16x64_f16 a[44:47], a[56:59], v[40:47], v244
    s_waitcnt lgkmcnt(1)
    ds_read_b128 a[24:27], v225 offset:59392
    exph 36, 9
    exph 37, 11
    exph 38, 13
    exph 39, 15
    v_mfma_f32_32x32x16_bf16 v[0:15], a[8:11], v[128:131], v[48:63]
    s_waitcnt lgkmcnt(1)
    v_exp_f16 v40, v16
    v_exp_f16 v41, v18
    v_exp_f16 v42, v20
    v_mfma_f32_32x32x16_bf16 v[0:15], a[12:15], v[132:135], v[0:15]
    v_exp_f16 v43, v22
    exph 40, 17
    exph 41, 19
    v_mfma_f32_32x32x16_f16 v[96:111], a[16:19], v[32:35], v[96:111]
    exph 42, 21
    exph 43, 23
    v_exp_f16 v44, v24
    v_mfma_f32_32x32x16_f16 v[96:111], a[20:23], v[36:39], v[96:111]
    v_exp_f16 v45, v26
    v_exp_f16 v46, v28
    v_exp_f16 v47, v30
    v_smfmac_f32_16x16x64_f16 a[48:51], a[56:59], v[32:39], v244
    ds_read_b128 a[28:31], v225 offset:60416
    exph 44, 25
    exph 45, 27
    exph 46, 29
    exph 47, 31
    v_mfma_f32_32x32x16_bf16 v[16:31], a[8:11], v[136:139], v[48:63]
    v_exp_f16 v32, v0
    v_exp_f16 v33, v2
    v_exp_f16 v34, v4
    v_mfma_f32_32x32x16_bf16 v[16:31], a[12:15], v[140:143], v[16:31]
    v_exp_f16 v35, v6
    exph 32, 1
    exph 33, 3
    v_mfma_f32_32x32x16_f16 v[112:127], a[16:19], v[40:43], v[112:127]
    exph 34, 5
    exph 35, 7
    v_exp_f16 v36, v8
    v_mfma_f32_32x32x16_f16 v[112:127], a[20:23], v[44:47], v[112:127]
    v_exp_f16 v37, v10
    v_exp_f16 v38, v12
    v_exp_f16 v39, v14
    v_smfmac_f32_16x16x64_f16 a[52:55], a[56:59], v[40:47], v244
    ds_read_b128 a[0:3], v225 offset:45056
    exph 36, 9
    exph 37, 11
    exph 38, 13
    exph 39, 15
    v_mfma_f32_32x32x16_bf16 v[0:15], a[8:11], v[144:147], v[48:63]
    v_exp_f16 v40, v16
    v_exp_f16 v41, v18
    v_exp_f16 v42, v20
    v_mfma_f32_32x32x16_bf16 v[0:15], a[12:15], v[148:151], v[0:15]
    s_waitcnt lgkmcnt(2)
    v_exp_f16 v43, v22
    exph 40, 17
    exph 41, 19
    v_mfma_f32_32x32x16_f16 v[64:79], a[24:27], v[32:35], v[64:79]
    s_waitcnt lgkmcnt(1)
    exph 42, 21
    exph 43, 23
    v_exp_f16 v44, v24
    v_mfma_f32_32x32x16_f16 v[64:79], a[28:31], v[36:39], v[64:79]
    v_exp_f16 v45, v26
    v_exp_f16 v46, v28
    v_exp_f16 v47, v30
    v_smfmac_f32_16x16x64_f16 a[40:43], a[56:59], v[32:39], v244
    ds_read_b128 a[4:7], v225 offset:46080
    exph 44, 25
    exph 45, 27
    exph 46, 29
    exph 47, 31
    v_mfma_f32_32x32x16_bf16 v[16:31], a[8:11], v[152:155], v[48:63]
    v_exp_f16 v32, v0
    v_exp_f16 v33, v2
    v_exp_f16 v34, v4
    v_mfma_f32_32x32x16_bf16 v[16:31], a[12:15], v[156:159], v[16:31]
    v_exp_f16 v35, v6
    exph 32, 1
    exph 33, 3
    v_mfma_f32_32x32x16_f16 v[80:95], a[24:27], v[40:43], v[80:95]
    exph 34, 5
    exph 35, 7
    v_exp_f16 v36, v8
    v_mfma_f32_32x32x16_f16 v[80:95], a[28:31], v[44:47], v[80:95]
    v_exp_f16 v37, v10
    v_exp_f16 v38, v12
    v_exp_f16 v39, v14
    v_smfmac_f32_16x16x64_f16 a[44:47], a[56:59], v[40:47], v244
    s_waitcnt lgkmcnt(1)
    ds_read_b128 a[16:19], v225 offset:61440
    exph 36, 9
    exph 37, 11
    exph 38, 13
    exph 39, 15
    v_mfma_f32_32x32x16_bf16 v[0:15], a[0:3], v[128:131], v[48:63]
    s_waitcnt lgkmcnt(1)
    v_exp_f16 v40, v16
    v_exp_f16 v41, v18
    v_exp_f16 v42, v20
    v_mfma_f32_32x32x16_bf16 v[0:15], a[4:7], v[132:135], v[0:15]
    v_exp_f16 v43, v22
    exph 40, 17
    exph 41, 19
    v_mfma_f32_32x32x16_f16 v[96:111], a[24:27], v[32:35], v[96:111]
    exph 42, 21
    exph 43, 23
    v_exp_f16 v44, v24
    v_mfma_f32_32x32x16_f16 v[96:111], a[28:31], v[36:39], v[96:111]
    v_exp_f16 v45, v26
    v_exp_f16 v46, v28
    v_exp_f16 v47, v30
    v_smfmac_f32_16x16x64_f16 a[48:51], a[56:59], v[32:39], v244
    ds_read_b128 a[20:23], v225 offset:62464
    exph 44, 25
    exph 45, 27
    exph 46, 29
    exph 47, 31
    v_mfma_f32_32x32x16_bf16 v[16:31], a[0:3], v[136:139], v[48:63]
    v_exp_f16 v32, v0
    v_exp_f16 v33, v2
    v_exp_f16 v34, v4
    v_mfma_f32_32x32x16_bf16 v[16:31], a[4:7], v[140:143], v[16:31]
    v_exp_f16 v35, v6
    exph 32, 1
    exph 33, 3
    v_mfma_f32_32x32x16_f16 v[112:127], a[24:27], v[40:43], v[112:127]
    s_waitcnt vmcnt(0) lgkmcnt(0)
    exph 34, 5
    exph 35, 7
    v_exp_f16 v36, v8
    v_mfma_f32_32x32x16_f16 v[112:127], a[28:31], v[44:47], v[112:127]
    s_barrier
    v_exp_f16 v37, v10
    v_exp_f16 v38, v12
    v_exp_f16 v39, v14
    v_smfmac_f32_16x16x64_f16 a[52:55], a[56:59], v[40:47], v244
    ds_read_b128 a[8:11], v225 offset:0
    exph 36, 9
    exph 37, 11
    exph 38, 13
    exph 39, 15
    v_mfma_f32_32x32x16_bf16 v[0:15], a[0:3], v[144:147], v[48:63]
    v_exp_f16 v40, v16
    v_exp_f16 v41, v18
    v_exp_f16 v42, v20
    v_mfma_f32_32x32x16_bf16 v[0:15], a[4:7], v[148:151], v[0:15]
    v_exp_f16 v43, v22
    exph 40, 17
    exph 41, 19
    v_mfma_f32_32x32x16_f16 v[64:79], a[16:19], v[32:35], v[64:79]
    exph 42, 21
    exph 43, 23
    v_exp_f16 v44, v24
    v_mfma_f32_32x32x16_f16 v[64:79], a[20:23], v[36:39], v[64:79]
    v_exp_f16 v45, v26
    v_exp_f16 v46, v28
    v_exp_f16 v47, v30
    v_smfmac_f32_16x16x64_f16 a[40:43], a[56:59], v[32:39], v244
    ds_read_b128 a[12:15], v225 offset:1024
    exph 44, 25
    exph 45, 27
    exph 46, 29
    exph 47, 31
    v_mfma_f32_32x32x16_bf16 v[16:31], a[0:3], v[152:155], v[48:63]
    v_exp_f16 v32, v0
    v_exp_f16 v33, v2
    v_exp_f16 v34, v4
    v_mfma_f32_32x32x16_bf16 v[16:31], a[4:7], v[156:159], v[16:31]
    v_exp_f16 v35, v6
    exph 32, 1
    exph 33, 3
    v_mfma_f32_32x32x16_f16 v[80:95], a[16:19], v[40:43], v[80:95]
    exph 34, 5
    exph 35, 7
    v_exp_f16 v36, v8
    v_mfma_f32_32x32x16_f16 v[80:95], a[20:23], v[44:47], v[80:95]
    v_exp_f16 v37, v10
    v_exp_f16 v38, v12
    v_exp_f16 v39, v14
    v_smfmac_f32_16x16x64_f16 a[44:47], a[56:59], v[40:47], v244
    s_waitcnt lgkmcnt(1)
    ds_read_b128 a[24:27], v225 offset:16384
    exph 36, 9
    exph 37, 11
    exph 38, 13
    exph 39, 15
    v_mfma_f32_32x32x16_bf16 v[0:15], a[8:11], v[128:131], v[48:63]
    s_waitcnt lgkmcnt(1)
    v_exp_f16 v40, v16
    v_exp_f16 v41, v18
    v_exp_f16 v42, v20
    v_mfma_f32_32x32x16_bf16 v[0:15], a[12:15], v[132:135], v[0:15]
    v_exp_f16 v43, v22
    exph 40, 17
    exph 41, 19
    v_mfma_f32_32x32x16_f16 v[96:111], a[16:19], v[32:35], v[96:111]
    exph 42, 21
    exph 43, 23
    v_exp_f16 v44, v24
    v_mfma_f32_32x32x16_f16 v[96:111], a[20:23], v[36:39], v[96:111]
    v_exp_f16 v45, v26
    v_exp_f16 v46, v28
    v_exp_f16 v47, v30
    v_smfmac_f32_16x16x64_f16 a[48:51], a[56:59], v[32:39], v244
    ds_read_b128 a[28:31], v225 offset:17408
    exph 44, 25
    exph 45, 27
    exph 46, 29
    exph 47, 31
    v_mfma_f32_32x32x16_bf16 v[16:31], a[8:11], v[136:139], v[48:63]
    v_exp_f16 v32, v0
    v_exp_f16 v33, v2
    v_exp_f16 v34, v4
    v_mfma_f32_32x32x16_bf16 v[16:31], a[12:15], v[140:143], v[16:31]
    v_exp_f16 v35, v6
    exph 32, 1
    exph 33, 3
    v_mfma_f32_32x32x16_f16 v[112:127], a[16:19], v[40:43], v[112:127]
    exph 34, 5
    exph 35, 7
    v_exp_f16 v36, v8
    v_mfma_f32_32x32x16_f16 v[112:127], a[20:23], v[44:47], v[112:127]
    v_exp_f16 v37, v10
    v_exp_f16 v38, v12
    v_exp_f16 v39, v14
    v_smfmac_f32_16x16x64_f16 a[52:55], a[56:59], v[40:47], v244
    ds_read_b128 a[0:3], v225 offset:2048
    exph 36, 9
    exph 37, 11
    exph 38, 13
    exph 39, 15
    v_mfma_f32_32x32x16_bf16 v[0:15], a[8:11], v[144:147], v[48:63]
    v_exp_f16 v40, v16
    v_exp_f16 v41, v18
    v_exp_f16 v42, v20
    v_mfma_f32_32x32x16_bf16 v[0:15], a[12:15], v[148:151], v[0:15]
    s_waitcnt lgkmcnt(2)
    v_exp_f16 v43, v22
    exph 40, 17
    exph 41, 19
    v_mfma_f32_32x32x16_f16 v[64:79], a[24:27], v[32:35], v[64:79]
    s_waitcnt lgkmcnt(1)
    exph 42, 21
    exph 43, 23
    v_exp_f16 v44, v24
    v_mfma_f32_32x32x16_f16 v[64:79], a[28:31], v[36:39], v[64:79]
    v_exp_f16 v45, v26
    v_exp_f16 v46, v28
    v_exp_f16 v47, v30
    v_smfmac_f32_16x16x64_f16 a[40:43], a[56:59], v[32:39], v244
    ds_read_b128 a[4:7], v225 offset:3072
    exph 44, 25
    exph 45, 27
    exph 46, 29
    exph 47, 31
    v_mfma_f32_32x32x16_bf16 v[16:31], a[8:11], v[152:155], v[48:63]
    v_exp_f16 v32, v0
    v_exp_f16 v33, v2
    v_exp_f16 v34, v4
    v_mfma_f32_32x32x16_bf16 v[16:31], a[12:15], v[156:159], v[16:31]
    v_exp_f16 v35, v6
    exph 32, 1
    exph 33, 3
    v_mfma_f32_32x32x16_f16 v[80:95], a[24:27], v[40:43], v[80:95]
    exph 34, 5
    exph 35, 7
    v_exp_f16 v36, v8
    v_mfma_f32_32x32x16_f16 v[80:95], a[28:31], v[44:47], v[80:95]
    v_exp_f16 v37, v10
    v_exp_f16 v38, v12
    v_exp_f16 v39, v14
    v_smfmac_f32_16x16x64_f16 a[44:47], a[56:59], v[40:47], v244
    s_waitcnt lgkmcnt(1)
    ds_read_b128 a[16:19], v225 offset:18432
    exph 36, 9
    exph 37, 11
    exph 38, 13
    exph 39, 15
    v_mfma_f32_32x32x16_bf16 v[0:15], a[0:3], v[128:131], v[48:63]
    s_waitcnt lgkmcnt(1)
    v_exp_f16 v40, v16
    v_exp_f16 v41, v18
    v_exp_f16 v42, v20
    v_mfma_f32_32x32x16_bf16 v[0:15], a[4:7], v[132:135], v[0:15]
    v_exp_f16 v43, v22
    exph 40, 17
    exph 41, 19
    v_mfma_f32_32x32x16_f16 v[96:111], a[24:27], v[32:35], v[96:111]
    exph 42, 21
    exph 43, 23
    v_exp_f16 v44, v24
    v_mfma_f32_32x32x16_f16 v[96:111], a[28:31], v[36:39], v[96:111]
    v_exp_f16 v45, v26
    v_exp_f16 v46, v28
    v_exp_f16 v47, v30
    v_smfmac_f32_16x16x64_f16 a[48:51], a[56:59], v[32:39], v244
    ds_read_b128 a[20:23], v225 offset:19456
    exph 44, 25
    exph 45, 27
    exph 46, 29
    exph 47, 31
    v_mfma_f32_32x32x16_bf16 v[16:31], a[0:3], v[136:139], v[48:63]
    v_exp_f16 v32, v0
    v_exp_f16 v33, v2
    v_exp_f16 v34, v4
    v_mfma_f32_32x32x16_bf16 v[16:31], a[4:7], v[140:143], v[16:31]
    v_exp_f16 v35, v6
    exph 32, 1
    exph 33, 3
    v_mfma_f32_32x32x16_f16 v[112:127], a[24:27], v[40:43], v[112:127]
    exph 34, 5
    exph 35, 7
    v_exp_f16 v36, v8
    v_mfma_f32_32x32x16_f16 v[112:127], a[28:31], v[44:47], v[112:127]
    v_exp_f16 v37, v10
    v_exp_f16 v38, v12
    v_exp_f16 v39, v14
    v_smfmac_f32_16x16x64_f16 a[52:55], a[56:59], v[40:47], v244
    ds_read_b128 a[8:11], v225 offset:4096
    exph 36, 9
    exph 37, 11
    exph 38, 13
    exph 39, 15
    v_mfma_f32_32x32x16_bf16 v[0:15], a[0:3], v[144:147], v[48:63]
    v_exp_f16 v40, v16
    v_exp_f16 v41, v18
    v_exp_f16 v42, v20
    v_mfma_f32_32x32x16_bf16 v[0:15], a[4:7], v[148:151], v[0:15]
    s_waitcnt lgkmcnt(2)
    v_exp_f16 v43, v22
    exph 40, 17
    exph 41, 19
    v_mfma_f32_32x32x16_f16 v[64:79], a[16:19], v[32:35], v[64:79]
    s_waitcnt lgkmcnt(1)
    exph 42, 21
    exph 43, 23
    v_exp_f16 v44, v24
    v_mfma_f32_32x32x16_f16 v[64:79], a[20:23], v[36:39], v[64:79]
    v_exp_f16 v45, v26
    v_exp_f16 v46, v28
    v_exp_f16 v47, v30
    v_smfmac_f32_16x16x64_f16 a[40:43], a[56:59], v[32:39], v244
    ds_read_b128 a[12:15], v225 offset:5120
    exph 44, 25
    exph 45, 27
    exph 46, 29
    exph 47, 31
    v_mfma_f32_32x32x16_bf16 v[16:31], a[0:3], v[152:155], v[48:63]
    v_exp_f16 v32, v0
    v_exp_f16 v33, v2
    v_exp_f16 v34, v4
    v_mfma_f32_32x32x16_bf16 v[16:31], a[4:7], v[156:159], v[16:31]
    v_exp_f16 v35, v6
    exph 32, 1
    exph 33, 3
    v_mfma_f32_32x32x16_f16 v[80:95], a[16:19], v[40:43], v[80:95]
    exph 34, 5
    exph 35, 7
    v_exp_f16 v36, v8
    v_mfma_f32_32x32x16_f16 v[80:95], a[20:23], v[44:47], v[80:95]
    v_exp_f16 v37, v10
    v_exp_f16 v38, v12
    v_exp_f16 v39, v14
    v_smfmac_f32_16x16x64_f16 a[44:47], a[56:59], v[40:47], v244
    s_waitcnt lgkmcnt(1)
    ds_read_b128 a[24:27], v225 offset:20480
    exph 36, 9
    exph 37, 11
    exph 38, 13
    exph 39, 15
    v_mfma_f32_32x32x16_bf16 v[0:15], a[8:11], v[128:131], v[48:63]
    s_waitcnt lgkmcnt(1)
    v_exp_f16 v40, v16
    v_exp_f16 v41, v18
    v_exp_f16 v42, v20
    v_mfma_f32_32x32x16_bf16 v[0:15], a[12:15], v[132:135], v[0:15]
    v_exp_f16 v43, v22
    exph 40, 17
    exph 41, 19
    v_mfma_f32_32x32x16_f16 v[96:111], a[16:19], v[32:35], v[96:111]
    exph 42, 21
    exph 43, 23
    v_exp_f16 v44, v24
    v_mfma_f32_32x32x16_f16 v[96:111], a[20:23], v[36:39], v[96:111]
    v_exp_f16 v45, v26
    v_exp_f16 v46, v28
    v_exp_f16 v47, v30
    v_smfmac_f32_16x16x64_f16 a[48:51], a[56:59], v[32:39], v244
    ds_read_b128 a[28:31], v225 offset:21504
    exph 44, 25
    exph 45, 27
    exph 46, 29
    exph 47, 31
    v_mfma_f32_32x32x16_bf16 v[16:31], a[8:11], v[136:139], v[48:63]
    v_exp_f16 v32, v0
    v_exp_f16 v33, v2
    v_exp_f16 v34, v4
    v_mfma_f32_32x32x16_bf16 v[16:31], a[12:15], v[140:143], v[16:31]
    v_exp_f16 v35, v6
    exph 32, 1
    exph 33, 3
    v_mfma_f32_32x32x16_f16 v[112:127], a[16:19], v[40:43], v[112:127]
    exph 34, 5
    exph 35, 7
    v_exp_f16 v36, v8
    v_mfma_f32_32x32x16_f16 v[112:127], a[20:23], v[44:47], v[112:127]
    v_exp_f16 v37, v10
    v_exp_f16 v38, v12
    v_exp_f16 v39, v14
    v_smfmac_f32_16x16x64_f16 a[52:55], a[56:59], v[40:47], v244
    ds_read_b128 a[0:3], v225 offset:6144
    exph 36, 9
    exph 37, 11
    exph 38, 13
    exph 39, 15
    v_mfma_f32_32x32x16_bf16 v[0:15], a[8:11], v[144:147], v[48:63]
    v_exp_f16 v40, v16
    v_exp_f16 v41, v18
    v_exp_f16 v42, v20
    v_mfma_f32_32x32x16_bf16 v[0:15], a[12:15], v[148:151], v[0:15]
    s_waitcnt lgkmcnt(2)
    v_exp_f16 v43, v22
    exph 40, 17
    exph 41, 19
    v_mfma_f32_32x32x16_f16 v[64:79], a[24:27], v[32:35], v[64:79]
    s_waitcnt lgkmcnt(1)
    exph 42, 21
    exph 43, 23
    v_exp_f16 v44, v24
    v_mfma_f32_32x32x16_f16 v[64:79], a[28:31], v[36:39], v[64:79]
    v_exp_f16 v45, v26
    v_exp_f16 v46, v28
    v_exp_f16 v47, v30
    v_smfmac_f32_16x16x64_f16 a[40:43], a[56:59], v[32:39], v244
    ds_read_b128 a[4:7], v225 offset:7168
    exph 44, 25
    exph 45, 27
    exph 46, 29
    exph 47, 31
    v_mfma_f32_32x32x16_bf16 v[16:31], a[8:11], v[152:155], v[48:63]
    v_exp_f16 v32, v0
    v_exp_f16 v33, v2
    v_exp_f16 v34, v4
    v_mfma_f32_32x32x16_bf16 v[16:31], a[12:15], v[156:159], v[16:31]
    v_exp_f16 v35, v6
    exph 32, 1
    exph 33, 3
    v_mfma_f32_32x32x16_f16 v[80:95], a[24:27], v[40:43], v[80:95]
    exph 34, 5
    exph 35, 7
    v_exp_f16 v36, v8
    v_mfma_f32_32x32x16_f16 v[80:95], a[28:31], v[44:47], v[80:95]
    v_exp_f16 v37, v10
    v_exp_f16 v38, v12
    v_exp_f16 v39, v14
    v_smfmac_f32_16x16x64_f16 a[44:47], a[56:59], v[40:47], v244
    s_waitcnt lgkmcnt(1)
    ds_read_b128 a[16:19], v225 offset:22528
    exph 36, 9
    exph 37, 11
    exph 38, 13
    exph 39, 15
    v_mfma_f32_32x32x16_bf16 v[0:15], a[0:3], v[128:131], v[48:63]
    s_waitcnt lgkmcnt(1)
    v_exp_f16 v40, v16
    v_exp_f16 v41, v18
    v_exp_f16 v42, v20
    v_mfma_f32_32x32x16_bf16 v[0:15], a[4:7], v[132:135], v[0:15]
    v_exp_f16 v43, v22
    exph 40, 17
    exph 41, 19
    v_mfma_f32_32x32x16_f16 v[96:111], a[24:27], v[32:35], v[96:111]
    exph 42, 21
    exph 43, 23
    v_exp_f16 v44, v24
    v_mfma_f32_32x32x16_f16 v[96:111], a[28:31], v[36:39], v[96:111]
    v_exp_f16 v45, v26
    v_exp_f16 v46, v28
    v_exp_f16 v47, v30
    v_smfmac_f32_16x16x64_f16 a[48:51], a[56:59], v[32:39], v244
    ds_read_b128 a[20:23], v225 offset:23552
    exph 44, 25
    exph 45, 27
    exph 46, 29
    exph 47, 31
    v_mfma_f32_32x32x16_bf16 v[16:31], a[0:3], v[136:139], v[48:63]
    ds_read_b128 a[8:11], v225 offset:8192
    v_exp_f16 v32, v0
    v_exp_f16 v33, v2
    v_exp_f16 v34, v4
    v_mfma_f32_32x32x16_bf16 v[16:31], a[4:7], v[140:143], v[16:31]
    ds_read_b128 a[12:15], v225 offset:9216
    v_exp_f16 v35, v6
    exph 32, 1
    exph 33, 3
    v_mfma_f32_32x32x16_f16 v[112:127], a[24:27], v[40:43], v[112:127]
    exph 34, 5
    exph 35, 7
    v_exp_f16 v36, v8
    v_mfma_f32_32x32x16_f16 v[112:127], a[28:31], v[44:47], v[112:127]
    v_exp_f16 v37, v10
    v_exp_f16 v38, v12
    v_exp_f16 v39, v14
    v_smfmac_f32_16x16x64_f16 a[52:55], a[56:59], v[40:47], v244
    s_waitcnt lgkmcnt(1)
    ds_read_b128 a[24:27], v225 offset:24576
    exph 36, 9
    exph 37, 11
    exph 38, 13
    exph 39, 15
    v_mfma_f32_32x32x16_bf16 v[0:15], a[8:11], v[128:131], v[48:63]
    s_waitcnt lgkmcnt(1)
    v_exp_f16 v40, v16
    v_exp_f16 v41, v18
    v_exp_f16 v42, v20
    v_mfma_f32_32x32x16_bf16 v[0:15], a[12:15], v[132:135], v[0:15]
L_pad10F:
    s_cbranch_vccnz L_ret
    v_exp_f16 v43, v22
    exph 40, 17
    exph 41, 19
    v_mfma_f32_32x32x16_f16 v[64:79], a[16:19], v[32:35], v[64:79]
    exph 42, 21
    exph 43, 23
    v_exp_f16 v44, v24
    v_mfma_f32_32x32x16_f16 v[64:79], a[20:23], v[36:39], v[64:79]
    v_exp_f16 v45, v26
    v_exp_f16 v46, v28
    v_exp_f16 v47, v30
    v_smfmac_f32_16x16x64_f16 a[40:43], a[56:59], v[32:39], v244
    ds_read_b128 a[28:31], v225 offset:25600
    exph 44, 25
    exph 45, 27
    exph 46, 29
    exph 47, 31
    v_mfma_f32_32x32x16_bf16 v[16:31], a[8:11], v[136:139], v[48:63]
    ds_read_b128 a[0:3], v225 offset:10240
    v_exp_f16 v32, v0
    v_exp_f16 v33, v2
    v_exp_f16 v34, v4
    v_mfma_f32_32x32x16_bf16 v[16:31], a[12:15], v[140:143], v[16:31]
    ds_read_b128 a[4:7], v225 offset:11264
    v_exp_f16 v35, v6
    exph 32, 1
    exph 33, 3
    v_mfma_f32_32x32x16_f16 v[80:95], a[16:19], v[40:43], v[80:95]
    exph 34, 5
    exph 35, 7
    v_exp_f16 v36, v8
    v_mfma_f32_32x32x16_f16 v[80:95], a[20:23], v[44:47], v[80:95]
    v_exp_f16 v37, v10
    v_exp_f16 v38, v12
    v_exp_f16 v39, v14
    v_smfmac_f32_16x16x64_f16 a[44:47], a[56:59], v[40:47], v244
    s_waitcnt lgkmcnt(1)
    ds_read_b128 a[16:19], v225 offset:26624
    exph 36, 9
    exph 37, 11
    exph 38, 13
    exph 39, 15
    v_mfma_f32_32x32x16_bf16 v[0:15], a[0:3], v[128:131], v[48:63]
    s_waitcnt lgkmcnt(1)
    v_exp_f16 v40, v16
    v_exp_f16 v41, v18
    v_exp_f16 v42, v20
    v_mfma_f32_32x32x16_bf16 v[0:15], a[4:7], v[132:135], v[0:15]
    v_exp_f16 v43, v22
    exph 40, 17
    exph 41, 19
    v_mfma_f32_32x32x16_f16 v[64:79], a[24:27], v[32:35], v[64:79]
    exph 42, 21
    exph 43, 23
    v_exp_f16 v44, v24
    v_mfma_f32_32x32x16_f16 v[64:79], a[28:31], v[36:39], v[64:79]
    v_exp_f16 v45, v26
    v_exp_f16 v46, v28
    v_exp_f16 v47, v30
    v_smfmac_f32_16x16x64_f16 a[40:43], a[56:59], v[32:39], v244
    ds_read_b128 a[20:23], v225 offset:27648
    exph 44, 25
    exph 45, 27
    exph 46, 29
    exph 47, 31
    v_mfma_f32_32x32x16_bf16 v[16:31], a[0:3], v[136:139], v[48:63]
    ds_read_b128 a[8:11], v225 offset:12288
    v_exp_f16 v32, v0
    v_exp_f16 v33, v2
    v_exp_f16 v34, v4
    v_mfma_f32_32x32x16_bf16 v[16:31], a[4:7], v[140:143], v[16:31]
    ds_read_b128 a[12:15], v225 offset:13312
    v_exp_f16 v35, v6
    exph 32, 1
    exph 33, 3
    v_mfma_f32_32x32x16_f16 v[80:95], a[24:27], v[40:43], v[80:95]
    exph 34, 5
    exph 35, 7
    v_exp_f16 v36, v8
    v_mfma_f32_32x32x16_f16 v[80:95], a[28:31], v[44:47], v[80:95]
    v_exp_f16 v37, v10
    v_exp_f16 v38, v12
    v_exp_f16 v39, v14
    v_smfmac_f32_16x16x64_f16 a[44:47], a[56:59], v[40:47], v244
    s_waitcnt lgkmcnt(1)
    ds_read_b128 a[24:27], v225 offset:28672
    exph 36, 9
    exph 37, 11
    exph 38, 13
    exph 39, 15
    v_mfma_f32_32x32x16_bf16 v[0:15], a[8:11], v[128:131], v[48:63]
    s_waitcnt lgkmcnt(1)
    v_exp_f16 v40, v16
    v_exp_f16 v41, v18
    v_exp_f16 v42, v20
    v_mfma_f32_32x32x16_bf16 v[0:15], a[12:15], v[132:135], v[0:15]
    v_exp_f16 v43, v22
    exph 40, 17
    exph 41, 19
    v_mfma_f32_32x32x16_f16 v[64:79], a[16:19], v[32:35], v[64:79]
    exph 42, 21
    exph 43, 23
    v_exp_f16 v44, v24
    v_mfma_f32_32x32x16_f16 v[64:79], a[20:23], v[36:39], v[64:79]
    v_exp_f16 v45, v26
    v_exp_f16 v46, v28
    v_exp_f16 v47, v30
    v_smfmac_f32_16x16x64_f16 a[40:43], a[56:59], v[32:39], v244
    ds_read_b128 a[28:31], v225 offset:29696
    exph 44, 25
    exph 45, 27
    exph 46, 29
    exph 47, 31
    v_mfma_f32_32x32x16_bf16 v[16:31], a[8:11], v[136:139], v[48:63]
    ds_read_b128 a[0:3], v225 offset:6144
    v_exp_f16 v32, v0
    v_exp_f16 v33, v2
    v_exp_f16 v34, v4
    v_mfma_f32_32x32x16_bf16 v[16:31], a[12:15], v[140:143], v[16:31]
    ds_read_b128 a[4:7], v225 offset:7168
    v_exp_f16 v35, v6
    exph 32, 1
    exph 33, 3
    v_mfma_f32_32x32x16_f16 v[80:95], a[16:19], v[40:43], v[80:95]
    exph 34, 5
    exph 35, 7
    v_exp_f16 v36, v8
    v_mfma_f32_32x32x16_f16 v[80:95], a[20:23], v[44:47], v[80:95]
    v_exp_f16 v37, v10
    v_exp_f16 v38, v12
    v_exp_f16 v39, v14
    v_smfmac_f32_16x16x64_f16 a[44:47], a[56:59], v[40:47], v244
    s_waitcnt lgkmcnt(1)
    ds_read_b128 a[16:19], v225 offset:22528
    exph 36, 9
    exph 37, 11
    exph 38, 13
    exph 39, 15
    v_mfma_f32_32x32x16_bf16 v[0:15], a[0:3], v[144:147], v[48:63]
    s_waitcnt lgkmcnt(1)
    v_exp_f16 v40, v16
    v_exp_f16 v41, v18
    v_exp_f16 v42, v20
    v_mfma_f32_32x32x16_bf16 v[0:15], a[4:7], v[148:151], v[0:15]
    v_exp_f16 v43, v22
    exph 40, 17
    exph 41, 19
    v_mfma_f32_32x32x16_f16 v[64:79], a[24:27], v[32:35], v[64:79]
    exph 42, 21
    exph 43, 23
    v_exp_f16 v44, v24
    v_mfma_f32_32x32x16_f16 v[64:79], a[28:31], v[36:39], v[64:79]
    v_exp_f16 v45, v26
    v_exp_f16 v46, v28
    v_exp_f16 v47, v30
    v_smfmac_f32_16x16x64_f16 a[40:43], a[56:59], v[32:39], v244
    ds_read_b128 a[20:23], v225 offset:23552
    exph 44, 25
    exph 45, 27
    exph 46, 29
    exph 47, 31
    v_mfma_f32_32x32x16_bf16 v[16:31], a[0:3], v[152:155], v[48:63]
    ds_read_b128 a[8:11], v225 offset:8192
    v_exp_f16 v32, v0
    v_exp_f16 v33, v2
    v_exp_f16 v34, v4
    v_mfma_f32_32x32x16_bf16 v[16:31], a[4:7], v[156:159], v[16:31]
    ds_read_b128 a[12:15], v225 offset:9216
    v_exp_f16 v35, v6
    exph 32, 1
    v_accvgpr_read_b32 v236, a40
    exph 33, 3
    v_mfma_f32_32x32x16_f16 v[80:95], a[24:27], v[40:43], v[80:95]
    exph 34, 5
    v_accvgpr_read_b32 v237, a41
    exph 35, 7
    v_add_f32 v236, v236, v237
    v_exp_f16 v36, v8
    v_mfma_f32_32x32x16_f16 v[80:95], a[28:31], v[44:47], v[80:95]
    v_exp_f16 v37, v10
    v_rcp_f32 v236, v236
    v_exp_f16 v38, v12
    v_exp_f16 v39, v14
    v_smfmac_f32_16x16x64_f16 a[44:47], a[56:59], v[40:47], v244
    s_waitcnt lgkmcnt(1)
    ds_read_b128 a[24:27], v225 offset:24576
    exph 36, 9
    v_mul_f32 v237, v246, v236
    exph 37, 11
    exph 38, 13
    exph 39, 15
    v_pk_fma_f32 v[64:65], v[64:65], v[236:237], v[236:237] op_sel:[0,0,1] op_sel_hi:[1,0,1]
    v_pk_fma_f32 v[66:67], v[66:67], v[236:237], v[236:237] op_sel:[0,0,1] op_sel_hi:[1,0,1]
    v_pk_fma_f32 v[68:69], v[68:69], v[236:237], v[236:237] op_sel:[0,0,1] op_sel_hi:[1,0,1]
    v_pk_fma_f32 v[70:71], v[70:71], v[236:237], v[236:237] op_sel:[0,0,1] op_sel_hi:[1,0,1]
    v_pk_fma_f32 v[72:73], v[72:73], v[236:237], v[236:237] op_sel:[0,0,1] op_sel_hi:[1,0,1]
    v_pk_fma_f32 v[74:75], v[74:75], v[236:237], v[236:237] op_sel:[0,0,1] op_sel_hi:[1,0,1]
    v_pk_fma_f32 v[76:77], v[76:77], v[236:237], v[236:237] op_sel:[0,0,1] op_sel_hi:[1,0,1]
    v_pk_fma_f32 v[78:79], v[78:79], v[236:237], v[236:237] op_sel:[0,0,1] op_sel_hi:[1,0,1]
    v_cvt_pk_bf16_f32 v160, v64, v65
    v_cvt_pk_bf16_f32 v164, v72, v73
    v_cvt_pk_bf16_f32 v161, v66, v67
    v_cvt_pk_bf16_f32 v165, v74, v75
    v_cvt_pk_bf16_f32 v162, v68, v69
    v_cvt_pk_bf16_f32 v166, v76, v77
    v_cvt_pk_bf16_f32 v163, v70, v71
    v_cvt_pk_bf16_f32 v167, v78, v79
    v_permlane16_swap_b32 v160, v164
    v_permlane16_swap_b32 v161, v165
    v_permlane16_swap_b32 v162, v166
    v_permlane16_swap_b32 v163, v167
    v_mfma_f32_32x32x16_bf16 v[0:15], a[8:11], v[144:147], v[48:63]
    s_waitcnt lgkmcnt(1)
    v_exp_f16 v40, v16
    v_exp_f16 v41, v18
    v_exp_f16 v42, v20
    v_mfma_f32_32x32x16_bf16 v[0:15], a[12:15], v[148:151], v[0:15]
    v_exp_f16 v43, v22
    exph 40, 17
    exph 41, 19
    v_mfma_f32_32x32x16_f16 v[96:111], a[16:19], v[32:35], v[96:111]
    exph 42, 21
    exph 43, 23
    v_exp_f16 v44, v24
    v_mfma_f32_32x32x16_f16 v[96:111], a[20:23], v[36:39], v[96:111]
    ds_read_b128 a[28:31], v225 offset:25600
    v_exp_f16 v45, v26
    v_exp_f16 v46, v28
    v_exp_f16 v47, v30
    v_smfmac_f32_16x16x64_f16 a[48:51], a[56:59], v[32:39], v244
    buffer_store_dwordx4 v[160:163], v229, s[28:31], s98 offen offset:0 sc1
    exph 44, 25
    exph 45, 27
    exph 46, 29
    exph 47, 31
    v_mfma_f32_32x32x16_bf16 v[16:31], a[8:11], v[152:155], v[48:63]
    ds_read_b128 a[0:3], v225 offset:10240
    v_exp_f16 v32, v0
    v_exp_f16 v33, v2
    v_exp_f16 v34, v4
    v_mfma_f32_32x32x16_bf16 v[16:31], a[12:15], v[156:159], v[16:31]
    ds_read_b128 a[4:7], v225 offset:11264
    v_exp_f16 v35, v6
    exph 32, 1
    v_accvgpr_read_b32 v236, a44
    exph 33, 3
    v_mfma_f32_32x32x16_f16 v[112:127], a[16:19], v[40:43], v[112:127]
    exph 34, 5
    v_accvgpr_read_b32 v237, a45
    exph 35, 7
    v_add_f32 v236, v236, v237
    v_exp_f16 v36, v8
    v_mfma_f32_32x32x16_f16 v[112:127], a[20:23], v[44:47], v[112:127]
    ds_read_b128 a[16:19], v225 offset:26624
    v_exp_f16 v37, v10
    v_rcp_f32 v236, v236
    v_exp_f16 v38, v12
    v_exp_f16 v39, v14
    v_smfmac_f32_16x16x64_f16 a[52:55], a[56:59], v[40:47], v244
    s_waitcnt lgkmcnt(2)
    buffer_store_dwordx4 v[164:167], v229, s[28:31], s98 offen offset:1024 sc1
    exph 36, 9
    v_mul_f32 v237, v246, v236
    exph 37, 11
    exph 38, 13
    exph 39, 15
    v_pk_fma_f32 v[80:81], v[80:81], v[236:237], v[236:237] op_sel:[0,0,1] op_sel_hi:[1,0,1]
    v_pk_fma_f32 v[82:83], v[82:83], v[236:237], v[236:237] op_sel:[0,0,1] op_sel_hi:[1,0,1]
    v_pk_fma_f32 v[84:85], v[84:85], v[236:237], v[236:237] op_sel:[0,0,1] op_sel_hi:[1,0,1]
    v_pk_fma_f32 v[86:87], v[86:87], v[236:237], v[236:237] op_sel:[0,0,1] op_sel_hi:[1,0,1]
    v_pk_fma_f32 v[88:89], v[88:89], v[236:237], v[236:237] op_sel:[0,0,1] op_sel_hi:[1,0,1]
    v_pk_fma_f32 v[90:91], v[90:91], v[236:237], v[236:237] op_sel:[0,0,1] op_sel_hi:[1,0,1]
    v_pk_fma_f32 v[92:93], v[92:93], v[236:237], v[236:237] op_sel:[0,0,1] op_sel_hi:[1,0,1]
    v_pk_fma_f32 v[94:95], v[94:95], v[236:237], v[236:237] op_sel:[0,0,1] op_sel_hi:[1,0,1]
    v_cvt_pk_bf16_f32 v168, v80, v81
    v_cvt_pk_bf16_f32 v172, v88, v89
    v_cvt_pk_bf16_f32 v169, v82, v83
    v_cvt_pk_bf16_f32 v173, v90, v91
    v_cvt_pk_bf16_f32 v170, v84, v85
    v_cvt_pk_bf16_f32 v174, v92, v93
    v_cvt_pk_bf16_f32 v171, v86, v87
    v_cvt_pk_bf16_f32 v175, v94, v95
    v_permlane16_swap_b32 v168, v172
    v_permlane16_swap_b32 v169, v173
    v_permlane16_swap_b32 v170, v174
    v_permlane16_swap_b32 v171, v175
    v_mfma_f32_32x32x16_bf16 v[0:15], a[0:3], v[144:147], v[48:63]
    s_waitcnt lgkmcnt(1)
    v_exp_f16 v40, v16
    v_exp_f16 v41, v18
    v_exp_f16 v42, v20
    v_mfma_f32_32x32x16_bf16 v[0:15], a[4:7], v[148:151], v[0:15]
    v_exp_f16 v43, v22
    exph 40, 17
    exph 41, 19
    v_mfma_f32_32x32x16_f16 v[96:111], a[24:27], v[32:35], v[96:111]
    exph 42, 21
    exph 43, 23
    v_exp_f16 v44, v24
    v_mfma_f32_32x32x16_f16 v[96:111], a[28:31], v[36:39], v[96:111]
    ds_read_b128 a[20:23], v225 offset:27648
    v_exp_f16 v45, v26
    v_exp_f16 v46, v28
    v_exp_f16 v47, v30
    v_smfmac_f32_16x16x64_f16 a[48:51], a[56:59], v[32:39], v244
    buffer_store_dwordx4 v[168:171], v229, s[28:31], s99 offen offset:0 sc1
    exph 44, 25
    exph 45, 27
    exph 46, 29
    exph 47, 31
    v_mfma_f32_32x32x16_bf16 v[16:31], a[0:3], v[152:155], v[48:63]
    ds_read_b128 a[8:11], v225 offset:12288
    v_exp_f16 v32, v0
    v_exp_f16 v33, v2
    v_exp_f16 v34, v4
    v_mfma_f32_32x32x16_bf16 v[16:31], a[4:7], v[156:159], v[16:31]
    ds_read_b128 a[12:15], v225 offset:13312
    v_exp_f16 v35, v6
    exph 32, 1
    exph 33, 3
    v_mfma_f32_32x32x16_f16 v[112:127], a[24:27], v[40:43], v[112:127]
    exph 34, 5
    exph 35, 7
    v_exp_f16 v36, v8
    v_mfma_f32_32x32x16_f16 v[112:127], a[28:31], v[44:47], v[112:127]
    ds_read_b128 a[24:27], v225 offset:28672
    v_exp_f16 v37, v10
    v_exp_f16 v38, v12
    v_exp_f16 v39, v14
    v_smfmac_f32_16x16x64_f16 a[52:55], a[56:59], v[40:47], v244
    s_waitcnt lgkmcnt(2)
    buffer_store_dwordx4 v[172:175], v229, s[28:31], s99 offen offset:1024 sc1
    exph 36, 9
    exph 37, 11
    exph 38, 13
    exph 39, 15
    v_mfma_f32_32x32x16_bf16 v[0:15], a[8:11], v[144:147], v[48:63]
    s_waitcnt lgkmcnt(1)
    v_exp_f16 v40, v16
    v_exp_f16 v41, v18
    v_exp_f16 v42, v20
    v_mfma_f32_32x32x16_bf16 v[0:15], a[12:15], v[148:151], v[0:15]
    v_exp_f16 v43, v22
    exph 40, 17
    exph 41, 19
    v_mfma_f32_32x32x16_f16 v[96:111], a[16:19], v[32:35], v[96:111]
    exph 42, 21
    exph 43, 23
    v_exp_f16 v44, v24
    v_mfma_f32_32x32x16_f16 v[96:111], a[20:23], v[36:39], v[96:111]
    v_exp_f16 v45, v26
    v_exp_f16 v46, v28
    v_exp_f16 v47, v30
    v_smfmac_f32_16x16x64_f16 a[48:51], a[56:59], v[32:39], v244
    ds_read_b128 a[28:31], v225 offset:29696
    exph 44, 25
    exph 45, 27
    exph 46, 29
    exph 47, 31
    v_mfma_f32_32x32x16_bf16 v[16:31], a[8:11], v[152:155], v[48:63]
    v_exp_f16 v32, v0
    v_exp_f16 v33, v2
    v_exp_f16 v34, v4
    v_mfma_f32_32x32x16_bf16 v[16:31], a[12:15], v[156:159], v[16:31]
    v_exp_f16 v35, v6
    exph 32, 1
    exph 33, 3
    v_mfma_f32_32x32x16_f16 v[112:127], a[16:19], v[40:43], v[112:127]
    exph 34, 5
    exph 35, 7
    v_exp_f16 v36, v8
    v_mfma_f32_32x32x16_f16 v[112:127], a[20:23], v[44:47], v[112:127]
    v_exp_f16 v37, v10
    v_exp_f16 v38, v12
    v_exp_f16 v39, v14
    v_smfmac_f32_16x16x64_f16 a[52:55], a[56:59], v[40:47], v244
    s_waitcnt lgkmcnt(1)
    exph 36, 9
    exph 37, 11
    exph 38, 13
    exph 39, 15
    v_mfma_f32_32x32x16_f16 v[96:111], a[24:27], v[32:35], v[96:111]
    s_waitcnt lgkmcnt(0)
    v_exp_f16 v40, v16
    v_exp_f16 v41, v18
    v_exp_f16 v42, v20
    v_mfma_f32_32x32x16_f16 v[96:111], a[28:31], v[36:39], v[96:111]
    v_exp_f16 v43, v22
    exph 40, 17
    exph 41, 19
    v_smfmac_f32_16x16x64_f16 a[48:51], a[56:59], v[32:39], v244
    exph 42, 21
    exph 43, 23
    v_exp_f16 v44, v24
    v_exp_f16 v45, v26
    v_mfma_f32_32x32x16_f16 v[112:127], a[24:27], v[40:43], v[112:127]
    v_exp_f16 v46, v28
    v_exp_f16 v47, v30
    exph 44, 25
    v_accvgpr_read_b32 v236, a48
    v_accvgpr_read_b32 v237, a49
    v_add_f32 v236, v236, v237
    exph 45, 27
    v_rcp_f32 v236, v236
    exph 46, 29
    exph 47, 31
    v_mul_f32 v237, v246, v236
    v_pk_fma_f32 v[96:97], v[96:97], v[236:237], v[236:237] op_sel:[0,0,1] op_sel_hi:[1,0,1]
    v_pk_fma_f32 v[98:99], v[98:99], v[236:237], v[236:237] op_sel:[0,0,1] op_sel_hi:[1,0,1]
    v_pk_fma_f32 v[100:101], v[100:101], v[236:237], v[236:237] op_sel:[0,0,1] op_sel_hi:[1,0,1]
    v_pk_fma_f32 v[102:103], v[102:103], v[236:237], v[236:237] op_sel:[0,0,1] op_sel_hi:[1,0,1]
    v_pk_fma_f32 v[104:105], v[104:105], v[236:237], v[236:237] op_sel:[0,0,1] op_sel_hi:[1,0,1]
    v_pk_fma_f32 v[106:107], v[106:107], v[236:237], v[236:237] op_sel:[0,0,1] op_sel_hi:[1,0,1]
    v_pk_fma_f32 v[108:109], v[108:109], v[236:237], v[236:237] op_sel:[0,0,1] op_sel_hi:[1,0,1]
    v_pk_fma_f32 v[110:111], v[110:111], v[236:237], v[236:237] op_sel:[0,0,1] op_sel_hi:[1,0,1]
    v_mfma_f32_32x32x16_f16 v[112:127], a[28:31], v[44:47], v[112:127]
    v_smfmac_f32_16x16x64_f16 a[52:55], a[56:59], v[40:47], v244
    v_cvt_pk_bf16_f32 v176, v96, v97
    v_cvt_pk_bf16_f32 v180, v104, v105
    v_cvt_pk_bf16_f32 v177, v98, v99
    v_cvt_pk_bf16_f32 v181, v106, v107
    v_cvt_pk_bf16_f32 v178, v100, v101
    v_cvt_pk_bf16_f32 v182, v108, v109
    v_cvt_pk_bf16_f32 v179, v102, v103
    v_cvt_pk_bf16_f32 v183, v110, v111
    v_permlane16_swap_b32 v176, v180
    v_permlane16_swap_b32 v177, v181
    v_permlane16_swap_b32 v178, v182
    v_permlane16_swap_b32 v179, v183
    buffer_store_dwordx4 v[176:179], v229, s[28:31], s100 offen offset:0 sc1
    buffer_store_dwordx4 v[180:183], v229, s[28:31], s100 offen offset:1024 sc1
    v_accvgpr_read_b32 v236, a52
    v_accvgpr_read_b32 v237, a53
    v_add_f32 v236, v236, v237
    v_rcp_f32 v236, v236
    s_nop 0
    v_mul_f32 v237, v246, v236
    v_pk_fma_f32 v[112:113], v[112:113], v[236:237], v[236:237] op_sel:[0,0,1] op_sel_hi:[1,0,1]
    v_pk_fma_f32 v[114:115], v[114:115], v[236:237], v[236:237] op_sel:[0,0,1] op_sel_hi:[1,0,1]
    v_pk_fma_f32 v[116:117], v[116:117], v[236:237], v[236:237] op_sel:[0,0,1] op_sel_hi:[1,0,1]
    v_pk_fma_f32 v[118:119], v[118:119], v[236:237], v[236:237] op_sel:[0,0,1] op_sel_hi:[1,0,1]
    v_pk_fma_f32 v[120:121], v[120:121], v[236:237], v[236:237] op_sel:[0,0,1] op_sel_hi:[1,0,1]
    v_pk_fma_f32 v[122:123], v[122:123], v[236:237], v[236:237] op_sel:[0,0,1] op_sel_hi:[1,0,1]
    v_pk_fma_f32 v[124:125], v[124:125], v[236:237], v[236:237] op_sel:[0,0,1] op_sel_hi:[1,0,1]
    v_pk_fma_f32 v[126:127], v[126:127], v[236:237], v[236:237] op_sel:[0,0,1] op_sel_hi:[1,0,1]
    v_cvt_pk_bf16_f32 v184, v112, v113
    v_cvt_pk_bf16_f32 v188, v120, v121
    v_cvt_pk_bf16_f32 v185, v114, v115
    v_cvt_pk_bf16_f32 v189, v122, v123
    v_cvt_pk_bf16_f32 v186, v116, v117
    v_cvt_pk_bf16_f32 v190, v124, v125
    v_cvt_pk_bf16_f32 v187, v118, v119
    v_cvt_pk_bf16_f32 v191, v126, v127
    v_permlane16_swap_b32 v184, v188
    v_permlane16_swap_b32 v185, v189
    v_permlane16_swap_b32 v186, v190
    v_permlane16_swap_b32 v187, v191
    buffer_store_dwordx4 v[184:187], v229, s[28:31], s101 offen offset:0 sc1
    buffer_store_dwordx4 v[188:191], v229, s[28:31], s101 offen offset:1024 sc1
    v_pk_mul_f32 v[236:237], 0, 0
    v_dot2c_f32_bf16 v236, v160, v237
    v_dot2c_f32_bf16 v236, v161, v237
    v_dot2c_f32_bf16 v236, v162, v237
    v_dot2c_f32_bf16 v236, v163, v237
    v_dot2c_f32_bf16 v236, v164, v237
    v_dot2c_f32_bf16 v236, v165, v237
    v_dot2c_f32_bf16 v236, v166, v237
    v_dot2c_f32_bf16 v236, v167, v237
    v_dot2c_f32_bf16 v236, v168, v237
    v_dot2c_f32_bf16 v236, v169, v237
    v_dot2c_f32_bf16 v236, v170, v237
    v_dot2c_f32_bf16 v236, v171, v237
    v_dot2c_f32_bf16 v236, v172, v237
    v_dot2c_f32_bf16 v236, v173, v237
    v_dot2c_f32_bf16 v236, v174, v237
    v_dot2c_f32_bf16 v236, v175, v237
    v_dot2c_f32_bf16 v236, v176, v237
    v_dot2c_f32_bf16 v236, v177, v237
    v_dot2c_f32_bf16 v236, v178, v237
    v_dot2c_f32_bf16 v236, v179, v237
    v_dot2c_f32_bf16 v236, v180, v237
    v_dot2c_f32_bf16 v236, v181, v237
    v_dot2c_f32_bf16 v236, v182, v237
    v_dot2c_f32_bf16 v236, v183, v237
    v_dot2c_f32_bf16 v236, v184, v237
    v_dot2c_f32_bf16 v236, v185, v237
    v_dot2c_f32_bf16 v236, v186, v237
    v_dot2c_f32_bf16 v236, v187, v237
    v_dot2c_f32_bf16 v236, v188, v237
    v_dot2c_f32_bf16 v236, v189, v237
    v_dot2c_f32_bf16 v236, v190, v237
    v_dot2c_f32_bf16 v236, v191, v237
    s_nop 2
    v_cmp_u_f32 s[62:63], v236, v236
    s_nop 1
    s_cmp_eq_u64 s[62:63], 0
    s_cbranch_scc1 L_fin
    ds_write_b32 v235, v235
L_fin:
    s_waitcnt lgkmcnt(0)
    s_barrier
    ds_read_b32 v239, v235
    s_waitcnt lgkmcnt(0)
    v_readfirstlane_b32 s62, v239
    s_nop 1
    s_cmp_lg_u32 s62, 0
    s_cbranch_scc1 L_slow
    s_endpgm
.p2align 12
L_mainB:
L_pad0B:
    s_cbranch_vccnz L_goB
L_goB:
    s_mov_b64 vcc, 0
    s_add_u32 m0, s58, 4096
    s_nop 0
    buffer_load_dwordx4 v249, s[20:23], s38 offen offset:0 nt lds
    buffer_load_dwordx4 v249, s[20:23], s38 offen offset:1024 nt lds
    s_add_u32 m0, s58, 6144
    s_nop 0
    buffer_load_dwordx4 v249, s[16:19], s99 offen offset:0 nt lds
    buffer_load_dwordx4 v249, s[16:19], s99 offen offset:1024 nt lds
    s_add_u32 m0, s47, 24576
    s_nop 0
    buffer_load_dwordx4 v225, s[24:27], s38 offen offset:0 nt lds
    buffer_load_dwordx4 v225, s[24:27], s38 offen offset:1024 nt lds
    buffer_load_dwordx2 v[232:233], v225, s[52:55], 0 offen sc1
    ds_write_b32 v235, v241
    s_waitcnt vmcnt(7)
    ds_read_b128 v[16:19], v250 offset:0
    ds_read_b128 v[128:131], v250 offset:2048
    ds_read_b128 v[20:23], v251 offset:0
    ds_read_b128 v[132:135], v251 offset:2048
    v_mfma_f32_32x32x16_bf16 v[64:79], v[240:243], a[36:39], 0
    v_lshrrev_b32 v39, 4, v225
    v_and_b32 v37, 32, v39
    v_lshlrev_b32 v226, 4, v37
    v_and_b32 v37, 12, v39
    v_lshl_add_u32 v226, v37, 4, v226
    v_and_b32 v37, 1, v39
    v_mfma_f32_32x32x16_bf16 v[80:95], v[240:243], a[36:39], 0
    v_lshl_add_u32 v226, v37, 5, v226
    v_and_b32 v37, 16, v39
    v_add_u32 v226, v226, v37
    v_and_b32 v37, 2, v39
    v_lshl_add_u32 v226, v37, 2, v226
    v_and_b32 v37, 7, v39
    v_mfma_f32_32x32x16_bf16 v[96:111], v[240:243], a[36:39], 0
    v_cmp_eq_u32 s[62:63], 0, v37
    v_add_u32 v226, 0x4000, v226
    v_mov_b32 v36, 0x3f803f80
    v_cndmask_b32 v38, 0, v36, s[62:63]
    v_cmp_eq_u32 s[62:63], 4, v37
    v_accvgpr_write_b32 a32, v38
    v_mfma_f32_32x32x16_bf16 v[112:127], v[240:243], a[36:39], 0
    v_accvgpr_write_b32 a33, v38
    v_cndmask_b32 v38, 0, v36, s[62:63]
    v_mov_b32 v224, 0xdddddddd
    v_accvgpr_write_b32 a34, v38
    v_accvgpr_write_b32 a35, v38
    v_pk_mul_f32 v[208:209], 0, 0
    v_pk_mul_f32 v[210:211], 0, 0
    v_pk_mul_f32 v[212:213], 0, 0
    v_pk_mul_f32 v[214:215], 0, 0
    v_pk_mul_f32 v[216:217], 0, 0
    v_pk_mul_f32 v[218:219], 0, 0
    v_pk_mul_f32 v[220:221], 0, 0
    v_pk_mul_f32 v[222:223], 0, 0
    v_pk_mul_f32 v[236:237], 0, 0
    s_waitcnt lgkmcnt(3)
    v_dot2c_f32_bf16 v236, v16, v16
    s_waitcnt lgkmcnt(2)
    v_dot2c_f32_bf16 v237, v128, v128
    v_dot2c_f32_bf16 v236, v17, v17
    v_dot2c_f32_bf16 v237, v129, v129
    v_dot2c_f32_bf16 v236, v18, v18
    v_dot2c_f32_bf16 v237, v130, v130
    v_dot2c_f32_bf16 v236, v19, v19
    v_dot2c_f32_bf16 v237, v131, v131
    s_waitcnt lgkmcnt(1)
    v_dot2c_f32_bf16 v236, v20, v20
    s_waitcnt lgkmcnt(0)
    v_dot2c_f32_bf16 v237, v132, v132
    v_dot2c_f32_bf16 v236, v21, v21
    v_dot2c_f32_bf16 v237, v133, v133
    v_dot2c_f32_bf16 v236, v22, v22
    v_dot2c_f32_bf16 v237, v134, v134
    v_dot2c_f32_bf16 v236, v23, v23
    v_dot2c_f32_bf16 v237, v135, v135
    v_mfma_f32_4x4x4_16b_bf16 v[160:163], v[230:231], v[16:17], 0
    v_mfma_f32_4x4x4_16b_bf16 v[164:167], v[230:231], v[18:19], 0
    v_mfma_f32_4x4x4_16b_bf16 v[168:171], v[230:231], v[20:21], 0
    v_permlane32_swap_b32 v236, v237
    v_add_f32 v236, v236, v237
    v_mfma_f32_4x4x4_16b_bf16 v[172:175], v[230:231], v[22:23], 0
    v_sqrt_f32 v236, v236
    v_mfma_f32_4x4x4_16b_bf16 v[176:179], v[230:231], v[128:129], 0
    v_add_f32 v236, 0x358637bd, v236
    v_rcp_f32 v236, v236
    v_mfma_f32_4x4x4_16b_bf16 v[180:183], v[230:231], v[130:131], 0
    v_mov_b32 v237, v236
    v_mfma_f32_4x4x4_16b_bf16 v[184:187], v[230:231], v[132:133], 0
    v_mfma_f32_4x4x4_16b_bf16 v[188:191], v[230:231], v[134:135], 0
    v_permlane32_swap_b32 v236, v237
    v_mul_f32 v237, v238, v237
    v_pk_mul_f32 v[160:161], v[160:161], v[236:237] op_sel_hi:[1,0]
    v_pk_mul_f32 v[162:163], v[162:163], v[236:237] op_sel_hi:[1,0]
    v_pk_mul_f32 v[164:165], v[164:165], v[236:237] op_sel_hi:[1,0]
    v_pk_mul_f32 v[166:167], v[166:167], v[236:237] op_sel_hi:[1,0]
    v_pk_mul_f32 v[168:169], v[168:169], v[236:237] op_sel_hi:[1,0]
    v_pk_mul_f32 v[170:171], v[170:171], v[236:237] op_sel_hi:[1,0]
    v_pk_mul_f32 v[172:173], v[172:173], v[236:237] op_sel_hi:[1,0]
    v_pk_mul_f32 v[174:175], v[174:175], v[236:237] op_sel_hi:[1,0]
    v_pk_mul_f32 v[176:177], v[176:177], v[236:237] op_sel:[0,1]
    v_pk_mul_f32 v[178:179], v[178:179], v[236:237] op_sel:[0,1]
    v_pk_mul_f32 v[180:181], v[180:181], v[236:237] op_sel:[0,1]
    v_pk_mul_f32 v[182:183], v[182:183], v[236:237] op_sel:[0,1]
    v_pk_mul_f32 v[184:185], v[184:185], v[236:237] op_sel:[0,1]
    v_pk_mul_f32 v[186:187], v[186:187], v[236:237] op_sel:[0,1]
    v_pk_mul_f32 v[188:189], v[188:189], v[236:237] op_sel:[0,1]
    v_pk_mul_f32 v[190:191], v[190:191], v[236:237] op_sel:[0,1]
    v_cvt_pk_bf16_f32 v16, v160, v161
    v_cvt_pk_bf16_f32 v17, v162, v163
    v_cvt_pk_bf16_f32 v18, v164, v165
    v_cvt_pk_bf16_f32 v19, v166, v167
    v_cvt_pk_bf16_f32 v20, v168, v169
    v_cvt_pk_bf16_f32 v21, v170, v171
    v_cvt_pk_bf16_f32 v22, v172, v173
    v_cvt_pk_bf16_f32 v23, v174, v175
    ds_write_b128 v245, v[16:19] offset:0
    ds_write_b128 v245, v[20:23] offset:1024
    v_cvt_pk_bf16_f32 v128, v176, v177
    v_cvt_pk_bf16_f32 v129, v178, v179
    v_cvt_pk_bf16_f32 v130, v180, v181
    v_cvt_pk_bf16_f32 v131, v182, v183
    v_cvt_pk_bf16_f32 v132, v184, v185
    v_cvt_pk_bf16_f32 v133, v186, v187
    v_cvt_pk_bf16_f32 v134, v188, v189
    v_cvt_pk_bf16_f32 v135, v190, v191
    s_waitcnt lgkmcnt(0)
    s_barrier
    ds_read_b128 a[0:3], v225 offset:0
    ds_read_b128 a[4:7], v225 offset:1024
    ds_read_b128 a[8:11], v225 offset:2048
    ds_read_b128 a[12:15], v225 offset:3072
    ds_read_b64_tr_b16 a[16:17], v226 offset:0
    ds_read_b64_tr_b16 a[18:19], v226 offset:256
    ds_read_b64_tr_b16 a[20:21], v226 offset:1024
    ds_read_b64_tr_b16 a[22:23], v226 offset:1280
    s_waitcnt lgkmcnt(7)
    v_mfma_f32_32x32x16_bf16 v[0:15], a[0:3], v[128:131], 4.0
    s_waitcnt lgkmcnt(6)
    v_mfma_f32_32x32x16_bf16 v[0:15], a[4:7], v[132:135], v[0:15]
    s_nop 8
    s_waitcnt lgkmcnt(5)
    v_mfma_f32_32x32x16_bf16 v[16:31], a[8:11], v[128:131], 4.0
    s_waitcnt lgkmcnt(4)
    ds_read_b128 a[0:3], v225 offset:4096
    v_exp_f32 v0, v0
    v_exp_f32 v1, v1
    v_exp_f32 v2, v2
    v_mfma_f32_32x32x16_bf16 v[16:31], a[12:15], v[132:135], v[16:31]
    s_waitcnt lgkmcnt(3)
    ds_read_b128 a[4:7], v225 offset:5120
    v_exp_f32 v3, v3
    v_exp_f32 v4, v4
    v_exp_f32 v5, v5
    v_exp_f32 v6, v6
    v_exp_f32 v7, v7
    v_exp_f32 v8, v8
    ds_read_b64_tr_b16 a[24:25], v226 offset:2048
    ds_read_b64_tr_b16 a[26:27], v226 offset:2304
    v_exp_f32 v9, v9
    v_smfmac_f32_32x32x32_bf16 v[64:79], a[16:19], v[0:7], v224
    s_add_u32 m0, s58, 8192
    v_exp_f32 v10, v10
    v_exp_f32 v11, v11
    v_exp_f32 v12, v12
    v_smfmac_f32_16x16x64_bf16 v[208:211], a[32:35], v[0:7], v224
    s_waitcnt lgkmcnt(3)
    ds_read_b64_tr_b16 a[28:29], v226 offset:3072
    ds_read_b64_tr_b16 a[30:31], v226 offset:3328
    buffer_load_dwordx4 v249, s[16:19], s100 offen offset:0 nt lds
    buffer_load_dwordx4 v249, s[16:19], s100 offen offset:1024 nt lds
    v_exp_f32 v13, v13
    v_exp_f32 v14, v14
    v_exp_f32 v15, v15
    v_mfma_f32_32x32x16_bf16 v[32:47], a[0:3], v[128:131], 4.0
    s_waitcnt lgkmcnt(4)
    ds_read_b128 a[8:11], v225 offset:6144
    v_exp_f32 v16, v16
    v_exp_f32 v17, v17
    v_exp_f32 v18, v18
    v_mfma_f32_32x32x16_bf16 v[32:47], a[4:7], v[132:135], v[32:47]
    ds_read_b128 a[12:15], v225 offset:7168
    v_exp_f32 v19, v19
    v_exp_f32 v20, v20
    v_exp_f32 v21, v21
    v_smfmac_f32_32x32x32_bf16 v[64:79], a[20:23], v[8:15], v224
    s_lshl_b32 s45, s34, 1
    s_mul_i32 s37, s45, 14336
    v_exp_f32 v22, v22
    v_exp_f32 v23, v23
    v_exp_f32 v24, v24
    v_smfmac_f32_16x16x64_bf16 v[208:211], a[32:35], v[8:15], v224
    s_waitcnt lgkmcnt(4)
    ds_read_b64_tr_b16 a[16:17], v226 offset:4096
    ds_read_b64_tr_b16 a[18:19], v226 offset:4352
    v_exp_f32 v25, v25
    v_smfmac_f32_32x32x32_bf16 v[64:79], a[24:27], v[16:23], v224
    s_add_u32 m0, s58, 10240
    v_exp_f32 v26, v26
    v_exp_f32 v27, v27
    v_exp_f32 v28, v28
    v_smfmac_f32_16x16x64_bf16 v[208:211], a[32:35], v[16:23], v224
    s_waitcnt lgkmcnt(3)
    ds_read_b64_tr_b16 a[20:21], v226 offset:5120
    ds_read_b64_tr_b16 a[22:23], v226 offset:5376
    buffer_load_dwordx4 v249, s[16:19], s101 offen offset:0 nt lds
    buffer_load_dwordx4 v249, s[16:19], s101 offen offset:1024 nt lds
    v_exp_f32 v29, v29
    v_exp_f32 v30, v30
    v_exp_f32 v31, v31
    v_mfma_f32_32x32x16_bf16 v[48:63], a[8:11], v[128:131], 4.0
    s_waitcnt lgkmcnt(4)
    ds_read_b128 a[0:3], v225 offset:0
    v_exp_f32 v32, v32
    v_exp_f32 v33, v33
    v_exp_f32 v34, v34
    v_mfma_f32_32x32x16_bf16 v[48:63], a[12:15], v[132:135], v[48:63]
    ds_read_b128 a[4:7], v225 offset:1024
    v_exp_f32 v35, v35
    v_exp_f32 v36, v36
    v_exp_f32 v37, v37
    v_smfmac_f32_32x32x32_bf16 v[64:79], a[28:31], v[24:31], v224
    s_waitcnt vmcnt(7)
    ds_read_b128 v[192:195], v250 offset:4096
    ds_read_b128 v[136:139], v250 offset:6144
    v_exp_f32 v38, v38
    v_exp_f32 v39, v39
    v_exp_f32 v40, v40
    v_smfmac_f32_16x16x64_bf16 v[208:211], a[32:35], v[24:31], v224
    s_waitcnt lgkmcnt(6)
    ds_read_b64_tr_b16 a[24:25], v226 offset:6144
    ds_read_b64_tr_b16 a[26:27], v226 offset:6400
    v_exp_f32 v41, v41
    v_smfmac_f32_32x32x32_bf16 v[64:79], a[16:19], v[32:39], v224
    ds_read_b128 v[196:199], v251 offset:4096
    ds_read_b128 v[140:143], v251 offset:6144
    v_exp_f32 v42, v42
    v_exp_f32 v43, v43
    v_exp_f32 v44, v44
    v_smfmac_f32_16x16x64_bf16 v[208:211], a[32:35], v[32:39], v224
    s_waitcnt lgkmcnt(0)
    ds_read_b64_tr_b16 a[28:29], v226 offset:7168
    ds_read_b64_tr_b16 a[30:31], v226 offset:7424
    v_exp_f32 v45, v45
    v_exp_f32 v46, v46
    v_exp_f32 v47, v47
    v_pk_mul_f32 v[236:237], 0, 0
    v_dot2c_f32_bf16 v236, v192, v192
    v_dot2c_f32_bf16 v237, v136, v136
    v_dot2c_f32_bf16 v236, v193, v193
    v_dot2c_f32_bf16 v237, v137, v137
    v_dot2c_f32_bf16 v236, v194, v194
    v_dot2c_f32_bf16 v237, v138, v138
    v_dot2c_f32_bf16 v236, v195, v195
    v_dot2c_f32_bf16 v237, v139, v139
    v_dot2c_f32_bf16 v236, v196, v196
    v_dot2c_f32_bf16 v237, v140, v140
    v_dot2c_f32_bf16 v236, v197, v197
    v_dot2c_f32_bf16 v237, v141, v141
    v_dot2c_f32_bf16 v236, v198, v198
    v_dot2c_f32_bf16 v237, v142, v142
    v_dot2c_f32_bf16 v236, v199, v199
    v_dot2c_f32_bf16 v237, v143, v143
    v_mfma_f32_4x4x4_16b_bf16 v[160:163], v[230:231], v[192:193], 0
    v_mfma_f32_4x4x4_16b_bf16 v[164:167], v[230:231], v[194:195], 0
    v_mfma_f32_4x4x4_16b_bf16 v[168:171], v[230:231], v[196:197], 0
    v_permlane32_swap_b32 v236, v237
    v_add_f32 v236, v236, v237
    v_mfma_f32_4x4x4_16b_bf16 v[172:175], v[230:231], v[198:199], 0
    v_sqrt_f32 v236, v236
    v_mfma_f32_4x4x4_16b_bf16 v[176:179], v[230:231], v[136:137], 0
    v_add_f32 v236, 0x358637bd, v236
    v_rcp_f32 v236, v236
    v_mfma_f32_4x4x4_16b_bf16 v[180:183], v[230:231], v[138:139], 0
    v_mov_b32 v237, v236
    v_mfma_f32_4x4x4_16b_bf16 v[184:187], v[230:231], v[140:141], 0
    v_mfma_f32_4x4x4_16b_bf16 v[188:191], v[230:231], v[142:143], 0
    v_permlane32_swap_b32 v236, v237
    v_mul_f32 v237, v238, v237
    v_pk_mul_f32 v[160:161], v[160:161], v[236:237] op_sel_hi:[1,0]
    v_pk_mul_f32 v[162:163], v[162:163], v[236:237] op_sel_hi:[1,0]
    v_pk_mul_f32 v[164:165], v[164:165], v[236:237] op_sel_hi:[1,0]
    v_pk_mul_f32 v[166:167], v[166:167], v[236:237] op_sel_hi:[1,0]
    v_pk_mul_f32 v[168:169], v[168:169], v[236:237] op_sel_hi:[1,0]
    v_pk_mul_f32 v[170:171], v[170:171], v[236:237] op_sel_hi:[1,0]
    v_pk_mul_f32 v[172:173], v[172:173], v[236:237] op_sel_hi:[1,0]
    v_pk_mul_f32 v[174:175], v[174:175], v[236:237] op_sel_hi:[1,0]
    v_pk_mul_f32 v[176:177], v[176:177], v[236:237] op_sel:[0,1]
    v_pk_mul_f32 v[178:179], v[178:179], v[236:237] op_sel:[0,1]
    v_pk_mul_f32 v[180:181], v[180:181], v[236:237] op_sel:[0,1]
    v_pk_mul_f32 v[182:183], v[182:183], v[236:237] op_sel:[0,1]
    v_pk_mul_f32 v[184:185], v[184:185], v[236:237] op_sel:[0,1]
    v_pk_mul_f32 v[186:187], v[186:187], v[236:237] op_sel:[0,1]
    v_pk_mul_f32 v[188:189], v[188:189], v[236:237] op_sel:[0,1]
    v_pk_mul_f32 v[190:191], v[190:191], v[236:237] op_sel:[0,1]
    v_cvt_pk_bf16_f32 v136, v176, v177
    v_cvt_pk_bf16_f32 v137, v178, v179
    v_cvt_pk_bf16_f32 v138, v180, v181
    v_cvt_pk_bf16_f32 v139, v182, v183
    v_cvt_pk_bf16_f32 v140, v184, v185
    v_cvt_pk_bf16_f32 v141, v186, v187
    v_cvt_pk_bf16_f32 v142, v188, v189
    v_cvt_pk_bf16_f32 v143, v190, v191
    v_cvt_pk_bf16_f32 v192, v160, v161
    v_cvt_pk_bf16_f32 v193, v162, v163
    v_cvt_pk_bf16_f32 v194, v164, v165
    v_cvt_pk_bf16_f32 v195, v166, v167
    v_cvt_pk_bf16_f32 v196, v168, v169
    v_cvt_pk_bf16_f32 v197, v170, v171
    v_cvt_pk_bf16_f32 v198, v172, v173
    v_cvt_pk_bf16_f32 v199, v174, v175
    v_mfma_f32_32x32x16_bf16 v[0:15], a[0:3], v[136:139], 4.0
    ds_read_b128 a[8:11], v225 offset:2048
    v_exp_f32 v48, v48
    v_exp_f32 v49, v49
    v_exp_f32 v50, v50
    v_mfma_f32_32x32x16_bf16 v[0:15], a[4:7], v[140:143], v[0:15]
    ds_read_b128 a[12:15], v225 offset:3072
    v_exp_f32 v51, v51
    v_exp_f32 v52, v52
    v_exp_f32 v53, v53
    v_smfmac_f32_32x32x32_bf16 v[64:79], a[20:23], v[40:47], v224
    ds_write_b128 v245, v[192:195] offset:8192
    v_exp_f32 v54, v54
    v_exp_f32 v55, v55
    v_exp_f32 v56, v56
    v_smfmac_f32_16x16x64_bf16 v[208:211], a[32:35], v[40:47], v224
    ds_read_b64_tr_b16 a[16:17], v226 offset:0
    ds_read_b64_tr_b16 a[18:19], v226 offset:256
    v_exp_f32 v57, v57
    v_smfmac_f32_32x32x32_bf16 v[64:79], a[24:27], v[48:55], v224
    ds_write_b128 v245, v[196:199] offset:9216
    v_exp_f32 v58, v58
    v_exp_f32 v59, v59
    v_exp_f32 v60, v60
    v_smfmac_f32_16x16x64_bf16 v[208:211], a[32:35], v[48:55], v224
    s_waitcnt lgkmcnt(5)
    ds_read_b64_tr_b16 a[20:21], v226 offset:1024
    ds_read_b64_tr_b16 a[22:23], v226 offset:1280
    v_exp_f32 v61, v61
    v_exp_f32 v62, v62
    v_exp_f32 v63, v63
    v_mfma_f32_32x32x16_bf16 v[16:31], a[8:11], v[136:139], 4.0
    s_waitcnt lgkmcnt(6)
    ds_read_b128 a[0:3], v225 offset:4096
    v_exp_f32 v0, v0
    v_exp_f32 v1, v1
    v_exp_f32 v2, v2
    v_mfma_f32_32x32x16_bf16 v[16:31], a[12:15], v[140:143], v[16:31]
    ds_read_b128 a[4:7], v225 offset:5120
    v_exp_f32 v3, v3
    v_exp_f32 v4, v4
    v_exp_f32 v5, v5
    v_smfmac_f32_32x32x32_bf16 v[64:79], a[28:31], v[56:63], v224
    s_add_u32 s37, s37, s56
    s_add_u32 s13, s37, s41
    v_exp_f32 v6, v6
    v_exp_f32 v7, v7
    v_exp_f32 v8, v8
    v_smfmac_f32_16x16x64_bf16 v[208:211], a[32:35], v[56:63], v224
    s_waitcnt lgkmcnt(5)
    ds_read_b64_tr_b16 a[24:25], v226 offset:2048
    ds_read_b64_tr_b16 a[26:27], v226 offset:2304
    v_exp_f32 v9, v9
    v_smfmac_f32_32x32x32_bf16 v[80:95], a[16:19], v[0:7], v224
    v_exp_f32 v10, v10
    v_exp_f32 v11, v11
    v_exp_f32 v12, v12
    v_smfmac_f32_16x16x64_bf16 v[212:215], a[32:35], v[0:7], v224
    s_waitcnt lgkmcnt(3)
    ds_read_b64_tr_b16 a[28:29], v226 offset:3072
    ds_read_b64_tr_b16 a[30:31], v226 offset:3328
    v_exp_f32 v13, v13
    v_exp_f32 v14, v14
    v_exp_f32 v15, v15
    v_mfma_f32_32x32x16_bf16 v[32:47], a[0:3], v[136:139], 4.0
    s_waitcnt lgkmcnt(4)
    ds_read_b128 a[8:11], v225 offset:6144
    v_exp_f32 v16, v16
    v_exp_f32 v17, v17
    v_exp_f32 v18, v18
    v_mfma_f32_32x32x16_bf16 v[32:47], a[4:7], v[140:143], v[32:47]
    s_waitcnt vmcnt(5)
    ds_read_b128 a[12:15], v225 offset:7168
    v_exp_f32 v19, v19
    v_exp_f32 v20, v20
    v_exp_f32 v21, v21
    v_smfmac_f32_32x32x32_bf16 v[80:95], a[20:23], v[8:15], v224
    s_barrier
    v_exp_f32 v22, v22
    v_exp_f32 v23, v23
    v_exp_f32 v24, v24
    v_smfmac_f32_16x16x64_bf16 v[212:215], a[32:35], v[8:15], v224
    s_waitcnt lgkmcnt(4)
    ds_read_b64_tr_b16 a[16:17], v226 offset:4096
    ds_read_b64_tr_b16 a[18:19], v226 offset:4352
    v_exp_f32 v25, v25
    v_smfmac_f32_32x32x32_bf16 v[80:95], a[24:27], v[16:23], v224
    v_exp_f32 v26, v26
    v_exp_f32 v27, v27
    v_exp_f32 v28, v28
    v_smfmac_f32_16x16x64_bf16 v[212:215], a[32:35], v[16:23], v224
    s_waitcnt lgkmcnt(3)
    ds_read_b64_tr_b16 a[20:21], v226 offset:5120
    ds_read_b64_tr_b16 a[22:23], v226 offset:5376
    v_exp_f32 v29, v29
    v_exp_f32 v30, v30
    v_exp_f32 v31, v31
    v_mfma_f32_32x32x16_bf16 v[48:63], a[8:11], v[136:139], 4.0
    s_waitcnt lgkmcnt(4)
    ds_read_b128 a[0:3], v225 offset:8192
    v_exp_f32 v32, v32
    v_exp_f32 v33, v33
    v_exp_f32 v34, v34
    v_mfma_f32_32x32x16_bf16 v[48:63], a[12:15], v[140:143], v[48:63]
    ds_read_b128 a[4:7], v225 offset:9216
    v_exp_f32 v35, v35
    v_exp_f32 v36, v36
    v_exp_f32 v37, v37
    v_smfmac_f32_32x32x32_bf16 v[80:95], a[28:31], v[24:31], v224
    v_exp_f32 v38, v38
    v_exp_f32 v39, v39
    v_exp_f32 v40, v40
    v_smfmac_f32_16x16x64_bf16 v[212:215], a[32:35], v[24:31], v224
    s_waitcnt lgkmcnt(4)
    ds_read_b64_tr_b16 a[24:25], v226 offset:6144
    ds_read_b64_tr_b16 a[26:27], v226 offset:6400
    v_exp_f32 v41, v41
    v_smfmac_f32_32x32x32_bf16 v[80:95], a[16:19], v[32:39], v224
    s_mov_b32 m0, s58
    v_exp_f32 v42, v42
    v_exp_f32 v43, v43
    v_exp_f32 v44, v44
    v_smfmac_f32_16x16x64_bf16 v[212:215], a[32:35], v[32:39], v224
    s_waitcnt lgkmcnt(3)
    ds_read_b64_tr_b16 a[28:29], v226 offset:7168
    ds_read_b64_tr_b16 a[30:31], v226 offset:7424
    buffer_load_dwordx4 v249, s[20:23], s37 offen offset:0 nt lds
    buffer_load_dwordx4 v249, s[20:23], s37 offen offset:1024 nt lds
    v_exp_f32 v45, v45
    v_exp_f32 v46, v46
    v_exp_f32 v47, v47
    v_mfma_f32_32x32x16_bf16 v[0:15], a[0:3], v[128:131], 4.0
    s_waitcnt lgkmcnt(4)
    ds_read_b128 a[8:11], v225 offset:10240
    v_exp_f32 v48, v48
    v_exp_f32 v49, v49
    v_exp_f32 v50, v50
    v_mfma_f32_32x32x16_bf16 v[0:15], a[4:7], v[132:135], v[0:15]
    ds_read_b128 a[12:15], v225 offset:11264
    v_exp_f32 v51, v51
    v_exp_f32 v52, v52
    v_exp_f32 v53, v53
    v_smfmac_f32_32x32x32_bf16 v[80:95], a[20:23], v[40:47], v224
    s_mov_b32 s38, s37
    v_exp_f32 v54, v54
    v_exp_f32 v55, v55
    v_exp_f32 v56, v56
    v_smfmac_f32_16x16x64_bf16 v[212:215], a[32:35], v[40:47], v224
    s_waitcnt lgkmcnt(4)
    ds_read_b64_tr_b16 a[16:17], v226 offset:8192
    ds_read_b64_tr_b16 a[18:19], v226 offset:8448
    v_exp_f32 v57, v57
    v_smfmac_f32_32x32x32_bf16 v[80:95], a[24:27], v[48:55], v224
    s_mov_b32 s12, s13
    v_exp_f32 v58, v58
    v_exp_f32 v59, v59
    v_exp_f32 v60, v60
    v_smfmac_f32_16x16x64_bf16 v[212:215], a[32:35], v[48:55], v224
    ds_read_b64_tr_b16 a[20:21], v226 offset:9216
    ds_read_b64_tr_b16 a[22:23], v226 offset:9472
    buffer_load_dwordx4 v249, s[20:23], s13 offen offset:2048 nt lds
    buffer_load_dwordx4 v249, s[20:23], s13 offen offset:3072 nt lds
    v_exp_f32 v61, v61
    v_exp_f32 v62, v62
    v_exp_f32 v63, v63
    v_mfma_f32_32x32x16_bf16 v[16:31], a[0:3], v[136:139], 4.0
    v_exp_f32 v0, v0
    v_exp_f32 v1, v1
    v_exp_f32 v2, v2
    v_mfma_f32_32x32x16_bf16 v[16:31], a[4:7], v[140:143], v[16:31]
    s_waitcnt lgkmcnt(6)
    v_exp_f32 v3, v3
    v_exp_f32 v4, v4
    v_exp_f32 v5, v5
    v_smfmac_f32_32x32x32_bf16 v[80:95], a[28:31], v[56:63], v224
    s_add_u32 s57, s56, 0x8000
    v_exp_f32 v6, v6
    v_exp_f32 v7, v7
    v_exp_f32 v8, v8
    v_smfmac_f32_16x16x64_bf16 v[212:215], a[32:35], v[56:63], v224
    s_waitcnt lgkmcnt(2)
    ds_read_b64_tr_b16 a[24:25], v226 offset:10240
    ds_read_b64_tr_b16 a[26:27], v226 offset:10496
    v_exp_f32 v9, v9
    v_smfmac_f32_32x32x32_bf16 v[64:79], a[16:19], v[0:7], v224
    v_exp_f32 v10, v10
    v_exp_f32 v11, v11
    v_exp_f32 v12, v12
    v_smfmac_f32_16x16x64_bf16 v[208:211], a[32:35], v[0:7], v224
    ds_read_b64_tr_b16 a[28:29], v226 offset:11264
    ds_read_b64_tr_b16 a[30:31], v226 offset:11520
    v_exp_f32 v13, v13
    v_exp_f32 v14, v14
    v_exp_f32 v15, v15
    v_mfma_f32_32x32x16_bf16 v[32:47], a[8:11], v[128:131], 4.0
    v_exp_f32 v16, v16
    v_exp_f32 v17, v17
    v_exp_f32 v18, v18
    v_mfma_f32_32x32x16_bf16 v[32:47], a[12:15], v[132:135], v[32:47]
    s_waitcnt lgkmcnt(4)
    v_exp_f32 v19, v19
    v_exp_f32 v20, v20
    v_exp_f32 v21, v21
    v_smfmac_f32_32x32x32_bf16 v[64:79], a[20:23], v[8:15], v224
    v_exp_f32 v22, v22
    v_exp_f32 v23, v23
    v_exp_f32 v24, v24
    v_smfmac_f32_16x16x64_bf16 v[208:211], a[32:35], v[8:15], v224
    ds_read_b128 a[0:3], v225 offset:0
    v_exp_f32 v25, v25
    v_smfmac_f32_32x32x32_bf16 v[80:95], a[16:19], v[16:23], v224
    v_exp_f32 v26, v26
    v_exp_f32 v27, v27
    v_exp_f32 v28, v28
    v_smfmac_f32_16x16x64_bf16 v[212:215], a[32:35], v[16:23], v224
    ds_read_b128 a[4:7], v225 offset:1024
    v_exp_f32 v29, v29
    v_exp_f32 v30, v30
    v_exp_f32 v31, v31
    v_mfma_f32_32x32x16_bf16 v[48:63], a[8:11], v[136:139], 4.0
    s_waitcnt vmcnt(4)
    ds_read_b128 v[144:147], v250 offset:8192
    v_exp_f32 v32, v32
    v_exp_f32 v33, v33
    v_exp_f32 v34, v34
    v_mfma_f32_32x32x16_bf16 v[48:63], a[12:15], v[140:143], v[48:63]
    ds_read_b128 v[152:155], v250 offset:10240
    v_exp_f32 v35, v35
    v_exp_f32 v36, v36
    v_exp_f32 v37, v37
    v_smfmac_f32_32x32x32_bf16 v[80:95], a[20:23], v[24:31], v224
    ds_read_b128 v[148:151], v251 offset:8192
    v_exp_f32 v38, v38
    v_exp_f32 v39, v39
    v_exp_f32 v40, v40
    v_smfmac_f32_16x16x64_bf16 v[212:215], a[32:35], v[24:31], v224
    s_waitcnt lgkmcnt(7)
    ds_read_b64_tr_b16 a[16:17], v226 offset:0
    ds_read_b64_tr_b16 a[18:19], v226 offset:256
    v_exp_f32 v41, v41
    v_smfmac_f32_32x32x32_bf16 v[64:79], a[24:27], v[32:39], v224
    ds_read_b128 v[156:159], v251 offset:10240
    v_exp_f32 v42, v42
    v_exp_f32 v43, v43
    v_exp_f32 v44, v44
    v_smfmac_f32_16x16x64_bf16 v[208:211], a[32:35], v[32:39], v224
    s_waitcnt lgkmcnt(0)
    ds_read_b64_tr_b16 a[20:21], v226 offset:1024
    ds_read_b64_tr_b16 a[22:23], v226 offset:1280
    v_exp_f32 v45, v45
    v_exp_f32 v46, v46
    v_exp_f32 v47, v47
    v_pk_mul_f32 v[236:237], 0, 0
    v_dot2c_f32_bf16 v236, v144, v144
    v_dot2c_f32_bf16 v237, v152, v152
    v_dot2c_f32_bf16 v236, v145, v145
    v_dot2c_f32_bf16 v237, v153, v153
    v_dot2c_f32_bf16 v236, v146, v146
    v_dot2c_f32_bf16 v237, v154, v154
    v_dot2c_f32_bf16 v236, v147, v147
    v_dot2c_f32_bf16 v237, v155, v155
    v_dot2c_f32_bf16 v236, v148, v148
    v_dot2c_f32_bf16 v237, v156, v156
    v_dot2c_f32_bf16 v236, v149, v149
    v_dot2c_f32_bf16 v237, v157, v157
    v_dot2c_f32_bf16 v236, v150, v150
    v_dot2c_f32_bf16 v237, v158, v158
    v_dot2c_f32_bf16 v236, v151, v151
    v_dot2c_f32_bf16 v237, v159, v159
    v_mfma_f32_4x4x4_16b_bf16 v[160:163], v[230:231], v[144:145], 0
    v_mfma_f32_4x4x4_16b_bf16 v[164:167], v[230:231], v[146:147], 0
    v_mfma_f32_4x4x4_16b_bf16 v[168:171], v[230:231], v[148:149], 0
    v_permlane32_swap_b32 v236, v237
    v_add_f32 v236, v236, v237
    v_mfma_f32_4x4x4_16b_bf16 v[172:175], v[230:231], v[150:151], 0
    v_sqrt_f32 v236, v236
    v_mfma_f32_4x4x4_16b_bf16 v[176:179], v[230:231], v[152:153], 0
    v_add_f32 v236, 0x358637bd, v236
    v_rcp_f32 v236, v236
    v_mfma_f32_4x4x4_16b_bf16 v[180:183], v[230:231], v[154:155], 0
    v_mul_f32 v237, v238, v236
    v_mul_f32 v236, v238, v236
    v_mfma_f32_4x4x4_16b_bf16 v[184:187], v[230:231], v[156:157], 0
    v_mfma_f32_4x4x4_16b_bf16 v[188:191], v[230:231], v[158:159], 0
    v_permlane32_swap_b32 v236, v237
    v_pk_mul_f32 v[160:161], v[160:161], v[236:237] op_sel_hi:[1,0]
    v_pk_mul_f32 v[162:163], v[162:163], v[236:237] op_sel_hi:[1,0]
    v_pk_mul_f32 v[164:165], v[164:165], v[236:237] op_sel_hi:[1,0]
    v_pk_mul_f32 v[166:167], v[166:167], v[236:237] op_sel_hi:[1,0]
    v_pk_mul_f32 v[168:169], v[168:169], v[236:237] op_sel_hi:[1,0]
    v_pk_mul_f32 v[170:171], v[170:171], v[236:237] op_sel_hi:[1,0]
    v_pk_mul_f32 v[172:173], v[172:173], v[236:237] op_sel_hi:[1,0]
    v_pk_mul_f32 v[174:175], v[174:175], v[236:237] op_sel_hi:[1,0]
    v_pk_mul_f32 v[176:177], v[176:177], v[236:237] op_sel:[0,1]
    v_pk_mul_f32 v[178:179], v[178:179], v[236:237] op_sel:[0,1]
    v_pk_mul_f32 v[180:181], v[180:181], v[236:237] op_sel:[0,1]
    v_pk_mul_f32 v[182:183], v[182:183], v[236:237] op_sel:[0,1]
    v_pk_mul_f32 v[184:185], v[184:185], v[236:237] op_sel:[0,1]
    v_pk_mul_f32 v[186:187], v[186:187], v[236:237] op_sel:[0,1]
    v_pk_mul_f32 v[188:189], v[188:189], v[236:237] op_sel:[0,1]
    v_pk_mul_f32 v[190:191], v[190:191], v[236:237] op_sel:[0,1]
    v_cvt_pk_bf16_f32 v144, v160, v161
    v_cvt_pk_bf16_f32 v145, v162, v163
    v_cvt_pk_bf16_f32 v146, v164, v165
    v_cvt_pk_bf16_f32 v147, v166, v167
    v_cvt_pk_bf16_f32 v148, v168, v169
    v_cvt_pk_bf16_f32 v149, v170, v171
    v_cvt_pk_bf16_f32 v150, v172, v173
    v_cvt_pk_bf16_f32 v151, v174, v175
    v_cvt_pk_bf16_f32 v152, v176, v177
    v_cvt_pk_bf16_f32 v153, v178, v179
    v_cvt_pk_bf16_f32 v154, v180, v181
    v_cvt_pk_bf16_f32 v155, v182, v183
    v_cvt_pk_bf16_f32 v156, v184, v185
    v_cvt_pk_bf16_f32 v157, v186, v187
    v_cvt_pk_bf16_f32 v158, v188, v189
    v_cvt_pk_bf16_f32 v159, v190, v191
    s_nop 0
    v_mfma_f32_32x32x16_bf16 v[0:15], a[0:3], v[144:147], 4.0
    v_exp_f32 v48, v48
    v_exp_f32 v49, v49
    v_exp_f32 v50, v50
    v_mfma_f32_32x32x16_bf16 v[0:15], a[4:7], v[148:151], v[0:15]
    v_exp_f32 v51, v51
    v_exp_f32 v52, v52
    v_exp_f32 v53, v53
    v_smfmac_f32_32x32x32_bf16 v[64:79], a[28:31], v[40:47], v224
    v_exp_f32 v54, v54
    v_exp_f32 v55, v55
    v_exp_f32 v56, v56
    v_smfmac_f32_16x16x64_bf16 v[208:211], a[32:35], v[40:47], v224
    ds_read_b128 a[8:11], v225 offset:2048
    v_exp_f32 v57, v57
    v_smfmac_f32_32x32x32_bf16 v[80:95], a[24:27], v[48:55], v224
    v_exp_f32 v58, v58
    v_exp_f32 v59, v59
    v_exp_f32 v60, v60
    v_smfmac_f32_16x16x64_bf16 v[212:215], a[32:35], v[48:55], v224
    ds_read_b128 a[12:15], v225 offset:3072
    v_exp_f32 v61, v61
    v_exp_f32 v62, v62
    v_exp_f32 v63, v63
    v_mfma_f32_32x32x16_bf16 v[16:31], a[0:3], v[152:155], 4.0
    v_exp_f32 v0, v0
    v_exp_f32 v1, v1
    v_exp_f32 v2, v2
    v_mfma_f32_32x32x16_bf16 v[16:31], a[4:7], v[156:159], v[16:31]
    v_exp_f32 v3, v3
    v_exp_f32 v4, v4
    v_exp_f32 v5, v5
    v_smfmac_f32_32x32x32_bf16 v[80:95], a[28:31], v[56:63], v224
    v_exp_f32 v6, v6
    v_exp_f32 v7, v7
    v_exp_f32 v8, v8
    v_smfmac_f32_16x16x64_bf16 v[212:215], a[32:35], v[56:63], v224
    ds_read_b64_tr_b16 a[24:25], v226 offset:2048
    ds_read_b64_tr_b16 a[26:27], v226 offset:2304
    v_exp_f32 v9, v9
    v_smfmac_f32_32x32x32_bf16 v[96:111], a[16:19], v[0:7], v224
    s_mov_b32 m0, s57
    v_exp_f32 v10, v10
    v_exp_f32 v11, v11
    v_exp_f32 v12, v12
    v_smfmac_f32_16x16x64_bf16 v[216:219], a[32:35], v[0:7], v224
    s_waitcnt lgkmcnt(3)
    ds_read_b64_tr_b16 a[28:29], v226 offset:3072
    ds_read_b64_tr_b16 a[30:31], v226 offset:3328
    v_exp_f32 v13, v13
    v_exp_f32 v14, v14
    v_exp_f32 v15, v15
    v_mfma_f32_32x32x16_bf16 v[32:47], a[8:11], v[144:147], 4.0
    s_waitcnt lgkmcnt(4)
    buffer_load_dwordx4 v225, s[24:27], s38 offen offset:0 nt lds
    v_exp_f32 v16, v16
    v_exp_f32 v17, v17
    v_exp_f32 v18, v18
    v_mfma_f32_32x32x16_bf16 v[32:47], a[12:15], v[148:151], v[32:47]
L_pad1B:
    s_cbranch_vccnz L_goB
    buffer_load_dwordx4 v225, s[24:27], s38 offen offset:1024 nt lds
    v_exp_f32 v19, v19
    v_exp_f32 v20, v20
    v_exp_f32 v21, v21
    v_smfmac_f32_32x32x32_bf16 v[96:111], a[20:23], v[8:15], v224
    v_exp_f32 v22, v22
    v_exp_f32 v23, v23
    v_exp_f32 v24, v24
    v_smfmac_f32_16x16x64_bf16 v[216:219], a[32:35], v[8:15], v224
    ds_read_b128 a[0:3], v225 offset:4096
    v_exp_f32 v25, v25
    v_smfmac_f32_32x32x32_bf16 v[112:127], a[16:19], v[16:23], v224
    v_exp_f32 v26, v26
    v_exp_f32 v27, v27
    v_exp_f32 v28, v28
    v_smfmac_f32_16x16x64_bf16 v[220:223], a[32:35], v[16:23], v224
    ds_read_b128 a[4:7], v225 offset:5120
    v_exp_f32 v29, v29
    v_exp_f32 v30, v30
    v_exp_f32 v31, v31
    v_mfma_f32_32x32x16_bf16 v[48:63], a[8:11], v[152:155], 4.0
    buffer_load_dwordx4 v225, s[24:27], s12 offen offset:2048 nt lds
    v_exp_f32 v32, v32
    v_exp_f32 v33, v33
    v_exp_f32 v34, v34
    v_mfma_f32_32x32x16_bf16 v[48:63], a[12:15], v[156:159], v[48:63]
    buffer_load_dwordx4 v225, s[24:27], s12 offen offset:3072 nt lds
    v_exp_f32 v35, v35
    v_exp_f32 v36, v36
    v_exp_f32 v37, v37
    v_smfmac_f32_32x32x32_bf16 v[112:127], a[20:23], v[24:31], v224
    v_exp_f32 v38, v38
    v_exp_f32 v39, v39
    v_exp_f32 v40, v40
    v_smfmac_f32_16x16x64_bf16 v[220:223], a[32:35], v[24:31], v224
    s_waitcnt lgkmcnt(4)
    ds_read_b64_tr_b16 a[16:17], v226 offset:4096
    ds_read_b64_tr_b16 a[18:19], v226 offset:4352
    v_exp_f32 v41, v41
    v_smfmac_f32_32x32x32_bf16 v[96:111], a[24:27], v[32:39], v224
    v_exp_f32 v42, v42
    v_exp_f32 v43, v43
    v_exp_f32 v44, v44
    v_smfmac_f32_16x16x64_bf16 v[216:219], a[32:35], v[32:39], v224
    s_waitcnt lgkmcnt(3)
    ds_read_b64_tr_b16 a[20:21], v226 offset:5120
    ds_read_b64_tr_b16 a[22:23], v226 offset:5376
    v_exp_f32 v45, v45
    v_exp_f32 v46, v46
    v_exp_f32 v47, v47
    v_mfma_f32_32x32x16_bf16 v[0:15], a[0:3], v[144:147], 4.0
    s_waitcnt vmcnt(4) lgkmcnt(4)
    ds_read_b128 v[192:195], v252 offset:0
    v_exp_f32 v48, v48
    v_exp_f32 v49, v49
    v_exp_f32 v50, v50
    v_mfma_f32_32x32x16_bf16 v[0:15], a[4:7], v[148:151], v[0:15]
    ds_read_b128 v[196:199], v253 offset:0
    v_exp_f32 v51, v51
    v_exp_f32 v52, v52
    v_exp_f32 v53, v53
    v_smfmac_f32_32x32x32_bf16 v[96:111], a[28:31], v[40:47], v224
    s_add_u32 s37, s37, 14336
    v_exp_f32 v54, v54
    v_exp_f32 v55, v55
    v_exp_f32 v56, v56
    v_smfmac_f32_16x16x64_bf16 v[216:219], a[32:35], v[40:47], v224
    ds_read_b128 a[8:11], v225 offset:6144
    v_exp_f32 v57, v57
    v_smfmac_f32_32x32x32_bf16 v[112:127], a[24:27], v[48:55], v224
    s_add_u32 s13, s37, s41
    v_exp_f32 v58, v58
    v_exp_f32 v59, v59
    v_exp_f32 v60, v60
    v_smfmac_f32_16x16x64_bf16 v[220:223], a[32:35], v[48:55], v224
    ds_read_b128 a[12:15], v225 offset:7168
    v_exp_f32 v61, v61
    v_exp_f32 v62, v62
    v_exp_f32 v63, v63
    v_mfma_f32_32x32x16_bf16 v[16:31], a[0:3], v[152:155], 4.0
    ds_read_b128 v[200:203], v254 offset:0
    v_exp_f32 v0, v0
    v_exp_f32 v1, v1
    v_exp_f32 v2, v2
    v_mfma_f32_32x32x16_bf16 v[16:31], a[4:7], v[156:159], v[16:31]
    ds_read_b128 v[204:207], v255 offset:0
    v_exp_f32 v3, v3
    v_exp_f32 v4, v4
    v_exp_f32 v5, v5
    v_smfmac_f32_32x32x32_bf16 v[112:127], a[28:31], v[56:63], v224
    s_lshl_b32 s39, s34, 15
    v_exp_f32 v6, v6
    v_exp_f32 v7, v7
    v_exp_f32 v8, v8
    v_smfmac_f32_16x16x64_bf16 v[220:223], a[32:35], v[56:63], v224
    s_waitcnt lgkmcnt(8)
    ds_read_b64_tr_b16 a[24:25], v226 offset:6144
    ds_read_b64_tr_b16 a[26:27], v226 offset:6400
    v_exp_f32 v9, v9
    v_smfmac_f32_32x32x32_bf16 v[96:111], a[16:19], v[0:7], v224
    s_add_u32 s61, s44, 0x8000
    v_exp_f32 v10, v10
    v_exp_f32 v11, v11
    v_exp_f32 v12, v12
    v_smfmac_f32_16x16x64_bf16 v[216:219], a[32:35], v[0:7], v224
    s_waitcnt lgkmcnt(2)
    ds_read_b64_tr_b16 a[28:29], v226 offset:7168
    ds_read_b64_tr_b16 a[30:31], v226 offset:7424
    v_exp_f32 v13, v13
    v_exp_f32 v14, v14
    v_exp_f32 v15, v15
    v_pk_mul_f32 v[236:237], 0, 0
    v_dot2c_f32_bf16 v236, v192, v192
    v_dot2c_f32_bf16 v237, v193, v193
    v_dot2c_f32_bf16 v236, v194, v194
    v_dot2c_f32_bf16 v237, v195, v195
    v_dot2c_f32_bf16 v236, v196, v196
    v_dot2c_f32_bf16 v237, v197, v197
    v_dot2c_f32_bf16 v236, v198, v198
    v_dot2c_f32_bf16 v237, v199, v199
    v_dot2c_f32_bf16 v236, v200, v200
    v_dot2c_f32_bf16 v237, v201, v201
    v_dot2c_f32_bf16 v236, v202, v202
    v_dot2c_f32_bf16 v237, v203, v203
    v_dot2c_f32_bf16 v236, v204, v204
    v_dot2c_f32_bf16 v237, v205, v205
    v_dot2c_f32_bf16 v236, v206, v206
    v_dot2c_f32_bf16 v237, v207, v207
    v_mfma_f32_32x32x16_bf16 v[32:47], a[8:11], v[144:147], 4.0
    v_exp_f32 v16, v16
    v_exp_f32 v17, v17
    v_exp_f32 v18, v18
    v_mfma_f32_32x32x16_bf16 v[32:47], a[12:15], v[148:151], v[32:47]
    v_exp_f32 v19, v19
    v_exp_f32 v20, v20
    v_exp_f32 v21, v21
    v_smfmac_f32_32x32x32_bf16 v[96:111], a[20:23], v[8:15], v224
    s_add_u32 s45, s45, 1
    v_exp_f32 v22, v22
    v_exp_f32 v23, v23
    v_exp_f32 v24, v24
    v_smfmac_f32_16x16x64_bf16 v[216:219], a[32:35], v[8:15], v224
    ds_read_b128 a[0:3], v225 offset:8192
    v_exp_f32 v25, v25
    v_smfmac_f32_32x32x32_bf16 v[112:127], a[16:19], v[16:23], v224
    s_and_b32 s45, s45, 7
    v_exp_f32 v26, v26
    v_exp_f32 v27, v27
    v_exp_f32 v28, v28
    v_smfmac_f32_16x16x64_bf16 v[220:223], a[32:35], v[16:23], v224
    ds_read_b128 a[4:7], v225 offset:9216
    v_exp_f32 v29, v29
    v_mfma_f32_4x4x4_16b_bf16 v[160:163], v[230:231], v[192:193], 0
    v_exp_f32 v30, v30
    v_mfma_f32_4x4x4_16b_bf16 v[164:167], v[230:231], v[194:195], 0
    v_exp_f32 v31, v31
    v_mfma_f32_32x32x16_bf16 v[48:63], a[8:11], v[152:155], 4.0
    v_exp_f32 v32, v32
    v_exp_f32 v33, v33
    v_add_f32 v236, v236, v237
    v_exp_f32 v34, v34
    v_mfma_f32_32x32x16_bf16 v[48:63], a[12:15], v[156:159], v[48:63]
    v_exp_f32 v35, v35
    v_exp_f32 v36, v36
    v_sqrt_f32 v236, v236
    v_exp_f32 v37, v37
    v_smfmac_f32_32x32x32_bf16 v[112:127], a[20:23], v[24:31], v224
    s_mul_i32 s38, s45, 14336
    v_exp_f32 v38, v38
    v_exp_f32 v39, v39
    v_add_f32 v236, 0x358637bd, v236
    v_exp_f32 v40, v40
    v_smfmac_f32_16x16x64_bf16 v[220:223], a[32:35], v[24:31], v224
    s_waitcnt lgkmcnt(4)
    ds_read_b64_tr_b16 a[16:17], v226 offset:8192
    ds_read_b64_tr_b16 a[18:19], v226 offset:8448
    v_exp_f32 v41, v41
    v_smfmac_f32_32x32x32_bf16 v[96:111], a[24:27], v[32:39], v224
    s_add_u32 s38, s38, s56
    v_exp_f32 v42, v42
    v_rcp_f32 v236, v236
    v_exp_f32 v43, v43
    v_exp_f32 v44, v44
    v_smfmac_f32_16x16x64_bf16 v[216:219], a[32:35], v[32:39], v224
    s_waitcnt lgkmcnt(3)
    ds_read_b64_tr_b16 a[20:21], v226 offset:9216
    ds_read_b64_tr_b16 a[22:23], v226 offset:9472
    v_exp_f32 v45, v45
    v_mfma_f32_4x4x4_16b_bf16 v[168:171], v[230:231], v[196:197], 0
    v_exp_f32 v46, v46
    v_mfma_f32_4x4x4_16b_bf16 v[172:175], v[230:231], v[198:199], 0
    v_exp_f32 v47, v47
    v_mfma_f32_32x32x16_bf16 v[0:15], a[0:3], v[144:147], 4.0
    s_waitcnt lgkmcnt(4)
    v_exp_f32 v48, v48
    v_exp_f32 v49, v49
    v_exp_f32 v50, v50
    v_mfma_f32_32x32x16_bf16 v[0:15], a[4:7], v[148:151], v[0:15]
    v_exp_f32 v51, v51
    v_exp_f32 v52, v52
    v_exp_f32 v53, v53
    v_smfmac_f32_32x32x32_bf16 v[96:111], a[28:31], v[40:47], v224
    v_exp_f32 v54, v54
    v_exp_f32 v55, v55
    v_exp_f32 v56, v56
    v_smfmac_f32_16x16x64_bf16 v[216:219], a[32:35], v[40:47], v224
    ds_read_b128 a[8:11], v225 offset:10240
    v_exp_f32 v57, v57
    v_smfmac_f32_32x32x32_bf16 v[112:127], a[24:27], v[48:55], v224
    s_mov_b32 m0, s58
    v_exp_f32 v58, v58
    v_exp_f32 v59, v59
    v_exp_f32 v60, v60
    v_smfmac_f32_16x16x64_bf16 v[220:223], a[32:35], v[48:55], v224
    ds_read_b128 a[12:15], v225 offset:11264
    v_exp_f32 v61, v61
    v_mfma_f32_4x4x4_16b_bf16 v[176:179], v[230:231], v[200:201], 0
    v_exp_f32 v62, v62
    v_mfma_f32_4x4x4_16b_bf16 v[180:183], v[230:231], v[202:203], 0
    v_exp_f32 v63, v63
    v_mfma_f32_32x32x16_bf16 v[16:31], a[0:3], v[152:155], 4.0
    buffer_load_dwordx4 v249, s[20:23], s37 offen offset:0 nt lds
    v_exp_f32 v0, v0
    v_exp_f32 v1, v1
    v_exp_f32 v2, v2
    v_mfma_f32_32x32x16_bf16 v[16:31], a[4:7], v[156:159], v[16:31]
    buffer_load_dwordx4 v249, s[20:23], s37 offen offset:1024 nt lds
    v_exp_f32 v3, v3
    v_exp_f32 v4, v4
    v_exp_f32 v5, v5
    v_smfmac_f32_32x32x32_bf16 v[112:127], a[28:31], v[56:63], v224
    s_add_u32 s12, s38, s41
    v_exp_f32 v6, v6
    v_exp_f32 v7, v7
    v_exp_f32 v8, v8
    v_smfmac_f32_16x16x64_bf16 v[220:223], a[32:35], v[56:63], v224
    s_waitcnt lgkmcnt(4)
    ds_read_b64_tr_b16 a[24:25], v226 offset:10240
    ds_read_b64_tr_b16 a[26:27], v226 offset:10496
    v_exp_f32 v9, v9
    v_smfmac_f32_32x32x32_bf16 v[96:111], a[16:19], v[0:7], v224
    v_exp_f32 v10, v10
    v_exp_f32 v11, v11
    v_exp_f32 v12, v12
    v_smfmac_f32_16x16x64_bf16 v[216:219], a[32:35], v[0:7], v224
    s_waitcnt lgkmcnt(3)
    ds_read_b64_tr_b16 a[28:29], v226 offset:11264
    ds_read_b64_tr_b16 a[30:31], v226 offset:11520
    v_exp_f32 v13, v13
    v_mfma_f32_4x4x4_16b_bf16 v[184:187], v[230:231], v[204:205], 0
    v_exp_f32 v14, v14
    v_mfma_f32_4x4x4_16b_bf16 v[188:191], v[230:231], v[206:207], 0
    v_exp_f32 v15, v15
    v_mfma_f32_32x32x16_bf16 v[32:47], a[8:11], v[144:147], 4.0
    s_waitcnt lgkmcnt(4)
    buffer_load_dwordx4 v249, s[20:23], s13 offen offset:2048 nt lds
    v_exp_f32 v16, v16
    v_exp_f32 v17, v17
    v_exp_f32 v18, v18
    v_mfma_f32_32x32x16_bf16 v[32:47], a[12:15], v[148:151], v[32:47]
    buffer_load_dwordx4 v249, s[20:23], s13 offen offset:3072 nt lds
    v_exp_f32 v19, v19
    v_exp_f32 v20, v20
    v_exp_f32 v21, v21
    v_smfmac_f32_32x32x32_bf16 v[96:111], a[20:23], v[8:15], v224
    v_exp_f32 v22, v22
    v_exp_f32 v23, v23
    v_exp_f32 v24, v24
    v_smfmac_f32_16x16x64_bf16 v[216:219], a[32:35], v[8:15], v224
    ds_read_b128 a[0:3], v225 offset:12288
    v_exp_f32 v25, v25
    v_smfmac_f32_32x32x32_bf16 v[112:127], a[16:19], v[16:23], v224
    v_exp_f32 v26, v26
    v_exp_f32 v27, v27
    v_exp_f32 v28, v28
    v_smfmac_f32_16x16x64_bf16 v[220:223], a[32:35], v[16:23], v224
    ds_read_b128 a[4:7], v225 offset:13312
    v_exp_f32 v29, v29
    v_exp_f32 v30, v30
    v_exp_f32 v31, v31
    v_pk_mul_f32 v[160:161], v[160:161], v[236:237] op_sel_hi:[1,0]
    v_pk_mul_f32 v[162:163], v[162:163], v[236:237] op_sel_hi:[1,0]
    v_pk_mul_f32 v[164:165], v[164:165], v[236:237] op_sel_hi:[1,0]
    v_pk_mul_f32 v[166:167], v[166:167], v[236:237] op_sel_hi:[1,0]
    v_pk_mul_f32 v[168:169], v[168:169], v[236:237] op_sel_hi:[1,0]
    v_pk_mul_f32 v[170:171], v[170:171], v[236:237] op_sel_hi:[1,0]
    v_pk_mul_f32 v[172:173], v[172:173], v[236:237] op_sel_hi:[1,0]
    v_pk_mul_f32 v[174:175], v[174:175], v[236:237] op_sel_hi:[1,0]
    v_mfma_f32_32x32x16_bf16 v[48:63], a[8:11], v[152:155], 4.0
    v_exp_f32 v32, v32
    v_cvt_pk_bf16_f32 v192, v160, v161
    v_exp_f32 v33, v33
    v_cvt_pk_bf16_f32 v193, v162, v163
    v_exp_f32 v34, v34
    v_mfma_f32_32x32x16_bf16 v[48:63], a[12:15], v[156:159], v[48:63]
    v_exp_f32 v35, v35
    v_cvt_pk_bf16_f32 v194, v164, v165
    v_exp_f32 v36, v36
    v_cvt_pk_bf16_f32 v195, v166, v167
    v_exp_f32 v37, v37
    v_smfmac_f32_32x32x32_bf16 v[112:127], a[20:23], v[24:31], v224
    v_exp_f32 v38, v38
    v_cvt_pk_bf16_f32 v196, v168, v169
    v_exp_f32 v39, v39
    v_cvt_pk_bf16_f32 v197, v170, v171
    v_exp_f32 v40, v40
    v_smfmac_f32_16x16x64_bf16 v[220:223], a[32:35], v[24:31], v224
    s_waitcnt lgkmcnt(4)
    ds_read_b64_tr_b16 a[16:17], v226 offset:12288
    ds_read_b64_tr_b16 a[18:19], v226 offset:12544
    v_exp_f32 v41, v41
    v_smfmac_f32_32x32x32_bf16 v[96:111], a[24:27], v[32:39], v224
    v_exp_f32 v42, v42
    v_cvt_pk_bf16_f32 v198, v172, v173
    v_exp_f32 v43, v43
    v_cvt_pk_bf16_f32 v199, v174, v175
    v_exp_f32 v44, v44
    v_smfmac_f32_16x16x64_bf16 v[216:219], a[32:35], v[32:39], v224
    s_waitcnt lgkmcnt(3)
    ds_read_b64_tr_b16 a[20:21], v226 offset:13312
    ds_read_b64_tr_b16 a[22:23], v226 offset:13568
    v_exp_f32 v45, v45
    v_exp_f32 v46, v46
    v_exp_f32 v47, v47
    v_pk_mul_f32 v[176:177], v[176:177], v[236:237] op_sel_hi:[1,0]
    v_pk_mul_f32 v[178:179], v[178:179], v[236:237] op_sel_hi:[1,0]
    v_pk_mul_f32 v[180:181], v[180:181], v[236:237] op_sel_hi:[1,0]
    v_pk_mul_f32 v[182:183], v[182:183], v[236:237] op_sel_hi:[1,0]
    v_pk_mul_f32 v[184:185], v[184:185], v[236:237] op_sel_hi:[1,0]
    v_pk_mul_f32 v[186:187], v[186:187], v[236:237] op_sel_hi:[1,0]
    v_pk_mul_f32 v[188:189], v[188:189], v[236:237] op_sel_hi:[1,0]
    v_pk_mul_f32 v[190:191], v[190:191], v[236:237] op_sel_hi:[1,0]
    v_mfma_f32_32x32x16_bf16 v[0:15], a[0:3], v[128:131], 4.0
    s_waitcnt lgkmcnt(4)
    ds_write_b128 v227, v[192:195] offset:32768
    v_exp_f32 v48, v48
    v_cvt_pk_bf16_f32 v200, v176, v177
    v_exp_f32 v49, v49
    v_cvt_pk_bf16_f32 v201, v178, v179
    v_exp_f32 v50, v50
    v_mfma_f32_32x32x16_bf16 v[0:15], a[4:7], v[132:135], v[0:15]
    ds_write_b128 v227, v[196:199] offset:33280
    v_exp_f32 v51, v51
    v_cvt_pk_bf16_f32 v202, v180, v181
    v_exp_f32 v52, v52
    v_cvt_pk_bf16_f32 v203, v182, v183
    v_exp_f32 v53, v53
    v_smfmac_f32_32x32x32_bf16 v[96:111], a[28:31], v[40:47], v224
    v_exp_f32 v54, v54
    v_cvt_pk_bf16_f32 v204, v184, v185
    v_exp_f32 v55, v55
    v_cvt_pk_bf16_f32 v205, v186, v187
    v_exp_f32 v56, v56
    v_smfmac_f32_16x16x64_bf16 v[216:219], a[32:35], v[40:47], v224
    ds_read_b128 a[8:11], v225 offset:14336
    v_exp_f32 v57, v57
    v_smfmac_f32_32x32x32_bf16 v[112:127], a[24:27], v[48:55], v224
    v_exp_f32 v58, v58
    v_cvt_pk_bf16_f32 v206, v188, v189
    v_exp_f32 v59, v59
    v_cvt_pk_bf16_f32 v207, v190, v191
    v_exp_f32 v60, v60
    v_smfmac_f32_16x16x64_bf16 v[220:223], a[32:35], v[48:55], v224
    ds_read_b128 a[12:15], v225 offset:15360
    v_exp_f32 v61, v61
    v_exp_f32 v62, v62
    v_exp_f32 v63, v63
    v_mfma_f32_32x32x16_bf16 v[16:31], a[0:3], v[136:139], 4.0
    ds_write_b128 v227, v[200:203] offset:33792
    v_exp_f32 v0, v0
    v_exp_f32 v1, v1
    v_exp_f32 v2, v2
    v_mfma_f32_32x32x16_bf16 v[16:31], a[4:7], v[140:143], v[16:31]
    ds_write_b128 v227, v[204:207] offset:34304
    v_exp_f32 v3, v3
    v_exp_f32 v4, v4
    v_exp_f32 v5, v5
    v_smfmac_f32_32x32x32_bf16 v[112:127], a[28:31], v[56:63], v224
    v_exp_f32 v6, v6
    v_exp_f32 v7, v7
    v_exp_f32 v8, v8
    v_smfmac_f32_16x16x64_bf16 v[220:223], a[32:35], v[56:63], v224
    s_waitcnt lgkmcnt(8)
    ds_read_b64_tr_b16 a[24:25], v226 offset:14336
    v_exp_f32 v9, v9
    v_smfmac_f32_32x32x32_bf16 v[64:79], a[16:19], v[0:7], v224
    v_exp_f32 v10, v10
    v_exp_f32 v11, v11
    v_exp_f32 v12, v12
    v_smfmac_f32_16x16x64_bf16 v[208:211], a[32:35], v[0:7], v224
    ds_read_b64_tr_b16 a[26:27], v226 offset:14592
    v_exp_f32 v13, v13
    v_exp_f32 v14, v14
    v_exp_f32 v15, v15
    v_mfma_f32_32x32x16_bf16 v[32:47], a[0:3], v[144:147], 4.0
    v_exp_f32 v16, v16
    v_exp_f32 v17, v17
    v_exp_f32 v18, v18
    v_mfma_f32_32x32x16_bf16 v[32:47], a[4:7], v[148:151], v[32:47]
    s_waitcnt lgkmcnt(8)
    v_exp_f32 v19, v19
    v_exp_f32 v20, v20
    v_exp_f32 v21, v21
    v_smfmac_f32_32x32x32_bf16 v[64:79], a[20:23], v[8:15], v224
    v_exp_f32 v22, v22
    v_exp_f32 v23, v23
    v_exp_f32 v24, v24
    v_smfmac_f32_16x16x64_bf16 v[208:211], a[32:35], v[8:15], v224
    ds_read_b64_tr_b16 a[28:29], v226 offset:15360
    v_exp_f32 v25, v25
    v_smfmac_f32_32x32x32_bf16 v[80:95], a[16:19], v[16:23], v224
    v_exp_f32 v26, v26
    v_exp_f32 v27, v27
    v_exp_f32 v28, v28
    v_smfmac_f32_16x16x64_bf16 v[212:215], a[32:35], v[16:23], v224
    ds_read_b64_tr_b16 a[30:31], v226 offset:15616
    v_exp_f32 v29, v29
    v_exp_f32 v30, v30
    v_exp_f32 v31, v31
    v_mfma_f32_32x32x16_bf16 v[48:63], a[0:3], v[152:155], 4.0
    v_exp_f32 v32, v32
    v_exp_f32 v33, v33
    v_exp_f32 v34, v34
    v_mfma_f32_32x32x16_bf16 v[48:63], a[4:7], v[156:159], v[48:63]
    v_exp_f32 v35, v35
    v_exp_f32 v36, v36
    v_exp_f32 v37, v37
    v_smfmac_f32_32x32x32_bf16 v[80:95], a[20:23], v[24:31], v224
    v_exp_f32 v38, v38
    v_exp_f32 v39, v39
    v_exp_f32 v40, v40
    v_smfmac_f32_16x16x64_bf16 v[212:215], a[32:35], v[24:31], v224
    buffer_store_dwordx4 v[192:195], v247, s[48:51], s39 offen offset:0 sc1
    v_exp_f32 v41, v41
    v_smfmac_f32_32x32x32_bf16 v[96:111], a[16:19], v[32:39], v224
    v_exp_f32 v42, v42
    v_exp_f32 v43, v43
    v_exp_f32 v44, v44
    v_smfmac_f32_16x16x64_bf16 v[216:219], a[32:35], v[32:39], v224
    s_waitcnt lgkmcnt(7)
    buffer_store_dwordx4 v[196:199], v247, s[48:51], s39 offen offset:512 sc1
    v_exp_f32 v45, v45
    v_exp_f32 v46, v46
    v_exp_f32 v47, v47
    v_mfma_f32_32x32x16_bf16 v[0:15], a[8:11], v[128:131], 4.0
    s_waitcnt lgkmcnt(6)
    v_exp_f32 v48, v48
    v_exp_f32 v49, v49
    v_exp_f32 v50, v50
    v_mfma_f32_32x32x16_bf16 v[0:15], a[12:15], v[132:135], v[0:15]
    s_waitcnt vmcnt(6) lgkmcnt(0)
    v_exp_f32 v51, v51
    v_exp_f32 v52, v52
    v_exp_f32 v53, v53
    v_smfmac_f32_32x32x32_bf16 v[96:111], a[20:23], v[40:47], v224
    s_barrier
    v_exp_f32 v54, v54
    v_exp_f32 v55, v55
    v_exp_f32 v56, v56
    v_smfmac_f32_16x16x64_bf16 v[216:219], a[32:35], v[40:47], v224
    ds_read_b128 a[0:3], v225 offset:32768
    v_exp_f32 v57, v57
    v_smfmac_f32_32x32x32_bf16 v[112:127], a[16:19], v[48:55], v224
    s_mov_b32 m0, s56
    v_exp_f32 v58, v58
    v_exp_f32 v59, v59
    v_exp_f32 v60, v60
    v_smfmac_f32_16x16x64_bf16 v[220:223], a[32:35], v[48:55], v224
    ds_read_b128 a[4:7], v225 offset:33792
    v_exp_f32 v61, v61
    v_exp_f32 v62, v62
    v_exp_f32 v63, v63
    v_mfma_f32_32x32x16_bf16 v[16:31], a[8:11], v[136:139], 4.0
    buffer_load_dwordx4 v225, s[24:27], s38 offen offset:0 nt lds
    v_exp_f32 v0, v0
    v_exp_f32 v1, v1
    v_exp_f32 v2, v2
    v_mfma_f32_32x32x16_bf16 v[16:31], a[12:15], v[140:143], v[16:31]
    buffer_load_dwordx4 v225, s[24:27], s38 offen offset:1024 nt lds
    v_exp_f32 v3, v3
    v_exp_f32 v4, v4
    v_exp_f32 v5, v5
    v_smfmac_f32_32x32x32_bf16 v[112:127], a[20:23], v[56:63], v224
    v_exp_f32 v6, v6
    v_exp_f32 v7, v7
    v_exp_f32 v8, v8
    v_smfmac_f32_16x16x64_bf16 v[220:223], a[32:35], v[56:63], v224
    ds_read_b64_tr_b16 a[16:17], v226 offset:32768
    v_exp_f32 v9, v9
    v_smfmac_f32_32x32x32_bf16 v[64:79], a[24:27], v[0:7], v224
    v_exp_f32 v10, v10
    v_exp_f32 v11, v11
    v_exp_f32 v12, v12
    v_smfmac_f32_16x16x64_bf16 v[208:211], a[32:35], v[0:7], v224
    ds_read_b64_tr_b16 a[18:19], v226 offset:33024
    v_exp_f32 v13, v13
    v_exp_f32 v14, v14
    v_exp_f32 v15, v15
    v_mfma_f32_32x32x16_bf16 v[32:47], a[8:11], v[144:147], 4.0
    buffer_load_dwordx4 v225, s[24:27], s12 offen offset:2048 nt lds
    v_exp_f32 v16, v16
    v_exp_f32 v17, v17
    v_exp_f32 v18, v18
    v_mfma_f32_32x32x16_bf16 v[32:47], a[12:15], v[148:151], v[32:47]
    buffer_load_dwordx4 v225, s[24:27], s12 offen offset:3072 nt lds
    v_exp_f32 v19, v19
    v_exp_f32 v20, v20
    v_exp_f32 v21, v21
    v_smfmac_f32_32x32x32_bf16 v[64:79], a[28:31], v[8:15], v224
    v_exp_f32 v22, v22
    v_exp_f32 v23, v23
    v_exp_f32 v24, v24
    v_smfmac_f32_16x16x64_bf16 v[208:211], a[32:35], v[8:15], v224
    ds_read_b64_tr_b16 a[20:21], v226 offset:33792
    v_exp_f32 v25, v25
    v_smfmac_f32_32x32x32_bf16 v[80:95], a[24:27], v[16:23], v224
    v_exp_f32 v26, v26
    v_exp_f32 v27, v27
    v_exp_f32 v28, v28
    v_smfmac_f32_16x16x64_bf16 v[212:215], a[32:35], v[16:23], v224
    ds_read_b64_tr_b16 a[22:23], v226 offset:34048
    v_exp_f32 v29, v29
    v_exp_f32 v30, v30
    v_exp_f32 v31, v31
    v_mfma_f32_32x32x16_bf16 v[48:63], a[8:11], v[152:155], 4.0
    v_exp_f32 v32, v32
    v_exp_f32 v33, v33
    v_exp_f32 v34, v34
    v_mfma_f32_32x32x16_bf16 v[48:63], a[12:15], v[156:159], v[48:63]
    v_exp_f32 v35, v35
    v_exp_f32 v36, v36
    v_exp_f32 v37, v37
    v_smfmac_f32_32x32x32_bf16 v[80:95], a[28:31], v[24:31], v224
    v_exp_f32 v38, v38
    v_exp_f32 v39, v39
    v_exp_f32 v40, v40
    v_smfmac_f32_16x16x64_bf16 v[212:215], a[32:35], v[24:31], v224
    buffer_store_dwordx4 v[200:203], v247, s[48:51], s39 offen offset:1024 sc1
    v_exp_f32 v41, v41
    v_smfmac_f32_32x32x32_bf16 v[96:111], a[24:27], v[32:39], v224
    v_exp_f32 v42, v42
    v_exp_f32 v43, v43
    v_exp_f32 v44, v44
    v_smfmac_f32_16x16x64_bf16 v[216:219], a[32:35], v[32:39], v224
    s_waitcnt lgkmcnt(5)
    buffer_store_dwordx4 v[204:207], v247, s[48:51], s39 offen offset:1536 sc1
    v_exp_f32 v45, v45
    v_exp_f32 v46, v46
    v_exp_f32 v47, v47
    v_mfma_f32_32x32x16_bf16 v[0:15], a[0:3], v[128:131], 4.0
    s_waitcnt lgkmcnt(4)
    v_exp_f32 v48, v48
    v_exp_f32 v49, v49
    v_exp_f32 v50, v50
    v_mfma_f32_32x32x16_bf16 v[0:15], a[4:7], v[132:135], v[0:15]
    v_exp_f32 v51, v51
    v_exp_f32 v52, v52
    v_exp_f32 v53, v53
    v_smfmac_f32_32x32x32_bf16 v[96:111], a[28:31], v[40:47], v224
    s_add_u32 s39, s39, 0x4000
    v_exp_f32 v54, v54
    v_exp_f32 v55, v55
    v_exp_f32 v56, v56
    v_smfmac_f32_16x16x64_bf16 v[216:219], a[32:35], v[40:47], v224
    ds_read_b128 a[8:11], v225 offset:34816
    v_exp_f32 v57, v57
    v_smfmac_f32_32x32x32_bf16 v[112:127], a[24:27], v[48:55], v224
    s_add_u32 s45, s45, 1
    v_exp_f32 v58, v58
    v_exp_f32 v59, v59
    v_exp_f32 v60, v60
    v_smfmac_f32_16x16x64_bf16 v[220:223], a[32:35], v[48:55], v224
    ds_read_b128 a[12:15], v225 offset:35840
    v_exp_f32 v61, v61
    v_exp_f32 v62, v62
    v_exp_f32 v63, v63
    v_mfma_f32_32x32x16_bf16 v[16:31], a[0:3], v[136:139], 4.0
    v_exp_f32 v0, v0
    v_exp_f32 v1, v1
    v_exp_f32 v2, v2
    v_mfma_f32_32x32x16_bf16 v[16:31], a[4:7], v[140:143], v[16:31]
    v_exp_f32 v3, v3
    v_exp_f32 v4, v4
    v_exp_f32 v5, v5
    v_smfmac_f32_32x32x32_bf16 v[112:127], a[28:31], v[56:63], v224
    s_and_b32 s45, s45, 7
    v_exp_f32 v6, v6
    v_exp_f32 v7, v7
    v_exp_f32 v8, v8
    v_smfmac_f32_16x16x64_bf16 v[220:223], a[32:35], v[56:63], v224
    s_waitcnt lgkmcnt(4)
    ds_read_b64_tr_b16 a[24:25], v226 offset:34816
    v_exp_f32 v9, v9
    v_smfmac_f32_32x32x32_bf16 v[64:79], a[16:19], v[0:7], v224
    s_mul_i32 s38, s45, 14336
    v_exp_f32 v10, v10
    v_exp_f32 v11, v11
    v_exp_f32 v12, v12
    v_smfmac_f32_16x16x64_bf16 v[208:211], a[32:35], v[0:7], v224
    ds_read_b64_tr_b16 a[26:27], v226 offset:35072
    v_exp_f32 v13, v13
    v_exp_f32 v14, v14
    v_exp_f32 v15, v15
    v_mfma_f32_32x32x16_bf16 v[32:47], a[0:3], v[144:147], 4.0
    v_exp_f32 v16, v16
    v_exp_f32 v17, v17
    v_exp_f32 v18, v18
    v_mfma_f32_32x32x16_bf16 v[32:47], a[4:7], v[148:151], v[32:47]
    s_waitcnt lgkmcnt(4)
    v_exp_f32 v19, v19
    v_exp_f32 v20, v20
    v_exp_f32 v21, v21
    v_smfmac_f32_32x32x32_bf16 v[64:79], a[20:23], v[8:15], v224
    s_add_u32 s38, s38, s56
    v_exp_f32 v22, v22
    v_exp_f32 v23, v23
    v_exp_f32 v24, v24
    v_smfmac_f32_16x16x64_bf16 v[208:211], a[32:35], v[8:15], v224
    ds_read_b64_tr_b16 a[28:29], v226 offset:35840
    v_exp_f32 v25, v25
    v_smfmac_f32_32x32x32_bf16 v[80:95], a[16:19], v[16:23], v224
    s_lshl_b32 s46, s45, 14
    v_exp_f32 v26, v26
    v_exp_f32 v27, v27
    v_exp_f32 v28, v28
    v_smfmac_f32_16x16x64_bf16 v[212:215], a[32:35], v[16:23], v224
    ds_read_b64_tr_b16 a[30:31], v226 offset:36096
    v_exp_f32 v29, v29
    v_exp_f32 v30, v30
    v_exp_f32 v31, v31
    v_mfma_f32_32x32x16_bf16 v[48:63], a[0:3], v[152:155], 4.0
    v_exp_f32 v32, v32
    v_exp_f32 v33, v33
    v_exp_f32 v34, v34
    v_mfma_f32_32x32x16_bf16 v[48:63], a[4:7], v[156:159], v[48:63]
    v_exp_f32 v35, v35
    v_exp_f32 v36, v36
    v_exp_f32 v37, v37
    v_smfmac_f32_32x32x32_bf16 v[80:95], a[20:23], v[24:31], v224
    s_add_u32 s46, s46, s44
    v_exp_f32 v38, v38
    v_exp_f32 v39, v39
    v_exp_f32 v40, v40
    v_smfmac_f32_16x16x64_bf16 v[212:215], a[32:35], v[24:31], v224
    s_waitcnt vmcnt(8)
    ds_read_b128 v[192:195], v252 offset:0
    v_exp_f32 v41, v41
    v_smfmac_f32_32x32x32_bf16 v[96:111], a[16:19], v[32:39], v224
    s_add_u32 s12, s38, s41
    v_exp_f32 v42, v42
    v_exp_f32 v43, v43
    v_exp_f32 v44, v44
    v_smfmac_f32_16x16x64_bf16 v[216:219], a[32:35], v[32:39], v224
    s_waitcnt lgkmcnt(6)
    ds_read_b128 v[196:199], v253 offset:0
    v_exp_f32 v45, v45
    v_exp_f32 v46, v46
    v_exp_f32 v47, v47
    v_mfma_f32_32x32x16_bf16 v[0:15], a[8:11], v[128:131], 4.0
    s_waitcnt lgkmcnt(6)
    v_exp_f32 v48, v48
    v_exp_f32 v49, v49
    v_exp_f32 v50, v50
    v_mfma_f32_32x32x16_bf16 v[0:15], a[12:15], v[132:135], v[0:15]
    v_exp_f32 v51, v51
    v_exp_f32 v52, v52
    v_exp_f32 v53, v53
    v_smfmac_f32_32x32x32_bf16 v[96:111], a[20:23], v[40:47], v224
    s_add_u32 s14, s46, s41
    v_exp_f32 v54, v54
    v_exp_f32 v55, v55
    v_exp_f32 v56, v56
    v_smfmac_f32_16x16x64_bf16 v[216:219], a[32:35], v[40:47], v224
    ds_read_b128 a[0:3], v225 offset:36864
    v_exp_f32 v57, v57
    v_smfmac_f32_32x32x32_bf16 v[112:127], a[16:19], v[48:55], v224
    v_exp_f32 v58, v58
    v_exp_f32 v59, v59
    v_exp_f32 v60, v60
    v_smfmac_f32_16x16x64_bf16 v[220:223], a[32:35], v[48:55], v224
    ds_read_b128 a[4:7], v225 offset:37888
    v_exp_f32 v61, v61
    v_exp_f32 v62, v62
    v_exp_f32 v63, v63
    v_mfma_f32_32x32x16_bf16 v[16:31], a[8:11], v[136:139], 4.0
    v_exp_f32 v0, v0
    v_exp_f32 v1, v1
    v_exp_f32 v2, v2
    v_mfma_f32_32x32x16_bf16 v[16:31], a[12:15], v[140:143], v[16:31]
    v_exp_f32 v3, v3
    v_exp_f32 v4, v4
    v_exp_f32 v5, v5
    v_smfmac_f32_32x32x32_bf16 v[112:127], a[20:23], v[56:63], v224
    v_exp_f32 v6, v6
    v_exp_f32 v7, v7
    v_exp_f32 v8, v8
    v_smfmac_f32_16x16x64_bf16 v[220:223], a[32:35], v[56:63], v224
    s_waitcnt lgkmcnt(6)
    ds_read_b64_tr_b16 a[16:17], v226 offset:36864
    v_exp_f32 v9, v9
    v_smfmac_f32_32x32x32_bf16 v[64:79], a[24:27], v[0:7], v224
    v_exp_f32 v10, v10
    v_exp_f32 v11, v11
    v_exp_f32 v12, v12
    v_smfmac_f32_16x16x64_bf16 v[208:211], a[32:35], v[0:7], v224
    ds_read_b64_tr_b16 a[18:19], v226 offset:37120
    v_exp_f32 v13, v13
    v_exp_f32 v14, v14
    v_exp_f32 v15, v15
    v_mfma_f32_32x32x16_bf16 v[32:47], a[8:11], v[144:147], 4.0
    v_exp_f32 v16, v16
    v_exp_f32 v17, v17
    v_exp_f32 v18, v18
    v_mfma_f32_32x32x16_bf16 v[32:47], a[12:15], v[148:151], v[32:47]
    s_waitcnt lgkmcnt(6)
    v_exp_f32 v19, v19
    v_exp_f32 v20, v20
    v_exp_f32 v21, v21
    v_smfmac_f32_32x32x32_bf16 v[64:79], a[28:31], v[8:15], v224
    v_exp_f32 v22, v22
    v_exp_f32 v23, v23
    v_exp_f32 v24, v24
    v_smfmac_f32_16x16x64_bf16 v[208:211], a[32:35], v[8:15], v224
    ds_read_b64_tr_b16 a[20:21], v226 offset:37888
    v_exp_f32 v25, v25
    v_smfmac_f32_32x32x32_bf16 v[80:95], a[24:27], v[16:23], v224
    v_exp_f32 v26, v26
    v_exp_f32 v27, v27
    v_exp_f32 v28, v28
    v_smfmac_f32_16x16x64_bf16 v[212:215], a[32:35], v[16:23], v224
    ds_read_b64_tr_b16 a[22:23], v226 offset:38144
    v_exp_f32 v29, v29
    v_exp_f32 v30, v30
    v_exp_f32 v31, v31
    v_mfma_f32_32x32x16_bf16 v[48:63], a[8:11], v[152:155], 4.0
    v_exp_f32 v32, v32
    v_exp_f32 v33, v33
    v_exp_f32 v34, v34
    v_mfma_f32_32x32x16_bf16 v[48:63], a[12:15], v[156:159], v[48:63]
L_pad2B:
    s_cbranch_vccnz L_goB
    v_exp_f32 v35, v35
    v_exp_f32 v36, v36
    v_exp_f32 v37, v37
    v_smfmac_f32_32x32x32_bf16 v[80:95], a[28:31], v[24:31], v224
    v_exp_f32 v38, v38
    v_exp_f32 v39, v39
    v_exp_f32 v40, v40
    v_smfmac_f32_16x16x64_bf16 v[212:215], a[32:35], v[24:31], v224
    ds_read_b128 v[200:203], v254 offset:0
    v_exp_f32 v41, v41
    v_smfmac_f32_32x32x32_bf16 v[96:111], a[24:27], v[32:39], v224
    v_exp_f32 v42, v42
    v_exp_f32 v43, v43
    v_exp_f32 v44, v44
    v_smfmac_f32_16x16x64_bf16 v[216:219], a[32:35], v[32:39], v224
    s_waitcnt lgkmcnt(0)
    ds_read_b128 v[204:207], v255 offset:0
    v_exp_f32 v45, v45
    v_exp_f32 v46, v46
    v_exp_f32 v47, v47
    v_pk_mul_f32 v[236:237], 0, 0
    v_dot2c_f32_bf16 v236, v192, v192
    v_dot2c_f32_bf16 v237, v193, v193
    v_dot2c_f32_bf16 v236, v194, v194
    v_dot2c_f32_bf16 v237, v195, v195
    v_dot2c_f32_bf16 v236, v196, v196
    v_dot2c_f32_bf16 v237, v197, v197
    v_dot2c_f32_bf16 v236, v198, v198
    v_dot2c_f32_bf16 v237, v199, v199
    v_dot2c_f32_bf16 v236, v200, v200
    v_dot2c_f32_bf16 v237, v201, v201
    v_dot2c_f32_bf16 v236, v202, v202
    v_dot2c_f32_bf16 v237, v203, v203
    s_waitcnt lgkmcnt(0)
    v_dot2c_f32_bf16 v236, v204, v204
    v_dot2c_f32_bf16 v237, v205, v205
    v_dot2c_f32_bf16 v236, v206, v206
    v_dot2c_f32_bf16 v237, v207, v207
    v_mfma_f32_32x32x16_bf16 v[0:15], a[0:3], v[128:131], 4.0
    v_exp_f32 v48, v48
    v_exp_f32 v49, v49
    v_exp_f32 v50, v50
    v_mfma_f32_32x32x16_bf16 v[0:15], a[4:7], v[132:135], v[0:15]
    v_exp_f32 v51, v51
    v_exp_f32 v52, v52
    v_exp_f32 v53, v53
    v_smfmac_f32_32x32x32_bf16 v[96:111], a[28:31], v[40:47], v224
    v_exp_f32 v54, v54
    v_exp_f32 v55, v55
    v_exp_f32 v56, v56
    v_smfmac_f32_16x16x64_bf16 v[216:219], a[32:35], v[40:47], v224
    ds_read_b128 a[8:11], v225 offset:38912
    v_exp_f32 v57, v57
    v_smfmac_f32_32x32x32_bf16 v[112:127], a[24:27], v[48:55], v224
    v_exp_f32 v58, v58
    v_exp_f32 v59, v59
    v_exp_f32 v60, v60
    v_smfmac_f32_16x16x64_bf16 v[220:223], a[32:35], v[48:55], v224
    ds_read_b128 a[12:15], v225 offset:39936
    v_exp_f32 v61, v61
    v_mfma_f32_4x4x4_16b_bf16 v[160:163], v[230:231], v[192:193], 0
    v_exp_f32 v62, v62
    v_mfma_f32_4x4x4_16b_bf16 v[164:167], v[230:231], v[194:195], 0
    v_exp_f32 v63, v63
    v_mfma_f32_32x32x16_bf16 v[16:31], a[0:3], v[136:139], 4.0
    v_exp_f32 v0, v0
    v_exp_f32 v1, v1
    v_add_f32 v236, v236, v237
    v_exp_f32 v2, v2
    v_mfma_f32_32x32x16_bf16 v[16:31], a[4:7], v[140:143], v[16:31]
    v_exp_f32 v3, v3
    v_exp_f32 v4, v4
    v_sqrt_f32 v236, v236
    v_exp_f32 v5, v5
    v_smfmac_f32_32x32x32_bf16 v[112:127], a[28:31], v[56:63], v224
    v_exp_f32 v6, v6
    v_exp_f32 v7, v7
    v_add_f32 v236, 0x358637bd, v236
    v_exp_f32 v8, v8
    v_smfmac_f32_16x16x64_bf16 v[220:223], a[32:35], v[56:63], v224
    ds_read_b64_tr_b16 a[24:25], v226 offset:38912
    v_exp_f32 v9, v9
    v_smfmac_f32_32x32x32_bf16 v[64:79], a[16:19], v[0:7], v224
    v_exp_f32 v10, v10
    v_rcp_f32 v236, v236
    v_exp_f32 v11, v11
    v_exp_f32 v12, v12
    v_smfmac_f32_16x16x64_bf16 v[208:211], a[32:35], v[0:7], v224
    ds_read_b64_tr_b16 a[26:27], v226 offset:39168
    v_exp_f32 v13, v13
    v_mfma_f32_4x4x4_16b_bf16 v[168:171], v[230:231], v[196:197], 0
    v_exp_f32 v14, v14
    v_mfma_f32_4x4x4_16b_bf16 v[172:175], v[230:231], v[198:199], 0
    v_exp_f32 v15, v15
    v_mfma_f32_32x32x16_bf16 v[32:47], a[0:3], v[144:147], 4.0
    v_exp_f32 v16, v16
    v_exp_f32 v17, v17
    v_exp_f32 v18, v18
    v_mfma_f32_32x32x16_bf16 v[32:47], a[4:7], v[148:151], v[32:47]
    v_exp_f32 v19, v19
    v_exp_f32 v20, v20
    v_exp_f32 v21, v21
    v_smfmac_f32_32x32x32_bf16 v[64:79], a[20:23], v[8:15], v224
    v_exp_f32 v22, v22
    v_exp_f32 v23, v23
    v_exp_f32 v24, v24
    v_smfmac_f32_16x16x64_bf16 v[208:211], a[32:35], v[8:15], v224
    ds_read_b64_tr_b16 a[28:29], v226 offset:39936
    v_exp_f32 v25, v25
    v_smfmac_f32_32x32x32_bf16 v[80:95], a[16:19], v[16:23], v224
    v_exp_f32 v26, v26
    v_exp_f32 v27, v27
    v_exp_f32 v28, v28
    v_smfmac_f32_16x16x64_bf16 v[212:215], a[32:35], v[16:23], v224
    ds_read_b64_tr_b16 a[30:31], v226 offset:40192
    v_exp_f32 v29, v29
    v_mfma_f32_4x4x4_16b_bf16 v[176:179], v[230:231], v[200:201], 0
    v_exp_f32 v30, v30
    v_mfma_f32_4x4x4_16b_bf16 v[180:183], v[230:231], v[202:203], 0
    v_exp_f32 v31, v31
    v_mfma_f32_32x32x16_bf16 v[48:63], a[0:3], v[152:155], 4.0
    v_exp_f32 v32, v32
    v_exp_f32 v33, v33
    v_exp_f32 v34, v34
    v_mfma_f32_32x32x16_bf16 v[48:63], a[4:7], v[156:159], v[48:63]
    v_exp_f32 v35, v35
    v_exp_f32 v36, v36
    v_exp_f32 v37, v37
    v_smfmac_f32_32x32x32_bf16 v[80:95], a[20:23], v[24:31], v224
    v_exp_f32 v38, v38
    v_exp_f32 v39, v39
    v_exp_f32 v40, v40
    v_smfmac_f32_16x16x64_bf16 v[212:215], a[32:35], v[24:31], v224
    v_exp_f32 v41, v41
    v_smfmac_f32_32x32x32_bf16 v[96:111], a[16:19], v[32:39], v224
    v_exp_f32 v42, v42
    v_exp_f32 v43, v43
    v_exp_f32 v44, v44
    v_smfmac_f32_16x16x64_bf16 v[216:219], a[32:35], v[32:39], v224
    s_waitcnt lgkmcnt(5)
    v_exp_f32 v45, v45
    v_mfma_f32_4x4x4_16b_bf16 v[184:187], v[230:231], v[204:205], 0
    v_exp_f32 v46, v46
    v_mfma_f32_4x4x4_16b_bf16 v[188:191], v[230:231], v[206:207], 0
    v_exp_f32 v47, v47
    v_mfma_f32_32x32x16_bf16 v[0:15], a[8:11], v[128:131], 4.0
    s_waitcnt lgkmcnt(4)
    v_exp_f32 v48, v48
    v_exp_f32 v49, v49
    v_exp_f32 v50, v50
    v_mfma_f32_32x32x16_bf16 v[0:15], a[12:15], v[132:135], v[0:15]
    v_exp_f32 v51, v51
    v_exp_f32 v52, v52
    v_exp_f32 v53, v53
    v_smfmac_f32_32x32x32_bf16 v[96:111], a[20:23], v[40:47], v224
    v_exp_f32 v54, v54
    v_exp_f32 v55, v55
    v_exp_f32 v56, v56
    v_smfmac_f32_16x16x64_bf16 v[216:219], a[32:35], v[40:47], v224
    ds_read_b128 a[0:3], v225 offset:40960
    v_exp_f32 v57, v57
    v_smfmac_f32_32x32x32_bf16 v[112:127], a[16:19], v[48:55], v224
    v_exp_f32 v58, v58
    v_exp_f32 v59, v59
    v_exp_f32 v60, v60
    v_smfmac_f32_16x16x64_bf16 v[220:223], a[32:35], v[48:55], v224
    ds_read_b128 a[4:7], v225 offset:41984
    v_exp_f32 v61, v61
    v_exp_f32 v62, v62
    v_exp_f32 v63, v63
    v_pk_mul_f32 v[160:161], v[160:161], v[236:237] op_sel_hi:[1,0]
    v_pk_mul_f32 v[162:163], v[162:163], v[236:237] op_sel_hi:[1,0]
    v_pk_mul_f32 v[164:165], v[164:165], v[236:237] op_sel_hi:[1,0]
    v_pk_mul_f32 v[166:167], v[166:167], v[236:237] op_sel_hi:[1,0]
    v_pk_mul_f32 v[168:169], v[168:169], v[236:237] op_sel_hi:[1,0]
    v_pk_mul_f32 v[170:171], v[170:171], v[236:237] op_sel_hi:[1,0]
    v_pk_mul_f32 v[172:173], v[172:173], v[236:237] op_sel_hi:[1,0]
    v_pk_mul_f32 v[174:175], v[174:175], v[236:237] op_sel_hi:[1,0]
    v_mfma_f32_32x32x16_bf16 v[16:31], a[8:11], v[136:139], 4.0
    v_exp_f32 v0, v0
    v_cvt_pk_bf16_f32 v192, v160, v161
    v_exp_f32 v1, v1
    v_cvt_pk_bf16_f32 v193, v162, v163
    v_exp_f32 v2, v2
    v_mfma_f32_32x32x16_bf16 v[16:31], a[12:15], v[140:143], v[16:31]
    v_exp_f32 v3, v3
    v_cvt_pk_bf16_f32 v194, v164, v165
    v_exp_f32 v4, v4
    v_cvt_pk_bf16_f32 v195, v166, v167
    v_exp_f32 v5, v5
    v_smfmac_f32_32x32x32_bf16 v[112:127], a[20:23], v[56:63], v224
    v_exp_f32 v6, v6
    v_cvt_pk_bf16_f32 v196, v168, v169
    v_exp_f32 v7, v7
    v_cvt_pk_bf16_f32 v197, v170, v171
    v_exp_f32 v8, v8
    v_smfmac_f32_16x16x64_bf16 v[220:223], a[32:35], v[56:63], v224
    s_waitcnt lgkmcnt(4)
    ds_read_b64_tr_b16 a[16:17], v226 offset:40960
    v_exp_f32 v9, v9
    v_smfmac_f32_32x32x32_bf16 v[64:79], a[24:27], v[0:7], v224
    v_exp_f32 v10, v10
    v_cvt_pk_bf16_f32 v198, v172, v173
    v_exp_f32 v11, v11
    v_cvt_pk_bf16_f32 v199, v174, v175
    v_exp_f32 v12, v12
    v_smfmac_f32_16x16x64_bf16 v[208:211], a[32:35], v[0:7], v224
    ds_read_b64_tr_b16 a[18:19], v226 offset:41216
    v_exp_f32 v13, v13
    v_exp_f32 v14, v14
    v_exp_f32 v15, v15
    v_pk_mul_f32 v[176:177], v[176:177], v[236:237] op_sel_hi:[1,0]
    v_pk_mul_f32 v[178:179], v[178:179], v[236:237] op_sel_hi:[1,0]
    v_pk_mul_f32 v[180:181], v[180:181], v[236:237] op_sel_hi:[1,0]
    v_pk_mul_f32 v[182:183], v[182:183], v[236:237] op_sel_hi:[1,0]
    v_pk_mul_f32 v[184:185], v[184:185], v[236:237] op_sel_hi:[1,0]
    v_pk_mul_f32 v[186:187], v[186:187], v[236:237] op_sel_hi:[1,0]
    v_pk_mul_f32 v[188:189], v[188:189], v[236:237] op_sel_hi:[1,0]
    v_pk_mul_f32 v[190:191], v[190:191], v[236:237] op_sel_hi:[1,0]
    v_mfma_f32_32x32x16_bf16 v[32:47], a[8:11], v[144:147], 4.0
    v_exp_f32 v16, v16
    v_cvt_pk_bf16_f32 v200, v176, v177
    v_exp_f32 v17, v17
    v_cvt_pk_bf16_f32 v201, v178, v179
    v_exp_f32 v18, v18
    v_mfma_f32_32x32x16_bf16 v[32:47], a[12:15], v[148:151], v[32:47]
    s_waitcnt lgkmcnt(4)
    v_exp_f32 v19, v19
    v_cvt_pk_bf16_f32 v202, v180, v181
    v_exp_f32 v20, v20
    v_cvt_pk_bf16_f32 v203, v182, v183
    v_exp_f32 v21, v21
    v_smfmac_f32_32x32x32_bf16 v[64:79], a[28:31], v[8:15], v224
    v_exp_f32 v22, v22
    v_cvt_pk_bf16_f32 v204, v184, v185
    v_exp_f32 v23, v23
    v_cvt_pk_bf16_f32 v205, v186, v187
    v_exp_f32 v24, v24
    v_smfmac_f32_16x16x64_bf16 v[208:211], a[32:35], v[8:15], v224
    ds_read_b64_tr_b16 a[20:21], v226 offset:41984
    v_exp_f32 v25, v25
    v_smfmac_f32_32x32x32_bf16 v[80:95], a[24:27], v[16:23], v224
    v_exp_f32 v26, v26
    v_cvt_pk_bf16_f32 v206, v188, v189
    v_exp_f32 v27, v27
    v_cvt_pk_bf16_f32 v207, v190, v191
    v_exp_f32 v28, v28
    v_smfmac_f32_16x16x64_bf16 v[212:215], a[32:35], v[16:23], v224
    ds_read_b64_tr_b16 a[22:23], v226 offset:42240
    v_exp_f32 v29, v29
    v_exp_f32 v30, v30
    v_exp_f32 v31, v31
    v_mfma_f32_32x32x16_bf16 v[48:63], a[8:11], v[152:155], 4.0
    v_exp_f32 v32, v32
    v_exp_f32 v33, v33
    v_exp_f32 v34, v34
    v_mfma_f32_32x32x16_bf16 v[48:63], a[12:15], v[156:159], v[48:63]
    v_exp_f32 v35, v35
    v_exp_f32 v36, v36
    v_exp_f32 v37, v37
    v_smfmac_f32_32x32x32_bf16 v[80:95], a[28:31], v[24:31], v224
    v_exp_f32 v38, v38
    v_exp_f32 v39, v39
    v_exp_f32 v40, v40
    v_smfmac_f32_16x16x64_bf16 v[212:215], a[32:35], v[24:31], v224
    ds_write_b128 v227, v[192:195] offset:0
    v_exp_f32 v41, v41
    v_smfmac_f32_32x32x32_bf16 v[96:111], a[24:27], v[32:39], v224
    v_exp_f32 v42, v42
    v_exp_f32 v43, v43
    v_exp_f32 v44, v44
    v_smfmac_f32_16x16x64_bf16 v[216:219], a[32:35], v[32:39], v224
    s_waitcnt lgkmcnt(6)
    ds_write_b128 v227, v[196:199] offset:512
    v_exp_f32 v45, v45
    v_exp_f32 v46, v46
    v_exp_f32 v47, v47
    v_mfma_f32_32x32x16_bf16 v[0:15], a[0:3], v[128:131], 4.0
    s_waitcnt lgkmcnt(6)
    v_exp_f32 v48, v48
    v_exp_f32 v49, v49
    v_exp_f32 v50, v50
    v_not_b32 v248, v232
    v_mfma_f32_32x32x16_bf16 v[0:15], a[4:7], v[132:135], v[0:15]
    v_exp_f32 v51, v51
    v_exp_f32 v52, v52
    v_exp_f32 v53, v53
    v_smfmac_f32_32x32x32_bf16 v[96:111], a[28:31], v[40:47], v224
    v_exp_f32 v54, v54
    v_exp_f32 v55, v55
    v_exp_f32 v56, v56
    v_smfmac_f32_16x16x64_bf16 v[216:219], a[32:35], v[40:47], v224
    ds_read_b128 a[8:11], v225 offset:43008
    v_exp_f32 v57, v57
    v_smfmac_f32_32x32x32_bf16 v[112:127], a[24:27], v[48:55], v224
    v_exp_f32 v58, v58
    v_exp_f32 v59, v59
    v_exp_f32 v60, v60
    v_smfmac_f32_16x16x64_bf16 v[220:223], a[32:35], v[48:55], v224
    ds_read_b128 a[12:15], v225 offset:44032
    v_exp_f32 v61, v61
    v_exp_f32 v62, v62
    v_exp_f32 v63, v63
    v_mfma_f32_32x32x16_bf16 v[16:31], a[0:3], v[136:139], 4.0
    s_waitcnt vmcnt(0)
    buffer_store_dword v248, v228, s[52:55], 0 offen offset:0 sc1
    v_exp_f32 v0, v0
    v_exp_f32 v1, v1
    v_exp_f32 v2, v2
    v_mfma_f32_32x32x16_bf16 v[16:31], a[4:7], v[140:143], v[16:31]
    v_exp_f32 v3, v3
    v_exp_f32 v4, v4
    v_exp_f32 v5, v5
    v_smfmac_f32_32x32x32_bf16 v[112:127], a[28:31], v[56:63], v224
    v_exp_f32 v6, v6
    v_exp_f32 v7, v7
    v_exp_f32 v8, v8
    v_smfmac_f32_16x16x64_bf16 v[220:223], a[32:35], v[56:63], v224
    s_waitcnt lgkmcnt(6)
    ds_read_b64_tr_b16 a[24:25], v226 offset:43008
    v_exp_f32 v9, v9
    v_smfmac_f32_32x32x32_bf16 v[64:79], a[16:19], v[0:7], v224
    v_exp_f32 v10, v10
    v_exp_f32 v11, v11
    v_exp_f32 v12, v12
    v_smfmac_f32_16x16x64_bf16 v[208:211], a[32:35], v[0:7], v224
    ds_read_b64_tr_b16 a[26:27], v226 offset:43264
    v_exp_f32 v13, v13
    v_exp_f32 v14, v14
    v_exp_f32 v15, v15
    v_mfma_f32_32x32x16_bf16 v[32:47], a[0:3], v[144:147], 4.0
    v_exp_f32 v16, v16
    v_exp_f32 v17, v17
    v_exp_f32 v18, v18
    v_mfma_f32_32x32x16_bf16 v[32:47], a[4:7], v[148:151], v[32:47]
    s_waitcnt lgkmcnt(6)
    v_exp_f32 v19, v19
    v_exp_f32 v20, v20
    v_exp_f32 v21, v21
    v_smfmac_f32_32x32x32_bf16 v[64:79], a[20:23], v[8:15], v224
    v_exp_f32 v22, v22
    v_exp_f32 v23, v23
    v_exp_f32 v24, v24
    v_smfmac_f32_16x16x64_bf16 v[208:211], a[32:35], v[8:15], v224
    ds_read_b64_tr_b16 a[28:29], v226 offset:44032
    v_exp_f32 v25, v25
    v_smfmac_f32_32x32x32_bf16 v[80:95], a[16:19], v[16:23], v224
    v_exp_f32 v26, v26
    v_exp_f32 v27, v27
    v_exp_f32 v28, v28
    v_smfmac_f32_16x16x64_bf16 v[212:215], a[32:35], v[16:23], v224
    ds_read_b64_tr_b16 a[30:31], v226 offset:44288
    v_exp_f32 v29, v29
    v_exp_f32 v30, v30
    v_exp_f32 v31, v31
    v_mfma_f32_32x32x16_bf16 v[48:63], a[0:3], v[152:155], 4.0
    v_exp_f32 v32, v32
    v_exp_f32 v33, v33
    v_exp_f32 v34, v34
    v_mfma_f32_32x32x16_bf16 v[48:63], a[4:7], v[156:159], v[48:63]
    v_exp_f32 v35, v35
    v_exp_f32 v36, v36
    v_exp_f32 v37, v37
    v_smfmac_f32_32x32x32_bf16 v[80:95], a[20:23], v[24:31], v224
    v_exp_f32 v38, v38
    v_exp_f32 v39, v39
    v_exp_f32 v40, v40
    v_smfmac_f32_16x16x64_bf16 v[212:215], a[32:35], v[24:31], v224
    ds_write_b128 v227, v[200:203] offset:1024
    v_exp_f32 v41, v41
    v_smfmac_f32_32x32x32_bf16 v[96:111], a[16:19], v[32:39], v224
    v_exp_f32 v42, v42
    v_exp_f32 v43, v43
    v_exp_f32 v44, v44
    v_smfmac_f32_16x16x64_bf16 v[216:219], a[32:35], v[32:39], v224
    s_waitcnt lgkmcnt(6)
    ds_write_b128 v227, v[204:207] offset:1536
    v_exp_f32 v45, v45
    v_exp_f32 v46, v46
    v_exp_f32 v47, v47
    v_mfma_f32_32x32x16_bf16 v[0:15], a[8:11], v[128:131], 4.0
    s_waitcnt lgkmcnt(6)
    v_exp_f32 v48, v48
    v_exp_f32 v49, v49
    v_exp_f32 v50, v50
    v_mfma_f32_32x32x16_bf16 v[0:15], a[12:15], v[132:135], v[0:15]
    v_exp_f32 v51, v51
    v_exp_f32 v52, v52
    v_exp_f32 v53, v53
    v_smfmac_f32_32x32x32_bf16 v[96:111], a[20:23], v[40:47], v224
    v_exp_f32 v54, v54
    v_exp_f32 v55, v55
    v_exp_f32 v56, v56
    v_smfmac_f32_16x16x64_bf16 v[216:219], a[32:35], v[40:47], v224
    ds_read_b128 a[0:3], v225 offset:45056
    v_exp_f32 v57, v57
    v_smfmac_f32_32x32x32_bf16 v[112:127], a[16:19], v[48:55], v224
    v_exp_f32 v58, v58
    v_exp_f32 v59, v59
    v_exp_f32 v60, v60
    v_smfmac_f32_16x16x64_bf16 v[220:223], a[32:35], v[48:55], v224
    ds_read_b128 a[4:7], v225 offset:46080
    v_exp_f32 v61, v61
    v_exp_f32 v62, v62
    v_exp_f32 v63, v63
    v_mfma_f32_32x32x16_bf16 v[16:31], a[8:11], v[136:139], 4.0
    v_exp_f32 v0, v0
    v_exp_f32 v1, v1
    v_exp_f32 v2, v2
    v_mfma_f32_32x32x16_bf16 v[16:31], a[12:15], v[140:143], v[16:31]
    v_exp_f32 v3, v3
    v_exp_f32 v4, v4
    v_exp_f32 v5, v5
    v_smfmac_f32_32x32x32_bf16 v[112:127], a[20:23], v[56:63], v224
    v_exp_f32 v6, v6
    v_exp_f32 v7, v7
    v_exp_f32 v8, v8
    v_smfmac_f32_16x16x64_bf16 v[220:223], a[32:35], v[56:63], v224
    s_waitcnt lgkmcnt(6)
    ds_read_b64_tr_b16 a[16:17], v226 offset:45056
    v_exp_f32 v9, v9
    v_smfmac_f32_32x32x32_bf16 v[64:79], a[24:27], v[0:7], v224
    v_exp_f32 v10, v10
    v_exp_f32 v11, v11
    v_exp_f32 v12, v12
    v_smfmac_f32_16x16x64_bf16 v[208:211], a[32:35], v[0:7], v224
    ds_read_b64_tr_b16 a[18:19], v226 offset:45312
    v_exp_f32 v13, v13
    v_exp_f32 v14, v14
    v_exp_f32 v15, v15
    v_mfma_f32_32x32x16_bf16 v[32:47], a[8:11], v[144:147], 4.0
    v_exp_f32 v16, v16
    v_exp_f32 v17, v17
    v_exp_f32 v18, v18
    v_mfma_f32_32x32x16_bf16 v[32:47], a[12:15], v[148:151], v[32:47]
    s_waitcnt lgkmcnt(6)
    v_exp_f32 v19, v19
    v_exp_f32 v20, v20
    v_exp_f32 v21, v21
    v_smfmac_f32_32x32x32_bf16 v[64:79], a[28:31], v[8:15], v224
    v_exp_f32 v22, v22
    v_exp_f32 v23, v23
    v_exp_f32 v24, v24
    v_smfmac_f32_16x16x64_bf16 v[208:211], a[32:35], v[8:15], v224
    ds_read_b64_tr_b16 a[20:21], v226 offset:46080
    v_exp_f32 v25, v25
    v_smfmac_f32_32x32x32_bf16 v[80:95], a[24:27], v[16:23], v224
    v_exp_f32 v26, v26
    v_exp_f32 v27, v27
    v_exp_f32 v28, v28
    v_smfmac_f32_16x16x64_bf16 v[212:215], a[32:35], v[16:23], v224
    ds_read_b64_tr_b16 a[22:23], v226 offset:46336
    v_exp_f32 v29, v29
    v_exp_f32 v30, v30
    v_exp_f32 v31, v31
    v_mfma_f32_32x32x16_bf16 v[48:63], a[8:11], v[152:155], 4.0
    v_exp_f32 v32, v32
    v_exp_f32 v33, v33
    v_exp_f32 v34, v34
    v_mfma_f32_32x32x16_bf16 v[48:63], a[12:15], v[156:159], v[48:63]
    v_exp_f32 v35, v35
    v_exp_f32 v36, v36
    v_exp_f32 v37, v37
    v_smfmac_f32_32x32x32_bf16 v[80:95], a[28:31], v[24:31], v224
    v_exp_f32 v38, v38
    v_exp_f32 v39, v39
    v_exp_f32 v40, v40
    v_smfmac_f32_16x16x64_bf16 v[212:215], a[32:35], v[24:31], v224
    v_exp_f32 v41, v41
    v_smfmac_f32_32x32x32_bf16 v[96:111], a[24:27], v[32:39], v224
    v_exp_f32 v42, v42
    v_exp_f32 v43, v43
    v_exp_f32 v44, v44
    v_smfmac_f32_16x16x64_bf16 v[216:219], a[32:35], v[32:39], v224
    s_waitcnt lgkmcnt(5)
    v_exp_f32 v45, v45
    v_exp_f32 v46, v46
    v_exp_f32 v47, v47
    v_mfma_f32_32x32x16_bf16 v[0:15], a[0:3], v[128:131], 4.0
    s_waitcnt lgkmcnt(4)
    v_exp_f32 v48, v48
    v_exp_f32 v49, v49
    v_exp_f32 v50, v50
    v_mfma_f32_32x32x16_bf16 v[0:15], a[4:7], v[132:135], v[0:15]
    s_waitcnt lgkmcnt(0)
    v_exp_f32 v51, v51
    v_exp_f32 v52, v52
    v_exp_f32 v53, v53
    v_smfmac_f32_32x32x32_bf16 v[96:111], a[28:31], v[40:47], v224
    s_barrier
    v_exp_f32 v54, v54
    v_exp_f32 v55, v55
    v_exp_f32 v56, v56
    v_smfmac_f32_16x16x64_bf16 v[216:219], a[32:35], v[40:47], v224
    ds_read_b128 a[8:11], v225 offset:0
    v_exp_f32 v57, v57
    v_smfmac_f32_32x32x32_bf16 v[112:127], a[24:27], v[48:55], v224
    v_exp_f32 v58, v58
    v_exp_f32 v59, v59
    v_exp_f32 v60, v60
    v_smfmac_f32_16x16x64_bf16 v[220:223], a[32:35], v[48:55], v224
    ds_read_b128 a[12:15], v225 offset:1024
    v_exp_f32 v61, v61
    v_exp_f32 v62, v62
    v_exp_f32 v63, v63
    v_mfma_f32_32x32x16_bf16 v[16:31], a[0:3], v[136:139], 4.0
    v_exp_f32 v0, v0
    v_exp_f32 v1, v1
    v_exp_f32 v2, v2
    v_mfma_f32_32x32x16_bf16 v[16:31], a[4:7], v[140:143], v[16:31]
    v_exp_f32 v3, v3
    v_exp_f32 v4, v4
    v_exp_f32 v5, v5
    v_smfmac_f32_32x32x32_bf16 v[112:127], a[28:31], v[56:63], v224
    v_exp_f32 v6, v6
    v_exp_f32 v7, v7
    v_exp_f32 v8, v8
    v_smfmac_f32_16x16x64_bf16 v[220:223], a[32:35], v[56:63], v224
    ds_read_b64_tr_b16 a[24:25], v226 offset:0
    v_exp_f32 v9, v9
    v_smfmac_f32_32x32x32_bf16 v[64:79], a[16:19], v[0:7], v224
    v_exp_f32 v10, v10
    v_exp_f32 v11, v11
    v_exp_f32 v12, v12
    v_smfmac_f32_16x16x64_bf16 v[208:211], a[32:35], v[0:7], v224
    ds_read_b64_tr_b16 a[26:27], v226 offset:256
    v_exp_f32 v13, v13
    v_exp_f32 v14, v14
    v_exp_f32 v15, v15
    v_mfma_f32_32x32x16_bf16 v[32:47], a[0:3], v[144:147], 4.0
    v_exp_f32 v16, v16
    v_exp_f32 v17, v17
    v_exp_f32 v18, v18
    v_mfma_f32_32x32x16_bf16 v[32:47], a[4:7], v[148:151], v[32:47]
    v_exp_f32 v19, v19
    v_exp_f32 v20, v20
    v_exp_f32 v21, v21
    v_smfmac_f32_32x32x32_bf16 v[64:79], a[20:23], v[8:15], v224
    v_exp_f32 v22, v22
    v_exp_f32 v23, v23
    v_exp_f32 v24, v24
    v_smfmac_f32_16x16x64_bf16 v[208:211], a[32:35], v[8:15], v224
    ds_read_b64_tr_b16 a[28:29], v226 offset:1024
    v_exp_f32 v25, v25
    v_smfmac_f32_32x32x32_bf16 v[80:95], a[16:19], v[16:23], v224
    s_mov_b32 m0, s57
    v_exp_f32 v26, v26
    v_exp_f32 v27, v27
    v_exp_f32 v28, v28
    v_smfmac_f32_16x16x64_bf16 v[212:215], a[32:35], v[16:23], v224
    ds_read_b64_tr_b16 a[30:31], v226 offset:1280
    v_exp_f32 v29, v29
    v_exp_f32 v30, v30
    v_exp_f32 v31, v31
    v_mfma_f32_32x32x16_bf16 v[48:63], a[0:3], v[152:155], 4.0
    buffer_load_dwordx4 v225, s[24:27], s38 offen offset:0 nt lds
    v_exp_f32 v32, v32
    v_exp_f32 v33, v33
    v_exp_f32 v34, v34
    v_mfma_f32_32x32x16_bf16 v[48:63], a[4:7], v[156:159], v[48:63]
    buffer_load_dwordx4 v225, s[24:27], s38 offen offset:1024 nt lds
    v_exp_f32 v35, v35
    v_exp_f32 v36, v36
    v_exp_f32 v37, v37
    v_smfmac_f32_32x32x32_bf16 v[80:95], a[20:23], v[24:31], v224
    v_exp_f32 v38, v38
    v_exp_f32 v39, v39
    v_exp_f32 v40, v40
    v_smfmac_f32_16x16x64_bf16 v[212:215], a[32:35], v[24:31], v224
    buffer_load_dwordx4 v225, s[24:27], s12 offen offset:2048 nt lds
    v_exp_f32 v41, v41
    v_smfmac_f32_32x32x32_bf16 v[96:111], a[16:19], v[32:39], v224
    v_exp_f32 v42, v42
    v_exp_f32 v43, v43
    v_exp_f32 v44, v44
    v_smfmac_f32_16x16x64_bf16 v[216:219], a[32:35], v[32:39], v224
    s_waitcnt lgkmcnt(5)
    buffer_load_dwordx4 v225, s[24:27], s12 offen offset:3072 nt lds
    v_exp_f32 v45, v45
    v_exp_f32 v46, v46
    v_exp_f32 v47, v47
    v_mfma_f32_32x32x16_bf16 v[0:15], a[8:11], v[128:131], 4.0
    s_waitcnt lgkmcnt(4)
    v_exp_f32 v48, v48
    v_exp_f32 v49, v49
    v_exp_f32 v50, v50
    v_mfma_f32_32x32x16_bf16 v[0:15], a[12:15], v[132:135], v[0:15]
    v_exp_f32 v51, v51
    v_exp_f32 v52, v52
    v_exp_f32 v53, v53
    v_smfmac_f32_32x32x32_bf16 v[96:111], a[20:23], v[40:47], v224
    v_exp_f32 v54, v54
    v_exp_f32 v55, v55
    v_exp_f32 v56, v56
    v_smfmac_f32_16x16x64_bf16 v[216:219], a[32:35], v[40:47], v224
    ds_read_b128 a[0:3], v225 offset:2048
    v_exp_f32 v57, v57
    v_smfmac_f32_32x32x32_bf16 v[112:127], a[16:19], v[48:55], v224
    v_exp_f32 v58, v58
    v_exp_f32 v59, v59
    v_exp_f32 v60, v60
    v_smfmac_f32_16x16x64_bf16 v[220:223], a[32:35], v[48:55], v224
    ds_read_b128 a[4:7], v225 offset:3072
    v_exp_f32 v61, v61
    v_exp_f32 v62, v62
    v_exp_f32 v63, v63
    v_mfma_f32_32x32x16_bf16 v[16:31], a[8:11], v[136:139], 4.0
    v_exp_f32 v0, v0
    v_exp_f32 v1, v1
    v_exp_f32 v2, v2
    v_mfma_f32_32x32x16_bf16 v[16:31], a[12:15], v[140:143], v[16:31]
    v_exp_f32 v3, v3
    v_exp_f32 v4, v4
    v_exp_f32 v5, v5
    v_smfmac_f32_32x32x32_bf16 v[112:127], a[20:23], v[56:63], v224
    v_exp_f32 v6, v6
    v_exp_f32 v7, v7
    v_exp_f32 v8, v8
    v_smfmac_f32_16x16x64_bf16 v[220:223], a[32:35], v[56:63], v224
    s_waitcnt lgkmcnt(4)
    ds_read_b64_tr_b16 a[16:17], v226 offset:2048
    v_exp_f32 v9, v9
    v_smfmac_f32_32x32x32_bf16 v[64:79], a[24:27], v[0:7], v224
    v_exp_f32 v10, v10
    v_exp_f32 v11, v11
    v_exp_f32 v12, v12
    v_smfmac_f32_16x16x64_bf16 v[208:211], a[32:35], v[0:7], v224
    ds_read_b64_tr_b16 a[18:19], v226 offset:2304
    v_exp_f32 v13, v13
    v_exp_f32 v14, v14
    v_exp_f32 v15, v15
    v_mfma_f32_32x32x16_bf16 v[32:47], a[8:11], v[144:147], 4.0
    v_exp_f32 v16, v16
    v_exp_f32 v17, v17
    v_exp_f32 v18, v18
    v_mfma_f32_32x32x16_bf16 v[32:47], a[12:15], v[148:151], v[32:47]
    s_waitcnt lgkmcnt(4)
    v_exp_f32 v19, v19
    v_exp_f32 v20, v20
    v_exp_f32 v21, v21
    v_smfmac_f32_32x32x32_bf16 v[64:79], a[28:31], v[8:15], v224
    v_exp_f32 v22, v22
    v_exp_f32 v23, v23
    v_exp_f32 v24, v24
    v_smfmac_f32_16x16x64_bf16 v[208:211], a[32:35], v[8:15], v224
    ds_read_b64_tr_b16 a[20:21], v226 offset:3072
    v_exp_f32 v25, v25
    v_smfmac_f32_32x32x32_bf16 v[80:95], a[24:27], v[16:23], v224
    v_exp_f32 v26, v26
    v_exp_f32 v27, v27
    v_exp_f32 v28, v28
    v_smfmac_f32_16x16x64_bf16 v[212:215], a[32:35], v[16:23], v224
    ds_read_b64_tr_b16 a[22:23], v226 offset:3328
    v_exp_f32 v29, v29
    v_exp_f32 v30, v30
    v_exp_f32 v31, v31
    v_mfma_f32_32x32x16_bf16 v[48:63], a[8:11], v[152:155], 4.0
    v_exp_f32 v32, v32
    v_exp_f32 v33, v33
    v_exp_f32 v34, v34
    v_mfma_f32_32x32x16_bf16 v[48:63], a[12:15], v[156:159], v[48:63]
    v_exp_f32 v35, v35
    v_exp_f32 v36, v36
    v_exp_f32 v37, v37
    v_smfmac_f32_32x32x32_bf16 v[80:95], a[28:31], v[24:31], v224
    v_exp_f32 v38, v38
    v_exp_f32 v39, v39
    v_exp_f32 v40, v40
    v_smfmac_f32_16x16x64_bf16 v[212:215], a[32:35], v[24:31], v224
    buffer_load_dword v239, v225, s[52:55], 0 offen offset:0 sc1
    v_exp_f32 v41, v41
    v_smfmac_f32_32x32x32_bf16 v[96:111], a[24:27], v[32:39], v224
    v_exp_f32 v42, v42
    v_exp_f32 v43, v43
    v_exp_f32 v44, v44
    v_smfmac_f32_16x16x64_bf16 v[216:219], a[32:35], v[32:39], v224
    s_waitcnt lgkmcnt(5)
    v_exp_f32 v45, v45
    v_exp_f32 v46, v46
    v_exp_f32 v47, v47
    v_mfma_f32_32x32x16_bf16 v[0:15], a[0:3], v[128:131], 4.0
    s_waitcnt lgkmcnt(4)
    v_exp_f32 v48, v48
    v_exp_f32 v49, v49
    v_exp_f32 v50, v50
    v_mfma_f32_32x32x16_bf16 v[0:15], a[4:7], v[132:135], v[0:15]
    v_exp_f32 v51, v51
    v_exp_f32 v52, v52
    v_exp_f32 v53, v53
    v_smfmac_f32_32x32x32_bf16 v[96:111], a[28:31], v[40:47], v224
    v_exp_f32 v54, v54
    v_exp_f32 v55, v55
    v_exp_f32 v56, v56
    v_smfmac_f32_16x16x64_bf16 v[216:219], a[32:35], v[40:47], v224
    ds_read_b128 a[8:11], v225 offset:4096
    v_exp_f32 v57, v57
    v_smfmac_f32_32x32x32_bf16 v[112:127], a[24:27], v[48:55], v224
    v_exp_f32 v58, v58
    v_exp_f32 v59, v59
    v_exp_f32 v60, v60
    v_smfmac_f32_16x16x64_bf16 v[220:223], a[32:35], v[48:55], v224
    ds_read_b128 a[12:15], v225 offset:5120
    v_exp_f32 v61, v61
    v_exp_f32 v62, v62
    v_exp_f32 v63, v63
    v_mfma_f32_32x32x16_bf16 v[16:31], a[0:3], v[136:139], 4.0
    v_exp_f32 v0, v0
    v_exp_f32 v1, v1
    v_exp_f32 v2, v2
    v_mfma_f32_32x32x16_bf16 v[16:31], a[4:7], v[140:143], v[16:31]
    v_exp_f32 v3, v3
    v_exp_f32 v4, v4
    v_exp_f32 v5, v5
    v_smfmac_f32_32x32x32_bf16 v[112:127], a[28:31], v[56:63], v224
    v_exp_f32 v6, v6
    v_exp_f32 v7, v7
    v_exp_f32 v8, v8
    v_smfmac_f32_16x16x64_bf16 v[220:223], a[32:35], v[56:63], v224
    s_waitcnt lgkmcnt(4)
    ds_read_b64_tr_b16 a[24:25], v226 offset:4096
    v_exp_f32 v9, v9
    v_smfmac_f32_32x32x32_bf16 v[64:79], a[16:19], v[0:7], v224
    v_exp_f32 v10, v10
    v_exp_f32 v11, v11
    v_exp_f32 v12, v12
    v_smfmac_f32_16x16x64_bf16 v[208:211], a[32:35], v[0:7], v224
    ds_read_b64_tr_b16 a[26:27], v226 offset:4352
    v_exp_f32 v13, v13
    v_exp_f32 v14, v14
    v_exp_f32 v15, v15
    v_mfma_f32_32x32x16_bf16 v[32:47], a[0:3], v[144:147], 4.0
    v_exp_f32 v16, v16
    v_exp_f32 v17, v17
    v_exp_f32 v18, v18
    v_mfma_f32_32x32x16_bf16 v[32:47], a[4:7], v[148:151], v[32:47]
    s_waitcnt lgkmcnt(4)
    v_exp_f32 v19, v19
    v_exp_f32 v20, v20
    v_exp_f32 v21, v21
    v_smfmac_f32_32x32x32_bf16 v[64:79], a[20:23], v[8:15], v224
    v_exp_f32 v22, v22
    v_exp_f32 v23, v23
    v_exp_f32 v24, v24
    v_smfmac_f32_16x16x64_bf16 v[208:211], a[32:35], v[8:15], v224
    ds_read_b64_tr_b16 a[28:29], v226 offset:5120
    v_exp_f32 v25, v25
    v_smfmac_f32_32x32x32_bf16 v[80:95], a[16:19], v[16:23], v224
    v_exp_f32 v26, v26
    v_exp_f32 v27, v27
    v_exp_f32 v28, v28
    v_smfmac_f32_16x16x64_bf16 v[212:215], a[32:35], v[16:23], v224
    ds_read_b64_tr_b16 a[30:31], v226 offset:5376
    v_exp_f32 v29, v29
    v_exp_f32 v30, v30
    v_exp_f32 v31, v31
    v_mfma_f32_32x32x16_bf16 v[48:63], a[0:3], v[152:155], 4.0
    v_exp_f32 v32, v32
    v_exp_f32 v33, v33
    v_exp_f32 v34, v34
    v_mfma_f32_32x32x16_bf16 v[48:63], a[4:7], v[156:159], v[48:63]
L_pad3B:
    s_cbranch_vccnz L_goB
    v_exp_f32 v35, v35
    v_exp_f32 v36, v36
    v_exp_f32 v37, v37
    v_smfmac_f32_32x32x32_bf16 v[80:95], a[20:23], v[24:31], v224
    s_waitcnt vmcnt(0)
    v_exp_f32 v38, v38
    v_exp_f32 v39, v39
    v_exp_f32 v40, v40
    v_cmp_ne_u32 s[62:63], v239, v232
    v_smfmac_f32_16x16x64_bf16 v[212:215], a[32:35], v[24:31], v224
    v_exp_f32 v41, v41
    v_smfmac_f32_32x32x32_bf16 v[96:111], a[16:19], v[32:39], v224
    s_cmp_eq_u32 s62, 15
    s_cbranch_scc0 L_spin0B
L_back0B:
    v_exp_f32 v42, v42
    v_exp_f32 v43, v43
    v_exp_f32 v44, v44
    v_smfmac_f32_16x16x64_bf16 v[216:219], a[32:35], v[32:39], v224
    s_waitcnt lgkmcnt(5)
    v_exp_f32 v45, v45
    v_exp_f32 v46, v46
    v_exp_f32 v47, v47
    v_mfma_f32_32x32x16_bf16 v[0:15], a[8:11], v[128:131], 4.0
    s_waitcnt lgkmcnt(4)
    v_exp_f32 v48, v48
    v_exp_f32 v49, v49
    v_exp_f32 v50, v50
    v_mfma_f32_32x32x16_bf16 v[0:15], a[12:15], v[132:135], v[0:15]
    v_exp_f32 v51, v51
    v_exp_f32 v52, v52
    v_exp_f32 v53, v53
    v_smfmac_f32_32x32x32_bf16 v[96:111], a[20:23], v[40:47], v224
    v_exp_f32 v54, v54
    v_exp_f32 v55, v55
    v_exp_f32 v56, v56
    v_smfmac_f32_16x16x64_bf16 v[216:219], a[32:35], v[40:47], v224
    ds_read_b128 a[0:3], v225 offset:6144
    v_exp_f32 v57, v57
    v_smfmac_f32_32x32x32_bf16 v[112:127], a[16:19], v[48:55], v224
    s_mov_b32 m0, s61
    v_exp_f32 v58, v58
    v_exp_f32 v59, v59
    v_exp_f32 v60, v60
    v_smfmac_f32_16x16x64_bf16 v[220:223], a[32:35], v[48:55], v224
    ds_read_b128 a[4:7], v225 offset:7168
    v_exp_f32 v61, v61
    v_exp_f32 v62, v62
    v_exp_f32 v63, v63
    v_mfma_f32_32x32x16_bf16 v[16:31], a[8:11], v[136:139], 4.0
    buffer_load_dwordx4 v225, s[48:51], s46 offen offset:0 sc1 lds
    v_exp_f32 v0, v0
    v_exp_f32 v1, v1
    v_exp_f32 v2, v2
    v_mfma_f32_32x32x16_bf16 v[16:31], a[12:15], v[140:143], v[16:31]
    buffer_load_dwordx4 v225, s[48:51], s46 offen offset:1024 sc1 lds
    v_exp_f32 v3, v3
    v_exp_f32 v4, v4
    v_exp_f32 v5, v5
    v_smfmac_f32_32x32x32_bf16 v[112:127], a[20:23], v[56:63], v224
    v_exp_f32 v6, v6
    v_exp_f32 v7, v7
    v_exp_f32 v8, v8
    v_smfmac_f32_16x16x64_bf16 v[220:223], a[32:35], v[56:63], v224
    s_waitcnt lgkmcnt(4)
    ds_read_b64_tr_b16 a[16:17], v226 offset:6144
    v_exp_f32 v9, v9
    v_smfmac_f32_32x32x32_bf16 v[64:79], a[24:27], v[0:7], v224
    v_exp_f32 v10, v10
    v_exp_f32 v11, v11
    v_exp_f32 v12, v12
    v_smfmac_f32_16x16x64_bf16 v[208:211], a[32:35], v[0:7], v224
    ds_read_b64_tr_b16 a[18:19], v226 offset:6400
    v_exp_f32 v13, v13
    v_exp_f32 v14, v14
    v_exp_f32 v15, v15
    v_mfma_f32_32x32x16_bf16 v[32:47], a[8:11], v[144:147], 4.0
    buffer_load_dwordx4 v225, s[48:51], s14 offen offset:2048 sc1 lds
    v_exp_f32 v16, v16
    v_exp_f32 v17, v17
    v_exp_f32 v18, v18
    v_mfma_f32_32x32x16_bf16 v[32:47], a[12:15], v[148:151], v[32:47]
    s_waitcnt lgkmcnt(4)
    buffer_load_dwordx4 v225, s[48:51], s14 offen offset:3072 sc1 lds
    v_exp_f32 v19, v19
    v_exp_f32 v20, v20
    v_exp_f32 v21, v21
    v_smfmac_f32_32x32x32_bf16 v[64:79], a[28:31], v[8:15], v224
    v_exp_f32 v22, v22
    v_exp_f32 v23, v23
    v_exp_f32 v24, v24
    v_smfmac_f32_16x16x64_bf16 v[208:211], a[32:35], v[8:15], v224
    ds_read_b64_tr_b16 a[20:21], v226 offset:7168
    v_exp_f32 v25, v25
    v_smfmac_f32_32x32x32_bf16 v[80:95], a[24:27], v[16:23], v224
    v_exp_f32 v26, v26
    v_exp_f32 v27, v27
    v_exp_f32 v28, v28
    v_smfmac_f32_16x16x64_bf16 v[212:215], a[32:35], v[16:23], v224
    ds_read_b64_tr_b16 a[22:23], v226 offset:7424
    v_exp_f32 v29, v29
    v_exp_f32 v30, v30
    v_exp_f32 v31, v31
    v_mfma_f32_32x32x16_bf16 v[48:63], a[8:11], v[152:155], 4.0
    v_exp_f32 v32, v32
    v_exp_f32 v33, v33
    v_exp_f32 v34, v34
    v_mfma_f32_32x32x16_bf16 v[48:63], a[12:15], v[156:159], v[48:63]
    v_exp_f32 v35, v35
    v_exp_f32 v36, v36
    v_exp_f32 v37, v37
    v_smfmac_f32_32x32x32_bf16 v[80:95], a[28:31], v[24:31], v224
    s_add_u32 s45, s45, 2
    v_exp_f32 v38, v38
    v_exp_f32 v39, v39
    v_exp_f32 v40, v40
    v_smfmac_f32_16x16x64_bf16 v[212:215], a[32:35], v[24:31], v224
    v_exp_f32 v41, v41
    v_smfmac_f32_32x32x32_bf16 v[96:111], a[24:27], v[32:39], v224
    s_and_b32 s45, s45, 7
    v_exp_f32 v42, v42
    v_exp_f32 v43, v43
    v_exp_f32 v44, v44
    v_smfmac_f32_16x16x64_bf16 v[216:219], a[32:35], v[32:39], v224
    s_waitcnt lgkmcnt(5)
    v_exp_f32 v45, v45
    v_exp_f32 v46, v46
    v_exp_f32 v47, v47
    v_mfma_f32_32x32x16_bf16 v[0:15], a[0:3], v[128:131], 4.0
    s_waitcnt lgkmcnt(4)
    v_exp_f32 v48, v48
    v_exp_f32 v49, v49
    v_exp_f32 v50, v50
    v_mfma_f32_32x32x16_bf16 v[0:15], a[4:7], v[132:135], v[0:15]
    v_exp_f32 v51, v51
    v_exp_f32 v52, v52
    v_exp_f32 v53, v53
    v_smfmac_f32_32x32x32_bf16 v[96:111], a[28:31], v[40:47], v224
    s_mul_i32 s38, s45, 14336
    v_exp_f32 v54, v54
    v_exp_f32 v55, v55
    v_exp_f32 v56, v56
    v_smfmac_f32_16x16x64_bf16 v[216:219], a[32:35], v[40:47], v224
    ds_read_b128 a[8:11], v225 offset:8192
    v_exp_f32 v57, v57
    v_smfmac_f32_32x32x32_bf16 v[112:127], a[24:27], v[48:55], v224
    s_add_u32 s38, s38, s56
    v_exp_f32 v58, v58
    v_exp_f32 v59, v59
    v_exp_f32 v60, v60
    v_smfmac_f32_16x16x64_bf16 v[220:223], a[32:35], v[48:55], v224
    ds_read_b128 a[12:15], v225 offset:9216
    v_exp_f32 v61, v61
    v_exp_f32 v62, v62
    v_exp_f32 v63, v63
    v_mfma_f32_32x32x16_bf16 v[16:31], a[0:3], v[136:139], 4.0
    v_exp_f32 v0, v0
    v_exp_f32 v1, v1
    v_exp_f32 v2, v2
    v_mfma_f32_32x32x16_bf16 v[16:31], a[4:7], v[140:143], v[16:31]
    v_exp_f32 v3, v3
    v_exp_f32 v4, v4
    v_exp_f32 v5, v5
    v_smfmac_f32_32x32x32_bf16 v[112:127], a[28:31], v[56:63], v224
    s_lshl_b32 s46, s45, 14
    v_exp_f32 v6, v6
    v_exp_f32 v7, v7
    v_exp_f32 v8, v8
    v_smfmac_f32_16x16x64_bf16 v[220:223], a[32:35], v[56:63], v224
    s_waitcnt lgkmcnt(4)
    ds_read_b64_tr_b16 a[24:25], v226 offset:8192
    v_exp_f32 v9, v9
    v_smfmac_f32_32x32x32_bf16 v[64:79], a[16:19], v[0:7], v224
    s_add_u32 s46, s46, s44
    v_exp_f32 v10, v10
    v_exp_f32 v11, v11
    v_exp_f32 v12, v12
    v_smfmac_f32_16x16x64_bf16 v[208:211], a[32:35], v[0:7], v224
    ds_read_b64_tr_b16 a[26:27], v226 offset:8448
    v_exp_f32 v13, v13
    v_exp_f32 v14, v14
    v_exp_f32 v15, v15
    v_mfma_f32_32x32x16_bf16 v[32:47], a[0:3], v[144:147], 4.0
    v_exp_f32 v16, v16
    v_exp_f32 v17, v17
    v_exp_f32 v18, v18
    v_mfma_f32_32x32x16_bf16 v[32:47], a[4:7], v[148:151], v[32:47]
    s_waitcnt lgkmcnt(4)
    v_exp_f32 v19, v19
    v_exp_f32 v20, v20
    v_exp_f32 v21, v21
    v_smfmac_f32_32x32x32_bf16 v[64:79], a[20:23], v[8:15], v224
    s_add_u32 s12, s38, s41
    v_exp_f32 v22, v22
    v_exp_f32 v23, v23
    v_exp_f32 v24, v24
    v_smfmac_f32_16x16x64_bf16 v[208:211], a[32:35], v[8:15], v224
    ds_read_b64_tr_b16 a[28:29], v226 offset:9216
    v_exp_f32 v25, v25
    v_smfmac_f32_32x32x32_bf16 v[80:95], a[16:19], v[16:23], v224
    s_add_u32 s14, s46, s41
    v_exp_f32 v26, v26
    v_exp_f32 v27, v27
    v_exp_f32 v28, v28
    v_smfmac_f32_16x16x64_bf16 v[212:215], a[32:35], v[16:23], v224
    ds_read_b64_tr_b16 a[30:31], v226 offset:9472
    v_exp_f32 v29, v29
    v_exp_f32 v30, v30
    v_exp_f32 v31, v31
    v_mfma_f32_32x32x16_bf16 v[48:63], a[0:3], v[152:155], 4.0
    v_exp_f32 v32, v32
    v_exp_f32 v33, v33
    v_exp_f32 v34, v34
    v_mfma_f32_32x32x16_bf16 v[48:63], a[4:7], v[156:159], v[48:63]
    v_exp_f32 v35, v35
    v_exp_f32 v36, v36
    v_exp_f32 v37, v37
    v_smfmac_f32_32x32x32_bf16 v[80:95], a[20:23], v[24:31], v224
    v_exp_f32 v38, v38
    v_exp_f32 v39, v39
    v_exp_f32 v40, v40
    v_smfmac_f32_16x16x64_bf16 v[212:215], a[32:35], v[24:31], v224
    v_exp_f32 v41, v41
    v_smfmac_f32_32x32x32_bf16 v[96:111], a[16:19], v[32:39], v224
    v_exp_f32 v42, v42
    v_exp_f32 v43, v43
    v_exp_f32 v44, v44
    v_smfmac_f32_16x16x64_bf16 v[216:219], a[32:35], v[32:39], v224
    s_waitcnt lgkmcnt(5)
    v_exp_f32 v45, v45
    v_exp_f32 v46, v46
    v_exp_f32 v47, v47
    v_mfma_f32_32x32x16_bf16 v[0:15], a[8:11], v[128:131], 4.0
    s_waitcnt lgkmcnt(4)
    v_exp_f32 v48, v48
    v_exp_f32 v49, v49
    v_exp_f32 v50, v50
    v_mfma_f32_32x32x16_bf16 v[0:15], a[12:15], v[132:135], v[0:15]
    v_exp_f32 v51, v51
    v_exp_f32 v52, v52
    v_exp_f32 v53, v53
    v_smfmac_f32_32x32x32_bf16 v[96:111], a[20:23], v[40:47], v224
    v_exp_f32 v54, v54
    v_exp_f32 v55, v55
    v_exp_f32 v56, v56
    v_smfmac_f32_16x16x64_bf16 v[216:219], a[32:35], v[40:47], v224
    ds_read_b128 a[0:3], v225 offset:10240
    v_exp_f32 v57, v57
    v_smfmac_f32_32x32x32_bf16 v[112:127], a[16:19], v[48:55], v224
    v_exp_f32 v58, v58
    v_exp_f32 v59, v59
    v_exp_f32 v60, v60
    v_smfmac_f32_16x16x64_bf16 v[220:223], a[32:35], v[48:55], v224
    ds_read_b128 a[4:7], v225 offset:11264
    v_exp_f32 v61, v61
    v_exp_f32 v62, v62
    v_exp_f32 v63, v63
    v_mfma_f32_32x32x16_bf16 v[16:31], a[8:11], v[136:139], 4.0
    v_exp_f32 v0, v0
    v_exp_f32 v1, v1
    v_exp_f32 v2, v2
    v_mfma_f32_32x32x16_bf16 v[16:31], a[12:15], v[140:143], v[16:31]
    v_exp_f32 v3, v3
    v_exp_f32 v4, v4
    v_exp_f32 v5, v5
    v_smfmac_f32_32x32x32_bf16 v[112:127], a[20:23], v[56:63], v224
    v_exp_f32 v6, v6
    v_exp_f32 v7, v7
    v_exp_f32 v8, v8
    v_smfmac_f32_16x16x64_bf16 v[220:223], a[32:35], v[56:63], v224
    s_waitcnt lgkmcnt(4)
    ds_read_b64_tr_b16 a[16:17], v226 offset:10240
    v_exp_f32 v9, v9
    v_smfmac_f32_32x32x32_bf16 v[64:79], a[24:27], v[0:7], v224
    v_exp_f32 v10, v10
    v_exp_f32 v11, v11
    v_exp_f32 v12, v12
    v_smfmac_f32_16x16x64_bf16 v[208:211], a[32:35], v[0:7], v224
    ds_read_b64_tr_b16 a[18:19], v226 offset:10496
    v_exp_f32 v13, v13
    v_exp_f32 v14, v14
    v_exp_f32 v15, v15
    v_mfma_f32_32x32x16_bf16 v[32:47], a[8:11], v[144:147], 4.0
    v_exp_f32 v16, v16
    v_exp_f32 v17, v17
    v_exp_f32 v18, v18
    v_mfma_f32_32x32x16_bf16 v[32:47], a[12:15], v[148:151], v[32:47]
    s_waitcnt lgkmcnt(4)
    v_exp_f32 v19, v19
    v_exp_f32 v20, v20
    v_exp_f32 v21, v21
    v_smfmac_f32_32x32x32_bf16 v[64:79], a[28:31], v[8:15], v224
    v_exp_f32 v22, v22
    v_exp_f32 v23, v23
    v_exp_f32 v24, v24
    v_smfmac_f32_16x16x64_bf16 v[208:211], a[32:35], v[8:15], v224
    ds_read_b64_tr_b16 a[20:21], v226 offset:11264
    v_exp_f32 v25, v25
    v_smfmac_f32_32x32x32_bf16 v[80:95], a[24:27], v[16:23], v224
    v_exp_f32 v26, v26
    v_exp_f32 v27, v27
    v_exp_f32 v28, v28
    v_smfmac_f32_16x16x64_bf16 v[212:215], a[32:35], v[16:23], v224
    ds_read_b64_tr_b16 a[22:23], v226 offset:11520
    v_exp_f32 v29, v29
    v_exp_f32 v30, v30
    v_exp_f32 v31, v31
    v_mfma_f32_32x32x16_bf16 v[48:63], a[8:11], v[152:155], 4.0
    v_exp_f32 v32, v32
    v_exp_f32 v33, v33
    v_exp_f32 v34, v34
    v_mfma_f32_32x32x16_bf16 v[48:63], a[12:15], v[156:159], v[48:63]
    v_exp_f32 v35, v35
    v_exp_f32 v36, v36
    v_exp_f32 v37, v37
    v_smfmac_f32_32x32x32_bf16 v[80:95], a[28:31], v[24:31], v224
    v_exp_f32 v38, v38
    v_exp_f32 v39, v39
    v_exp_f32 v40, v40
    v_smfmac_f32_16x16x64_bf16 v[212:215], a[32:35], v[24:31], v224
    v_exp_f32 v41, v41
    v_smfmac_f32_32x32x32_bf16 v[96:111], a[24:27], v[32:39], v224
    v_exp_f32 v42, v42
    v_exp_f32 v43, v43
    v_exp_f32 v44, v44
    v_smfmac_f32_16x16x64_bf16 v[216:219], a[32:35], v[32:39], v224
    s_waitcnt lgkmcnt(5)
    v_exp_f32 v45, v45
    v_exp_f32 v46, v46
    v_exp_f32 v47, v47
    v_mfma_f32_32x32x16_bf16 v[0:15], a[0:3], v[128:131], 4.0
    s_waitcnt lgkmcnt(4)
    v_exp_f32 v48, v48
    v_exp_f32 v49, v49
    v_exp_f32 v50, v50
    v_mfma_f32_32x32x16_bf16 v[0:15], a[4:7], v[132:135], v[0:15]
    v_exp_f32 v51, v51
    v_exp_f32 v52, v52
    v_exp_f32 v53, v53
    v_smfmac_f32_32x32x32_bf16 v[96:111], a[28:31], v[40:47], v224
    v_exp_f32 v54, v54
    v_exp_f32 v55, v55
    v_exp_f32 v56, v56
    v_smfmac_f32_16x16x64_bf16 v[216:219], a[32:35], v[40:47], v224
    ds_read_b128 a[8:11], v225 offset:12288
    v_exp_f32 v57, v57
    v_smfmac_f32_32x32x32_bf16 v[112:127], a[24:27], v[48:55], v224
    v_exp_f32 v58, v58
    v_exp_f32 v59, v59
    v_exp_f32 v60, v60
    v_smfmac_f32_16x16x64_bf16 v[220:223], a[32:35], v[48:55], v224
    ds_read_b128 a[12:15], v225 offset:13312
    v_exp_f32 v61, v61
    v_exp_f32 v62, v62
    v_exp_f32 v63, v63
    v_mfma_f32_32x32x16_bf16 v[16:31], a[0:3], v[136:139], 4.0
    v_exp_f32 v0, v0
    v_exp_f32 v1, v1
    v_exp_f32 v2, v2
    v_mfma_f32_32x32x16_bf16 v[16:31], a[4:7], v[140:143], v[16:31]
    v_exp_f32 v3, v3
    v_exp_f32 v4, v4
    v_exp_f32 v5, v5
    v_smfmac_f32_32x32x32_bf16 v[112:127], a[28:31], v[56:63], v224
    v_exp_f32 v6, v6
    v_exp_f32 v7, v7
    v_exp_f32 v8, v8
    v_smfmac_f32_16x16x64_bf16 v[220:223], a[32:35], v[56:63], v224
    s_waitcnt lgkmcnt(4)
    ds_read_b64_tr_b16 a[24:25], v226 offset:12288
    v_exp_f32 v9, v9
    v_smfmac_f32_32x32x32_bf16 v[64:79], a[16:19], v[0:7], v224
    v_exp_f32 v10, v10
    v_exp_f32 v11, v11
    v_exp_f32 v12, v12
    v_smfmac_f32_16x16x64_bf16 v[208:211], a[32:35], v[0:7], v224
    ds_read_b64_tr_b16 a[26:27], v226 offset:12544
    v_exp_f32 v13, v13
    v_exp_f32 v14, v14
    v_exp_f32 v15, v15
    v_mfma_f32_32x32x16_bf16 v[32:47], a[0:3], v[144:147], 4.0
    v_exp_f32 v16, v16
    v_exp_f32 v17, v17
    v_exp_f32 v18, v18
    v_mfma_f32_32x32x16_bf16 v[32:47], a[4:7], v[148:151], v[32:47]
    s_waitcnt lgkmcnt(4)
    v_exp_f32 v19, v19
    v_exp_f32 v20, v20
    v_exp_f32 v21, v21
    v_smfmac_f32_32x32x32_bf16 v[64:79], a[20:23], v[8:15], v224
    v_exp_f32 v22, v22
    v_exp_f32 v23, v23
    v_exp_f32 v24, v24
    v_smfmac_f32_16x16x64_bf16 v[208:211], a[32:35], v[8:15], v224
    ds_read_b64_tr_b16 a[28:29], v226 offset:13312
    v_exp_f32 v25, v25
    v_smfmac_f32_32x32x32_bf16 v[80:95], a[16:19], v[16:23], v224
    v_exp_f32 v26, v26
    v_exp_f32 v27, v27
    v_exp_f32 v28, v28
    v_smfmac_f32_16x16x64_bf16 v[212:215], a[32:35], v[16:23], v224
    ds_read_b64_tr_b16 a[30:31], v226 offset:13568
    v_exp_f32 v29, v29
    v_exp_f32 v30, v30
    v_exp_f32 v31, v31
    v_mfma_f32_32x32x16_bf16 v[48:63], a[0:3], v[152:155], 4.0
    v_exp_f32 v32, v32
    v_exp_f32 v33, v33
    v_exp_f32 v34, v34
    v_mfma_f32_32x32x16_bf16 v[48:63], a[4:7], v[156:159], v[48:63]
    v_exp_f32 v35, v35
    v_exp_f32 v36, v36
    v_exp_f32 v37, v37
    v_smfmac_f32_32x32x32_bf16 v[80:95], a[20:23], v[24:31], v224
    v_exp_f32 v38, v38
    v_exp_f32 v39, v39
    v_exp_f32 v40, v40
    v_smfmac_f32_16x16x64_bf16 v[212:215], a[32:35], v[24:31], v224
    v_exp_f32 v41, v41
    v_smfmac_f32_32x32x32_bf16 v[96:111], a[16:19], v[32:39], v224
    v_exp_f32 v42, v42
    v_exp_f32 v43, v43
    v_exp_f32 v44, v44
    v_smfmac_f32_16x16x64_bf16 v[216:219], a[32:35], v[32:39], v224
    s_waitcnt lgkmcnt(5)
    v_exp_f32 v45, v45
    v_exp_f32 v46, v46
    v_exp_f32 v47, v47
    v_mfma_f32_32x32x16_bf16 v[0:15], a[8:11], v[128:131], 4.0
    s_waitcnt lgkmcnt(4)
    v_exp_f32 v48, v48
    v_exp_f32 v49, v49
    v_exp_f32 v50, v50
    v_mfma_f32_32x32x16_bf16 v[0:15], a[12:15], v[132:135], v[0:15]
    s_waitcnt vmcnt(0) lgkmcnt(0)
    v_exp_f32 v51, v51
    v_exp_f32 v52, v52
    v_exp_f32 v53, v53
    v_smfmac_f32_32x32x32_bf16 v[96:111], a[20:23], v[40:47], v224
    s_barrier
    v_exp_f32 v54, v54
    v_exp_f32 v55, v55
    v_exp_f32 v56, v56
    v_smfmac_f32_16x16x64_bf16 v[216:219], a[32:35], v[40:47], v224
    ds_read_b128 a[0:3], v225 offset:32768
    v_exp_f32 v57, v57
    v_smfmac_f32_32x32x32_bf16 v[112:127], a[16:19], v[48:55], v224
    s_mov_b32 m0, s56
    v_exp_f32 v58, v58
    v_exp_f32 v59, v59
    v_exp_f32 v60, v60
    v_smfmac_f32_16x16x64_bf16 v[220:223], a[32:35], v[48:55], v224
    ds_read_b128 a[4:7], v225 offset:33792
    v_exp_f32 v61, v61
    v_exp_f32 v62, v62
    v_exp_f32 v63, v63
    v_mfma_f32_32x32x16_bf16 v[16:31], a[8:11], v[136:139], 4.0
    buffer_load_dwordx4 v225, s[24:27], s38 offen offset:0 nt lds
    v_exp_f32 v0, v0
    v_exp_f32 v1, v1
    v_exp_f32 v2, v2
    v_mfma_f32_32x32x16_bf16 v[16:31], a[12:15], v[140:143], v[16:31]
    buffer_load_dwordx4 v225, s[24:27], s38 offen offset:1024 nt lds
    v_exp_f32 v3, v3
    v_exp_f32 v4, v4
    v_exp_f32 v5, v5
    v_smfmac_f32_32x32x32_bf16 v[112:127], a[20:23], v[56:63], v224
    v_exp_f32 v6, v6
    v_exp_f32 v7, v7
    v_exp_f32 v8, v8
    v_smfmac_f32_16x16x64_bf16 v[220:223], a[32:35], v[56:63], v224
    ds_read_b64_tr_b16 a[16:17], v226 offset:32768
    v_exp_f32 v9, v9
    v_smfmac_f32_32x32x32_bf16 v[64:79], a[24:27], v[0:7], v224
    v_exp_f32 v10, v10
    v_exp_f32 v11, v11
    v_exp_f32 v12, v12
    v_smfmac_f32_16x16x64_bf16 v[208:211], a[32:35], v[0:7], v224
    ds_read_b64_tr_b16 a[18:19], v226 offset:33024
    v_exp_f32 v13, v13
    v_exp_f32 v14, v14
    v_exp_f32 v15, v15
    v_mfma_f32_32x32x16_bf16 v[32:47], a[8:11], v[144:147], 4.0
    buffer_load_dwordx4 v225, s[24:27], s12 offen offset:2048 nt lds
    v_exp_f32 v16, v16
    v_exp_f32 v17, v17
    v_exp_f32 v18, v18
    v_mfma_f32_32x32x16_bf16 v[32:47], a[12:15], v[148:151], v[32:47]
    buffer_load_dwordx4 v225, s[24:27], s12 offen offset:3072 nt lds
    v_exp_f32 v19, v19
    v_exp_f32 v20, v20
    v_exp_f32 v21, v21
    v_smfmac_f32_32x32x32_bf16 v[64:79], a[28:31], v[8:15], v224
    v_exp_f32 v22, v22
    v_exp_f32 v23, v23
    v_exp_f32 v24, v24
    v_smfmac_f32_16x16x64_bf16 v[208:211], a[32:35], v[8:15], v224
    ds_read_b64_tr_b16 a[20:21], v226 offset:33792
    v_exp_f32 v25, v25
    v_smfmac_f32_32x32x32_bf16 v[80:95], a[24:27], v[16:23], v224
    s_mov_b32 m0, s44
    v_exp_f32 v26, v26
    v_exp_f32 v27, v27
    v_exp_f32 v28, v28
    v_smfmac_f32_16x16x64_bf16 v[212:215], a[32:35], v[16:23], v224
    ds_read_b64_tr_b16 a[22:23], v226 offset:34048
    v_exp_f32 v29, v29
    v_exp_f32 v30, v30
    v_exp_f32 v31, v31
    v_mfma_f32_32x32x16_bf16 v[48:63], a[8:11], v[152:155], 4.0
    buffer_load_dwordx4 v225, s[48:51], s46 offen offset:0 sc1 lds
    v_exp_f32 v32, v32
    v_exp_f32 v33, v33
    v_exp_f32 v34, v34
    v_mfma_f32_32x32x16_bf16 v[48:63], a[12:15], v[156:159], v[48:63]
    buffer_load_dwordx4 v225, s[48:51], s46 offen offset:1024 sc1 lds
    v_exp_f32 v35, v35
    v_exp_f32 v36, v36
    v_exp_f32 v37, v37
    v_smfmac_f32_32x32x32_bf16 v[80:95], a[28:31], v[24:31], v224
    v_exp_f32 v38, v38
    v_exp_f32 v39, v39
    v_exp_f32 v40, v40
    v_smfmac_f32_16x16x64_bf16 v[212:215], a[32:35], v[24:31], v224
    ds_read_b32 v239, v235
    v_exp_f32 v41, v41
    v_smfmac_f32_32x32x32_bf16 v[96:111], a[24:27], v[32:39], v224
    v_exp_f32 v42, v42
    v_exp_f32 v43, v43
    v_exp_f32 v44, v44
    v_smfmac_f32_16x16x64_bf16 v[216:219], a[32:35], v[32:39], v224
    s_waitcnt lgkmcnt(6)
    v_exp_f32 v45, v45
    v_exp_f32 v46, v46
    v_exp_f32 v47, v47
    v_mfma_f32_32x32x16_bf16 v[0:15], a[0:3], v[128:131], 4.0
    s_waitcnt lgkmcnt(5)
    buffer_load_dwordx4 v225, s[48:51], s14 offen offset:2048 sc1 lds
    v_exp_f32 v48, v48
    v_exp_f32 v49, v49
    v_exp_f32 v50, v50
    v_mfma_f32_32x32x16_bf16 v[0:15], a[4:7], v[132:135], v[0:15]
    buffer_load_dwordx4 v225, s[48:51], s14 offen offset:3072 sc1 lds
    v_exp_f32 v51, v51
    v_exp_f32 v52, v52
    v_exp_f32 v53, v53
    v_smfmac_f32_32x32x32_bf16 v[96:111], a[28:31], v[40:47], v224
    s_waitcnt lgkmcnt(0)
    v_exp_f32 v54, v54
    v_exp_f32 v55, v55
    v_exp_f32 v56, v56
    v_readfirstlane_b32 s62, v239
    v_smfmac_f32_16x16x64_bf16 v[216:219], a[32:35], v[40:47], v224
    ds_read_b128 a[8:11], v225 offset:34816
    v_exp_f32 v57, v57
    v_smfmac_f32_32x32x32_bf16 v[112:127], a[24:27], v[48:55], v224
    s_cmp_lg_u32 s62, 0
    s_cbranch_scc1 L_slow
    v_exp_f32 v58, v58
    v_exp_f32 v59, v59
    v_exp_f32 v60, v60
    v_smfmac_f32_16x16x64_bf16 v[220:223], a[32:35], v[48:55], v224
    ds_read_b128 a[12:15], v225 offset:35840
    v_exp_f32 v61, v61
    v_exp_f32 v62, v62
    v_exp_f32 v63, v63
    s_mov_b64 vcc, -1
    s_cmp_eq_u32 s32, 0
    s_cbranch_scc1 L_pad4B
    s_cmp_eq_u32 s32, 1
    s_cbranch_scc1 L_pad5B
    s_cmp_eq_u32 s32, 2
    s_cbranch_scc1 L_pad6B
    s_branch L_pad7B
L_retB:
    s_mov_b64 vcc, 0
    v_mfma_f32_32x32x16_bf16 v[16:31], a[0:3], v[136:139], 4.0
    v_exp_f32 v0, v0
    v_exp_f32 v1, v1
    v_exp_f32 v2, v2
    v_mfma_f32_32x32x16_bf16 v[16:31], a[4:7], v[140:143], v[16:31]
    v_exp_f32 v3, v3
    v_exp_f32 v4, v4
    v_exp_f32 v5, v5
    v_smfmac_f32_32x32x32_bf16 v[112:127], a[28:31], v[56:63], v224
    s_add_u32 s45, s45, 2
    v_exp_f32 v6, v6
    v_exp_f32 v7, v7
    v_exp_f32 v8, v8
    v_smfmac_f32_16x16x64_bf16 v[220:223], a[32:35], v[56:63], v224
    ds_read_b64_tr_b16 a[24:25], v226 offset:34816
    v_exp_f32 v9, v9
    v_smfmac_f32_32x32x32_bf16 v[64:79], a[16:19], v[0:7], v224
    s_and_b32 s45, s45, 7
    v_exp_f32 v10, v10
    v_exp_f32 v11, v11
    v_exp_f32 v12, v12
    v_smfmac_f32_16x16x64_bf16 v[208:211], a[32:35], v[0:7], v224
    ds_read_b64_tr_b16 a[26:27], v226 offset:35072
    v_exp_f32 v13, v13
    v_exp_f32 v14, v14
    v_exp_f32 v15, v15
    v_mfma_f32_32x32x16_bf16 v[32:47], a[0:3], v[144:147], 4.0
    v_exp_f32 v16, v16
    v_exp_f32 v17, v17
    v_exp_f32 v18, v18
    v_mfma_f32_32x32x16_bf16 v[32:47], a[4:7], v[148:151], v[32:47]
    v_exp_f32 v19, v19
    v_exp_f32 v20, v20
    v_exp_f32 v21, v21
    v_smfmac_f32_32x32x32_bf16 v[64:79], a[20:23], v[8:15], v224
    s_mul_i32 s38, s45, 14336
    v_exp_f32 v22, v22
    v_exp_f32 v23, v23
    v_exp_f32 v24, v24
    v_smfmac_f32_16x16x64_bf16 v[208:211], a[32:35], v[8:15], v224
    ds_read_b64_tr_b16 a[28:29], v226 offset:35840
    v_exp_f32 v25, v25
    v_smfmac_f32_32x32x32_bf16 v[80:95], a[16:19], v[16:23], v224
    s_add_u32 s38, s38, s56
    v_exp_f32 v26, v26
    v_exp_f32 v27, v27
    v_exp_f32 v28, v28
    v_smfmac_f32_16x16x64_bf16 v[212:215], a[32:35], v[16:23], v224
    ds_read_b64_tr_b16 a[30:31], v226 offset:36096
    v_exp_f32 v29, v29
    v_exp_f32 v30, v30
    v_exp_f32 v31, v31
    v_mfma_f32_32x32x16_bf16 v[48:63], a[0:3], v[152:155], 4.0
    v_exp_f32 v32, v32
    v_exp_f32 v33, v33
    v_exp_f32 v34, v34
    v_mfma_f32_32x32x16_bf16 v[48:63], a[4:7], v[156:159], v[48:63]
    v_exp_f32 v35, v35
    v_exp_f32 v36, v36
    v_exp_f32 v37, v37
    v_smfmac_f32_32x32x32_bf16 v[80:95], a[20:23], v[24:31], v224
    s_lshl_b32 s46, s45, 14
    v_exp_f32 v38, v38
    v_exp_f32 v39, v39
    v_exp_f32 v40, v40
    v_smfmac_f32_16x16x64_bf16 v[212:215], a[32:35], v[24:31], v224
    buffer_store_dwordx4 v[192:195], v247, s[48:51], s39 offen offset:0 sc1
    v_exp_f32 v41, v41
    v_smfmac_f32_32x32x32_bf16 v[96:111], a[16:19], v[32:39], v224
    s_add_u32 s46, s46, s44
    v_exp_f32 v42, v42
    v_exp_f32 v43, v43
    v_exp_f32 v44, v44
    v_smfmac_f32_16x16x64_bf16 v[216:219], a[32:35], v[32:39], v224
    s_waitcnt lgkmcnt(5)
    buffer_store_dwordx4 v[196:199], v247, s[48:51], s39 offen offset:512 sc1
    v_exp_f32 v45, v45
    v_exp_f32 v46, v46
    v_exp_f32 v47, v47
    v_mfma_f32_32x32x16_bf16 v[0:15], a[8:11], v[128:131], 4.0
    s_waitcnt lgkmcnt(4)
    v_exp_f32 v48, v48
    v_exp_f32 v49, v49
    v_exp_f32 v50, v50
    v_mfma_f32_32x32x16_bf16 v[0:15], a[12:15], v[132:135], v[0:15]
    v_exp_f32 v51, v51
    v_exp_f32 v52, v52
    v_exp_f32 v53, v53
    v_smfmac_f32_32x32x32_bf16 v[96:111], a[20:23], v[40:47], v224
    s_add_u32 s12, s38, s41
    v_exp_f32 v54, v54
    v_exp_f32 v55, v55
    v_exp_f32 v56, v56
    v_smfmac_f32_16x16x64_bf16 v[216:219], a[32:35], v[40:47], v224
    ds_read_b128 a[0:3], v225 offset:36864
    v_exp_f32 v57, v57
    v_smfmac_f32_32x32x32_bf16 v[112:127], a[16:19], v[48:55], v224
    s_add_u32 s14, s46, s41
    v_exp_f32 v58, v58
    v_exp_f32 v59, v59
    v_exp_f32 v60, v60
    v_smfmac_f32_16x16x64_bf16 v[220:223], a[32:35], v[48:55], v224
    ds_read_b128 a[4:7], v225 offset:37888
    v_exp_f32 v61, v61
    v_exp_f32 v62, v62
    v_exp_f32 v63, v63
    v_mfma_f32_32x32x16_bf16 v[16:31], a[8:11], v[136:139], 4.0
    v_exp_f32 v0, v0
    v_exp_f32 v1, v1
    v_exp_f32 v2, v2
    v_mfma_f32_32x32x16_bf16 v[16:31], a[12:15], v[140:143], v[16:31]
    v_exp_f32 v3, v3
    v_exp_f32 v4, v4
    v_exp_f32 v5, v5
    v_smfmac_f32_32x32x32_bf16 v[112:127], a[20:23], v[56:63], v224
    v_exp_f32 v6, v6
    v_exp_f32 v7, v7
    v_exp_f32 v8, v8
    v_smfmac_f32_16x16x64_bf16 v[220:223], a[32:35], v[56:63], v224
    s_waitcnt lgkmcnt(4)
    ds_read_b64_tr_b16 a[16:17], v226 offset:36864
    v_exp_f32 v9, v9
    v_smfmac_f32_32x32x32_bf16 v[64:79], a[24:27], v[0:7], v224
    v_exp_f32 v10, v10
    v_exp_f32 v11, v11
    v_exp_f32 v12, v12
    v_smfmac_f32_16x16x64_bf16 v[208:211], a[32:35], v[0:7], v224
    ds_read_b64_tr_b16 a[18:19], v226 offset:37120
    v_exp_f32 v13, v13
    v_exp_f32 v14, v14
    v_exp_f32 v15, v15
    v_mfma_f32_32x32x16_bf16 v[32:47], a[8:11], v[144:147], 4.0
    v_exp_f32 v16, v16
    v_exp_f32 v17, v17
    v_exp_f32 v18, v18
    v_mfma_f32_32x32x16_bf16 v[32:47], a[12:15], v[148:151], v[32:47]
    s_waitcnt lgkmcnt(4)
    v_exp_f32 v19, v19
    v_exp_f32 v20, v20
    v_exp_f32 v21, v21
    v_smfmac_f32_32x32x32_bf16 v[64:79], a[28:31], v[8:15], v224
    v_exp_f32 v22, v22
    v_exp_f32 v23, v23
    v_exp_f32 v24, v24
    v_smfmac_f32_16x16x64_bf16 v[208:211], a[32:35], v[8:15], v224
    ds_read_b64_tr_b16 a[20:21], v226 offset:37888
    v_exp_f32 v25, v25
    v_smfmac_f32_32x32x32_bf16 v[80:95], a[24:27], v[16:23], v224
    v_exp_f32 v26, v26
    v_exp_f32 v27, v27
    v_exp_f32 v28, v28
    v_smfmac_f32_16x16x64_bf16 v[212:215], a[32:35], v[16:23], v224
    ds_read_b64_tr_b16 a[22:23], v226 offset:38144
    v_exp_f32 v29, v29
    v_exp_f32 v30, v30
    v_exp_f32 v31, v31
    v_mfma_f32_32x32x16_bf16 v[48:63], a[8:11], v[152:155], 4.0
    v_exp_f32 v32, v32
    v_exp_f32 v33, v33
    v_exp_f32 v34, v34
    v_mfma_f32_32x32x16_bf16 v[48:63], a[12:15], v[156:159], v[48:63]
    v_exp_f32 v35, v35
    v_exp_f32 v36, v36
    v_exp_f32 v37, v37
    v_smfmac_f32_32x32x32_bf16 v[80:95], a[28:31], v[24:31], v224
    v_exp_f32 v38, v38
    v_exp_f32 v39, v39
    v_exp_f32 v40, v40
    v_smfmac_f32_16x16x64_bf16 v[212:215], a[32:35], v[24:31], v224
    buffer_store_dwordx4 v[200:203], v247, s[48:51], s39 offen offset:1024 sc1
    v_exp_f32 v41, v41
    v_smfmac_f32_32x32x32_bf16 v[96:111], a[24:27], v[32:39], v224
    v_exp_f32 v42, v42
    v_exp_f32 v43, v43
    v_exp_f32 v44, v44
    v_smfmac_f32_16x16x64_bf16 v[216:219], a[32:35], v[32:39], v224
    s_waitcnt lgkmcnt(5)
    buffer_store_dwordx4 v[204:207], v247, s[48:51], s39 offen offset:1536 sc1
    v_exp_f32 v45, v45
    v_exp_f32 v46, v46
    v_exp_f32 v47, v47
    v_mfma_f32_32x32x16_bf16 v[0:15], a[0:3], v[128:131], 4.0
    s_waitcnt lgkmcnt(4)
    v_exp_f32 v48, v48
    v_exp_f32 v49, v49
    v_exp_f32 v50, v50
    v_mfma_f32_32x32x16_bf16 v[0:15], a[4:7], v[132:135], v[0:15]
    v_exp_f32 v51, v51
    v_exp_f32 v52, v52
    v_exp_f32 v53, v53
    v_smfmac_f32_32x32x32_bf16 v[96:111], a[28:31], v[40:47], v224
    v_exp_f32 v54, v54
    v_exp_f32 v55, v55
    v_exp_f32 v56, v56
    v_smfmac_f32_16x16x64_bf16 v[216:219], a[32:35], v[40:47], v224
    ds_read_b128 a[8:11], v225 offset:38912
    v_exp_f32 v57, v57
    v_smfmac_f32_32x32x32_bf16 v[112:127], a[24:27], v[48:55], v224
    v_exp_f32 v58, v58
    v_exp_f32 v59, v59
    v_exp_f32 v60, v60
    v_smfmac_f32_16x16x64_bf16 v[220:223], a[32:35], v[48:55], v224
    ds_read_b128 a[12:15], v225 offset:39936
    v_exp_f32 v61, v61
    v_exp_f32 v62, v62
    v_exp_f32 v63, v63
    v_mfma_f32_32x32x16_bf16 v[16:31], a[0:3], v[136:139], 4.0
L_pad4B:
    s_cbranch_vccnz L_retB
    v_exp_f32 v0, v0
    v_exp_f32 v1, v1
    v_exp_f32 v2, v2
    v_mfma_f32_32x32x16_bf16 v[16:31], a[4:7], v[140:143], v[16:31]
    v_exp_f32 v3, v3
    v_exp_f32 v4, v4
    v_exp_f32 v5, v5
    v_smfmac_f32_32x32x32_bf16 v[112:127], a[28:31], v[56:63], v224
    v_exp_f32 v6, v6
    v_exp_f32 v7, v7
    v_exp_f32 v8, v8
    v_smfmac_f32_16x16x64_bf16 v[220:223], a[32:35], v[56:63], v224
    s_waitcnt lgkmcnt(4)
    ds_read_b64_tr_b16 a[24:25], v226 offset:38912
    v_exp_f32 v9, v9
    v_smfmac_f32_32x32x32_bf16 v[64:79], a[16:19], v[0:7], v224
    v_exp_f32 v10, v10
    v_exp_f32 v11, v11
    v_exp_f32 v12, v12
    v_smfmac_f32_16x16x64_bf16 v[208:211], a[32:35], v[0:7], v224
    ds_read_b64_tr_b16 a[26:27], v226 offset:39168
    v_exp_f32 v13, v13
    v_exp_f32 v14, v14
    v_exp_f32 v15, v15
    v_mfma_f32_32x32x16_bf16 v[32:47], a[0:3], v[144:147], 4.0
    v_exp_f32 v16, v16
    v_exp_f32 v17, v17
    v_exp_f32 v18, v18
    v_mfma_f32_32x32x16_bf16 v[32:47], a[4:7], v[148:151], v[32:47]
    s_waitcnt lgkmcnt(4)
    v_exp_f32 v19, v19
    v_exp_f32 v20, v20
    v_exp_f32 v21, v21
    v_smfmac_f32_32x32x32_bf16 v[64:79], a[20:23], v[8:15], v224
    v_exp_f32 v22, v22
    v_exp_f32 v23, v23
    v_exp_f32 v24, v24
    v_smfmac_f32_16x16x64_bf16 v[208:211], a[32:35], v[8:15], v224
    ds_read_b64_tr_b16 a[28:29], v226 offset:39936
    v_exp_f32 v25, v25
    v_smfmac_f32_32x32x32_bf16 v[80:95], a[16:19], v[16:23], v224
    v_exp_f32 v26, v26
    v_exp_f32 v27, v27
    v_exp_f32 v28, v28
    v_smfmac_f32_16x16x64_bf16 v[212:215], a[32:35], v[16:23], v224
    ds_read_b64_tr_b16 a[30:31], v226 offset:40192
    v_exp_f32 v29, v29
    v_exp_f32 v30, v30
    v_exp_f32 v31, v31
    v_mfma_f32_32x32x16_bf16 v[48:63], a[0:3], v[152:155], 4.0
    v_exp_f32 v32, v32
    v_exp_f32 v33, v33
    v_exp_f32 v34, v34
    v_mfma_f32_32x32x16_bf16 v[48:63], a[4:7], v[156:159], v[48:63]
    v_exp_f32 v35, v35
    v_exp_f32 v36, v36
    v_exp_f32 v37, v37
    v_smfmac_f32_32x32x32_bf16 v[80:95], a[20:23], v[24:31], v224
    v_exp_f32 v38, v38
    v_exp_f32 v39, v39
    v_exp_f32 v40, v40
    v_smfmac_f32_16x16x64_bf16 v[212:215], a[32:35], v[24:31], v224
    v_exp_f32 v41, v41
    v_smfmac_f32_32x32x32_bf16 v[96:111], a[16:19], v[32:39], v224
    v_exp_f32 v42, v42
    v_exp_f32 v43, v43
    v_exp_f32 v44, v44
    v_smfmac_f32_16x16x64_bf16 v[216:219], a[32:35], v[32:39], v224
    s_waitcnt lgkmcnt(5)
    v_exp_f32 v45, v45
    v_exp_f32 v46, v46
    v_exp_f32 v47, v47
    v_mfma_f32_32x32x16_bf16 v[0:15], a[8:11], v[128:131], 4.0
    s_waitcnt lgkmcnt(4)
    v_exp_f32 v48, v48
    v_exp_f32 v49, v49
    v_exp_f32 v50, v50
    v_mfma_f32_32x32x16_bf16 v[0:15], a[12:15], v[132:135], v[0:15]
    v_exp_f32 v51, v51
    v_exp_f32 v52, v52
    v_exp_f32 v53, v53
    v_smfmac_f32_32x32x32_bf16 v[96:111], a[20:23], v[40:47], v224
    v_exp_f32 v54, v54
    v_exp_f32 v55, v55
    v_exp_f32 v56, v56
    v_smfmac_f32_16x16x64_bf16 v[216:219], a[32:35], v[40:47], v224
    ds_read_b128 a[0:3], v225 offset:40960
    v_exp_f32 v57, v57
    v_smfmac_f32_32x32x32_bf16 v[112:127], a[16:19], v[48:55], v224
    v_exp_f32 v58, v58
    v_exp_f32 v59, v59
    v_exp_f32 v60, v60
    v_smfmac_f32_16x16x64_bf16 v[220:223], a[32:35], v[48:55], v224
    ds_read_b128 a[4:7], v225 offset:41984
    v_exp_f32 v61, v61
    v_exp_f32 v62, v62
    v_exp_f32 v63, v63
    v_mfma_f32_32x32x16_bf16 v[16:31], a[8:11], v[136:139], 4.0
    v_exp_f32 v0, v0
    v_exp_f32 v1, v1
    v_exp_f32 v2, v2
    v_mfma_f32_32x32x16_bf16 v[16:31], a[12:15], v[140:143], v[16:31]
    v_exp_f32 v3, v3
    v_exp_f32 v4, v4
    v_exp_f32 v5, v5
    v_smfmac_f32_32x32x32_bf16 v[112:127], a[20:23], v[56:63], v224
    v_exp_f32 v6, v6
    v_exp_f32 v7, v7
    v_exp_f32 v8, v8
    v_smfmac_f32_16x16x64_bf16 v[220:223], a[32:35], v[56:63], v224
    s_waitcnt lgkmcnt(4)
    ds_read_b64_tr_b16 a[16:17], v226 offset:40960
    v_exp_f32 v9, v9
    v_smfmac_f32_32x32x32_bf16 v[64:79], a[24:27], v[0:7], v224
    v_exp_f32 v10, v10
    v_exp_f32 v11, v11
    v_exp_f32 v12, v12
    v_smfmac_f32_16x16x64_bf16 v[208:211], a[32:35], v[0:7], v224
    ds_read_b64_tr_b16 a[18:19], v226 offset:41216
    v_exp_f32 v13, v13
    v_exp_f32 v14, v14
    v_exp_f32 v15, v15
    v_mfma_f32_32x32x16_bf16 v[32:47], a[8:11], v[144:147], 4.0
    v_exp_f32 v16, v16
    v_exp_f32 v17, v17
    v_exp_f32 v18, v18
    v_mfma_f32_32x32x16_bf16 v[32:47], a[12:15], v[148:151], v[32:47]
    s_waitcnt lgkmcnt(4)
    v_exp_f32 v19, v19
    v_exp_f32 v20, v20
    v_exp_f32 v21, v21
    v_smfmac_f32_32x32x32_bf16 v[64:79], a[28:31], v[8:15], v224
    v_exp_f32 v22, v22
    v_exp_f32 v23, v23
    v_exp_f32 v24, v24
    v_smfmac_f32_16x16x64_bf16 v[208:211], a[32:35], v[8:15], v224
    ds_read_b64_tr_b16 a[20:21], v226 offset:41984
    v_exp_f32 v25, v25
    v_smfmac_f32_32x32x32_bf16 v[80:95], a[24:27], v[16:23], v224
    v_exp_f32 v26, v26
    v_exp_f32 v27, v27
    v_exp_f32 v28, v28
    v_smfmac_f32_16x16x64_bf16 v[212:215], a[32:35], v[16:23], v224
    ds_read_b64_tr_b16 a[22:23], v226 offset:42240
    v_exp_f32 v29, v29
    v_exp_f32 v30, v30
    v_exp_f32 v31, v31
    v_mfma_f32_32x32x16_bf16 v[48:63], a[8:11], v[152:155], 4.0
    v_exp_f32 v32, v32
    v_exp_f32 v33, v33
    v_exp_f32 v34, v34
    v_mfma_f32_32x32x16_bf16 v[48:63], a[12:15], v[156:159], v[48:63]
    v_exp_f32 v35, v35
    v_exp_f32 v36, v36
    v_exp_f32 v37, v37
    v_smfmac_f32_32x32x32_bf16 v[80:95], a[28:31], v[24:31], v224
    v_exp_f32 v38, v38
    v_exp_f32 v39, v39
    v_exp_f32 v40, v40
    v_smfmac_f32_16x16x64_bf16 v[212:215], a[32:35], v[24:31], v224
    v_exp_f32 v41, v41
    v_smfmac_f32_32x32x32_bf16 v[96:111], a[24:27], v[32:39], v224
    v_exp_f32 v42, v42
    v_exp_f32 v43, v43
    v_exp_f32 v44, v44
    v_smfmac_f32_16x16x64_bf16 v[216:219], a[32:35], v[32:39], v224
    s_waitcnt lgkmcnt(5)
    v_exp_f32 v45, v45
    v_exp_f32 v46, v46
    v_exp_f32 v47, v47
    v_mfma_f32_32x32x16_bf16 v[0:15], a[0:3], v[128:131], 4.0
    s_waitcnt lgkmcnt(4)
    v_exp_f32 v48, v48
    v_exp_f32 v49, v49
    v_exp_f32 v50, v50
    v_mfma_f32_32x32x16_bf16 v[0:15], a[4:7], v[132:135], v[0:15]
    v_exp_f32 v51, v51
    v_exp_f32 v52, v52
    v_exp_f32 v53, v53
    v_smfmac_f32_32x32x32_bf16 v[96:111], a[28:31], v[40:47], v224
    v_exp_f32 v54, v54
    v_exp_f32 v55, v55
    v_exp_f32 v56, v56
    v_smfmac_f32_16x16x64_bf16 v[216:219], a[32:35], v[40:47], v224
    ds_read_b128 a[8:11], v225 offset:43008
    v_exp_f32 v57, v57
    v_smfmac_f32_32x32x32_bf16 v[112:127], a[24:27], v[48:55], v224
    v_exp_f32 v58, v58
    v_exp_f32 v59, v59
    v_exp_f32 v60, v60
    v_smfmac_f32_16x16x64_bf16 v[220:223], a[32:35], v[48:55], v224
    ds_read_b128 a[12:15], v225 offset:44032
    v_exp_f32 v61, v61
    v_exp_f32 v62, v62
    v_exp_f32 v63, v63
    v_mfma_f32_32x32x16_bf16 v[16:31], a[0:3], v[136:139], 4.0
    v_exp_f32 v0, v0
    v_exp_f32 v1, v1
    v_exp_f32 v2, v2
    v_mfma_f32_32x32x16_bf16 v[16:31], a[4:7], v[140:143], v[16:31]
    v_exp_f32 v3, v3
    v_exp_f32 v4, v4
    v_exp_f32 v5, v5
    v_smfmac_f32_32x32x32_bf16 v[112:127], a[28:31], v[56:63], v224
    v_exp_f32 v6, v6
    v_exp_f32 v7, v7
    v_exp_f32 v8, v8
    v_smfmac_f32_16x16x64_bf16 v[220:223], a[32:35], v[56:63], v224
    s_waitcnt lgkmcnt(4)
    ds_read_b64_tr_b16 a[24:25], v226 offset:43008
    v_exp_f32 v9, v9
    v_smfmac_f32_32x32x32_bf16 v[64:79], a[16:19], v[0:7], v224
    v_exp_f32 v10, v10
    v_exp_f32 v11, v11
    v_exp_f32 v12, v12
    v_smfmac_f32_16x16x64_bf16 v[208:211], a[32:35], v[0:7], v224
    ds_read_b64_tr_b16 a[26:27], v226 offset:43264
    v_exp_f32 v13, v13
    v_exp_f32 v14, v14
    v_exp_f32 v15, v15
    v_mfma_f32_32x32x16_bf16 v[32:47], a[0:3], v[144:147], 4.0
    v_exp_f32 v16, v16
    v_exp_f32 v17, v17
    v_exp_f32 v18, v18
    v_mfma_f32_32x32x16_bf16 v[32:47], a[4:7], v[148:151], v[32:47]
    s_waitcnt lgkmcnt(4)
    v_exp_f32 v19, v19
    v_exp_f32 v20, v20
    v_exp_f32 v21, v21
    v_smfmac_f32_32x32x32_bf16 v[64:79], a[20:23], v[8:15], v224
    v_exp_f32 v22, v22
    v_exp_f32 v23, v23
    v_exp_f32 v24, v24
    v_smfmac_f32_16x16x64_bf16 v[208:211], a[32:35], v[8:15], v224
    ds_read_b64_tr_b16 a[28:29], v226 offset:44032
    v_exp_f32 v25, v25
    v_smfmac_f32_32x32x32_bf16 v[80:95], a[16:19], v[16:23], v224
    v_exp_f32 v26, v26
    v_exp_f32 v27, v27
    v_exp_f32 v28, v28
    v_smfmac_f32_16x16x64_bf16 v[212:215], a[32:35], v[16:23], v224
    ds_read_b64_tr_b16 a[30:31], v226 offset:44288
    v_exp_f32 v29, v29
    v_exp_f32 v30, v30
    v_exp_f32 v31, v31
    v_mfma_f32_32x32x16_bf16 v[48:63], a[0:3], v[152:155], 4.0
    v_exp_f32 v32, v32
    v_exp_f32 v33, v33
    v_exp_f32 v34, v34
    v_mfma_f32_32x32x16_bf16 v[48:63], a[4:7], v[156:159], v[48:63]
    v_exp_f32 v35, v35
    v_exp_f32 v36, v36
    v_exp_f32 v37, v37
    v_smfmac_f32_32x32x32_bf16 v[80:95], a[20:23], v[24:31], v224
    v_exp_f32 v38, v38
    v_exp_f32 v39, v39
    v_exp_f32 v40, v40
    v_smfmac_f32_16x16x64_bf16 v[212:215], a[32:35], v[24:31], v224
    v_exp_f32 v41, v41
    v_smfmac_f32_32x32x32_bf16 v[96:111], a[16:19], v[32:39], v224
    v_exp_f32 v42, v42
    v_exp_f32 v43, v43
    v_exp_f32 v44, v44
    v_smfmac_f32_16x16x64_bf16 v[216:219], a[32:35], v[32:39], v224
    s_waitcnt lgkmcnt(5)
    v_exp_f32 v45, v45
    v_exp_f32 v46, v46
    v_exp_f32 v47, v47
    v_mfma_f32_32x32x16_bf16 v[0:15], a[8:11], v[128:131], 4.0
    s_waitcnt lgkmcnt(4)
    v_exp_f32 v48, v48
    v_exp_f32 v49, v49
    v_exp_f32 v50, v50
    v_mfma_f32_32x32x16_bf16 v[0:15], a[12:15], v[132:135], v[0:15]
    v_exp_f32 v51, v51
    v_exp_f32 v52, v52
    v_exp_f32 v53, v53
    v_smfmac_f32_32x32x32_bf16 v[96:111], a[20:23], v[40:47], v224
    v_exp_f32 v54, v54
    v_exp_f32 v55, v55
    v_exp_f32 v56, v56
    v_smfmac_f32_16x16x64_bf16 v[216:219], a[32:35], v[40:47], v224
    ds_read_b128 a[0:3], v225 offset:45056
    v_exp_f32 v57, v57
    v_smfmac_f32_32x32x32_bf16 v[112:127], a[16:19], v[48:55], v224
    v_exp_f32 v58, v58
    v_exp_f32 v59, v59
    v_exp_f32 v60, v60
    v_smfmac_f32_16x16x64_bf16 v[220:223], a[32:35], v[48:55], v224
    ds_read_b128 a[4:7], v225 offset:46080
    v_exp_f32 v61, v61
    v_exp_f32 v62, v62
    v_exp_f32 v63, v63
    v_mfma_f32_32x32x16_bf16 v[16:31], a[8:11], v[136:139], 4.0
    v_exp_f32 v0, v0
    v_exp_f32 v1, v1
    v_exp_f32 v2, v2
    v_mfma_f32_32x32x16_bf16 v[16:31], a[12:15], v[140:143], v[16:31]
    v_exp_f32 v3, v3
    v_exp_f32 v4, v4
    v_exp_f32 v5, v5
    v_smfmac_f32_32x32x32_bf16 v[112:127], a[20:23], v[56:63], v224
    v_exp_f32 v6, v6
    v_exp_f32 v7, v7
    v_exp_f32 v8, v8
    v_smfmac_f32_16x16x64_bf16 v[220:223], a[32:35], v[56:63], v224
    s_waitcnt lgkmcnt(4)
    ds_read_b64_tr_b16 a[16:17], v226 offset:45056
    v_exp_f32 v9, v9
    v_smfmac_f32_32x32x32_bf16 v[64:79], a[24:27], v[0:7], v224
    v_exp_f32 v10, v10
    v_exp_f32 v11, v11
    v_exp_f32 v12, v12
    v_smfmac_f32_16x16x64_bf16 v[208:211], a[32:35], v[0:7], v224
    ds_read_b64_tr_b16 a[18:19], v226 offset:45312
    v_exp_f32 v13, v13
    v_exp_f32 v14, v14
    v_exp_f32 v15, v15
    v_mfma_f32_32x32x16_bf16 v[32:47], a[8:11], v[144:147], 4.0
    v_exp_f32 v16, v16
    v_exp_f32 v17, v17
    v_exp_f32 v18, v18
    v_not_b32 v248, v233
    v_mfma_f32_32x32x16_bf16 v[32:47], a[12:15], v[148:151], v[32:47]
    s_waitcnt lgkmcnt(4)
    v_exp_f32 v19, v19
    v_exp_f32 v20, v20
    v_exp_f32 v21, v21
    v_smfmac_f32_32x32x32_bf16 v[64:79], a[28:31], v[8:15], v224
    v_exp_f32 v22, v22
    v_exp_f32 v23, v23
    v_exp_f32 v24, v24
    v_smfmac_f32_16x16x64_bf16 v[208:211], a[32:35], v[8:15], v224
    ds_read_b64_tr_b16 a[20:21], v226 offset:46080
    v_exp_f32 v25, v25
    v_smfmac_f32_32x32x32_bf16 v[80:95], a[24:27], v[16:23], v224
    v_exp_f32 v26, v26
    v_exp_f32 v27, v27
    v_exp_f32 v28, v28
    v_smfmac_f32_16x16x64_bf16 v[212:215], a[32:35], v[16:23], v224
    ds_read_b64_tr_b16 a[22:23], v226 offset:46336
    v_exp_f32 v29, v29
    v_exp_f32 v30, v30
    v_exp_f32 v31, v31
    v_mfma_f32_32x32x16_bf16 v[48:63], a[8:11], v[152:155], 4.0
    s_waitcnt vmcnt(0)
    buffer_store_dword v248, v228, s[52:55], 0 offen offset:4 sc1
    v_exp_f32 v32, v32
    v_exp_f32 v33, v33
    v_exp_f32 v34, v34
    v_mfma_f32_32x32x16_bf16 v[48:63], a[12:15], v[156:159], v[48:63]
    v_exp_f32 v35, v35
    v_exp_f32 v36, v36
    v_exp_f32 v37, v37
    v_smfmac_f32_32x32x32_bf16 v[80:95], a[28:31], v[24:31], v224
    v_exp_f32 v38, v38
    v_exp_f32 v39, v39
    v_exp_f32 v40, v40
    v_smfmac_f32_16x16x64_bf16 v[212:215], a[32:35], v[24:31], v224
    v_exp_f32 v41, v41
    v_smfmac_f32_32x32x32_bf16 v[96:111], a[24:27], v[32:39], v224
    v_exp_f32 v42, v42
    v_exp_f32 v43, v43
    v_exp_f32 v44, v44
    v_smfmac_f32_16x16x64_bf16 v[216:219], a[32:35], v[32:39], v224
    s_waitcnt lgkmcnt(5)
    v_exp_f32 v45, v45
    v_exp_f32 v46, v46
    v_exp_f32 v47, v47
    v_mfma_f32_32x32x16_bf16 v[0:15], a[0:3], v[128:131], 4.0
    s_waitcnt lgkmcnt(4)
    v_exp_f32 v48, v48
    v_exp_f32 v49, v49
    v_exp_f32 v50, v50
    v_mfma_f32_32x32x16_bf16 v[0:15], a[4:7], v[132:135], v[0:15]
    s_waitcnt lgkmcnt(0)
    v_exp_f32 v51, v51
    v_exp_f32 v52, v52
    v_exp_f32 v53, v53
    v_smfmac_f32_32x32x32_bf16 v[96:111], a[28:31], v[40:47], v224
    s_barrier
    v_exp_f32 v54, v54
    v_exp_f32 v55, v55
    v_exp_f32 v56, v56
    v_smfmac_f32_16x16x64_bf16 v[216:219], a[32:35], v[40:47], v224
    ds_read_b128 a[8:11], v225 offset:0
    v_exp_f32 v57, v57
    v_smfmac_f32_32x32x32_bf16 v[112:127], a[24:27], v[48:55], v224
    v_exp_f32 v58, v58
    v_exp_f32 v59, v59
    v_exp_f32 v60, v60
    v_smfmac_f32_16x16x64_bf16 v[220:223], a[32:35], v[48:55], v224
    ds_read_b128 a[12:15], v225 offset:1024
    v_exp_f32 v61, v61
    v_exp_f32 v62, v62
    v_exp_f32 v63, v63
    v_mfma_f32_32x32x16_bf16 v[16:31], a[0:3], v[136:139], 4.0
    v_exp_f32 v0, v0
    v_exp_f32 v1, v1
    v_exp_f32 v2, v2
    v_mfma_f32_32x32x16_bf16 v[16:31], a[4:7], v[140:143], v[16:31]
    v_exp_f32 v3, v3
    v_exp_f32 v4, v4
    v_exp_f32 v5, v5
    v_smfmac_f32_32x32x32_bf16 v[112:127], a[28:31], v[56:63], v224
    v_exp_f32 v6, v6
    v_exp_f32 v7, v7
    v_exp_f32 v8, v8
    v_smfmac_f32_16x16x64_bf16 v[220:223], a[32:35], v[56:63], v224
    ds_read_b64_tr_b16 a[24:25], v226 offset:0
    v_exp_f32 v9, v9
    v_smfmac_f32_32x32x32_bf16 v[64:79], a[16:19], v[0:7], v224
    v_exp_f32 v10, v10
    v_exp_f32 v11, v11
    v_exp_f32 v12, v12
    v_smfmac_f32_16x16x64_bf16 v[208:211], a[32:35], v[0:7], v224
    ds_read_b64_tr_b16 a[26:27], v226 offset:256
    v_exp_f32 v13, v13
    v_exp_f32 v14, v14
    v_exp_f32 v15, v15
    v_mfma_f32_32x32x16_bf16 v[32:47], a[0:3], v[144:147], 4.0
    v_exp_f32 v16, v16
    v_exp_f32 v17, v17
    v_exp_f32 v18, v18
    v_mfma_f32_32x32x16_bf16 v[32:47], a[4:7], v[148:151], v[32:47]
    v_exp_f32 v19, v19
    v_exp_f32 v20, v20
    v_exp_f32 v21, v21
    v_smfmac_f32_32x32x32_bf16 v[64:79], a[20:23], v[8:15], v224
    v_exp_f32 v22, v22
    v_exp_f32 v23, v23
    v_exp_f32 v24, v24
    v_smfmac_f32_16x16x64_bf16 v[208:211], a[32:35], v[8:15], v224
    ds_read_b64_tr_b16 a[28:29], v226 offset:1024
    v_exp_f32 v25, v25
    v_smfmac_f32_32x32x32_bf16 v[80:95], a[16:19], v[16:23], v224
    s_mov_b32 m0, s57
    v_exp_f32 v26, v26
    v_exp_f32 v27, v27
    v_exp_f32 v28, v28
    v_smfmac_f32_16x16x64_bf16 v[212:215], a[32:35], v[16:23], v224
    ds_read_b64_tr_b16 a[30:31], v226 offset:1280
    v_exp_f32 v29, v29
    v_exp_f32 v30, v30
    v_exp_f32 v31, v31
    v_mfma_f32_32x32x16_bf16 v[48:63], a[0:3], v[152:155], 4.0
    buffer_load_dwordx4 v225, s[24:27], s38 offen offset:0 nt lds
    v_exp_f32 v32, v32
    v_exp_f32 v33, v33
    v_exp_f32 v34, v34
    v_mfma_f32_32x32x16_bf16 v[48:63], a[4:7], v[156:159], v[48:63]
    buffer_load_dwordx4 v225, s[24:27], s38 offen offset:1024 nt lds
    v_exp_f32 v35, v35
    v_exp_f32 v36, v36
    v_exp_f32 v37, v37
    v_smfmac_f32_32x32x32_bf16 v[80:95], a[20:23], v[24:31], v224
    v_exp_f32 v38, v38
    v_exp_f32 v39, v39
    v_exp_f32 v40, v40
    v_smfmac_f32_16x16x64_bf16 v[212:215], a[32:35], v[24:31], v224
    buffer_load_dwordx4 v225, s[24:27], s12 offen offset:2048 nt lds
    v_exp_f32 v41, v41
    v_smfmac_f32_32x32x32_bf16 v[96:111], a[16:19], v[32:39], v224
    v_exp_f32 v42, v42
    v_exp_f32 v43, v43
    v_exp_f32 v44, v44
    v_smfmac_f32_16x16x64_bf16 v[216:219], a[32:35], v[32:39], v224
    s_waitcnt lgkmcnt(5)
    buffer_load_dwordx4 v225, s[24:27], s12 offen offset:3072 nt lds
    v_exp_f32 v45, v45
    v_exp_f32 v46, v46
    v_exp_f32 v47, v47
    v_mfma_f32_32x32x16_bf16 v[0:15], a[8:11], v[128:131], 4.0
    s_waitcnt lgkmcnt(4)
    v_exp_f32 v48, v48
    v_exp_f32 v49, v49
    v_exp_f32 v50, v50
    v_mfma_f32_32x32x16_bf16 v[0:15], a[12:15], v[132:135], v[0:15]
    v_exp_f32 v51, v51
    v_exp_f32 v52, v52
    v_exp_f32 v53, v53
    v_smfmac_f32_32x32x32_bf16 v[96:111], a[20:23], v[40:47], v224
    v_exp_f32 v54, v54
    v_exp_f32 v55, v55
    v_exp_f32 v56, v56
    v_smfmac_f32_16x16x64_bf16 v[216:219], a[32:35], v[40:47], v224
    ds_read_b128 a[0:3], v225 offset:2048
    v_exp_f32 v57, v57
    v_smfmac_f32_32x32x32_bf16 v[112:127], a[16:19], v[48:55], v224
    v_exp_f32 v58, v58
    v_exp_f32 v59, v59
    v_exp_f32 v60, v60
    v_smfmac_f32_16x16x64_bf16 v[220:223], a[32:35], v[48:55], v224
    ds_read_b128 a[4:7], v225 offset:3072
    v_exp_f32 v61, v61
    v_exp_f32 v62, v62
    v_exp_f32 v63, v63
    v_mfma_f32_32x32x16_bf16 v[16:31], a[8:11], v[136:139], 4.0
    v_exp_f32 v0, v0
    v_exp_f32 v1, v1
    v_exp_f32 v2, v2
    v_mfma_f32_32x32x16_bf16 v[16:31], a[12:15], v[140:143], v[16:31]
    v_exp_f32 v3, v3
    v_exp_f32 v4, v4
    v_exp_f32 v5, v5
    v_smfmac_f32_32x32x32_bf16 v[112:127], a[20:23], v[56:63], v224
    v_exp_f32 v6, v6
    v_exp_f32 v7, v7
    v_exp_f32 v8, v8
    v_smfmac_f32_16x16x64_bf16 v[220:223], a[32:35], v[56:63], v224
    s_waitcnt lgkmcnt(4)
    ds_read_b64_tr_b16 a[16:17], v226 offset:2048
    v_exp_f32 v9, v9
    v_smfmac_f32_32x32x32_bf16 v[64:79], a[24:27], v[0:7], v224
    v_exp_f32 v10, v10
    v_exp_f32 v11, v11
    v_exp_f32 v12, v12
    v_smfmac_f32_16x16x64_bf16 v[208:211], a[32:35], v[0:7], v224
    ds_read_b64_tr_b16 a[18:19], v226 offset:2304
    v_exp_f32 v13, v13
    v_exp_f32 v14, v14
    v_exp_f32 v15, v15
    v_mfma_f32_32x32x16_bf16 v[32:47], a[8:11], v[144:147], 4.0
    v_exp_f32 v16, v16
    v_exp_f32 v17, v17
    v_exp_f32 v18, v18
    v_mfma_f32_32x32x16_bf16 v[32:47], a[12:15], v[148:151], v[32:47]
    s_waitcnt lgkmcnt(4)
    v_exp_f32 v19, v19
    v_exp_f32 v20, v20
    v_exp_f32 v21, v21
    v_smfmac_f32_32x32x32_bf16 v[64:79], a[28:31], v[8:15], v224
    v_exp_f32 v22, v22
    v_exp_f32 v23, v23
    v_exp_f32 v24, v24
    v_smfmac_f32_16x16x64_bf16 v[208:211], a[32:35], v[8:15], v224
    ds_read_b64_tr_b16 a[20:21], v226 offset:3072
    v_exp_f32 v25, v25
    v_smfmac_f32_32x32x32_bf16 v[80:95], a[24:27], v[16:23], v224
    s_mov_b32 m0, s61
    v_exp_f32 v26, v26
    v_exp_f32 v27, v27
    v_exp_f32 v28, v28
    v_smfmac_f32_16x16x64_bf16 v[212:215], a[32:35], v[16:23], v224
    ds_read_b64_tr_b16 a[22:23], v226 offset:3328
    v_exp_f32 v29, v29
    v_exp_f32 v30, v30
    v_exp_f32 v31, v31
    v_mfma_f32_32x32x16_bf16 v[48:63], a[8:11], v[152:155], 4.0
    buffer_load_dwordx4 v225, s[48:51], s46 offen offset:0 sc1 lds
    v_exp_f32 v32, v32
    v_exp_f32 v33, v33
    v_exp_f32 v34, v34
    v_mfma_f32_32x32x16_bf16 v[48:63], a[12:15], v[156:159], v[48:63]
    buffer_load_dwordx4 v225, s[48:51], s46 offen offset:1024 sc1 lds
    v_exp_f32 v35, v35
    v_exp_f32 v36, v36
    v_exp_f32 v37, v37
    v_smfmac_f32_32x32x32_bf16 v[80:95], a[28:31], v[24:31], v224
    v_exp_f32 v38, v38
    v_exp_f32 v39, v39
    v_exp_f32 v40, v40
    v_smfmac_f32_16x16x64_bf16 v[212:215], a[32:35], v[24:31], v224
    buffer_load_dwordx4 v225, s[48:51], s14 offen offset:2048 sc1 lds
    v_exp_f32 v41, v41
    v_smfmac_f32_32x32x32_bf16 v[96:111], a[24:27], v[32:39], v224
    v_exp_f32 v42, v42
    v_exp_f32 v43, v43
    v_exp_f32 v44, v44
    v_smfmac_f32_16x16x64_bf16 v[216:219], a[32:35], v[32:39], v224
    s_waitcnt lgkmcnt(5)
    buffer_load_dwordx4 v225, s[48:51], s14 offen offset:3072 sc1 lds
    v_exp_f32 v45, v45
    v_exp_f32 v46, v46
    v_exp_f32 v47, v47
    v_mfma_f32_32x32x16_bf16 v[0:15], a[0:3], v[128:131], 4.0
    s_waitcnt lgkmcnt(4)
    v_exp_f32 v48, v48
    v_exp_f32 v49, v49
    v_exp_f32 v50, v50
    v_mfma_f32_32x32x16_bf16 v[0:15], a[4:7], v[132:135], v[0:15]
    v_exp_f32 v51, v51
    v_exp_f32 v52, v52
    v_exp_f32 v53, v53
    v_smfmac_f32_32x32x32_bf16 v[96:111], a[28:31], v[40:47], v224
    s_add_u32 s45, s45, 5
    v_exp_f32 v54, v54
    v_exp_f32 v55, v55
    v_exp_f32 v56, v56
    v_smfmac_f32_16x16x64_bf16 v[216:219], a[32:35], v[40:47], v224
    ds_read_b128 a[8:11], v225 offset:4096
    v_exp_f32 v57, v57
    v_smfmac_f32_32x32x32_bf16 v[112:127], a[24:27], v[48:55], v224
    s_and_b32 s45, s45, 7
    v_exp_f32 v58, v58
    v_exp_f32 v59, v59
    v_exp_f32 v60, v60
    v_smfmac_f32_16x16x64_bf16 v[220:223], a[32:35], v[48:55], v224
    ds_read_b128 a[12:15], v225 offset:5120
    v_exp_f32 v61, v61
    v_exp_f32 v62, v62
    v_exp_f32 v63, v63
    v_mfma_f32_32x32x16_bf16 v[16:31], a[0:3], v[136:139], 4.0
    v_exp_f32 v0, v0
    v_exp_f32 v1, v1
    v_exp_f32 v2, v2
    v_mfma_f32_32x32x16_bf16 v[16:31], a[4:7], v[140:143], v[16:31]
    v_exp_f32 v3, v3
    v_exp_f32 v4, v4
    v_exp_f32 v5, v5
    v_smfmac_f32_32x32x32_bf16 v[112:127], a[28:31], v[56:63], v224
    s_mul_i32 s38, s45, 14336
    v_exp_f32 v6, v6
    v_exp_f32 v7, v7
    v_exp_f32 v8, v8
    v_smfmac_f32_16x16x64_bf16 v[220:223], a[32:35], v[56:63], v224
    s_waitcnt lgkmcnt(4)
    ds_read_b64_tr_b16 a[24:25], v226 offset:4096
    v_exp_f32 v9, v9
    v_smfmac_f32_32x32x32_bf16 v[64:79], a[16:19], v[0:7], v224
    s_add_u32 s38, s38, s56
    v_exp_f32 v10, v10
    v_exp_f32 v11, v11
    v_exp_f32 v12, v12
    v_smfmac_f32_16x16x64_bf16 v[208:211], a[32:35], v[0:7], v224
    ds_read_b64_tr_b16 a[26:27], v226 offset:4352
    v_exp_f32 v13, v13
    v_exp_f32 v14, v14
    v_exp_f32 v15, v15
    v_mfma_f32_32x32x16_bf16 v[32:47], a[0:3], v[144:147], 4.0
    v_exp_f32 v16, v16
    v_exp_f32 v17, v17
    v_exp_f32 v18, v18
    v_mfma_f32_32x32x16_bf16 v[32:47], a[4:7], v[148:151], v[32:47]
    s_waitcnt lgkmcnt(4)
    v_exp_f32 v19, v19
    v_exp_f32 v20, v20
    v_exp_f32 v21, v21
    v_smfmac_f32_32x32x32_bf16 v[64:79], a[20:23], v[8:15], v224
    s_lshl_b32 s46, s45, 14
    v_exp_f32 v22, v22
    v_exp_f32 v23, v23
    v_exp_f32 v24, v24
    v_smfmac_f32_16x16x64_bf16 v[208:211], a[32:35], v[8:15], v224
    ds_read_b64_tr_b16 a[28:29], v226 offset:5120
    v_exp_f32 v25, v25
    v_smfmac_f32_32x32x32_bf16 v[80:95], a[16:19], v[16:23], v224
    s_add_u32 s46, s46, s44
    v_exp_f32 v26, v26
    v_exp_f32 v27, v27
    v_exp_f32 v28, v28
    v_smfmac_f32_16x16x64_bf16 v[212:215], a[32:35], v[16:23], v224
    ds_read_b64_tr_b16 a[30:31], v226 offset:5376
    v_exp_f32 v29, v29
    v_exp_f32 v30, v30
    v_exp_f32 v31, v31
    v_mfma_f32_32x32x16_bf16 v[48:63], a[0:3], v[152:155], 4.0
    v_exp_f32 v32, v32
    v_exp_f32 v33, v33
    v_exp_f32 v34, v34
    v_mfma_f32_32x32x16_bf16 v[48:63], a[4:7], v[156:159], v[48:63]
    v_exp_f32 v35, v35
    v_exp_f32 v36, v36
    v_exp_f32 v37, v37
    v_smfmac_f32_32x32x32_bf16 v[80:95], a[20:23], v[24:31], v224
    s_add_u32 s12, s38, s41
    v_exp_f32 v38, v38
    v_exp_f32 v39, v39
    v_exp_f32 v40, v40
    v_smfmac_f32_16x16x64_bf16 v[212:215], a[32:35], v[24:31], v224
    v_exp_f32 v41, v41
    v_smfmac_f32_32x32x32_bf16 v[96:111], a[16:19], v[32:39], v224
    s_add_u32 s14, s46, s41
    v_exp_f32 v42, v42
    v_exp_f32 v43, v43
    v_exp_f32 v44, v44
    v_smfmac_f32_16x16x64_bf16 v[216:219], a[32:35], v[32:39], v224
    s_waitcnt lgkmcnt(5)
    v_exp_f32 v45, v45
    v_exp_f32 v46, v46
    v_exp_f32 v47, v47
    v_mfma_f32_32x32x16_bf16 v[0:15], a[8:11], v[128:131], 4.0
    s_waitcnt lgkmcnt(4)
    v_exp_f32 v48, v48
    v_exp_f32 v49, v49
    v_exp_f32 v50, v50
    v_mfma_f32_32x32x16_bf16 v[0:15], a[12:15], v[132:135], v[0:15]
    v_exp_f32 v51, v51
    v_exp_f32 v52, v52
    v_exp_f32 v53, v53
    v_smfmac_f32_32x32x32_bf16 v[96:111], a[20:23], v[40:47], v224
    v_exp_f32 v54, v54
    v_exp_f32 v55, v55
    v_exp_f32 v56, v56
    v_smfmac_f32_16x16x64_bf16 v[216:219], a[32:35], v[40:47], v224
    ds_read_b128 a[0:3], v225 offset:6144
    v_exp_f32 v57, v57
    v_smfmac_f32_32x32x32_bf16 v[112:127], a[16:19], v[48:55], v224
    v_exp_f32 v58, v58
    v_exp_f32 v59, v59
    v_exp_f32 v60, v60
    v_smfmac_f32_16x16x64_bf16 v[220:223], a[32:35], v[48:55], v224
    ds_read_b128 a[4:7], v225 offset:7168
    v_exp_f32 v61, v61
    v_exp_f32 v62, v62
    v_exp_f32 v63, v63
    v_mfma_f32_32x32x16_bf16 v[16:31], a[8:11], v[136:139], 4.0
    v_exp_f32 v0, v0
    v_exp_f32 v1, v1
    v_exp_f32 v2, v2
    v_mfma_f32_32x32x16_bf16 v[16:31], a[12:15], v[140:143], v[16:31]
    v_exp_f32 v3, v3
    v_exp_f32 v4, v4
    v_exp_f32 v5, v5
    v_smfmac_f32_32x32x32_bf16 v[112:127], a[20:23], v[56:63], v224
    v_exp_f32 v6, v6
    v_exp_f32 v7, v7
    v_exp_f32 v8, v8
    v_smfmac_f32_16x16x64_bf16 v[220:223], a[32:35], v[56:63], v224
    s_waitcnt lgkmcnt(4)
    ds_read_b64_tr_b16 a[16:17], v226 offset:6144
    v_exp_f32 v9, v9
    v_smfmac_f32_32x32x32_bf16 v[64:79], a[24:27], v[0:7], v224
    v_exp_f32 v10, v10
    v_exp_f32 v11, v11
    v_exp_f32 v12, v12
    v_smfmac_f32_16x16x64_bf16 v[208:211], a[32:35], v[0:7], v224
    ds_read_b64_tr_b16 a[18:19], v226 offset:6400
    v_exp_f32 v13, v13
    v_exp_f32 v14, v14
    v_exp_f32 v15, v15
    v_mfma_f32_32x32x16_bf16 v[32:47], a[8:11], v[144:147], 4.0
    v_exp_f32 v16, v16
    v_exp_f32 v17, v17
    v_exp_f32 v18, v18
    v_mfma_f32_32x32x16_bf16 v[32:47], a[12:15], v[148:151], v[32:47]
    s_waitcnt lgkmcnt(4)
    v_exp_f32 v19, v19
    v_exp_f32 v20, v20
    v_exp_f32 v21, v21
    v_smfmac_f32_32x32x32_bf16 v[64:79], a[28:31], v[8:15], v224
    v_exp_f32 v22, v22
    v_exp_f32 v23, v23
    v_exp_f32 v24, v24
    v_smfmac_f32_16x16x64_bf16 v[208:211], a[32:35], v[8:15], v224
    ds_read_b64_tr_b16 a[20:21], v226 offset:7168
    v_exp_f32 v25, v25
    v_smfmac_f32_32x32x32_bf16 v[80:95], a[24:27], v[16:23], v224
    v_exp_f32 v26, v26
    v_exp_f32 v27, v27
    v_exp_f32 v28, v28
    v_smfmac_f32_16x16x64_bf16 v[212:215], a[32:35], v[16:23], v224
    ds_read_b64_tr_b16 a[22:23], v226 offset:7424
    v_exp_f32 v29, v29
    v_exp_f32 v30, v30
    v_exp_f32 v31, v31
    v_mfma_f32_32x32x16_bf16 v[48:63], a[8:11], v[152:155], 4.0
    v_exp_f32 v32, v32
    v_exp_f32 v33, v33
    v_exp_f32 v34, v34
    v_mfma_f32_32x32x16_bf16 v[48:63], a[12:15], v[156:159], v[48:63]
    v_exp_f32 v35, v35
    v_exp_f32 v36, v36
    v_exp_f32 v37, v37
    v_smfmac_f32_32x32x32_bf16 v[80:95], a[28:31], v[24:31], v224
    v_exp_f32 v38, v38
    v_exp_f32 v39, v39
    v_exp_f32 v40, v40
    v_smfmac_f32_16x16x64_bf16 v[212:215], a[32:35], v[24:31], v224
    v_exp_f32 v41, v41
    v_smfmac_f32_32x32x32_bf16 v[96:111], a[24:27], v[32:39], v224
    v_exp_f32 v42, v42
    v_exp_f32 v43, v43
    v_exp_f32 v44, v44
    v_smfmac_f32_16x16x64_bf16 v[216:219], a[32:35], v[32:39], v224
    s_waitcnt lgkmcnt(5)
    v_exp_f32 v45, v45
    v_exp_f32 v46, v46
    v_exp_f32 v47, v47
    v_mfma_f32_32x32x16_bf16 v[0:15], a[0:3], v[128:131], 4.0
    s_waitcnt lgkmcnt(4)
    v_exp_f32 v48, v48
    v_exp_f32 v49, v49
    v_exp_f32 v50, v50
    v_mfma_f32_32x32x16_bf16 v[0:15], a[4:7], v[132:135], v[0:15]
L_pad5B:
    s_cbranch_vccnz L_retB
    v_exp_f32 v51, v51
    v_exp_f32 v52, v52
    v_exp_f32 v53, v53
    v_smfmac_f32_32x32x32_bf16 v[96:111], a[28:31], v[40:47], v224
    v_exp_f32 v54, v54
    v_exp_f32 v55, v55
    v_exp_f32 v56, v56
    v_smfmac_f32_16x16x64_bf16 v[216:219], a[32:35], v[40:47], v224
    ds_read_b128 a[8:11], v225 offset:8192
    v_exp_f32 v57, v57
    v_smfmac_f32_32x32x32_bf16 v[112:127], a[24:27], v[48:55], v224
    v_exp_f32 v58, v58
    v_exp_f32 v59, v59
    v_exp_f32 v60, v60
    v_smfmac_f32_16x16x64_bf16 v[220:223], a[32:35], v[48:55], v224
    ds_read_b128 a[12:15], v225 offset:9216
    v_exp_f32 v61, v61
    v_exp_f32 v62, v62
    v_exp_f32 v63, v63
    v_mfma_f32_32x32x16_bf16 v[16:31], a[0:3], v[136:139], 4.0
    v_exp_f32 v0, v0
    v_exp_f32 v1, v1
    v_exp_f32 v2, v2
    v_mfma_f32_32x32x16_bf16 v[16:31], a[4:7], v[140:143], v[16:31]
    v_exp_f32 v3, v3
    v_exp_f32 v4, v4
    v_exp_f32 v5, v5
    v_smfmac_f32_32x32x32_bf16 v[112:127], a[28:31], v[56:63], v224
    v_exp_f32 v6, v6
    v_exp_f32 v7, v7
    v_exp_f32 v8, v8
    v_smfmac_f32_16x16x64_bf16 v[220:223], a[32:35], v[56:63], v224
    s_waitcnt lgkmcnt(4)
    ds_read_b64_tr_b16 a[24:25], v226 offset:8192
    v_exp_f32 v9, v9
    v_smfmac_f32_32x32x32_bf16 v[64:79], a[16:19], v[0:7], v224
    v_exp_f32 v10, v10
    v_exp_f32 v11, v11
    v_exp_f32 v12, v12
    v_smfmac_f32_16x16x64_bf16 v[208:211], a[32:35], v[0:7], v224
    ds_read_b64_tr_b16 a[26:27], v226 offset:8448
    v_exp_f32 v13, v13
    v_exp_f32 v14, v14
    v_exp_f32 v15, v15
    v_mfma_f32_32x32x16_bf16 v[32:47], a[0:3], v[144:147], 4.0
    v_exp_f32 v16, v16
    v_exp_f32 v17, v17
    v_exp_f32 v18, v18
    v_mfma_f32_32x32x16_bf16 v[32:47], a[4:7], v[148:151], v[32:47]
    s_waitcnt lgkmcnt(4)
    v_exp_f32 v19, v19
    v_exp_f32 v20, v20
    v_exp_f32 v21, v21
    v_smfmac_f32_32x32x32_bf16 v[64:79], a[20:23], v[8:15], v224
    v_exp_f32 v22, v22
    v_exp_f32 v23, v23
    v_exp_f32 v24, v24
    v_smfmac_f32_16x16x64_bf16 v[208:211], a[32:35], v[8:15], v224
    ds_read_b64_tr_b16 a[28:29], v226 offset:9216
    v_exp_f32 v25, v25
    v_smfmac_f32_32x32x32_bf16 v[80:95], a[16:19], v[16:23], v224
    v_exp_f32 v26, v26
    v_exp_f32 v27, v27
    v_exp_f32 v28, v28
    v_smfmac_f32_16x16x64_bf16 v[212:215], a[32:35], v[16:23], v224
    ds_read_b64_tr_b16 a[30:31], v226 offset:9472
    v_exp_f32 v29, v29
    v_exp_f32 v30, v30
    v_exp_f32 v31, v31
    v_mfma_f32_32x32x16_bf16 v[48:63], a[0:3], v[152:155], 4.0
    v_exp_f32 v32, v32
    v_exp_f32 v33, v33
    v_exp_f32 v34, v34
    v_mfma_f32_32x32x16_bf16 v[48:63], a[4:7], v[156:159], v[48:63]
    v_exp_f32 v35, v35
    v_exp_f32 v36, v36
    v_exp_f32 v37, v37
    v_smfmac_f32_32x32x32_bf16 v[80:95], a[20:23], v[24:31], v224
    v_exp_f32 v38, v38
    v_exp_f32 v39, v39
    v_exp_f32 v40, v40
    v_smfmac_f32_16x16x64_bf16 v[212:215], a[32:35], v[24:31], v224
    v_exp_f32 v41, v41
    v_smfmac_f32_32x32x32_bf16 v[96:111], a[16:19], v[32:39], v224
    v_exp_f32 v42, v42
    v_exp_f32 v43, v43
    v_exp_f32 v44, v44
    v_smfmac_f32_16x16x64_bf16 v[216:219], a[32:35], v[32:39], v224
    s_waitcnt lgkmcnt(5)
    v_exp_f32 v45, v45
    v_exp_f32 v46, v46
    v_exp_f32 v47, v47
    v_mfma_f32_32x32x16_bf16 v[0:15], a[8:11], v[128:131], 4.0
    s_waitcnt lgkmcnt(4)
    v_exp_f32 v48, v48
    v_exp_f32 v49, v49
    v_exp_f32 v50, v50
    v_mfma_f32_32x32x16_bf16 v[0:15], a[12:15], v[132:135], v[0:15]
    v_exp_f32 v51, v51
    v_exp_f32 v52, v52
    v_exp_f32 v53, v53
    v_smfmac_f32_32x32x32_bf16 v[96:111], a[20:23], v[40:47], v224
    v_exp_f32 v54, v54
    v_exp_f32 v55, v55
    v_exp_f32 v56, v56
    v_smfmac_f32_16x16x64_bf16 v[216:219], a[32:35], v[40:47], v224
    ds_read_b128 a[0:3], v225 offset:10240
    v_exp_f32 v57, v57
    v_smfmac_f32_32x32x32_bf16 v[112:127], a[16:19], v[48:55], v224
    v_exp_f32 v58, v58
    v_exp_f32 v59, v59
    v_exp_f32 v60, v60
    v_smfmac_f32_16x16x64_bf16 v[220:223], a[32:35], v[48:55], v224
    ds_read_b128 a[4:7], v225 offset:11264
    v_exp_f32 v61, v61
    v_exp_f32 v62, v62
    v_exp_f32 v63, v63
    v_mfma_f32_32x32x16_bf16 v[16:31], a[8:11], v[136:139], 4.0
    v_exp_f32 v0, v0
    v_exp_f32 v1, v1
    v_exp_f32 v2, v2
    v_mfma_f32_32x32x16_bf16 v[16:31], a[12:15], v[140:143], v[16:31]
    v_exp_f32 v3, v3
    v_exp_f32 v4, v4
    v_exp_f32 v5, v5
    v_smfmac_f32_32x32x32_bf16 v[112:127], a[20:23], v[56:63], v224
    v_exp_f32 v6, v6
    v_exp_f32 v7, v7
    v_exp_f32 v8, v8
    v_smfmac_f32_16x16x64_bf16 v[220:223], a[32:35], v[56:63], v224
    s_waitcnt lgkmcnt(4)
    ds_read_b64_tr_b16 a[16:17], v226 offset:10240
    v_exp_f32 v9, v9
    v_smfmac_f32_32x32x32_bf16 v[64:79], a[24:27], v[0:7], v224
    v_exp_f32 v10, v10
    v_exp_f32 v11, v11
    v_exp_f32 v12, v12
    v_smfmac_f32_16x16x64_bf16 v[208:211], a[32:35], v[0:7], v224
    ds_read_b64_tr_b16 a[18:19], v226 offset:10496
    v_exp_f32 v13, v13
    v_exp_f32 v14, v14
    v_exp_f32 v15, v15
    v_mfma_f32_32x32x16_bf16 v[32:47], a[8:11], v[144:147], 4.0
    v_exp_f32 v16, v16
    v_exp_f32 v17, v17
    v_exp_f32 v18, v18
    v_mfma_f32_32x32x16_bf16 v[32:47], a[12:15], v[148:151], v[32:47]
    s_waitcnt lgkmcnt(4)
    v_exp_f32 v19, v19
    v_exp_f32 v20, v20
    v_exp_f32 v21, v21
    v_smfmac_f32_32x32x32_bf16 v[64:79], a[28:31], v[8:15], v224
    v_exp_f32 v22, v22
    v_exp_f32 v23, v23
    v_exp_f32 v24, v24
    v_smfmac_f32_16x16x64_bf16 v[208:211], a[32:35], v[8:15], v224
    ds_read_b64_tr_b16 a[20:21], v226 offset:11264
    v_exp_f32 v25, v25
    v_smfmac_f32_32x32x32_bf16 v[80:95], a[24:27], v[16:23], v224
    v_exp_f32 v26, v26
    v_exp_f32 v27, v27
    v_exp_f32 v28, v28
    v_smfmac_f32_16x16x64_bf16 v[212:215], a[32:35], v[16:23], v224
    ds_read_b64_tr_b16 a[22:23], v226 offset:11520
    v_exp_f32 v29, v29
    v_exp_f32 v30, v30
    v_exp_f32 v31, v31
    v_mfma_f32_32x32x16_bf16 v[48:63], a[8:11], v[152:155], 4.0
    v_exp_f32 v32, v32
    v_exp_f32 v33, v33
    v_exp_f32 v34, v34
    v_mfma_f32_32x32x16_bf16 v[48:63], a[12:15], v[156:159], v[48:63]
    v_exp_f32 v35, v35
    v_exp_f32 v36, v36
    v_exp_f32 v37, v37
    v_smfmac_f32_32x32x32_bf16 v[80:95], a[28:31], v[24:31], v224
    v_exp_f32 v38, v38
    v_exp_f32 v39, v39
    v_exp_f32 v40, v40
    v_smfmac_f32_16x16x64_bf16 v[212:215], a[32:35], v[24:31], v224
    v_exp_f32 v41, v41
    v_smfmac_f32_32x32x32_bf16 v[96:111], a[24:27], v[32:39], v224
    v_exp_f32 v42, v42
    v_exp_f32 v43, v43
    v_exp_f32 v44, v44
    v_smfmac_f32_16x16x64_bf16 v[216:219], a[32:35], v[32:39], v224
    s_waitcnt lgkmcnt(5)
    v_exp_f32 v45, v45
    v_exp_f32 v46, v46
    v_exp_f32 v47, v47
    v_mfma_f32_32x32x16_bf16 v[0:15], a[0:3], v[128:131], 4.0
    s_waitcnt lgkmcnt(4)
    v_exp_f32 v48, v48
    v_exp_f32 v49, v49
    v_exp_f32 v50, v50
    v_mfma_f32_32x32x16_bf16 v[0:15], a[4:7], v[132:135], v[0:15]
    v_exp_f32 v51, v51
    v_exp_f32 v52, v52
    v_exp_f32 v53, v53
    v_smfmac_f32_32x32x32_bf16 v[96:111], a[28:31], v[40:47], v224
    v_exp_f32 v54, v54
    v_exp_f32 v55, v55
    v_exp_f32 v56, v56
    v_smfmac_f32_16x16x64_bf16 v[216:219], a[32:35], v[40:47], v224
    ds_read_b128 a[8:11], v225 offset:12288
    v_exp_f32 v57, v57
    v_smfmac_f32_32x32x32_bf16 v[112:127], a[24:27], v[48:55], v224
    v_exp_f32 v58, v58
    v_exp_f32 v59, v59
    v_exp_f32 v60, v60
    v_smfmac_f32_16x16x64_bf16 v[220:223], a[32:35], v[48:55], v224
    ds_read_b128 a[12:15], v225 offset:13312
    v_exp_f32 v61, v61
    v_exp_f32 v62, v62
    v_exp_f32 v63, v63
    v_mfma_f32_32x32x16_bf16 v[16:31], a[0:3], v[136:139], 4.0
    v_exp_f32 v0, v0
    v_exp_f32 v1, v1
    v_exp_f32 v2, v2
    v_mfma_f32_32x32x16_bf16 v[16:31], a[4:7], v[140:143], v[16:31]
    v_exp_f32 v3, v3
    v_exp_f32 v4, v4
    v_exp_f32 v5, v5
    v_smfmac_f32_32x32x32_bf16 v[112:127], a[28:31], v[56:63], v224
    v_exp_f32 v6, v6
    v_exp_f32 v7, v7
    v_exp_f32 v8, v8
    v_smfmac_f32_16x16x64_bf16 v[220:223], a[32:35], v[56:63], v224
    s_waitcnt lgkmcnt(4)
    ds_read_b64_tr_b16 a[24:25], v226 offset:12288
    v_exp_f32 v9, v9
    v_smfmac_f32_32x32x32_bf16 v[64:79], a[16:19], v[0:7], v224
    v_exp_f32 v10, v10
    v_exp_f32 v11, v11
    v_exp_f32 v12, v12
    v_smfmac_f32_16x16x64_bf16 v[208:211], a[32:35], v[0:7], v224
    ds_read_b64_tr_b16 a[26:27], v226 offset:12544
    v_exp_f32 v13, v13
    v_exp_f32 v14, v14
    v_exp_f32 v15, v15
    v_mfma_f32_32x32x16_bf16 v[32:47], a[0:3], v[144:147], 4.0
    v_exp_f32 v16, v16
    v_exp_f32 v17, v17
    v_exp_f32 v18, v18
    v_mfma_f32_32x32x16_bf16 v[32:47], a[4:7], v[148:151], v[32:47]
    s_waitcnt lgkmcnt(4)
    v_exp_f32 v19, v19
    v_exp_f32 v20, v20
    v_exp_f32 v21, v21
    v_smfmac_f32_32x32x32_bf16 v[64:79], a[20:23], v[8:15], v224
    v_exp_f32 v22, v22
    v_exp_f32 v23, v23
    v_exp_f32 v24, v24
    v_smfmac_f32_16x16x64_bf16 v[208:211], a[32:35], v[8:15], v224
    ds_read_b64_tr_b16 a[28:29], v226 offset:13312
    v_exp_f32 v25, v25
    v_smfmac_f32_32x32x32_bf16 v[80:95], a[16:19], v[16:23], v224
    v_exp_f32 v26, v26
    v_exp_f32 v27, v27
    v_exp_f32 v28, v28
    v_smfmac_f32_16x16x64_bf16 v[212:215], a[32:35], v[16:23], v224
    ds_read_b64_tr_b16 a[30:31], v226 offset:13568
    v_exp_f32 v29, v29
    v_exp_f32 v30, v30
    v_exp_f32 v31, v31
    v_mfma_f32_32x32x16_bf16 v[48:63], a[0:3], v[152:155], 4.0
    v_exp_f32 v32, v32
    v_exp_f32 v33, v33
    v_exp_f32 v34, v34
    v_mfma_f32_32x32x16_bf16 v[48:63], a[4:7], v[156:159], v[48:63]
    v_exp_f32 v35, v35
    v_exp_f32 v36, v36
    v_exp_f32 v37, v37
    v_smfmac_f32_32x32x32_bf16 v[80:95], a[20:23], v[24:31], v224
    v_exp_f32 v38, v38
    v_exp_f32 v39, v39
    v_exp_f32 v40, v40
    v_smfmac_f32_16x16x64_bf16 v[212:215], a[32:35], v[24:31], v224
    buffer_load_dword v239, v225, s[52:55], 0 offen offset:4 sc1
    v_exp_f32 v41, v41
    v_smfmac_f32_32x32x32_bf16 v[96:111], a[16:19], v[32:39], v224
    v_exp_f32 v42, v42
    v_exp_f32 v43, v43
    v_exp_f32 v44, v44
    v_smfmac_f32_16x16x64_bf16 v[216:219], a[32:35], v[32:39], v224
    s_waitcnt lgkmcnt(5)
    v_exp_f32 v45, v45
    v_exp_f32 v46, v46
    v_exp_f32 v47, v47
    v_mfma_f32_32x32x16_bf16 v[0:15], a[8:11], v[128:131], 4.0
    s_waitcnt lgkmcnt(4)
    v_exp_f32 v48, v48
    v_exp_f32 v49, v49
    v_exp_f32 v50, v50
    v_mfma_f32_32x32x16_bf16 v[0:15], a[12:15], v[132:135], v[0:15]
    s_waitcnt vmcnt(1) lgkmcnt(0)
    v_exp_f32 v51, v51
    v_exp_f32 v52, v52
    v_exp_f32 v53, v53
    v_smfmac_f32_32x32x32_bf16 v[96:111], a[20:23], v[40:47], v224
    s_barrier
    v_exp_f32 v54, v54
    v_exp_f32 v55, v55
    v_exp_f32 v56, v56
    v_smfmac_f32_16x16x64_bf16 v[216:219], a[32:35], v[40:47], v224
    ds_read_b128 a[0:3], v225 offset:32768
    v_exp_f32 v57, v57
    v_smfmac_f32_32x32x32_bf16 v[112:127], a[16:19], v[48:55], v224
    v_exp_f32 v58, v58
    v_exp_f32 v59, v59
    v_exp_f32 v60, v60
    v_smfmac_f32_16x16x64_bf16 v[220:223], a[32:35], v[48:55], v224
    ds_read_b128 a[4:7], v225 offset:33792
    v_exp_f32 v61, v61
    v_exp_f32 v62, v62
    v_exp_f32 v63, v63
    v_mfma_f32_32x32x16_bf16 v[16:31], a[8:11], v[136:139], 4.0
    v_exp_f32 v0, v0
    v_exp_f32 v1, v1
    v_exp_f32 v2, v2
    v_mfma_f32_32x32x16_bf16 v[16:31], a[12:15], v[140:143], v[16:31]
    v_exp_f32 v3, v3
    v_exp_f32 v4, v4
    v_exp_f32 v5, v5
    v_smfmac_f32_32x32x32_bf16 v[112:127], a[20:23], v[56:63], v224
    v_exp_f32 v6, v6
    v_exp_f32 v7, v7
    v_exp_f32 v8, v8
    v_smfmac_f32_16x16x64_bf16 v[220:223], a[32:35], v[56:63], v224
    ds_read_b64_tr_b16 a[16:17], v226 offset:32768
    v_exp_f32 v9, v9
    v_smfmac_f32_32x32x32_bf16 v[64:79], a[24:27], v[0:7], v224
    v_exp_f32 v10, v10
    v_exp_f32 v11, v11
    v_exp_f32 v12, v12
    v_smfmac_f32_16x16x64_bf16 v[208:211], a[32:35], v[0:7], v224
    ds_read_b64_tr_b16 a[18:19], v226 offset:33024
    v_exp_f32 v13, v13
    v_exp_f32 v14, v14
    v_exp_f32 v15, v15
    v_mfma_f32_32x32x16_bf16 v[32:47], a[8:11], v[144:147], 4.0
    v_exp_f32 v16, v16
    v_exp_f32 v17, v17
    v_exp_f32 v18, v18
    v_mfma_f32_32x32x16_bf16 v[32:47], a[12:15], v[148:151], v[32:47]
    v_exp_f32 v19, v19
    v_exp_f32 v20, v20
    v_exp_f32 v21, v21
    v_smfmac_f32_32x32x32_bf16 v[64:79], a[28:31], v[8:15], v224
    v_exp_f32 v22, v22
    v_exp_f32 v23, v23
    v_exp_f32 v24, v24
    v_smfmac_f32_16x16x64_bf16 v[208:211], a[32:35], v[8:15], v224
    ds_read_b64_tr_b16 a[20:21], v226 offset:33792
    v_exp_f32 v25, v25
    v_smfmac_f32_32x32x32_bf16 v[80:95], a[24:27], v[16:23], v224
    s_mov_b32 m0, s56
    v_exp_f32 v26, v26
    v_exp_f32 v27, v27
    v_exp_f32 v28, v28
    v_smfmac_f32_16x16x64_bf16 v[212:215], a[32:35], v[16:23], v224
    ds_read_b64_tr_b16 a[22:23], v226 offset:34048
    v_exp_f32 v29, v29
    v_exp_f32 v30, v30
    v_exp_f32 v31, v31
    v_mfma_f32_32x32x16_bf16 v[48:63], a[8:11], v[152:155], 4.0
    buffer_load_dwordx4 v225, s[24:27], s38 offen offset:0 nt lds
    v_exp_f32 v32, v32
    v_exp_f32 v33, v33
    v_exp_f32 v34, v34
    v_mfma_f32_32x32x16_bf16 v[48:63], a[12:15], v[156:159], v[48:63]
    buffer_load_dwordx4 v225, s[24:27], s38 offen offset:1024 nt lds
    v_exp_f32 v35, v35
    v_exp_f32 v36, v36
    v_exp_f32 v37, v37
    v_smfmac_f32_32x32x32_bf16 v[80:95], a[28:31], v[24:31], v224
    v_exp_f32 v38, v38
    v_exp_f32 v39, v39
    v_exp_f32 v40, v40
    v_smfmac_f32_16x16x64_bf16 v[212:215], a[32:35], v[24:31], v224
    buffer_load_dwordx4 v225, s[24:27], s12 offen offset:2048 nt lds
    v_exp_f32 v41, v41
    v_smfmac_f32_32x32x32_bf16 v[96:111], a[24:27], v[32:39], v224
    v_exp_f32 v42, v42
    v_exp_f32 v43, v43
    v_exp_f32 v44, v44
    v_smfmac_f32_16x16x64_bf16 v[216:219], a[32:35], v[32:39], v224
    s_waitcnt lgkmcnt(5)
    buffer_load_dwordx4 v225, s[24:27], s12 offen offset:3072 nt lds
    v_exp_f32 v45, v45
    v_exp_f32 v46, v46
    v_exp_f32 v47, v47
    v_mfma_f32_32x32x16_bf16 v[0:15], a[0:3], v[128:131], 4.0
    s_waitcnt lgkmcnt(4)
    v_exp_f32 v48, v48
    v_exp_f32 v49, v49
    v_exp_f32 v50, v50
    v_mfma_f32_32x32x16_bf16 v[0:15], a[4:7], v[132:135], v[0:15]
    v_exp_f32 v51, v51
    v_exp_f32 v52, v52
    v_exp_f32 v53, v53
    v_smfmac_f32_32x32x32_bf16 v[96:111], a[28:31], v[40:47], v224
    v_exp_f32 v54, v54
    v_exp_f32 v55, v55
    v_exp_f32 v56, v56
    v_smfmac_f32_16x16x64_bf16 v[216:219], a[32:35], v[40:47], v224
    ds_read_b128 a[8:11], v225 offset:34816
    v_exp_f32 v57, v57
    v_smfmac_f32_32x32x32_bf16 v[112:127], a[24:27], v[48:55], v224
    v_exp_f32 v58, v58
    v_exp_f32 v59, v59
    v_exp_f32 v60, v60
    v_smfmac_f32_16x16x64_bf16 v[220:223], a[32:35], v[48:55], v224
    ds_read_b128 a[12:15], v225 offset:35840
    v_exp_f32 v61, v61
    v_exp_f32 v62, v62
    v_exp_f32 v63, v63
    v_mfma_f32_32x32x16_bf16 v[16:31], a[0:3], v[136:139], 4.0
    v_exp_f32 v0, v0
    v_exp_f32 v1, v1
    v_exp_f32 v2, v2
    v_mfma_f32_32x32x16_bf16 v[16:31], a[4:7], v[140:143], v[16:31]
    v_exp_f32 v3, v3
    v_exp_f32 v4, v4
    v_exp_f32 v5, v5
    v_smfmac_f32_32x32x32_bf16 v[112:127], a[28:31], v[56:63], v224
    s_waitcnt vmcnt(4)
    v_exp_f32 v6, v6
    v_exp_f32 v7, v7
    v_exp_f32 v8, v8
    v_cmp_ne_u32 s[62:63], v239, v233
    v_smfmac_f32_16x16x64_bf16 v[220:223], a[32:35], v[56:63], v224
    s_waitcnt lgkmcnt(4)
    ds_read_b64_tr_b16 a[24:25], v226 offset:34816
    v_exp_f32 v9, v9
    v_smfmac_f32_32x32x32_bf16 v[64:79], a[16:19], v[0:7], v224
    s_cmp_eq_u32 s62, 15
    s_cbranch_scc0 L_spin1B
L_back1B:
    v_exp_f32 v10, v10
    v_exp_f32 v11, v11
    v_exp_f32 v12, v12
    v_smfmac_f32_16x16x64_bf16 v[208:211], a[32:35], v[0:7], v224
    ds_read_b64_tr_b16 a[26:27], v226 offset:35072
    v_exp_f32 v13, v13
    v_exp_f32 v14, v14
    v_exp_f32 v15, v15
    v_mfma_f32_32x32x16_bf16 v[32:47], a[0:3], v[144:147], 4.0
    v_exp_f32 v16, v16
    v_exp_f32 v17, v17
    v_exp_f32 v18, v18
    v_mfma_f32_32x32x16_bf16 v[32:47], a[4:7], v[148:151], v[32:47]
    s_waitcnt lgkmcnt(4)
    v_exp_f32 v19, v19
    v_exp_f32 v20, v20
    v_exp_f32 v21, v21
    v_smfmac_f32_32x32x32_bf16 v[64:79], a[20:23], v[8:15], v224
    v_exp_f32 v22, v22
    v_exp_f32 v23, v23
    v_exp_f32 v24, v24
    v_smfmac_f32_16x16x64_bf16 v[208:211], a[32:35], v[8:15], v224
    ds_read_b64_tr_b16 a[28:29], v226 offset:35840
    v_exp_f32 v25, v25
    v_smfmac_f32_32x32x32_bf16 v[80:95], a[16:19], v[16:23], v224
    s_mov_b32 m0, s44
    v_exp_f32 v26, v26
    v_exp_f32 v27, v27
    v_exp_f32 v28, v28
    v_smfmac_f32_16x16x64_bf16 v[212:215], a[32:35], v[16:23], v224
    ds_read_b64_tr_b16 a[30:31], v226 offset:36096
    v_exp_f32 v29, v29
    v_exp_f32 v30, v30
    v_exp_f32 v31, v31
    v_mfma_f32_32x32x16_bf16 v[48:63], a[0:3], v[152:155], 4.0
    buffer_load_dwordx4 v225, s[48:51], s46 offen offset:0 sc1 lds
    v_exp_f32 v32, v32
    v_exp_f32 v33, v33
    v_exp_f32 v34, v34
    v_mfma_f32_32x32x16_bf16 v[48:63], a[4:7], v[156:159], v[48:63]
    buffer_load_dwordx4 v225, s[48:51], s46 offen offset:1024 sc1 lds
    v_exp_f32 v35, v35
    v_exp_f32 v36, v36
    v_exp_f32 v37, v37
    v_smfmac_f32_32x32x32_bf16 v[80:95], a[20:23], v[24:31], v224
    v_exp_f32 v38, v38
    v_exp_f32 v39, v39
    v_exp_f32 v40, v40
    v_smfmac_f32_16x16x64_bf16 v[212:215], a[32:35], v[24:31], v224
    buffer_load_dwordx4 v225, s[48:51], s14 offen offset:2048 sc1 lds
    v_exp_f32 v41, v41
    v_smfmac_f32_32x32x32_bf16 v[96:111], a[16:19], v[32:39], v224
    v_exp_f32 v42, v42
    v_exp_f32 v43, v43
    v_exp_f32 v44, v44
    v_smfmac_f32_16x16x64_bf16 v[216:219], a[32:35], v[32:39], v224
    s_waitcnt lgkmcnt(5)
    buffer_load_dwordx4 v225, s[48:51], s14 offen offset:3072 sc1 lds
    v_exp_f32 v45, v45
    v_exp_f32 v46, v46
    v_exp_f32 v47, v47
    v_mfma_f32_32x32x16_bf16 v[0:15], a[8:11], v[128:131], 4.0
    s_waitcnt lgkmcnt(4)
    v_exp_f32 v48, v48
    v_exp_f32 v49, v49
    v_exp_f32 v50, v50
    v_mfma_f32_32x32x16_bf16 v[0:15], a[12:15], v[132:135], v[0:15]
    v_exp_f32 v51, v51
    v_exp_f32 v52, v52
    v_exp_f32 v53, v53
    v_smfmac_f32_32x32x32_bf16 v[96:111], a[20:23], v[40:47], v224
    s_add_u32 s45, s45, 2
    v_exp_f32 v54, v54
    v_exp_f32 v55, v55
    v_exp_f32 v56, v56
    v_smfmac_f32_16x16x64_bf16 v[216:219], a[32:35], v[40:47], v224
    ds_read_b128 a[0:3], v225 offset:36864
    v_exp_f32 v57, v57
    v_smfmac_f32_32x32x32_bf16 v[112:127], a[16:19], v[48:55], v224
    s_and_b32 s45, s45, 7
    v_exp_f32 v58, v58
    v_exp_f32 v59, v59
    v_exp_f32 v60, v60
    v_smfmac_f32_16x16x64_bf16 v[220:223], a[32:35], v[48:55], v224
    ds_read_b128 a[4:7], v225 offset:37888
    v_exp_f32 v61, v61
    v_exp_f32 v62, v62
    v_exp_f32 v63, v63
    v_mfma_f32_32x32x16_bf16 v[16:31], a[8:11], v[136:139], 4.0
    v_exp_f32 v0, v0
    v_exp_f32 v1, v1
    v_exp_f32 v2, v2
    v_mfma_f32_32x32x16_bf16 v[16:31], a[12:15], v[140:143], v[16:31]
    v_exp_f32 v3, v3
    v_exp_f32 v4, v4
    v_exp_f32 v5, v5
    v_smfmac_f32_32x32x32_bf16 v[112:127], a[20:23], v[56:63], v224
    s_mul_i32 s38, s45, 14336
    v_exp_f32 v6, v6
    v_exp_f32 v7, v7
    v_exp_f32 v8, v8
    v_smfmac_f32_16x16x64_bf16 v[220:223], a[32:35], v[56:63], v224
    s_waitcnt lgkmcnt(4)
    ds_read_b64_tr_b16 a[16:17], v226 offset:36864
    v_exp_f32 v9, v9
    v_smfmac_f32_32x32x32_bf16 v[64:79], a[24:27], v[0:7], v224
    s_add_u32 s38, s38, s56
    v_exp_f32 v10, v10
    v_exp_f32 v11, v11
    v_exp_f32 v12, v12
    v_smfmac_f32_16x16x64_bf16 v[208:211], a[32:35], v[0:7], v224
    ds_read_b64_tr_b16 a[18:19], v226 offset:37120
    v_exp_f32 v13, v13
    v_exp_f32 v14, v14
    v_exp_f32 v15, v15
    v_mfma_f32_32x32x16_bf16 v[32:47], a[8:11], v[144:147], 4.0
    v_exp_f32 v16, v16
    v_exp_f32 v17, v17
    v_exp_f32 v18, v18
    v_mfma_f32_32x32x16_bf16 v[32:47], a[12:15], v[148:151], v[32:47]
    s_waitcnt lgkmcnt(4)
    v_exp_f32 v19, v19
    v_exp_f32 v20, v20
    v_exp_f32 v21, v21
    v_smfmac_f32_32x32x32_bf16 v[64:79], a[28:31], v[8:15], v224
    s_lshl_b32 s46, s45, 14
    v_exp_f32 v22, v22
    v_exp_f32 v23, v23
    v_exp_f32 v24, v24
    v_smfmac_f32_16x16x64_bf16 v[208:211], a[32:35], v[8:15], v224
    ds_read_b64_tr_b16 a[20:21], v226 offset:37888
    v_exp_f32 v25, v25
    v_smfmac_f32_32x32x32_bf16 v[80:95], a[24:27], v[16:23], v224
    s_add_u32 s46, s46, s44
    v_exp_f32 v26, v26
    v_exp_f32 v27, v27
    v_exp_f32 v28, v28
    v_smfmac_f32_16x16x64_bf16 v[212:215], a[32:35], v[16:23], v224
    ds_read_b64_tr_b16 a[22:23], v226 offset:38144
    v_exp_f32 v29, v29
    v_exp_f32 v30, v30
    v_exp_f32 v31, v31
    v_mfma_f32_32x32x16_bf16 v[48:63], a[8:11], v[152:155], 4.0
    v_exp_f32 v32, v32
    v_exp_f32 v33, v33
    v_exp_f32 v34, v34
    v_mfma_f32_32x32x16_bf16 v[48:63], a[12:15], v[156:159], v[48:63]
    v_exp_f32 v35, v35
    v_exp_f32 v36, v36
    v_exp_f32 v37, v37
    v_smfmac_f32_32x32x32_bf16 v[80:95], a[28:31], v[24:31], v224
    s_add_u32 s12, s38, s41
    v_exp_f32 v38, v38
    v_exp_f32 v39, v39
    v_exp_f32 v40, v40
    v_smfmac_f32_16x16x64_bf16 v[212:215], a[32:35], v[24:31], v224
    v_exp_f32 v41, v41
    v_smfmac_f32_32x32x32_bf16 v[96:111], a[24:27], v[32:39], v224
    s_add_u32 s14, s46, s41
    v_exp_f32 v42, v42
    v_exp_f32 v43, v43
    v_exp_f32 v44, v44
    v_smfmac_f32_16x16x64_bf16 v[216:219], a[32:35], v[32:39], v224
    s_waitcnt lgkmcnt(5)
    v_exp_f32 v45, v45
    v_exp_f32 v46, v46
    v_exp_f32 v47, v47
    v_mfma_f32_32x32x16_bf16 v[0:15], a[0:3], v[128:131], 4.0
    s_waitcnt lgkmcnt(4)
    v_exp_f32 v48, v48
    v_exp_f32 v49, v49
    v_exp_f32 v50, v50
    v_mfma_f32_32x32x16_bf16 v[0:15], a[4:7], v[132:135], v[0:15]
    v_exp_f32 v51, v51
    v_exp_f32 v52, v52
    v_exp_f32 v53, v53
    v_smfmac_f32_32x32x32_bf16 v[96:111], a[28:31], v[40:47], v224
    v_exp_f32 v54, v54
    v_exp_f32 v55, v55
    v_exp_f32 v56, v56
    v_smfmac_f32_16x16x64_bf16 v[216:219], a[32:35], v[40:47], v224
    ds_read_b128 a[8:11], v225 offset:38912
    v_exp_f32 v57, v57
    v_smfmac_f32_32x32x32_bf16 v[112:127], a[24:27], v[48:55], v224
    v_exp_f32 v58, v58
    v_exp_f32 v59, v59
    v_exp_f32 v60, v60
    v_smfmac_f32_16x16x64_bf16 v[220:223], a[32:35], v[48:55], v224
    ds_read_b128 a[12:15], v225 offset:39936
    v_exp_f32 v61, v61
    v_exp_f32 v62, v62
    v_exp_f32 v63, v63
    v_mfma_f32_32x32x16_bf16 v[16:31], a[0:3], v[136:139], 4.0
    v_exp_f32 v0, v0
    v_exp_f32 v1, v1
    v_exp_f32 v2, v2
    v_mfma_f32_32x32x16_bf16 v[16:31], a[4:7], v[140:143], v[16:31]
    v_exp_f32 v3, v3
    v_exp_f32 v4, v4
    v_exp_f32 v5, v5
    v_smfmac_f32_32x32x32_bf16 v[112:127], a[28:31], v[56:63], v224
    v_exp_f32 v6, v6
    v_exp_f32 v7, v7
    v_exp_f32 v8, v8
    v_smfmac_f32_16x16x64_bf16 v[220:223], a[32:35], v[56:63], v224
    s_waitcnt lgkmcnt(4)
    ds_read_b64_tr_b16 a[24:25], v226 offset:38912
    v_exp_f32 v9, v9
    v_smfmac_f32_32x32x32_bf16 v[64:79], a[16:19], v[0:7], v224
    v_exp_f32 v10, v10
    v_exp_f32 v11, v11
    v_exp_f32 v12, v12
    v_smfmac_f32_16x16x64_bf16 v[208:211], a[32:35], v[0:7], v224
    ds_read_b64_tr_b16 a[26:27], v226 offset:39168
    v_exp_f32 v13, v13
    v_exp_f32 v14, v14
    v_exp_f32 v15, v15
    v_mfma_f32_32x32x16_bf16 v[32:47], a[0:3], v[144:147], 4.0
    v_exp_f32 v16, v16
    v_exp_f32 v17, v17
    v_exp_f32 v18, v18
    v_mfma_f32_32x32x16_bf16 v[32:47], a[4:7], v[148:151], v[32:47]
    s_waitcnt lgkmcnt(4)
    v_exp_f32 v19, v19
    v_exp_f32 v20, v20
    v_exp_f32 v21, v21
    v_smfmac_f32_32x32x32_bf16 v[64:79], a[20:23], v[8:15], v224
    v_exp_f32 v22, v22
    v_exp_f32 v23, v23
    v_exp_f32 v24, v24
    v_smfmac_f32_16x16x64_bf16 v[208:211], a[32:35], v[8:15], v224
    ds_read_b64_tr_b16 a[28:29], v226 offset:39936
    v_exp_f32 v25, v25
    v_smfmac_f32_32x32x32_bf16 v[80:95], a[16:19], v[16:23], v224
    v_exp_f32 v26, v26
    v_exp_f32 v27, v27
    v_exp_f32 v28, v28
    v_smfmac_f32_16x16x64_bf16 v[212:215], a[32:35], v[16:23], v224
    ds_read_b64_tr_b16 a[30:31], v226 offset:40192
    v_exp_f32 v29, v29
    v_exp_f32 v30, v30
    v_exp_f32 v31, v31
    v_mfma_f32_32x32x16_bf16 v[48:63], a[0:3], v[152:155], 4.0
    v_exp_f32 v32, v32
    v_exp_f32 v33, v33
    v_exp_f32 v34, v34
    v_mfma_f32_32x32x16_bf16 v[48:63], a[4:7], v[156:159], v[48:63]
    v_exp_f32 v35, v35
    v_exp_f32 v36, v36
    v_exp_f32 v37, v37
    v_smfmac_f32_32x32x32_bf16 v[80:95], a[20:23], v[24:31], v224
    v_exp_f32 v38, v38
    v_exp_f32 v39, v39
    v_exp_f32 v40, v40
    v_smfmac_f32_16x16x64_bf16 v[212:215], a[32:35], v[24:31], v224
    v_exp_f32 v41, v41
    v_smfmac_f32_32x32x32_bf16 v[96:111], a[16:19], v[32:39], v224
    v_exp_f32 v42, v42
    v_exp_f32 v43, v43
    v_exp_f32 v44, v44
    v_smfmac_f32_16x16x64_bf16 v[216:219], a[32:35], v[32:39], v224
    s_waitcnt lgkmcnt(5)
    v_exp_f32 v45, v45
    v_exp_f32 v46, v46
    v_exp_f32 v47, v47
    v_mfma_f32_32x32x16_bf16 v[0:15], a[8:11], v[128:131], 4.0
    s_waitcnt lgkmcnt(4)
    v_exp_f32 v48, v48
    v_exp_f32 v49, v49
    v_exp_f32 v50, v50
    v_mfma_f32_32x32x16_bf16 v[0:15], a[12:15], v[132:135], v[0:15]
    v_exp_f32 v51, v51
    v_exp_f32 v52, v52
    v_exp_f32 v53, v53
    v_smfmac_f32_32x32x32_bf16 v[96:111], a[20:23], v[40:47], v224
    v_exp_f32 v54, v54
    v_exp_f32 v55, v55
    v_exp_f32 v56, v56
    v_smfmac_f32_16x16x64_bf16 v[216:219], a[32:35], v[40:47], v224
    ds_read_b128 a[0:3], v225 offset:40960
    v_exp_f32 v57, v57
    v_smfmac_f32_32x32x32_bf16 v[112:127], a[16:19], v[48:55], v224
    v_exp_f32 v58, v58
    v_exp_f32 v59, v59
    v_exp_f32 v60, v60
    v_smfmac_f32_16x16x64_bf16 v[220:223], a[32:35], v[48:55], v224
    ds_read_b128 a[4:7], v225 offset:41984
    v_exp_f32 v61, v61
    v_exp_f32 v62, v62
    v_exp_f32 v63, v63
    v_mfma_f32_32x32x16_bf16 v[16:31], a[8:11], v[136:139], 4.0
    v_exp_f32 v0, v0
    v_exp_f32 v1, v1
    v_exp_f32 v2, v2
    v_mfma_f32_32x32x16_bf16 v[16:31], a[12:15], v[140:143], v[16:31]
    v_exp_f32 v3, v3
    v_exp_f32 v4, v4
    v_exp_f32 v5, v5
    v_smfmac_f32_32x32x32_bf16 v[112:127], a[20:23], v[56:63], v224
    v_exp_f32 v6, v6
    v_exp_f32 v7, v7
    v_exp_f32 v8, v8
    v_smfmac_f32_16x16x64_bf16 v[220:223], a[32:35], v[56:63], v224
    s_waitcnt lgkmcnt(4)
    ds_read_b64_tr_b16 a[16:17], v226 offset:40960
    v_exp_f32 v9, v9
    v_smfmac_f32_32x32x32_bf16 v[64:79], a[24:27], v[0:7], v224
    v_exp_f32 v10, v10
    v_exp_f32 v11, v11
    v_exp_f32 v12, v12
    v_smfmac_f32_16x16x64_bf16 v[208:211], a[32:35], v[0:7], v224
    ds_read_b64_tr_b16 a[18:19], v226 offset:41216
    v_exp_f32 v13, v13
    v_exp_f32 v14, v14
    v_exp_f32 v15, v15
    v_mfma_f32_32x32x16_bf16 v[32:47], a[8:11], v[144:147], 4.0
    v_exp_f32 v16, v16
    v_exp_f32 v17, v17
    v_exp_f32 v18, v18
    v_mfma_f32_32x32x16_bf16 v[32:47], a[12:15], v[148:151], v[32:47]
    s_waitcnt lgkmcnt(4)
    v_exp_f32 v19, v19
    v_exp_f32 v20, v20
    v_exp_f32 v21, v21
    v_smfmac_f32_32x32x32_bf16 v[64:79], a[28:31], v[8:15], v224
    v_exp_f32 v22, v22
    v_exp_f32 v23, v23
    v_exp_f32 v24, v24
    v_smfmac_f32_16x16x64_bf16 v[208:211], a[32:35], v[8:15], v224
    ds_read_b64_tr_b16 a[20:21], v226 offset:41984
    v_exp_f32 v25, v25
    v_smfmac_f32_32x32x32_bf16 v[80:95], a[24:27], v[16:23], v224
    v_exp_f32 v26, v26
    v_exp_f32 v27, v27
    v_exp_f32 v28, v28
    v_smfmac_f32_16x16x64_bf16 v[212:215], a[32:35], v[16:23], v224
L_pad6B:
    s_cbranch_vccnz L_retB
    ds_read_b64_tr_b16 a[22:23], v226 offset:42240
    v_exp_f32 v29, v29
    v_exp_f32 v30, v30
    v_exp_f32 v31, v31
    v_mfma_f32_32x32x16_bf16 v[48:63], a[8:11], v[152:155], 4.0
    v_exp_f32 v32, v32
    v_exp_f32 v33, v33
    v_exp_f32 v34, v34
    v_mfma_f32_32x32x16_bf16 v[48:63], a[12:15], v[156:159], v[48:63]
    v_exp_f32 v35, v35
    v_exp_f32 v36, v36
    v_exp_f32 v37, v37
    v_smfmac_f32_32x32x32_bf16 v[80:95], a[28:31], v[24:31], v224
    v_exp_f32 v38, v38
    v_exp_f32 v39, v39
    v_exp_f32 v40, v40
    v_smfmac_f32_16x16x64_bf16 v[212:215], a[32:35], v[24:31], v224
    v_exp_f32 v41, v41
    v_smfmac_f32_32x32x32_bf16 v[96:111], a[24:27], v[32:39], v224
    v_exp_f32 v42, v42
    v_exp_f32 v43, v43
    v_exp_f32 v44, v44
    v_smfmac_f32_16x16x64_bf16 v[216:219], a[32:35], v[32:39], v224
    s_waitcnt lgkmcnt(5)
    v_exp_f32 v45, v45
    v_exp_f32 v46, v46
    v_exp_f32 v47, v47
    v_mfma_f32_32x32x16_bf16 v[0:15], a[0:3], v[128:131], 4.0
    s_waitcnt lgkmcnt(4)
    v_exp_f32 v48, v48
    v_exp_f32 v49, v49
    v_exp_f32 v50, v50
    v_mfma_f32_32x32x16_bf16 v[0:15], a[4:7], v[132:135], v[0:15]
    v_exp_f32 v51, v51
    v_exp_f32 v52, v52
    v_exp_f32 v53, v53
    v_smfmac_f32_32x32x32_bf16 v[96:111], a[28:31], v[40:47], v224
    v_exp_f32 v54, v54
    v_exp_f32 v55, v55
    v_exp_f32 v56, v56
    v_smfmac_f32_16x16x64_bf16 v[216:219], a[32:35], v[40:47], v224
    ds_read_b128 a[8:11], v225 offset:43008
    v_exp_f32 v57, v57
    v_smfmac_f32_32x32x32_bf16 v[112:127], a[24:27], v[48:55], v224
    v_exp_f32 v58, v58
    v_exp_f32 v59, v59
    v_exp_f32 v60, v60
    v_smfmac_f32_16x16x64_bf16 v[220:223], a[32:35], v[48:55], v224
    ds_read_b128 a[12:15], v225 offset:44032
    v_exp_f32 v61, v61
    v_exp_f32 v62, v62
    v_exp_f32 v63, v63
    v_mfma_f32_32x32x16_bf16 v[16:31], a[0:3], v[136:139], 4.0
    v_exp_f32 v0, v0
    v_exp_f32 v1, v1
    v_exp_f32 v2, v2
    v_mfma_f32_32x32x16_bf16 v[16:31], a[4:7], v[140:143], v[16:31]
    v_exp_f32 v3, v3
    v_exp_f32 v4, v4
    v_exp_f32 v5, v5
    v_smfmac_f32_32x32x32_bf16 v[112:127], a[28:31], v[56:63], v224
    v_exp_f32 v6, v6
    v_exp_f32 v7, v7
    v_exp_f32 v8, v8
    v_smfmac_f32_16x16x64_bf16 v[220:223], a[32:35], v[56:63], v224
    s_waitcnt lgkmcnt(4)
    ds_read_b64_tr_b16 a[24:25], v226 offset:43008
    v_exp_f32 v9, v9
    v_smfmac_f32_32x32x32_bf16 v[64:79], a[16:19], v[0:7], v224
    v_exp_f32 v10, v10
    v_exp_f32 v11, v11
    v_exp_f32 v12, v12
    v_smfmac_f32_16x16x64_bf16 v[208:211], a[32:35], v[0:7], v224
    ds_read_b64_tr_b16 a[26:27], v226 offset:43264
    v_exp_f32 v13, v13
    v_exp_f32 v14, v14
    v_exp_f32 v15, v15
    v_mfma_f32_32x32x16_bf16 v[32:47], a[0:3], v[144:147], 4.0
    v_exp_f32 v16, v16
    v_exp_f32 v17, v17
    v_exp_f32 v18, v18
    v_mfma_f32_32x32x16_bf16 v[32:47], a[4:7], v[148:151], v[32:47]
    s_waitcnt lgkmcnt(4)
    v_exp_f32 v19, v19
    v_exp_f32 v20, v20
    v_exp_f32 v21, v21
    v_smfmac_f32_32x32x32_bf16 v[64:79], a[20:23], v[8:15], v224
    v_exp_f32 v22, v22
    v_exp_f32 v23, v23
    v_exp_f32 v24, v24
    v_smfmac_f32_16x16x64_bf16 v[208:211], a[32:35], v[8:15], v224
    ds_read_b64_tr_b16 a[28:29], v226 offset:44032
    v_exp_f32 v25, v25
    v_smfmac_f32_32x32x32_bf16 v[80:95], a[16:19], v[16:23], v224
    v_exp_f32 v26, v26
    v_exp_f32 v27, v27
    v_exp_f32 v28, v28
    v_smfmac_f32_16x16x64_bf16 v[212:215], a[32:35], v[16:23], v224
    ds_read_b64_tr_b16 a[30:31], v226 offset:44288
    v_exp_f32 v29, v29
    v_exp_f32 v30, v30
    v_exp_f32 v31, v31
    v_mfma_f32_32x32x16_bf16 v[48:63], a[0:3], v[152:155], 4.0
    v_exp_f32 v32, v32
    v_exp_f32 v33, v33
    v_exp_f32 v34, v34
    v_mfma_f32_32x32x16_bf16 v[48:63], a[4:7], v[156:159], v[48:63]
    v_exp_f32 v35, v35
    v_exp_f32 v36, v36
    v_exp_f32 v37, v37
    v_smfmac_f32_32x32x32_bf16 v[80:95], a[20:23], v[24:31], v224
    v_exp_f32 v38, v38
    v_exp_f32 v39, v39
    v_exp_f32 v40, v40
    v_smfmac_f32_16x16x64_bf16 v[212:215], a[32:35], v[24:31], v224
    v_exp_f32 v41, v41
    v_smfmac_f32_32x32x32_bf16 v[96:111], a[16:19], v[32:39], v224
    v_exp_f32 v42, v42
    v_exp_f32 v43, v43
    v_exp_f32 v44, v44
    v_smfmac_f32_16x16x64_bf16 v[216:219], a[32:35], v[32:39], v224
    s_waitcnt lgkmcnt(5)
    v_exp_f32 v45, v45
    v_exp_f32 v46, v46
    v_exp_f32 v47, v47
    v_mfma_f32_32x32x16_bf16 v[0:15], a[8:11], v[128:131], 4.0
    s_waitcnt lgkmcnt(4)
    v_exp_f32 v48, v48
    v_exp_f32 v49, v49
    v_exp_f32 v50, v50
    v_mfma_f32_32x32x16_bf16 v[0:15], a[12:15], v[132:135], v[0:15]
    v_exp_f32 v51, v51
    v_exp_f32 v52, v52
    v_exp_f32 v53, v53
    v_smfmac_f32_32x32x32_bf16 v[96:111], a[20:23], v[40:47], v224
    v_exp_f32 v54, v54
    v_exp_f32 v55, v55
    v_exp_f32 v56, v56
    v_smfmac_f32_16x16x64_bf16 v[216:219], a[32:35], v[40:47], v224
    ds_read_b128 a[0:3], v225 offset:45056
    v_exp_f32 v57, v57
    v_smfmac_f32_32x32x32_bf16 v[112:127], a[16:19], v[48:55], v224
    v_exp_f32 v58, v58
    v_exp_f32 v59, v59
    v_exp_f32 v60, v60
    v_smfmac_f32_16x16x64_bf16 v[220:223], a[32:35], v[48:55], v224
    ds_read_b128 a[4:7], v225 offset:46080
    v_exp_f32 v61, v61
    v_exp_f32 v62, v62
    v_exp_f32 v63, v63
    v_mfma_f32_32x32x16_bf16 v[16:31], a[8:11], v[136:139], 4.0
    v_exp_f32 v0, v0
    v_exp_f32 v1, v1
    v_exp_f32 v2, v2
    v_mfma_f32_32x32x16_bf16 v[16:31], a[12:15], v[140:143], v[16:31]
    v_exp_f32 v3, v3
    v_exp_f32 v4, v4
    v_exp_f32 v5, v5
    v_smfmac_f32_32x32x32_bf16 v[112:127], a[20:23], v[56:63], v224
    v_exp_f32 v6, v6
    v_exp_f32 v7, v7
    v_exp_f32 v8, v8
    v_smfmac_f32_16x16x64_bf16 v[220:223], a[32:35], v[56:63], v224
    s_waitcnt lgkmcnt(4)
    ds_read_b64_tr_b16 a[16:17], v226 offset:45056
    v_exp_f32 v9, v9
    v_smfmac_f32_32x32x32_bf16 v[64:79], a[24:27], v[0:7], v224
    v_exp_f32 v10, v10
    v_exp_f32 v11, v11
    v_exp_f32 v12, v12
    v_smfmac_f32_16x16x64_bf16 v[208:211], a[32:35], v[0:7], v224
    ds_read_b64_tr_b16 a[18:19], v226 offset:45312
    v_exp_f32 v13, v13
    v_exp_f32 v14, v14
    v_exp_f32 v15, v15
    v_mfma_f32_32x32x16_bf16 v[32:47], a[8:11], v[144:147], 4.0
    v_exp_f32 v16, v16
    v_exp_f32 v17, v17
    v_exp_f32 v18, v18
    v_mfma_f32_32x32x16_bf16 v[32:47], a[12:15], v[148:151], v[32:47]
    s_waitcnt lgkmcnt(4)
    v_exp_f32 v19, v19
    v_exp_f32 v20, v20
    v_exp_f32 v21, v21
    v_smfmac_f32_32x32x32_bf16 v[64:79], a[28:31], v[8:15], v224
    v_exp_f32 v22, v22
    v_exp_f32 v23, v23
    v_exp_f32 v24, v24
    v_smfmac_f32_16x16x64_bf16 v[208:211], a[32:35], v[8:15], v224
    ds_read_b64_tr_b16 a[20:21], v226 offset:46080
    v_exp_f32 v25, v25
    v_smfmac_f32_32x32x32_bf16 v[80:95], a[24:27], v[16:23], v224
    v_exp_f32 v26, v26
    v_exp_f32 v27, v27
    v_exp_f32 v28, v28
    v_smfmac_f32_16x16x64_bf16 v[212:215], a[32:35], v[16:23], v224
    ds_read_b64_tr_b16 a[22:23], v226 offset:46336
    v_exp_f32 v29, v29
    v_exp_f32 v30, v30
    v_exp_f32 v31, v31
    v_mfma_f32_32x32x16_bf16 v[48:63], a[8:11], v[152:155], 4.0
    v_exp_f32 v32, v32
    v_exp_f32 v33, v33
    v_exp_f32 v34, v34
    v_mfma_f32_32x32x16_bf16 v[48:63], a[12:15], v[156:159], v[48:63]
    v_exp_f32 v35, v35
    v_exp_f32 v36, v36
    v_exp_f32 v37, v37
    v_smfmac_f32_32x32x32_bf16 v[80:95], a[28:31], v[24:31], v224
    v_exp_f32 v38, v38
    v_exp_f32 v39, v39
    v_exp_f32 v40, v40
    v_smfmac_f32_16x16x64_bf16 v[212:215], a[32:35], v[24:31], v224
    v_exp_f32 v41, v41
    v_smfmac_f32_32x32x32_bf16 v[96:111], a[24:27], v[32:39], v224
    v_exp_f32 v42, v42
    v_exp_f32 v43, v43
    v_exp_f32 v44, v44
    v_smfmac_f32_16x16x64_bf16 v[216:219], a[32:35], v[32:39], v224
    s_waitcnt lgkmcnt(5)
    v_exp_f32 v45, v45
    v_exp_f32 v46, v46
    v_exp_f32 v47, v47
    v_mfma_f32_32x32x16_bf16 v[0:15], a[0:3], v[128:131], 4.0
    s_waitcnt lgkmcnt(4)
    v_exp_f32 v48, v48
    v_exp_f32 v49, v49
    v_exp_f32 v50, v50
    v_mfma_f32_32x32x16_bf16 v[0:15], a[4:7], v[132:135], v[0:15]
    s_waitcnt vmcnt(0) lgkmcnt(0)
    v_exp_f32 v51, v51
    v_exp_f32 v52, v52
    v_exp_f32 v53, v53
    v_smfmac_f32_32x32x32_bf16 v[96:111], a[28:31], v[40:47], v224
    s_barrier
    v_exp_f32 v54, v54
    v_exp_f32 v55, v55
    v_exp_f32 v56, v56
    v_smfmac_f32_16x16x64_bf16 v[216:219], a[32:35], v[40:47], v224
    ds_read_b128 a[8:11], v225 offset:0
    v_exp_f32 v57, v57
    v_smfmac_f32_32x32x32_bf16 v[112:127], a[24:27], v[48:55], v224
    s_mov_b32 m0, s57
    v_exp_f32 v58, v58
    v_exp_f32 v59, v59
    v_exp_f32 v60, v60
    v_smfmac_f32_16x16x64_bf16 v[220:223], a[32:35], v[48:55], v224
    ds_read_b128 a[12:15], v225 offset:1024
    v_exp_f32 v61, v61
    v_exp_f32 v62, v62
    v_exp_f32 v63, v63
    v_mfma_f32_32x32x16_bf16 v[16:31], a[0:3], v[136:139], 4.0
    buffer_load_dwordx4 v225, s[24:27], s38 offen offset:0 nt lds
    v_exp_f32 v0, v0
    v_exp_f32 v1, v1
    v_exp_f32 v2, v2
    v_mfma_f32_32x32x16_bf16 v[16:31], a[4:7], v[140:143], v[16:31]
    buffer_load_dwordx4 v225, s[24:27], s38 offen offset:1024 nt lds
    v_exp_f32 v3, v3
    v_exp_f32 v4, v4
    v_exp_f32 v5, v5
    v_smfmac_f32_32x32x32_bf16 v[112:127], a[28:31], v[56:63], v224
    v_exp_f32 v6, v6
    v_exp_f32 v7, v7
    v_exp_f32 v8, v8
    v_smfmac_f32_16x16x64_bf16 v[220:223], a[32:35], v[56:63], v224
    ds_read_b64_tr_b16 a[24:25], v226 offset:0
    v_exp_f32 v9, v9
    v_smfmac_f32_32x32x32_bf16 v[64:79], a[16:19], v[0:7], v224
    v_exp_f32 v10, v10
    v_exp_f32 v11, v11
    v_exp_f32 v12, v12
    v_smfmac_f32_16x16x64_bf16 v[208:211], a[32:35], v[0:7], v224
    ds_read_b64_tr_b16 a[26:27], v226 offset:256
    v_exp_f32 v13, v13
    v_exp_f32 v14, v14
    v_exp_f32 v15, v15
    v_mfma_f32_32x32x16_bf16 v[32:47], a[0:3], v[144:147], 4.0
    buffer_load_dwordx4 v225, s[24:27], s12 offen offset:2048 nt lds
    v_exp_f32 v16, v16
    v_exp_f32 v17, v17
    v_exp_f32 v18, v18
    v_mfma_f32_32x32x16_bf16 v[32:47], a[4:7], v[148:151], v[32:47]
    buffer_load_dwordx4 v225, s[24:27], s12 offen offset:3072 nt lds
    v_exp_f32 v19, v19
    v_exp_f32 v20, v20
    v_exp_f32 v21, v21
    v_smfmac_f32_32x32x32_bf16 v[64:79], a[20:23], v[8:15], v224
    v_exp_f32 v22, v22
    v_exp_f32 v23, v23
    v_exp_f32 v24, v24
    v_smfmac_f32_16x16x64_bf16 v[208:211], a[32:35], v[8:15], v224
    ds_read_b64_tr_b16 a[28:29], v226 offset:1024
    v_exp_f32 v25, v25
    v_smfmac_f32_32x32x32_bf16 v[80:95], a[16:19], v[16:23], v224
    s_mov_b32 m0, s61
    v_exp_f32 v26, v26
    v_exp_f32 v27, v27
    v_exp_f32 v28, v28
    v_smfmac_f32_16x16x64_bf16 v[212:215], a[32:35], v[16:23], v224
    ds_read_b64_tr_b16 a[30:31], v226 offset:1280
    v_exp_f32 v29, v29
    v_exp_f32 v30, v30
    v_exp_f32 v31, v31
    v_mfma_f32_32x32x16_bf16 v[48:63], a[0:3], v[152:155], 4.0
    buffer_load_dwordx4 v225, s[48:51], s46 offen offset:0 sc1 lds
    v_exp_f32 v32, v32
    v_exp_f32 v33, v33
    v_exp_f32 v34, v34
    v_mfma_f32_32x32x16_bf16 v[48:63], a[4:7], v[156:159], v[48:63]
    buffer_load_dwordx4 v225, s[48:51], s46 offen offset:1024 sc1 lds
    v_exp_f32 v35, v35
    v_exp_f32 v36, v36
    v_exp_f32 v37, v37
    v_smfmac_f32_32x32x32_bf16 v[80:95], a[20:23], v[24:31], v224
    v_exp_f32 v38, v38
    v_exp_f32 v39, v39
    v_exp_f32 v40, v40
    v_smfmac_f32_16x16x64_bf16 v[212:215], a[32:35], v[24:31], v224
    ds_read_b32 v239, v235
    v_exp_f32 v41, v41
    v_smfmac_f32_32x32x32_bf16 v[96:111], a[16:19], v[32:39], v224
    v_exp_f32 v42, v42
    v_exp_f32 v43, v43
    v_exp_f32 v44, v44
    v_smfmac_f32_16x16x64_bf16 v[216:219], a[32:35], v[32:39], v224
    s_waitcnt lgkmcnt(6)
    v_exp_f32 v45, v45
    v_exp_f32 v46, v46
    v_exp_f32 v47, v47
    v_mfma_f32_32x32x16_bf16 v[0:15], a[8:11], v[128:131], 4.0
    s_waitcnt lgkmcnt(5)
    buffer_load_dwordx4 v225, s[48:51], s14 offen offset:2048 sc1 lds
    v_exp_f32 v48, v48
    v_exp_f32 v49, v49
    v_exp_f32 v50, v50
    v_mfma_f32_32x32x16_bf16 v[0:15], a[12:15], v[132:135], v[0:15]
    buffer_load_dwordx4 v225, s[48:51], s14 offen offset:3072 sc1 lds
    v_exp_f32 v51, v51
    v_exp_f32 v52, v52
    v_exp_f32 v53, v53
    v_smfmac_f32_32x32x32_bf16 v[96:111], a[20:23], v[40:47], v224
    s_waitcnt lgkmcnt(0)
    v_exp_f32 v54, v54
    v_exp_f32 v55, v55
    v_exp_f32 v56, v56
    v_readfirstlane_b32 s62, v239
    v_smfmac_f32_16x16x64_bf16 v[216:219], a[32:35], v[40:47], v224
    ds_read_b128 a[0:3], v225 offset:2048
    v_exp_f32 v57, v57
    v_smfmac_f32_32x32x32_bf16 v[112:127], a[16:19], v[48:55], v224
    s_cmp_lg_u32 s62, 0
    s_cbranch_scc1 L_slow
    v_exp_f32 v58, v58
    v_exp_f32 v59, v59
    v_exp_f32 v60, v60
    v_smfmac_f32_16x16x64_bf16 v[220:223], a[32:35], v[48:55], v224
    ds_read_b128 a[4:7], v225 offset:3072
    v_exp_f32 v61, v61
    v_exp_f32 v62, v62
    v_exp_f32 v63, v63
    v_mfma_f32_32x32x16_bf16 v[16:31], a[8:11], v[136:139], 4.0
    v_exp_f32 v0, v0
    v_exp_f32 v1, v1
    v_exp_f32 v2, v2
    v_mfma_f32_32x32x16_bf16 v[16:31], a[12:15], v[140:143], v[16:31]
    v_exp_f32 v3, v3
    v_exp_f32 v4, v4
    v_exp_f32 v5, v5
    v_smfmac_f32_32x32x32_bf16 v[112:127], a[20:23], v[56:63], v224
    s_add_u32 s45, s45, 2
    v_exp_f32 v6, v6
    v_exp_f32 v7, v7
    v_exp_f32 v8, v8
    v_smfmac_f32_16x16x64_bf16 v[220:223], a[32:35], v[56:63], v224
    ds_read_b64_tr_b16 a[16:17], v226 offset:2048
    v_exp_f32 v9, v9
    v_smfmac_f32_32x32x32_bf16 v[64:79], a[24:27], v[0:7], v224
    s_and_b32 s45, s45, 7
    v_exp_f32 v10, v10
    v_exp_f32 v11, v11
    v_exp_f32 v12, v12
    v_smfmac_f32_16x16x64_bf16 v[208:211], a[32:35], v[0:7], v224
    ds_read_b64_tr_b16 a[18:19], v226 offset:2304
    v_exp_f32 v13, v13
    v_exp_f32 v14, v14
    v_exp_f32 v15, v15
    v_mfma_f32_32x32x16_bf16 v[32:47], a[8:11], v[144:147], 4.0
    v_exp_f32 v16, v16
    v_exp_f32 v17, v17
    v_exp_f32 v18, v18
    v_mfma_f32_32x32x16_bf16 v[32:47], a[12:15], v[148:151], v[32:47]
    v_exp_f32 v19, v19
    v_exp_f32 v20, v20
    v_exp_f32 v21, v21
    v_smfmac_f32_32x32x32_bf16 v[64:79], a[28:31], v[8:15], v224
    s_mul_i32 s38, s45, 14336
    v_exp_f32 v22, v22
    v_exp_f32 v23, v23
    v_exp_f32 v24, v24
    v_smfmac_f32_16x16x64_bf16 v[208:211], a[32:35], v[8:15], v224
    ds_read_b64_tr_b16 a[20:21], v226 offset:3072
    v_exp_f32 v25, v25
    v_smfmac_f32_32x32x32_bf16 v[80:95], a[24:27], v[16:23], v224
    s_add_u32 s38, s38, s56
    v_exp_f32 v26, v26
    v_exp_f32 v27, v27
    v_exp_f32 v28, v28
    v_smfmac_f32_16x16x64_bf16 v[212:215], a[32:35], v[16:23], v224
    ds_read_b64_tr_b16 a[22:23], v226 offset:3328
    v_exp_f32 v29, v29
    v_exp_f32 v30, v30
    v_exp_f32 v31, v31
    v_mfma_f32_32x32x16_bf16 v[48:63], a[8:11], v[152:155], 4.0
    v_exp_f32 v32, v32
    v_exp_f32 v33, v33
    v_exp_f32 v34, v34
    v_mfma_f32_32x32x16_bf16 v[48:63], a[12:15], v[156:159], v[48:63]
    v_exp_f32 v35, v35
    v_exp_f32 v36, v36
    v_exp_f32 v37, v37
    v_smfmac_f32_32x32x32_bf16 v[80:95], a[28:31], v[24:31], v224
    s_lshl_b32 s46, s45, 14
    v_exp_f32 v38, v38
    v_exp_f32 v39, v39
    v_exp_f32 v40, v40
    v_smfmac_f32_16x16x64_bf16 v[212:215], a[32:35], v[24:31], v224
    v_exp_f32 v41, v41
    v_smfmac_f32_32x32x32_bf16 v[96:111], a[24:27], v[32:39], v224
    s_add_u32 s46, s46, s44
    v_exp_f32 v42, v42
    v_exp_f32 v43, v43
    v_exp_f32 v44, v44
    v_smfmac_f32_16x16x64_bf16 v[216:219], a[32:35], v[32:39], v224
    s_waitcnt lgkmcnt(5)
    v_exp_f32 v45, v45
    v_exp_f32 v46, v46
    v_exp_f32 v47, v47
    v_mfma_f32_32x32x16_bf16 v[0:15], a[0:3], v[128:131], 4.0
    s_waitcnt lgkmcnt(4)
    v_exp_f32 v48, v48
    v_exp_f32 v49, v49
    v_exp_f32 v50, v50
    v_mfma_f32_32x32x16_bf16 v[0:15], a[4:7], v[132:135], v[0:15]
    v_exp_f32 v51, v51
    v_exp_f32 v52, v52
    v_exp_f32 v53, v53
    v_smfmac_f32_32x32x32_bf16 v[96:111], a[28:31], v[40:47], v224
    s_add_u32 s12, s38, s41
    v_exp_f32 v54, v54
    v_exp_f32 v55, v55
    v_exp_f32 v56, v56
    v_smfmac_f32_16x16x64_bf16 v[216:219], a[32:35], v[40:47], v224
    ds_read_b128 a[8:11], v225 offset:4096
    v_exp_f32 v57, v57
    v_smfmac_f32_32x32x32_bf16 v[112:127], a[24:27], v[48:55], v224
    s_add_u32 s14, s46, s41
    v_exp_f32 v58, v58
    v_exp_f32 v59, v59
    v_exp_f32 v60, v60
    v_smfmac_f32_16x16x64_bf16 v[220:223], a[32:35], v[48:55], v224
    ds_read_b128 a[12:15], v225 offset:5120
    v_exp_f32 v61, v61
    v_exp_f32 v62, v62
    v_exp_f32 v63, v63
    v_mfma_f32_32x32x16_bf16 v[16:31], a[0:3], v[136:139], 4.0
    v_exp_f32 v0, v0
    v_exp_f32 v1, v1
    v_exp_f32 v2, v2
    v_mfma_f32_32x32x16_bf16 v[16:31], a[4:7], v[140:143], v[16:31]
    v_exp_f32 v3, v3
    v_exp_f32 v4, v4
    v_exp_f32 v5, v5
    v_smfmac_f32_32x32x32_bf16 v[112:127], a[28:31], v[56:63], v224
    v_exp_f32 v6, v6
    v_exp_f32 v7, v7
    v_exp_f32 v8, v8
    v_smfmac_f32_16x16x64_bf16 v[220:223], a[32:35], v[56:63], v224
    s_waitcnt lgkmcnt(4)
    ds_read_b64_tr_b16 a[24:25], v226 offset:4096
    v_exp_f32 v9, v9
    v_smfmac_f32_32x32x32_bf16 v[64:79], a[16:19], v[0:7], v224
    v_exp_f32 v10, v10
    v_exp_f32 v11, v11
    v_exp_f32 v12, v12
    v_smfmac_f32_16x16x64_bf16 v[208:211], a[32:35], v[0:7], v224
    ds_read_b64_tr_b16 a[26:27], v226 offset:4352
    v_exp_f32 v13, v13
    v_exp_f32 v14, v14
    v_exp_f32 v15, v15
    v_mfma_f32_32x32x16_bf16 v[32:47], a[0:3], v[144:147], 4.0
    v_exp_f32 v16, v16
    v_exp_f32 v17, v17
    v_exp_f32 v18, v18
    v_mfma_f32_32x32x16_bf16 v[32:47], a[4:7], v[148:151], v[32:47]
    s_waitcnt lgkmcnt(4)
    v_exp_f32 v19, v19
    v_exp_f32 v20, v20
    v_exp_f32 v21, v21
    v_smfmac_f32_32x32x32_bf16 v[64:79], a[20:23], v[8:15], v224
    v_exp_f32 v22, v22
    v_exp_f32 v23, v23
    v_exp_f32 v24, v24
    v_smfmac_f32_16x16x64_bf16 v[208:211], a[32:35], v[8:15], v224
    ds_read_b64_tr_b16 a[28:29], v226 offset:5120
    v_exp_f32 v25, v25
    v_smfmac_f32_32x32x32_bf16 v[80:95], a[16:19], v[16:23], v224
    v_exp_f32 v26, v26
    v_exp_f32 v27, v27
    v_exp_f32 v28, v28
    v_smfmac_f32_16x16x64_bf16 v[212:215], a[32:35], v[16:23], v224
    ds_read_b64_tr_b16 a[30:31], v226 offset:5376
    v_exp_f32 v29, v29
    v_exp_f32 v30, v30
    v_exp_f32 v31, v31
    v_mfma_f32_32x32x16_bf16 v[48:63], a[0:3], v[152:155], 4.0
    v_exp_f32 v32, v32
    v_exp_f32 v33, v33
    v_exp_f32 v34, v34
    v_mfma_f32_32x32x16_bf16 v[48:63], a[4:7], v[156:159], v[48:63]
    v_exp_f32 v35, v35
    v_exp_f32 v36, v36
    v_exp_f32 v37, v37
    v_smfmac_f32_32x32x32_bf16 v[80:95], a[20:23], v[24:31], v224
    v_exp_f32 v38, v38
    v_exp_f32 v39, v39
    v_exp_f32 v40, v40
    v_smfmac_f32_16x16x64_bf16 v[212:215], a[32:35], v[24:31], v224
    v_exp_f32 v41, v41
    v_smfmac_f32_32x32x32_bf16 v[96:111], a[16:19], v[32:39], v224
    v_exp_f32 v42, v42
    v_exp_f32 v43, v43
    v_exp_f32 v44, v44
    v_smfmac_f32_16x16x64_bf16 v[216:219], a[32:35], v[32:39], v224
    s_waitcnt lgkmcnt(5)
    v_exp_f32 v45, v45
    v_exp_f32 v46, v46
    v_exp_f32 v47, v47
    v_mfma_f32_32x32x16_bf16 v[0:15], a[8:11], v[128:131], 4.0
    s_waitcnt lgkmcnt(4)
    v_exp_f32 v48, v48
    v_exp_f32 v49, v49
    v_exp_f32 v50, v50
    v_mfma_f32_32x32x16_bf16 v[0:15], a[12:15], v[132:135], v[0:15]
    v_exp_f32 v51, v51
    v_exp_f32 v52, v52
    v_exp_f32 v53, v53
    v_smfmac_f32_32x32x32_bf16 v[96:111], a[20:23], v[40:47], v224
    v_exp_f32 v54, v54
    v_exp_f32 v55, v55
    v_exp_f32 v56, v56
    v_smfmac_f32_16x16x64_bf16 v[216:219], a[32:35], v[40:47], v224
    ds_read_b128 a[0:3], v225 offset:6144
    v_exp_f32 v57, v57
    v_smfmac_f32_32x32x32_bf16 v[112:127], a[16:19], v[48:55], v224
    v_exp_f32 v58, v58
    v_exp_f32 v59, v59
    v_exp_f32 v60, v60
    v_smfmac_f32_16x16x64_bf16 v[220:223], a[32:35], v[48:55], v224
    ds_read_b128 a[4:7], v225 offset:7168
    v_exp_f32 v61, v61
    v_exp_f32 v62, v62
    v_exp_f32 v63, v63
    v_mfma_f32_32x32x16_bf16 v[16:31], a[8:11], v[136:139], 4.0
    v_exp_f32 v0, v0
    v_exp_f32 v1, v1
    v_exp_f32 v2, v2
    v_mfma_f32_32x32x16_bf16 v[16:31], a[12:15], v[140:143], v[16:31]
    v_exp_f32 v3, v3
    v_exp_f32 v4, v4
    v_exp_f32 v5, v5
    v_smfmac_f32_32x32x32_bf16 v[112:127], a[20:23], v[56:63], v224
    v_exp_f32 v6, v6
    v_exp_f32 v7, v7
    v_exp_f32 v8, v8
    v_smfmac_f32_16x16x64_bf16 v[220:223], a[32:35], v[56:63], v224
    s_waitcnt lgkmcnt(4)
    ds_read_b64_tr_b16 a[16:17], v226 offset:6144
    v_exp_f32 v9, v9
    v_smfmac_f32_32x32x32_bf16 v[64:79], a[24:27], v[0:7], v224
    v_exp_f32 v10, v10
    v_exp_f32 v11, v11
    v_exp_f32 v12, v12
    v_smfmac_f32_16x16x64_bf16 v[208:211], a[32:35], v[0:7], v224
    ds_read_b64_tr_b16 a[18:19], v226 offset:6400
    v_exp_f32 v13, v13
    v_exp_f32 v14, v14
    v_exp_f32 v15, v15
    v_mfma_f32_32x32x16_bf16 v[32:47], a[8:11], v[144:147], 4.0
    v_exp_f32 v16, v16
    v_exp_f32 v17, v17
    v_exp_f32 v18, v18
    v_mfma_f32_32x32x16_bf16 v[32:47], a[12:15], v[148:151], v[32:47]
    s_waitcnt lgkmcnt(4)
    v_exp_f32 v19, v19
    v_exp_f32 v20, v20
    v_exp_f32 v21, v21
    v_smfmac_f32_32x32x32_bf16 v[64:79], a[28:31], v[8:15], v224
    v_exp_f32 v22, v22
    v_exp_f32 v23, v23
    v_exp_f32 v24, v24
    v_smfmac_f32_16x16x64_bf16 v[208:211], a[32:35], v[8:15], v224
    ds_read_b64_tr_b16 a[20:21], v226 offset:7168
    v_exp_f32 v25, v25
    v_smfmac_f32_32x32x32_bf16 v[80:95], a[24:27], v[16:23], v224
    v_exp_f32 v26, v26
    v_exp_f32 v27, v27
    v_exp_f32 v28, v28
    v_smfmac_f32_16x16x64_bf16 v[212:215], a[32:35], v[16:23], v224
    ds_read_b64_tr_b16 a[22:23], v226 offset:7424
    v_exp_f32 v29, v29
    v_exp_f32 v30, v30
    v_exp_f32 v31, v31
    v_mfma_f32_32x32x16_bf16 v[48:63], a[8:11], v[152:155], 4.0
    v_exp_f32 v32, v32
    v_exp_f32 v33, v33
    v_exp_f32 v34, v34
    v_mfma_f32_32x32x16_bf16 v[48:63], a[12:15], v[156:159], v[48:63]
    v_exp_f32 v35, v35
    v_exp_f32 v36, v36
    v_exp_f32 v37, v37
    v_smfmac_f32_32x32x32_bf16 v[80:95], a[28:31], v[24:31], v224
    v_exp_f32 v38, v38
    v_exp_f32 v39, v39
    v_exp_f32 v40, v40
    v_smfmac_f32_16x16x64_bf16 v[212:215], a[32:35], v[24:31], v224
    v_exp_f32 v41, v41
    v_smfmac_f32_32x32x32_bf16 v[96:111], a[24:27], v[32:39], v224
    v_exp_f32 v42, v42
    v_exp_f32 v43, v43
    v_exp_f32 v44, v44
    v_smfmac_f32_16x16x64_bf16 v[216:219], a[32:35], v[32:39], v224
    s_waitcnt lgkmcnt(5)
    v_exp_f32 v45, v45
    v_exp_f32 v46, v46
    v_exp_f32 v47, v47
    v_mfma_f32_32x32x16_bf16 v[0:15], a[0:3], v[128:131], 4.0
    s_waitcnt lgkmcnt(4)
    v_exp_f32 v48, v48
    v_exp_f32 v49, v49
    v_exp_f32 v50, v50
    v_mfma_f32_32x32x16_bf16 v[0:15], a[4:7], v[132:135], v[0:15]
    v_exp_f32 v51, v51
    v_exp_f32 v52, v52
    v_exp_f32 v53, v53
    v_smfmac_f32_32x32x32_bf16 v[96:111], a[28:31], v[40:47], v224
    v_exp_f32 v54, v54
    v_exp_f32 v55, v55
    v_exp_f32 v56, v56
    v_smfmac_f32_16x16x64_bf16 v[216:219], a[32:35], v[40:47], v224
    ds_read_b128 a[8:11], v225 offset:8192
    v_exp_f32 v57, v57
    v_smfmac_f32_32x32x32_bf16 v[112:127], a[24:27], v[48:55], v224
    v_exp_f32 v58, v58
    v_exp_f32 v59, v59
    v_exp_f32 v60, v60
    v_smfmac_f32_16x16x64_bf16 v[220:223], a[32:35], v[48:55], v224
    ds_read_b128 a[12:15], v225 offset:9216
    v_exp_f32 v61, v61
    v_exp_f32 v62, v62
    v_exp_f32 v63, v63
    v_mfma_f32_32x32x16_bf16 v[16:31], a[0:3], v[136:139], 4.0
    v_exp_f32 v0, v0
    v_exp_f32 v1, v1
    v_exp_f32 v2, v2
    v_mfma_f32_32x32x16_bf16 v[16:31], a[4:7], v[140:143], v[16:31]
    v_exp_f32 v3, v3
    v_exp_f32 v4, v4
    v_exp_f32 v5, v5
    v_smfmac_f32_32x32x32_bf16 v[112:127], a[28:31], v[56:63], v224
    v_exp_f32 v6, v6
    v_exp_f32 v7, v7
    v_exp_f32 v8, v8
    v_smfmac_f32_16x16x64_bf16 v[220:223], a[32:35], v[56:63], v224
    s_waitcnt lgkmcnt(4)
    ds_read_b64_tr_b16 a[24:25], v226 offset:8192
    v_exp_f32 v9, v9
    v_smfmac_f32_32x32x32_bf16 v[64:79], a[16:19], v[0:7], v224
    v_exp_f32 v10, v10
    v_exp_f32 v11, v11
    v_exp_f32 v12, v12
    v_smfmac_f32_16x16x64_bf16 v[208:211], a[32:35], v[0:7], v224
    ds_read_b64_tr_b16 a[26:27], v226 offset:8448
    v_exp_f32 v13, v13
    v_exp_f32 v14, v14
    v_exp_f32 v15, v15
    v_mfma_f32_32x32x16_bf16 v[32:47], a[0:3], v[144:147], 4.0
    v_exp_f32 v16, v16
    v_exp_f32 v17, v17
    v_exp_f32 v18, v18
    v_mfma_f32_32x32x16_bf16 v[32:47], a[4:7], v[148:151], v[32:47]
    s_waitcnt lgkmcnt(4)
    v_exp_f32 v19, v19
    v_exp_f32 v20, v20
    v_exp_f32 v21, v21
    v_smfmac_f32_32x32x32_bf16 v[64:79], a[20:23], v[8:15], v224
    v_exp_f32 v22, v22
    v_exp_f32 v23, v23
    v_exp_f32 v24, v24
    v_smfmac_f32_16x16x64_bf16 v[208:211], a[32:35], v[8:15], v224
    ds_read_b64_tr_b16 a[28:29], v226 offset:9216
    v_exp_f32 v25, v25
    v_smfmac_f32_32x32x32_bf16 v[80:95], a[16:19], v[16:23], v224
    v_exp_f32 v26, v26
    v_exp_f32 v27, v27
    v_exp_f32 v28, v28
    v_smfmac_f32_16x16x64_bf16 v[212:215], a[32:35], v[16:23], v224
    ds_read_b64_tr_b16 a[30:31], v226 offset:9472
    v_exp_f32 v29, v29
    v_exp_f32 v30, v30
    v_exp_f32 v31, v31
    v_mfma_f32_32x32x16_bf16 v[48:63], a[0:3], v[152:155], 4.0
    v_exp_f32 v32, v32
    v_exp_f32 v33, v33
    v_exp_f32 v34, v34
    v_mfma_f32_32x32x16_bf16 v[48:63], a[4:7], v[156:159], v[48:63]
    v_exp_f32 v35, v35
    v_exp_f32 v36, v36
    v_exp_f32 v37, v37
    v_smfmac_f32_32x32x32_bf16 v[80:95], a[20:23], v[24:31], v224
    v_exp_f32 v38, v38
    v_exp_f32 v39, v39
    v_exp_f32 v40, v40
    v_smfmac_f32_16x16x64_bf16 v[212:215], a[32:35], v[24:31], v224
    v_exp_f32 v41, v41
    v_smfmac_f32_32x32x32_bf16 v[96:111], a[16:19], v[32:39], v224
    v_exp_f32 v42, v42
    v_exp_f32 v43, v43
    v_exp_f32 v44, v44
    v_smfmac_f32_16x16x64_bf16 v[216:219], a[32:35], v[32:39], v224
    s_waitcnt lgkmcnt(5)
    v_exp_f32 v45, v45
    v_exp_f32 v46, v46
    v_exp_f32 v47, v47
    v_mfma_f32_32x32x16_bf16 v[0:15], a[8:11], v[128:131], 4.0
    s_waitcnt lgkmcnt(4)
    v_exp_f32 v48, v48
    v_exp_f32 v49, v49
    v_exp_f32 v50, v50
    v_mfma_f32_32x32x16_bf16 v[0:15], a[12:15], v[132:135], v[0:15]
    v_exp_f32 v51, v51
    v_exp_f32 v52, v52
    v_exp_f32 v53, v53
    v_smfmac_f32_32x32x32_bf16 v[96:111], a[20:23], v[40:47], v224
    v_exp_f32 v54, v54
    v_exp_f32 v55, v55
    v_exp_f32 v56, v56
    v_smfmac_f32_16x16x64_bf16 v[216:219], a[32:35], v[40:47], v224
    ds_read_b128 a[0:3], v225 offset:10240
    v_exp_f32 v57, v57
    v_smfmac_f32_32x32x32_bf16 v[112:127], a[16:19], v[48:55], v224
    v_exp_f32 v58, v58
    v_exp_f32 v59, v59
    v_exp_f32 v60, v60
    v_smfmac_f32_16x16x64_bf16 v[220:223], a[32:35], v[48:55], v224
    ds_read_b128 a[4:7], v225 offset:11264
    v_exp_f32 v61, v61
    v_exp_f32 v62, v62
    v_exp_f32 v63, v63
    v_mfma_f32_32x32x16_bf16 v[16:31], a[8:11], v[136:139], 4.0
    v_exp_f32 v0, v0
    v_exp_f32 v1, v1
    v_exp_f32 v2, v2
    v_mfma_f32_32x32x16_bf16 v[16:31], a[12:15], v[140:143], v[16:31]
    v_exp_f32 v3, v3
    v_exp_f32 v4, v4
    v_exp_f32 v5, v5
    v_smfmac_f32_32x32x32_bf16 v[112:127], a[20:23], v[56:63], v224
    v_exp_f32 v6, v6
    v_exp_f32 v7, v7
    v_exp_f32 v8, v8
    v_smfmac_f32_16x16x64_bf16 v[220:223], a[32:35], v[56:63], v224
    s_waitcnt lgkmcnt(4)
    ds_read_b64_tr_b16 a[16:17], v226 offset:10240
    v_exp_f32 v9, v9
    v_smfmac_f32_32x32x32_bf16 v[64:79], a[24:27], v[0:7], v224
    v_exp_f32 v10, v10
    v_exp_f32 v11, v11
    v_exp_f32 v12, v12
    v_smfmac_f32_16x16x64_bf16 v[208:211], a[32:35], v[0:7], v224
L_pad7B:
    s_cbranch_vccnz L_retB
    ds_read_b64_tr_b16 a[18:19], v226 offset:10496
    v_exp_f32 v13, v13
    v_exp_f32 v14, v14
    v_exp_f32 v15, v15
    v_mfma_f32_32x32x16_bf16 v[32:47], a[8:11], v[144:147], 4.0
    v_exp_f32 v16, v16
    v_exp_f32 v17, v17
    v_exp_f32 v18, v18
    v_mfma_f32_32x32x16_bf16 v[32:47], a[12:15], v[148:151], v[32:47]
    s_waitcnt lgkmcnt(4)
    v_exp_f32 v19, v19
    v_exp_f32 v20, v20
    v_exp_f32 v21, v21
    v_smfmac_f32_32x32x32_bf16 v[64:79], a[28:31], v[8:15], v224
    v_exp_f32 v22, v22
    v_exp_f32 v23, v23
    v_exp_f32 v24, v24
    v_smfmac_f32_16x16x64_bf16 v[208:211], a[32:35], v[8:15], v224
    ds_read_b64_tr_b16 a[20:21], v226 offset:11264
    v_exp_f32 v25, v25
    v_smfmac_f32_32x32x32_bf16 v[80:95], a[24:27], v[16:23], v224
    v_exp_f32 v26, v26
    v_exp_f32 v27, v27
    v_exp_f32 v28, v28
    v_smfmac_f32_16x16x64_bf16 v[212:215], a[32:35], v[16:23], v224
    ds_read_b64_tr_b16 a[22:23], v226 offset:11520
    v_exp_f32 v29, v29
    v_exp_f32 v30, v30
    v_exp_f32 v31, v31
    v_mfma_f32_32x32x16_bf16 v[48:63], a[8:11], v[152:155], 4.0
    v_exp_f32 v32, v32
    v_exp_f32 v33, v33
    v_exp_f32 v34, v34
    v_mfma_f32_32x32x16_bf16 v[48:63], a[12:15], v[156:159], v[48:63]
    v_exp_f32 v35, v35
    v_exp_f32 v36, v36
    v_exp_f32 v37, v37
    v_smfmac_f32_32x32x32_bf16 v[80:95], a[28:31], v[24:31], v224
    v_exp_f32 v38, v38
    v_exp_f32 v39, v39
    v_exp_f32 v40, v40
    v_smfmac_f32_16x16x64_bf16 v[212:215], a[32:35], v[24:31], v224
    v_exp_f32 v41, v41
    v_smfmac_f32_32x32x32_bf16 v[96:111], a[24:27], v[32:39], v224
    v_exp_f32 v42, v42
    v_exp_f32 v43, v43
    v_exp_f32 v44, v44
    v_smfmac_f32_16x16x64_bf16 v[216:219], a[32:35], v[32:39], v224
    s_waitcnt lgkmcnt(5)
    v_exp_f32 v45, v45
    v_exp_f32 v46, v46
    v_exp_f32 v47, v47
    v_mfma_f32_32x32x16_bf16 v[0:15], a[0:3], v[128:131], 4.0
    s_waitcnt lgkmcnt(4)
    v_exp_f32 v48, v48
    v_exp_f32 v49, v49
    v_exp_f32 v50, v50
    v_mfma_f32_32x32x16_bf16 v[0:15], a[4:7], v[132:135], v[0:15]
    v_exp_f32 v51, v51
    v_exp_f32 v52, v52
    v_exp_f32 v53, v53
    v_smfmac_f32_32x32x32_bf16 v[96:111], a[28:31], v[40:47], v224
    v_exp_f32 v54, v54
    v_exp_f32 v55, v55
    v_exp_f32 v56, v56
    v_smfmac_f32_16x16x64_bf16 v[216:219], a[32:35], v[40:47], v224
    ds_read_b128 a[8:11], v225 offset:12288
    v_exp_f32 v57, v57
    v_smfmac_f32_32x32x32_bf16 v[112:127], a[24:27], v[48:55], v224
    v_exp_f32 v58, v58
    v_exp_f32 v59, v59
    v_exp_f32 v60, v60
    v_smfmac_f32_16x16x64_bf16 v[220:223], a[32:35], v[48:55], v224
    ds_read_b128 a[12:15], v225 offset:13312
    v_exp_f32 v61, v61
    v_exp_f32 v62, v62
    v_exp_f32 v63, v63
    v_mfma_f32_32x32x16_bf16 v[16:31], a[0:3], v[136:139], 4.0
    v_exp_f32 v0, v0
    v_exp_f32 v1, v1
    v_exp_f32 v2, v2
    v_mfma_f32_32x32x16_bf16 v[16:31], a[4:7], v[140:143], v[16:31]
    v_exp_f32 v3, v3
    v_exp_f32 v4, v4
    v_exp_f32 v5, v5
    v_smfmac_f32_32x32x32_bf16 v[112:127], a[28:31], v[56:63], v224
    v_exp_f32 v6, v6
    v_exp_f32 v7, v7
    v_exp_f32 v8, v8
    v_smfmac_f32_16x16x64_bf16 v[220:223], a[32:35], v[56:63], v224
    s_waitcnt lgkmcnt(4)
    ds_read_b64_tr_b16 a[24:25], v226 offset:12288
    v_exp_f32 v9, v9
    v_smfmac_f32_32x32x32_bf16 v[64:79], a[16:19], v[0:7], v224
    v_exp_f32 v10, v10
    v_exp_f32 v11, v11
    v_exp_f32 v12, v12
    v_smfmac_f32_16x16x64_bf16 v[208:211], a[32:35], v[0:7], v224
    ds_read_b64_tr_b16 a[26:27], v226 offset:12544
    v_exp_f32 v13, v13
    v_exp_f32 v14, v14
    v_exp_f32 v15, v15
    v_mfma_f32_32x32x16_bf16 v[32:47], a[0:3], v[144:147], 4.0
    v_exp_f32 v16, v16
    v_exp_f32 v17, v17
    v_exp_f32 v18, v18
    v_mfma_f32_32x32x16_bf16 v[32:47], a[4:7], v[148:151], v[32:47]
    s_waitcnt lgkmcnt(4)
    v_exp_f32 v19, v19
    v_exp_f32 v20, v20
    v_exp_f32 v21, v21
    v_smfmac_f32_32x32x32_bf16 v[64:79], a[20:23], v[8:15], v224
    v_exp_f32 v22, v22
    v_exp_f32 v23, v23
    v_exp_f32 v24, v24
    v_smfmac_f32_16x16x64_bf16 v[208:211], a[32:35], v[8:15], v224
    ds_read_b64_tr_b16 a[28:29], v226 offset:13312
    v_exp_f32 v25, v25
    v_smfmac_f32_32x32x32_bf16 v[80:95], a[16:19], v[16:23], v224
    v_exp_f32 v26, v26
    v_exp_f32 v27, v27
    v_exp_f32 v28, v28
    v_smfmac_f32_16x16x64_bf16 v[212:215], a[32:35], v[16:23], v224
    ds_read_b64_tr_b16 a[30:31], v226 offset:13568
    v_exp_f32 v29, v29
    v_exp_f32 v30, v30
    v_exp_f32 v31, v31
    v_mfma_f32_32x32x16_bf16 v[48:63], a[0:3], v[152:155], 4.0
    v_exp_f32 v32, v32
    v_exp_f32 v33, v33
    v_exp_f32 v34, v34
    v_mfma_f32_32x32x16_bf16 v[48:63], a[4:7], v[156:159], v[48:63]
    v_exp_f32 v35, v35
    v_exp_f32 v36, v36
    v_exp_f32 v37, v37
    v_smfmac_f32_32x32x32_bf16 v[80:95], a[20:23], v[24:31], v224
    v_exp_f32 v38, v38
    v_exp_f32 v39, v39
    v_exp_f32 v40, v40
    v_smfmac_f32_16x16x64_bf16 v[212:215], a[32:35], v[24:31], v224
    v_exp_f32 v41, v41
    v_smfmac_f32_32x32x32_bf16 v[96:111], a[16:19], v[32:39], v224
    v_exp_f32 v42, v42
    v_exp_f32 v43, v43
    v_exp_f32 v44, v44
    v_smfmac_f32_16x16x64_bf16 v[216:219], a[32:35], v[32:39], v224
    s_waitcnt lgkmcnt(5)
    v_exp_f32 v45, v45
    v_exp_f32 v46, v46
    v_exp_f32 v47, v47
    v_mfma_f32_32x32x16_bf16 v[0:15], a[8:11], v[128:131], 4.0
    s_waitcnt lgkmcnt(4)
    v_exp_f32 v48, v48
    v_exp_f32 v49, v49
    v_exp_f32 v50, v50
    v_mfma_f32_32x32x16_bf16 v[0:15], a[12:15], v[132:135], v[0:15]
    s_waitcnt vmcnt(0) lgkmcnt(0)
    v_exp_f32 v51, v51
    v_exp_f32 v52, v52
    v_exp_f32 v53, v53
    v_smfmac_f32_32x32x32_bf16 v[96:111], a[20:23], v[40:47], v224
    s_barrier
    v_exp_f32 v54, v54
    v_exp_f32 v55, v55
    v_exp_f32 v56, v56
    v_smfmac_f32_16x16x64_bf16 v[216:219], a[32:35], v[40:47], v224
    ds_read_b128 a[0:3], v225 offset:32768
    v_exp_f32 v57, v57
    v_smfmac_f32_32x32x32_bf16 v[112:127], a[16:19], v[48:55], v224
    v_exp_f32 v58, v58
    v_exp_f32 v59, v59
    v_exp_f32 v60, v60
    v_smfmac_f32_16x16x64_bf16 v[220:223], a[32:35], v[48:55], v224
    ds_read_b128 a[4:7], v225 offset:33792
    v_exp_f32 v61, v61
    v_exp_f32 v62, v62
    v_exp_f32 v63, v63
    v_mfma_f32_32x32x16_bf16 v[16:31], a[8:11], v[136:139], 4.0
    v_exp_f32 v0, v0
    v_exp_f32 v1, v1
    v_exp_f32 v2, v2
    v_mfma_f32_32x32x16_bf16 v[16:31], a[12:15], v[140:143], v[16:31]
    v_exp_f32 v3, v3
    v_exp_f32 v4, v4
    v_exp_f32 v5, v5
    v_smfmac_f32_32x32x32_bf16 v[112:127], a[20:23], v[56:63], v224
    v_exp_f32 v6, v6
    v_exp_f32 v7, v7
    v_exp_f32 v8, v8
    v_smfmac_f32_16x16x64_bf16 v[220:223], a[32:35], v[56:63], v224
    ds_read_b64_tr_b16 a[16:17], v226 offset:32768
    v_exp_f32 v9, v9
    v_smfmac_f32_32x32x32_bf16 v[64:79], a[24:27], v[0:7], v224
    v_exp_f32 v10, v10
    v_exp_f32 v11, v11
    v_exp_f32 v12, v12
    v_smfmac_f32_16x16x64_bf16 v[208:211], a[32:35], v[0:7], v224
    ds_read_b64_tr_b16 a[18:19], v226 offset:33024
    v_exp_f32 v13, v13
    v_exp_f32 v14, v14
    v_exp_f32 v15, v15
    v_mfma_f32_32x32x16_bf16 v[32:47], a[8:11], v[144:147], 4.0
    v_exp_f32 v16, v16
    v_exp_f32 v17, v17
    v_exp_f32 v18, v18
    v_mfma_f32_32x32x16_bf16 v[32:47], a[12:15], v[148:151], v[32:47]
    v_exp_f32 v19, v19
    v_exp_f32 v20, v20
    v_exp_f32 v21, v21
    v_smfmac_f32_32x32x32_bf16 v[64:79], a[28:31], v[8:15], v224
    v_exp_f32 v22, v22
    v_exp_f32 v23, v23
    v_exp_f32 v24, v24
    v_smfmac_f32_16x16x64_bf16 v[208:211], a[32:35], v[8:15], v224
    ds_read_b64_tr_b16 a[20:21], v226 offset:33792
    v_exp_f32 v25, v25
    v_smfmac_f32_32x32x32_bf16 v[80:95], a[24:27], v[16:23], v224
    s_mov_b32 m0, s56
    v_exp_f32 v26, v26
    v_exp_f32 v27, v27
    v_exp_f32 v28, v28
    v_smfmac_f32_16x16x64_bf16 v[212:215], a[32:35], v[16:23], v224
    ds_read_b64_tr_b16 a[22:23], v226 offset:34048
    v_exp_f32 v29, v29
    v_exp_f32 v30, v30
    v_exp_f32 v31, v31
    v_mfma_f32_32x32x16_bf16 v[48:63], a[8:11], v[152:155], 4.0
    buffer_load_dwordx4 v225, s[24:27], s38 offen offset:0 nt lds
    v_exp_f32 v32, v32
    v_exp_f32 v33, v33
    v_exp_f32 v34, v34
    v_mfma_f32_32x32x16_bf16 v[48:63], a[12:15], v[156:159], v[48:63]
    buffer_load_dwordx4 v225, s[24:27], s38 offen offset:1024 nt lds
    v_exp_f32 v35, v35
    v_exp_f32 v36, v36
    v_exp_f32 v37, v37
    v_smfmac_f32_32x32x32_bf16 v[80:95], a[28:31], v[24:31], v224
    v_exp_f32 v38, v38
    v_exp_f32 v39, v39
    v_exp_f32 v40, v40
    v_smfmac_f32_16x16x64_bf16 v[212:215], a[32:35], v[24:31], v224
    buffer_load_dwordx4 v225, s[24:27], s12 offen offset:2048 nt lds
    v_exp_f32 v41, v41
    v_smfmac_f32_32x32x32_bf16 v[96:111], a[24:27], v[32:39], v224
    v_exp_f32 v42, v42
    v_exp_f32 v43, v43
    v_exp_f32 v44, v44
    v_smfmac_f32_16x16x64_bf16 v[216:219], a[32:35], v[32:39], v224
    s_waitcnt lgkmcnt(5)
    buffer_load_dwordx4 v225, s[24:27], s12 offen offset:3072 nt lds
    v_exp_f32 v45, v45
    v_exp_f32 v46, v46
    v_exp_f32 v47, v47
    v_mfma_f32_32x32x16_bf16 v[0:15], a[0:3], v[128:131], 4.0
    s_waitcnt lgkmcnt(4)
    v_exp_f32 v48, v48
    v_exp_f32 v49, v49
    v_exp_f32 v50, v50
    v_mfma_f32_32x32x16_bf16 v[0:15], a[4:7], v[132:135], v[0:15]
    v_exp_f32 v51, v51
    v_exp_f32 v52, v52
    v_exp_f32 v53, v53
    v_smfmac_f32_32x32x32_bf16 v[96:111], a[28:31], v[40:47], v224
    v_exp_f32 v54, v54
    v_exp_f32 v55, v55
    v_exp_f32 v56, v56
    v_smfmac_f32_16x16x64_bf16 v[216:219], a[32:35], v[40:47], v224
    ds_read_b128 a[8:11], v225 offset:34816
    v_exp_f32 v57, v57
    v_smfmac_f32_32x32x32_bf16 v[112:127], a[24:27], v[48:55], v224
    v_exp_f32 v58, v58
    v_exp_f32 v59, v59
    v_exp_f32 v60, v60
    v_smfmac_f32_16x16x64_bf16 v[220:223], a[32:35], v[48:55], v224
    ds_read_b128 a[12:15], v225 offset:35840
    v_exp_f32 v61, v61
    v_exp_f32 v62, v62
    v_exp_f32 v63, v63
    v_mfma_f32_32x32x16_bf16 v[16:31], a[0:3], v[136:139], 4.0
    v_exp_f32 v0, v0
    v_exp_f32 v1, v1
    v_exp_f32 v2, v2
    v_mfma_f32_32x32x16_bf16 v[16:31], a[4:7], v[140:143], v[16:31]
    v_exp_f32 v3, v3
    v_exp_f32 v4, v4
    v_exp_f32 v5, v5
    v_smfmac_f32_32x32x32_bf16 v[112:127], a[28:31], v[56:63], v224
    v_exp_f32 v6, v6
    v_exp_f32 v7, v7
    v_exp_f32 v8, v8
    v_smfmac_f32_16x16x64_bf16 v[220:223], a[32:35], v[56:63], v224
    s_waitcnt lgkmcnt(4)
    ds_read_b64_tr_b16 a[24:25], v226 offset:34816
    v_exp_f32 v9, v9
    v_smfmac_f32_32x32x32_bf16 v[64:79], a[16:19], v[0:7], v224
    v_exp_f32 v10, v10
    v_exp_f32 v11, v11
    v_exp_f32 v12, v12
    v_smfmac_f32_16x16x64_bf16 v[208:211], a[32:35], v[0:7], v224
    ds_read_b64_tr_b16 a[26:27], v226 offset:35072
    v_exp_f32 v13, v13
    v_exp_f32 v14, v14
    v_exp_f32 v15, v15
    v_mfma_f32_32x32x16_bf16 v[32:47], a[0:3], v[144:147], 4.0
    v_exp_f32 v16, v16
    v_exp_f32 v17, v17
    v_exp_f32 v18, v18
    v_mfma_f32_32x32x16_bf16 v[32:47], a[4:7], v[148:151], v[32:47]
    s_waitcnt lgkmcnt(4)
    v_exp_f32 v19, v19
    v_exp_f32 v20, v20
    v_exp_f32 v21, v21
    v_smfmac_f32_32x32x32_bf16 v[64:79], a[20:23], v[8:15], v224
    v_exp_f32 v22, v22
    v_exp_f32 v23, v23
    v_exp_f32 v24, v24
    v_smfmac_f32_16x16x64_bf16 v[208:211], a[32:35], v[8:15], v224
    ds_read_b64_tr_b16 a[28:29], v226 offset:35840
    v_exp_f32 v25, v25
    v_smfmac_f32_32x32x32_bf16 v[80:95], a[16:19], v[16:23], v224
    s_mov_b32 m0, s44
    v_exp_f32 v26, v26
    v_exp_f32 v27, v27
    v_exp_f32 v28, v28
    v_smfmac_f32_16x16x64_bf16 v[212:215], a[32:35], v[16:23], v224
    ds_read_b64_tr_b16 a[30:31], v226 offset:36096
    v_exp_f32 v29, v29
    v_exp_f32 v30, v30
    v_exp_f32 v31, v31
    v_mfma_f32_32x32x16_bf16 v[48:63], a[0:3], v[152:155], 4.0
    buffer_load_dwordx4 v225, s[48:51], s46 offen offset:0 sc1 lds
    v_exp_f32 v32, v32
    v_exp_f32 v33, v33
    v_exp_f32 v34, v34
    v_mfma_f32_32x32x16_bf16 v[48:63], a[4:7], v[156:159], v[48:63]
    buffer_load_dwordx4 v225, s[48:51], s46 offen offset:1024 sc1 lds
    v_exp_f32 v35, v35
    v_exp_f32 v36, v36
    v_exp_f32 v37, v37
    v_smfmac_f32_32x32x32_bf16 v[80:95], a[20:23], v[24:31], v224
    v_exp_f32 v38, v38
    v_exp_f32 v39, v39
    v_exp_f32 v40, v40
    v_smfmac_f32_16x16x64_bf16 v[212:215], a[32:35], v[24:31], v224
    buffer_load_dwordx4 v225, s[48:51], s14 offen offset:2048 sc1 lds
    v_exp_f32 v41, v41
    v_smfmac_f32_32x32x32_bf16 v[96:111], a[16:19], v[32:39], v224
    v_exp_f32 v42, v42
    v_exp_f32 v43, v43
    v_exp_f32 v44, v44
    v_smfmac_f32_16x16x64_bf16 v[216:219], a[32:35], v[32:39], v224
    s_waitcnt lgkmcnt(5)
    buffer_load_dwordx4 v225, s[48:51], s14 offen offset:3072 sc1 lds
    v_exp_f32 v45, v45
    v_exp_f32 v46, v46
    v_exp_f32 v47, v47
    v_mfma_f32_32x32x16_bf16 v[0:15], a[8:11], v[128:131], 4.0
    s_waitcnt lgkmcnt(4)
    v_exp_f32 v48, v48
    v_exp_f32 v49, v49
    v_exp_f32 v50, v50
    v_mfma_f32_32x32x16_bf16 v[0:15], a[12:15], v[132:135], v[0:15]
    v_exp_f32 v51, v51
    v_exp_f32 v52, v52
    v_exp_f32 v53, v53
    v_smfmac_f32_32x32x32_bf16 v[96:111], a[20:23], v[40:47], v224
    v_exp_f32 v54, v54
    v_exp_f32 v55, v55
    v_exp_f32 v56, v56
    v_smfmac_f32_16x16x64_bf16 v[216:219], a[32:35], v[40:47], v224
    ds_read_b128 a[0:3], v225 offset:36864
    v_exp_f32 v57, v57
    v_smfmac_f32_32x32x32_bf16 v[112:127], a[16:19], v[48:55], v224
    v_exp_f32 v58, v58
    v_exp_f32 v59, v59
    v_exp_f32 v60, v60
    v_smfmac_f32_16x16x64_bf16 v[220:223], a[32:35], v[48:55], v224
    ds_read_b128 a[4:7], v225 offset:37888
    v_exp_f32 v61, v61
    v_exp_f32 v62, v62
    v_exp_f32 v63, v63
    v_mfma_f32_32x32x16_bf16 v[16:31], a[8:11], v[136:139], 4.0
    v_exp_f32 v0, v0
    v_exp_f32 v1, v1
    v_exp_f32 v2, v2
    v_mfma_f32_32x32x16_bf16 v[16:31], a[12:15], v[140:143], v[16:31]
    v_exp_f32 v3, v3
    v_exp_f32 v4, v4
    v_exp_f32 v5, v5
    v_smfmac_f32_32x32x32_bf16 v[112:127], a[20:23], v[56:63], v224
    v_exp_f32 v6, v6
    v_exp_f32 v7, v7
    v_exp_f32 v8, v8
    v_smfmac_f32_16x16x64_bf16 v[220:223], a[32:35], v[56:63], v224
    s_waitcnt lgkmcnt(4)
    ds_read_b64_tr_b16 a[16:17], v226 offset:36864
    v_exp_f32 v9, v9
    v_smfmac_f32_32x32x32_bf16 v[64:79], a[24:27], v[0:7], v224
    v_exp_f32 v10, v10
    v_exp_f32 v11, v11
    v_exp_f32 v12, v12
    v_smfmac_f32_16x16x64_bf16 v[208:211], a[32:35], v[0:7], v224
    ds_read_b64_tr_b16 a[18:19], v226 offset:37120
    v_exp_f32 v13, v13
    v_exp_f32 v14, v14
    v_exp_f32 v15, v15
    v_mfma_f32_32x32x16_bf16 v[32:47], a[8:11], v[144:147], 4.0
    v_exp_f32 v16, v16
    v_exp_f32 v17, v17
    v_exp_f32 v18, v18
    v_mfma_f32_32x32x16_bf16 v[32:47], a[12:15], v[148:151], v[32:47]
    s_waitcnt lgkmcnt(4)
    v_exp_f32 v19, v19
    v_exp_f32 v20, v20
    v_exp_f32 v21, v21
    v_smfmac_f32_32x32x32_bf16 v[64:79], a[28:31], v[8:15], v224
    v_exp_f32 v22, v22
    v_exp_f32 v23, v23
    v_exp_f32 v24, v24
    v_smfmac_f32_16x16x64_bf16 v[208:211], a[32:35], v[8:15], v224
    ds_read_b64_tr_b16 a[20:21], v226 offset:37888
    v_exp_f32 v25, v25
    v_smfmac_f32_32x32x32_bf16 v[80:95], a[24:27], v[16:23], v224
    v_exp_f32 v26, v26
    v_exp_f32 v27, v27
    v_exp_f32 v28, v28
    v_smfmac_f32_16x16x64_bf16 v[212:215], a[32:35], v[16:23], v224
    ds_read_b64_tr_b16 a[22:23], v226 offset:38144
    v_exp_f32 v29, v29
    v_exp_f32 v30, v30
    v_exp_f32 v31, v31
    v_mfma_f32_32x32x16_bf16 v[48:63], a[8:11], v[152:155], 4.0
    v_exp_f32 v32, v32
    v_exp_f32 v33, v33
    v_exp_f32 v34, v34
    v_mfma_f32_32x32x16_bf16 v[48:63], a[12:15], v[156:159], v[48:63]
    v_exp_f32 v35, v35
    v_exp_f32 v36, v36
    v_exp_f32 v37, v37
    v_smfmac_f32_32x32x32_bf16 v[80:95], a[28:31], v[24:31], v224
    v_exp_f32 v38, v38
    v_exp_f32 v39, v39
    v_exp_f32 v40, v40
    v_smfmac_f32_16x16x64_bf16 v[212:215], a[32:35], v[24:31], v224
    v_exp_f32 v41, v41
    v_smfmac_f32_32x32x32_bf16 v[96:111], a[24:27], v[32:39], v224
    v_exp_f32 v42, v42
    v_exp_f32 v43, v43
    v_exp_f32 v44, v44
    v_smfmac_f32_16x16x64_bf16 v[216:219], a[32:35], v[32:39], v224
    s_waitcnt lgkmcnt(5)
    v_exp_f32 v45, v45
    v_exp_f32 v46, v46
    v_exp_f32 v47, v47
    v_mfma_f32_32x32x16_bf16 v[0:15], a[0:3], v[128:131], 4.0
    s_waitcnt lgkmcnt(4)
    v_exp_f32 v48, v48
    v_exp_f32 v49, v49
    v_exp_f32 v50, v50
    v_mfma_f32_32x32x16_bf16 v[0:15], a[4:7], v[132:135], v[0:15]
    v_exp_f32 v51, v51
    v_exp_f32 v52, v52
    v_exp_f32 v53, v53
    v_smfmac_f32_32x32x32_bf16 v[96:111], a[28:31], v[40:47], v224
    v_exp_f32 v54, v54
    v_exp_f32 v55, v55
    v_exp_f32 v56, v56
    v_smfmac_f32_16x16x64_bf16 v[216:219], a[32:35], v[40:47], v224
    ds_read_b128 a[8:11], v225 offset:38912
    v_exp_f32 v57, v57
    v_smfmac_f32_32x32x32_bf16 v[112:127], a[24:27], v[48:55], v224
    v_exp_f32 v58, v58
    v_exp_f32 v59, v59
    v_exp_f32 v60, v60
    v_smfmac_f32_16x16x64_bf16 v[220:223], a[32:35], v[48:55], v224
    ds_read_b128 a[12:15], v225 offset:39936
    v_exp_f32 v61, v61
    v_exp_f32 v62, v62
    v_exp_f32 v63, v63
    v_mfma_f32_32x32x16_bf16 v[16:31], a[0:3], v[136:139], 4.0
    v_exp_f32 v0, v0
    v_exp_f32 v1, v1
    v_exp_f32 v2, v2
    v_mfma_f32_32x32x16_bf16 v[16:31], a[4:7], v[140:143], v[16:31]
    v_exp_f32 v3, v3
    v_exp_f32 v4, v4
    v_exp_f32 v5, v5
    v_smfmac_f32_32x32x32_bf16 v[112:127], a[28:31], v[56:63], v224
    v_exp_f32 v6, v6
    v_exp_f32 v7, v7
    v_exp_f32 v8, v8
    v_smfmac_f32_16x16x64_bf16 v[220:223], a[32:35], v[56:63], v224
    s_waitcnt lgkmcnt(4)
    ds_read_b64_tr_b16 a[24:25], v226 offset:38912
    v_exp_f32 v9, v9
    v_smfmac_f32_32x32x32_bf16 v[64:79], a[16:19], v[0:7], v224
    v_exp_f32 v10, v10
    v_exp_f32 v11, v11
    v_exp_f32 v12, v12
    v_smfmac_f32_16x16x64_bf16 v[208:211], a[32:35], v[0:7], v224
    ds_read_b64_tr_b16 a[26:27], v226 offset:39168
    v_exp_f32 v13, v13
    v_exp_f32 v14, v14
    v_exp_f32 v15, v15
    v_mfma_f32_32x32x16_bf16 v[32:47], a[0:3], v[144:147], 4.0
    v_exp_f32 v16, v16
    v_exp_f32 v17, v17
    v_exp_f32 v18, v18
    v_mfma_f32_32x32x16_bf16 v[32:47], a[4:7], v[148:151], v[32:47]
    s_waitcnt lgkmcnt(4)
    v_exp_f32 v19, v19
    v_exp_f32 v20, v20
    v_exp_f32 v21, v21
    v_smfmac_f32_32x32x32_bf16 v[64:79], a[20:23], v[8:15], v224
    v_exp_f32 v22, v22
    v_exp_f32 v23, v23
    v_exp_f32 v24, v24
    v_smfmac_f32_16x16x64_bf16 v[208:211], a[32:35], v[8:15], v224
    ds_read_b64_tr_b16 a[28:29], v226 offset:39936
    v_exp_f32 v25, v25
    v_smfmac_f32_32x32x32_bf16 v[80:95], a[16:19], v[16:23], v224
    v_exp_f32 v26, v26
    v_exp_f32 v27, v27
    v_exp_f32 v28, v28
    v_smfmac_f32_16x16x64_bf16 v[212:215], a[32:35], v[16:23], v224
    ds_read_b64_tr_b16 a[30:31], v226 offset:40192
    v_exp_f32 v29, v29
    v_exp_f32 v30, v30
    v_exp_f32 v31, v31
    v_mfma_f32_32x32x16_bf16 v[48:63], a[0:3], v[152:155], 4.0
    v_exp_f32 v32, v32
    v_exp_f32 v33, v33
    v_exp_f32 v34, v34
    v_mfma_f32_32x32x16_bf16 v[48:63], a[4:7], v[156:159], v[48:63]
    v_exp_f32 v35, v35
    v_exp_f32 v36, v36
    v_exp_f32 v37, v37
    v_smfmac_f32_32x32x32_bf16 v[80:95], a[20:23], v[24:31], v224
    v_exp_f32 v38, v38
    v_exp_f32 v39, v39
    v_exp_f32 v40, v40
    v_smfmac_f32_16x16x64_bf16 v[212:215], a[32:35], v[24:31], v224
    v_exp_f32 v41, v41
    v_smfmac_f32_32x32x32_bf16 v[96:111], a[16:19], v[32:39], v224
    v_exp_f32 v42, v42
    v_exp_f32 v43, v43
    v_exp_f32 v44, v44
    v_smfmac_f32_16x16x64_bf16 v[216:219], a[32:35], v[32:39], v224
    s_waitcnt lgkmcnt(5)
    v_exp_f32 v45, v45
    v_exp_f32 v46, v46
    v_exp_f32 v47, v47
    v_mfma_f32_32x32x16_bf16 v[0:15], a[8:11], v[128:131], 4.0
    s_waitcnt lgkmcnt(4)
    v_exp_f32 v48, v48
    v_exp_f32 v49, v49
    v_exp_f32 v50, v50
    v_mfma_f32_32x32x16_bf16 v[0:15], a[12:15], v[132:135], v[0:15]
    v_exp_f32 v51, v51
    v_exp_f32 v52, v52
    v_exp_f32 v53, v53
    v_smfmac_f32_32x32x32_bf16 v[96:111], a[20:23], v[40:47], v224
    v_exp_f32 v54, v54
    v_exp_f32 v55, v55
    v_exp_f32 v56, v56
    v_smfmac_f32_16x16x64_bf16 v[216:219], a[32:35], v[40:47], v224
    ds_read_b128 a[0:3], v225 offset:40960
    v_exp_f32 v57, v57
    v_smfmac_f32_32x32x32_bf16 v[112:127], a[16:19], v[48:55], v224
    v_exp_f32 v58, v58
    v_exp_f32 v59, v59
    v_exp_f32 v60, v60
    v_smfmac_f32_16x16x64_bf16 v[220:223], a[32:35], v[48:55], v224
    ds_read_b128 a[4:7], v225 offset:41984
    v_exp_f32 v61, v61
    v_exp_f32 v62, v62
    v_exp_f32 v63, v63
    v_mfma_f32_32x32x16_bf16 v[16:31], a[8:11], v[136:139], 4.0
    v_exp_f32 v0, v0
    v_exp_f32 v1, v1
    v_exp_f32 v2, v2
    v_mfma_f32_32x32x16_bf16 v[16:31], a[12:15], v[140:143], v[16:31]
    v_exp_f32 v3, v3
    v_exp_f32 v4, v4
    v_exp_f32 v5, v5
    v_smfmac_f32_32x32x32_bf16 v[112:127], a[20:23], v[56:63], v224
    v_exp_f32 v6, v6
    v_exp_f32 v7, v7
    v_exp_f32 v8, v8
    v_smfmac_f32_16x16x64_bf16 v[220:223], a[32:35], v[56:63], v224
    s_waitcnt lgkmcnt(4)
    ds_read_b64_tr_b16 a[16:17], v226 offset:40960
    v_exp_f32 v9, v9
    v_smfmac_f32_32x32x32_bf16 v[64:79], a[24:27], v[0:7], v224
    v_exp_f32 v10, v10
    v_exp_f32 v11, v11
    v_exp_f32 v12, v12
    v_smfmac_f32_16x16x64_bf16 v[208:211], a[32:35], v[0:7], v224
    ds_read_b64_tr_b16 a[18:19], v226 offset:41216
    v_exp_f32 v13, v13
    v_exp_f32 v14, v14
    v_exp_f32 v15, v15
    v_mfma_f32_32x32x16_bf16 v[32:47], a[8:11], v[144:147], 4.0
    v_exp_f32 v16, v16
    v_exp_f32 v17, v17
    v_exp_f32 v18, v18
    v_mfma_f32_32x32x16_bf16 v[32:47], a[12:15], v[148:151], v[32:47]
    s_waitcnt lgkmcnt(4)
    v_exp_f32 v19, v19
    v_exp_f32 v20, v20
    v_exp_f32 v21, v21
    v_smfmac_f32_32x32x32_bf16 v[64:79], a[28:31], v[8:15], v224
    v_exp_f32 v22, v22
    v_exp_f32 v23, v23
    v_exp_f32 v24, v24
    v_smfmac_f32_16x16x64_bf16 v[208:211], a[32:35], v[8:15], v224
    ds_read_b64_tr_b16 a[20:21], v226 offset:41984
    v_exp_f32 v25, v25
    v_smfmac_f32_32x32x32_bf16 v[80:95], a[24:27], v[16:23], v224
    v_exp_f32 v26, v26
    v_exp_f32 v27, v27
    v_exp_f32 v28, v28
    v_smfmac_f32_16x16x64_bf16 v[212:215], a[32:35], v[16:23], v224
    ds_read_b64_tr_b16 a[22:23], v226 offset:42240
    v_exp_f32 v29, v29
    v_exp_f32 v30, v30
    v_exp_f32 v31, v31
    v_mfma_f32_32x32x16_bf16 v[48:63], a[8:11], v[152:155], 4.0
    v_exp_f32 v32, v32
    v_exp_f32 v33, v33
    v_exp_f32 v34, v34
    v_mfma_f32_32x32x16_bf16 v[48:63], a[12:15], v[156:159], v[48:63]
    v_exp_f32 v35, v35
    v_exp_f32 v36, v36
    v_exp_f32 v37, v37
    v_smfmac_f32_32x32x32_bf16 v[80:95], a[28:31], v[24:31], v224
    v_exp_f32 v38, v38
    v_exp_f32 v39, v39
    v_exp_f32 v40, v40
    v_smfmac_f32_16x16x64_bf16 v[212:215], a[32:35], v[24:31], v224
    v_exp_f32 v41, v41
    v_smfmac_f32_32x32x32_bf16 v[96:111], a[24:27], v[32:39], v224
    v_exp_f32 v42, v42
    v_exp_f32 v43, v43
    v_exp_f32 v44, v44
    v_smfmac_f32_16x16x64_bf16 v[216:219], a[32:35], v[32:39], v224
    s_waitcnt lgkmcnt(5)
    v_exp_f32 v45, v45
    v_exp_f32 v46, v46
    v_exp_f32 v47, v47
    v_mfma_f32_32x32x16_bf16 v[0:15], a[0:3], v[128:131], 4.0
    s_waitcnt lgkmcnt(4)
    v_exp_f32 v48, v48
    v_exp_f32 v49, v49
    v_exp_f32 v50, v50
    v_mfma_f32_32x32x16_bf16 v[0:15], a[4:7], v[132:135], v[0:15]
    v_exp_f32 v51, v51
    v_exp_f32 v52, v52
    v_exp_f32 v53, v53
    v_smfmac_f32_32x32x32_bf16 v[96:111], a[28:31], v[40:47], v224
    v_exp_f32 v54, v54
    v_exp_f32 v55, v55
    v_exp_f32 v56, v56
    v_smfmac_f32_16x16x64_bf16 v[216:219], a[32:35], v[40:47], v224
    ds_read_b128 a[8:11], v225 offset:43008
    v_exp_f32 v57, v57
    v_smfmac_f32_32x32x32_bf16 v[112:127], a[24:27], v[48:55], v224
    v_exp_f32 v58, v58
    v_exp_f32 v59, v59
    v_exp_f32 v60, v60
    v_smfmac_f32_16x16x64_bf16 v[220:223], a[32:35], v[48:55], v224
    ds_read_b128 a[12:15], v225 offset:44032
    v_exp_f32 v61, v61
    v_exp_f32 v62, v62
    v_exp_f32 v63, v63
    v_mfma_f32_32x32x16_bf16 v[16:31], a[0:3], v[136:139], 4.0
    v_exp_f32 v0, v0
    v_exp_f32 v1, v1
    v_exp_f32 v2, v2
    v_mfma_f32_32x32x16_bf16 v[16:31], a[4:7], v[140:143], v[16:31]
    v_exp_f32 v3, v3
    v_exp_f32 v4, v4
    v_exp_f32 v5, v5
    v_smfmac_f32_32x32x32_bf16 v[112:127], a[28:31], v[56:63], v224
    v_exp_f32 v6, v6
    v_exp_f32 v7, v7
    v_exp_f32 v8, v8
    v_smfmac_f32_16x16x64_bf16 v[220:223], a[32:35], v[56:63], v224
    s_waitcnt lgkmcnt(4)
    ds_read_b64_tr_b16 a[24:25], v226 offset:43008
    v_exp_f32 v9, v9
    v_smfmac_f32_32x32x32_bf16 v[64:79], a[16:19], v[0:7], v224
    v_exp_f32 v10, v10
    v_exp_f32 v11, v11
    v_exp_f32 v12, v12
    v_smfmac_f32_16x16x64_bf16 v[208:211], a[32:35], v[0:7], v224
    ds_read_b64_tr_b16 a[26:27], v226 offset:43264
    v_exp_f32 v13, v13
    v_exp_f32 v14, v14
    v_exp_f32 v15, v15
    v_mfma_f32_32x32x16_bf16 v[32:47], a[0:3], v[144:147], 4.0
    v_exp_f32 v16, v16
    v_exp_f32 v17, v17
    v_exp_f32 v18, v18
    v_mfma_f32_32x32x16_bf16 v[32:47], a[4:7], v[148:151], v[32:47]
    s_waitcnt lgkmcnt(4)
    v_exp_f32 v19, v19
    v_exp_f32 v20, v20
    v_exp_f32 v21, v21
    v_smfmac_f32_32x32x32_bf16 v[64:79], a[20:23], v[8:15], v224
    v_exp_f32 v22, v22
    v_exp_f32 v23, v23
    v_exp_f32 v24, v24
    v_smfmac_f32_16x16x64_bf16 v[208:211], a[32:35], v[8:15], v224
    ds_read_b64_tr_b16 a[28:29], v226 offset:44032
    v_exp_f32 v25, v25
    v_smfmac_f32_32x32x32_bf16 v[80:95], a[16:19], v[16:23], v224
    v_exp_f32 v26, v26
    v_exp_f32 v27, v27
    v_exp_f32 v28, v28
    v_smfmac_f32_16x16x64_bf16 v[212:215], a[32:35], v[16:23], v224
    ds_read_b64_tr_b16 a[30:31], v226 offset:44288
    v_exp_f32 v29, v29
    v_exp_f32 v30, v30
    v_exp_f32 v31, v31
    v_mfma_f32_32x32x16_bf16 v[48:63], a[0:3], v[152:155], 4.0
    v_exp_f32 v32, v32
    v_exp_f32 v33, v33
    v_exp_f32 v34, v34
    v_mfma_f32_32x32x16_bf16 v[48:63], a[4:7], v[156:159], v[48:63]
    v_exp_f32 v35, v35
    v_exp_f32 v36, v36
    v_exp_f32 v37, v37
    v_smfmac_f32_32x32x32_bf16 v[80:95], a[20:23], v[24:31], v224
    v_exp_f32 v38, v38
    v_exp_f32 v39, v39
    v_exp_f32 v40, v40
    v_smfmac_f32_16x16x64_bf16 v[212:215], a[32:35], v[24:31], v224
    v_exp_f32 v41, v41
    v_smfmac_f32_32x32x32_bf16 v[96:111], a[16:19], v[32:39], v224
    v_exp_f32 v42, v42
    v_exp_f32 v43, v43
    v_exp_f32 v44, v44
    v_smfmac_f32_16x16x64_bf16 v[216:219], a[32:35], v[32:39], v224
    s_waitcnt lgkmcnt(5)
    v_exp_f32 v45, v45
    v_exp_f32 v46, v46
    v_exp_f32 v47, v47
    v_mfma_f32_32x32x16_bf16 v[0:15], a[8:11], v[128:131], 4.0
    s_waitcnt lgkmcnt(4)
    v_exp_f32 v48, v48
    v_exp_f32 v49, v49
    v_exp_f32 v50, v50
    v_mfma_f32_32x32x16_bf16 v[0:15], a[12:15], v[132:135], v[0:15]
    v_exp_f32 v51, v51
    v_exp_f32 v52, v52
    v_exp_f32 v53, v53
    v_smfmac_f32_32x32x32_bf16 v[96:111], a[20:23], v[40:47], v224
    v_exp_f32 v54, v54
    v_exp_f32 v55, v55
    v_exp_f32 v56, v56
    v_smfmac_f32_16x16x64_bf16 v[216:219], a[32:35], v[40:47], v224
    ds_read_b128 a[0:3], v225 offset:45056
    v_exp_f32 v57, v57
    v_smfmac_f32_32x32x32_bf16 v[112:127], a[16:19], v[48:55], v224
    v_exp_f32 v58, v58
    v_exp_f32 v59, v59
    v_exp_f32 v60, v60
    v_smfmac_f32_16x16x64_bf16 v[220:223], a[32:35], v[48:55], v224
    ds_read_b128 a[4:7], v225 offset:46080
    v_exp_f32 v61, v61
    v_exp_f32 v62, v62
    v_exp_f32 v63, v63
    v_mfma_f32_32x32x16_bf16 v[16:31], a[8:11], v[136:139], 4.0
    v_exp_f32 v0, v0
    v_exp_f32 v1, v1
    v_exp_f32 v2, v2
    v_mfma_f32_32x32x16_bf16 v[16:31], a[12:15], v[140:143], v[16:31]
    v_exp_f32 v3, v3
    v_exp_f32 v4, v4
    v_exp_f32 v5, v5
    v_smfmac_f32_32x32x32_bf16 v[112:127], a[20:23], v[56:63], v224
    v_exp_f32 v6, v6
    v_exp_f32 v7, v7
    v_exp_f32 v8, v8
    v_smfmac_f32_16x16x64_bf16 v[220:223], a[32:35], v[56:63], v224
    s_waitcnt lgkmcnt(4)
    ds_read_b64_tr_b16 a[16:17], v226 offset:45056
    v_exp_f32 v9, v9
    v_smfmac_f32_32x32x32_bf16 v[64:79], a[24:27], v[0:7], v224
    v_exp_f32 v10, v10
    v_exp_f32 v11, v11
    v_exp_f32 v12, v12
    v_smfmac_f32_16x16x64_bf16 v[208:211], a[32:35], v[0:7], v224
    ds_read_b64_tr_b16 a[18:19], v226 offset:45312
    v_exp_f32 v13, v13
    v_exp_f32 v14, v14
    v_exp_f32 v15, v15
    v_mfma_f32_32x32x16_bf16 v[32:47], a[8:11], v[144:147], 4.0
    v_exp_f32 v16, v16
    v_exp_f32 v17, v17
    v_exp_f32 v18, v18
    v_mfma_f32_32x32x16_bf16 v[32:47], a[12:15], v[148:151], v[32:47]
    s_waitcnt lgkmcnt(4)
    v_exp_f32 v19, v19
    v_exp_f32 v20, v20
    v_exp_f32 v21, v21
    v_smfmac_f32_32x32x32_bf16 v[64:79], a[28:31], v[8:15], v224
    v_exp_f32 v22, v22
    v_exp_f32 v23, v23
    v_exp_f32 v24, v24
    v_smfmac_f32_16x16x64_bf16 v[208:211], a[32:35], v[8:15], v224
    ds_read_b64_tr_b16 a[20:21], v226 offset:46080
    v_exp_f32 v25, v25
    v_smfmac_f32_32x32x32_bf16 v[80:95], a[24:27], v[16:23], v224
    v_exp_f32 v26, v26
    v_exp_f32 v27, v27
    v_exp_f32 v28, v28
    v_smfmac_f32_16x16x64_bf16 v[212:215], a[32:35], v[16:23], v224
    ds_read_b64_tr_b16 a[22:23], v226 offset:46336
    v_exp_f32 v29, v29
    v_exp_f32 v30, v30
    v_exp_f32 v31, v31
    v_mfma_f32_32x32x16_bf16 v[48:63], a[8:11], v[152:155], 4.0
    v_exp_f32 v32, v32
    v_exp_f32 v33, v33
    v_exp_f32 v34, v34
    v_mfma_f32_32x32x16_bf16 v[48:63], a[12:15], v[156:159], v[48:63]
    v_exp_f32 v35, v35
    v_exp_f32 v36, v36
    v_exp_f32 v37, v37
    v_smfmac_f32_32x32x32_bf16 v[80:95], a[28:31], v[24:31], v224
    v_exp_f32 v38, v38
    v_exp_f32 v39, v39
    v_exp_f32 v40, v40
    v_smfmac_f32_16x16x64_bf16 v[212:215], a[32:35], v[24:31], v224
    v_exp_f32 v41, v41
    v_smfmac_f32_32x32x32_bf16 v[96:111], a[24:27], v[32:39], v224
    v_exp_f32 v42, v42
    v_exp_f32 v43, v43
    v_exp_f32 v44, v44
    v_smfmac_f32_16x16x64_bf16 v[216:219], a[32:35], v[32:39], v224
    s_waitcnt lgkmcnt(5)
    v_exp_f32 v45, v45
    v_exp_f32 v46, v46
    v_exp_f32 v47, v47
    v_mfma_f32_32x32x16_bf16 v[0:15], a[0:3], v[128:131], 4.0
    s_waitcnt lgkmcnt(4)
    v_exp_f32 v48, v48
    v_exp_f32 v49, v49
    v_exp_f32 v50, v50
    v_mfma_f32_32x32x16_bf16 v[0:15], a[4:7], v[132:135], v[0:15]
    s_waitcnt vmcnt(0) lgkmcnt(0)
    v_exp_f32 v51, v51
    v_exp_f32 v52, v52
    v_exp_f32 v53, v53
    v_smfmac_f32_32x32x32_bf16 v[96:111], a[28:31], v[40:47], v224
    s_barrier
    v_exp_f32 v54, v54
    v_exp_f32 v55, v55
    v_exp_f32 v56, v56
    v_smfmac_f32_16x16x64_bf16 v[216:219], a[32:35], v[40:47], v224
    ds_read_b128 a[8:11], v225 offset:0
    v_exp_f32 v57, v57
    v_smfmac_f32_32x32x32_bf16 v[112:127], a[24:27], v[48:55], v224
    v_exp_f32 v58, v58
    v_exp_f32 v59, v59
    v_exp_f32 v60, v60
    v_smfmac_f32_16x16x64_bf16 v[220:223], a[32:35], v[48:55], v224
    ds_read_b128 a[12:15], v225 offset:1024
    v_exp_f32 v61, v61
    v_exp_f32 v62, v62
    v_exp_f32 v63, v63
    v_mfma_f32_32x32x16_bf16 v[16:31], a[0:3], v[136:139], 4.0
    v_exp_f32 v0, v0
    v_exp_f32 v1, v1
    v_exp_f32 v2, v2
    v_mfma_f32_32x32x16_bf16 v[16:31], a[4:7], v[140:143], v[16:31]
    v_exp_f32 v3, v3
    v_exp_f32 v4, v4
    v_exp_f32 v5, v5
    v_smfmac_f32_32x32x32_bf16 v[112:127], a[28:31], v[56:63], v224
    v_exp_f32 v6, v6
    v_exp_f32 v7, v7
    v_exp_f32 v8, v8
    v_smfmac_f32_16x16x64_bf16 v[220:223], a[32:35], v[56:63], v224
    ds_read_b64_tr_b16 a[24:25], v226 offset:0
    v_exp_f32 v9, v9
    v_smfmac_f32_32x32x32_bf16 v[64:79], a[16:19], v[0:7], v224
    v_exp_f32 v10, v10
    v_exp_f32 v11, v11
    v_exp_f32 v12, v12
    v_smfmac_f32_16x16x64_bf16 v[208:211], a[32:35], v[0:7], v224
    ds_read_b64_tr_b16 a[26:27], v226 offset:256
    v_exp_f32 v13, v13
    v_exp_f32 v14, v14
    v_exp_f32 v15, v15
    v_mfma_f32_32x32x16_bf16 v[32:47], a[0:3], v[144:147], 4.0
    v_exp_f32 v16, v16
    v_exp_f32 v17, v17
    v_exp_f32 v18, v18
    v_mfma_f32_32x32x16_bf16 v[32:47], a[4:7], v[148:151], v[32:47]
    v_exp_f32 v19, v19
    v_exp_f32 v20, v20
    v_exp_f32 v21, v21
    v_smfmac_f32_32x32x32_bf16 v[64:79], a[20:23], v[8:15], v224
    v_exp_f32 v22, v22
    v_exp_f32 v23, v23
    v_exp_f32 v24, v24
    v_smfmac_f32_16x16x64_bf16 v[208:211], a[32:35], v[8:15], v224
    ds_read_b64_tr_b16 a[28:29], v226 offset:1024
    v_exp_f32 v25, v25
    v_smfmac_f32_32x32x32_bf16 v[80:95], a[16:19], v[16:23], v224
    v_exp_f32 v26, v26
    v_exp_f32 v27, v27
    v_exp_f32 v28, v28
    v_smfmac_f32_16x16x64_bf16 v[212:215], a[32:35], v[16:23], v224
    ds_read_b64_tr_b16 a[30:31], v226 offset:1280
    v_exp_f32 v29, v29
    v_exp_f32 v30, v30
    v_exp_f32 v31, v31
    v_mfma_f32_32x32x16_bf16 v[48:63], a[0:3], v[152:155], 4.0
    v_exp_f32 v32, v32
    v_exp_f32 v33, v33
    v_exp_f32 v34, v34
    v_mfma_f32_32x32x16_bf16 v[48:63], a[4:7], v[156:159], v[48:63]
    v_exp_f32 v35, v35
    v_exp_f32 v36, v36
    v_exp_f32 v37, v37
    v_smfmac_f32_32x32x32_bf16 v[80:95], a[20:23], v[24:31], v224
    v_exp_f32 v38, v38
    v_exp_f32 v39, v39
    v_exp_f32 v40, v40
    v_smfmac_f32_16x16x64_bf16 v[212:215], a[32:35], v[24:31], v224
    v_exp_f32 v41, v41
    v_smfmac_f32_32x32x32_bf16 v[96:111], a[16:19], v[32:39], v224
    v_exp_f32 v42, v42
    v_exp_f32 v43, v43
    v_exp_f32 v44, v44
    v_smfmac_f32_16x16x64_bf16 v[216:219], a[32:35], v[32:39], v224
    s_waitcnt lgkmcnt(5)
    v_exp_f32 v45, v45
    v_exp_f32 v46, v46
    v_exp_f32 v47, v47
    v_mfma_f32_32x32x16_bf16 v[0:15], a[8:11], v[128:131], 4.0
    s_waitcnt lgkmcnt(4)
    v_exp_f32 v48, v48
    v_exp_f32 v49, v49
    v_exp_f32 v50, v50
    v_mfma_f32_32x32x16_bf16 v[0:15], a[12:15], v[132:135], v[0:15]
    v_exp_f32 v51, v51
    v_exp_f32 v52, v52
    v_exp_f32 v53, v53
    v_smfmac_f32_32x32x32_bf16 v[96:111], a[20:23], v[40:47], v224
    v_exp_f32 v54, v54
    v_exp_f32 v55, v55
    v_exp_f32 v56, v56
    v_smfmac_f32_16x16x64_bf16 v[216:219], a[32:35], v[40:47], v224
    ds_read_b128 a[0:3], v225 offset:2048
    v_exp_f32 v57, v57
    v_smfmac_f32_32x32x32_bf16 v[112:127], a[16:19], v[48:55], v224
    v_exp_f32 v58, v58
    v_exp_f32 v59, v59
    v_exp_f32 v60, v60
    v_smfmac_f32_16x16x64_bf16 v[220:223], a[32:35], v[48:55], v224
    ds_read_b128 a[4:7], v225 offset:3072
    v_exp_f32 v61, v61
    v_exp_f32 v62, v62
    v_exp_f32 v63, v63
    v_mfma_f32_32x32x16_bf16 v[16:31], a[8:11], v[136:139], 4.0
    v_exp_f32 v0, v0
    v_exp_f32 v1, v1
    v_exp_f32 v2, v2
    v_mfma_f32_32x32x16_bf16 v[16:31], a[12:15], v[140:143], v[16:31]
    v_exp_f32 v3, v3
    v_exp_f32 v4, v4
    v_exp_f32 v5, v5
    v_smfmac_f32_32x32x32_bf16 v[112:127], a[20:23], v[56:63], v224
    v_exp_f32 v6, v6
    v_exp_f32 v7, v7
    v_exp_f32 v8, v8
    v_smfmac_f32_16x16x64_bf16 v[220:223], a[32:35], v[56:63], v224
    s_waitcnt lgkmcnt(4)
    ds_read_b64_tr_b16 a[16:17], v226 offset:2048
    v_exp_f32 v9, v9
    v_smfmac_f32_32x32x32_bf16 v[64:79], a[24:27], v[0:7], v224
    v_exp_f32 v10, v10
    v_exp_f32 v11, v11
    v_exp_f32 v12, v12
    v_smfmac_f32_16x16x64_bf16 v[208:211], a[32:35], v[0:7], v224
    ds_read_b64_tr_b16 a[18:19], v226 offset:2304
    v_exp_f32 v13, v13
    v_exp_f32 v14, v14
    v_exp_f32 v15, v15
    v_mfma_f32_32x32x16_bf16 v[32:47], a[8:11], v[144:147], 4.0
    v_exp_f32 v16, v16
    v_exp_f32 v17, v17
    v_exp_f32 v18, v18
    v_mfma_f32_32x32x16_bf16 v[32:47], a[12:15], v[148:151], v[32:47]
    s_waitcnt lgkmcnt(4)
    v_exp_f32 v19, v19
    v_exp_f32 v20, v20
    v_exp_f32 v21, v21
    v_smfmac_f32_32x32x32_bf16 v[64:79], a[28:31], v[8:15], v224
    v_exp_f32 v22, v22
    v_exp_f32 v23, v23
    v_exp_f32 v24, v24
    v_smfmac_f32_16x16x64_bf16 v[208:211], a[32:35], v[8:15], v224
    ds_read_b64_tr_b16 a[20:21], v226 offset:3072
    v_exp_f32 v25, v25
    v_smfmac_f32_32x32x32_bf16 v[80:95], a[24:27], v[16:23], v224
    v_exp_f32 v26, v26
    v_exp_f32 v27, v27
    v_exp_f32 v28, v28
    v_smfmac_f32_16x16x64_bf16 v[212:215], a[32:35], v[16:23], v224
    ds_read_b64_tr_b16 a[22:23], v226 offset:3328
    v_exp_f32 v29, v29
    v_exp_f32 v30, v30
    v_exp_f32 v31, v31
    v_mfma_f32_32x32x16_bf16 v[48:63], a[8:11], v[152:155], 4.0
    v_exp_f32 v32, v32
    v_exp_f32 v33, v33
    v_exp_f32 v34, v34
    v_mfma_f32_32x32x16_bf16 v[48:63], a[12:15], v[156:159], v[48:63]
    v_exp_f32 v35, v35
    v_exp_f32 v36, v36
    v_exp_f32 v37, v37
    v_smfmac_f32_32x32x32_bf16 v[80:95], a[28:31], v[24:31], v224
    v_exp_f32 v38, v38
    v_exp_f32 v39, v39
    v_exp_f32 v40, v40
    v_smfmac_f32_16x16x64_bf16 v[212:215], a[32:35], v[24:31], v224
    v_exp_f32 v41, v41
    v_smfmac_f32_32x32x32_bf16 v[96:111], a[24:27], v[32:39], v224
    v_exp_f32 v42, v42
    v_exp_f32 v43, v43
    v_exp_f32 v44, v44
    v_smfmac_f32_16x16x64_bf16 v[216:219], a[32:35], v[32:39], v224
    s_waitcnt lgkmcnt(5)
    v_exp_f32 v45, v45
    v_exp_f32 v46, v46
    v_exp_f32 v47, v47
    v_mfma_f32_32x32x16_bf16 v[0:15], a[0:3], v[128:131], 4.0
    s_waitcnt lgkmcnt(4)
    v_exp_f32 v48, v48
    v_exp_f32 v49, v49
    v_exp_f32 v50, v50
    v_mfma_f32_32x32x16_bf16 v[0:15], a[4:7], v[132:135], v[0:15]
    v_exp_f32 v51, v51
    v_exp_f32 v52, v52
    v_exp_f32 v53, v53
    v_smfmac_f32_32x32x32_bf16 v[96:111], a[28:31], v[40:47], v224
    v_exp_f32 v54, v54
    v_exp_f32 v55, v55
    v_exp_f32 v56, v56
    v_smfmac_f32_16x16x64_bf16 v[216:219], a[32:35], v[40:47], v224
    ds_read_b128 a[8:11], v225 offset:4096
    v_exp_f32 v57, v57
    v_smfmac_f32_32x32x32_bf16 v[112:127], a[24:27], v[48:55], v224
    v_exp_f32 v58, v58
    v_exp_f32 v59, v59
    v_exp_f32 v60, v60
    v_smfmac_f32_16x16x64_bf16 v[220:223], a[32:35], v[48:55], v224
    ds_read_b128 a[12:15], v225 offset:5120
    v_exp_f32 v61, v61
    v_exp_f32 v62, v62
    v_exp_f32 v63, v63
    v_mfma_f32_32x32x16_bf16 v[16:31], a[0:3], v[136:139], 4.0
    v_exp_f32 v0, v0
    v_exp_f32 v1, v1
    v_exp_f32 v2, v2
    v_mfma_f32_32x32x16_bf16 v[16:31], a[4:7], v[140:143], v[16:31]
    v_exp_f32 v3, v3
    v_exp_f32 v4, v4
    v_exp_f32 v5, v5
    v_smfmac_f32_32x32x32_bf16 v[112:127], a[28:31], v[56:63], v224
    v_exp_f32 v6, v6
    v_exp_f32 v7, v7
    v_exp_f32 v8, v8
    v_smfmac_f32_16x16x64_bf16 v[220:223], a[32:35], v[56:63], v224
    s_waitcnt lgkmcnt(4)
    ds_read_b64_tr_b16 a[24:25], v226 offset:4096
    v_exp_f32 v9, v9
    v_smfmac_f32_32x32x32_bf16 v[64:79], a[16:19], v[0:7], v224
    v_exp_f32 v10, v10
    v_exp_f32 v11, v11
    v_exp_f32 v12, v12
    v_smfmac_f32_16x16x64_bf16 v[208:211], a[32:35], v[0:7], v224
    ds_read_b64_tr_b16 a[26:27], v226 offset:4352
    v_exp_f32 v13, v13
    v_exp_f32 v14, v14
    v_exp_f32 v15, v15
    v_mfma_f32_32x32x16_bf16 v[32:47], a[0:3], v[144:147], 4.0
    v_exp_f32 v16, v16
    v_exp_f32 v17, v17
    v_exp_f32 v18, v18
    v_mfma_f32_32x32x16_bf16 v[32:47], a[4:7], v[148:151], v[32:47]
    s_waitcnt lgkmcnt(4)
    v_exp_f32 v19, v19
    v_exp_f32 v20, v20
    v_exp_f32 v21, v21
    v_smfmac_f32_32x32x32_bf16 v[64:79], a[20:23], v[8:15], v224
    v_exp_f32 v22, v22
    v_exp_f32 v23, v23
    v_exp_f32 v24, v24
    v_smfmac_f32_16x16x64_bf16 v[208:211], a[32:35], v[8:15], v224
    ds_read_b64_tr_b16 a[28:29], v226 offset:5120
    v_exp_f32 v25, v25
    v_smfmac_f32_32x32x32_bf16 v[80:95], a[16:19], v[16:23], v224
    v_exp_f32 v26, v26
    v_exp_f32 v27, v27
    v_exp_f32 v28, v28
    v_smfmac_f32_16x16x64_bf16 v[212:215], a[32:35], v[16:23], v224
    ds_read_b64_tr_b16 a[30:31], v226 offset:5376
    v_exp_f32 v29, v29
    v_exp_f32 v30, v30
    v_exp_f32 v31, v31
    v_mfma_f32_32x32x16_bf16 v[48:63], a[0:3], v[152:155], 4.0
    v_exp_f32 v32, v32
    v_exp_f32 v33, v33
    v_exp_f32 v34, v34
    v_mfma_f32_32x32x16_bf16 v[48:63], a[4:7], v[156:159], v[48:63]
    v_exp_f32 v35, v35
    v_exp_f32 v36, v36
    v_exp_f32 v37, v37
    v_smfmac_f32_32x32x32_bf16 v[80:95], a[20:23], v[24:31], v224
    v_exp_f32 v38, v38
    v_exp_f32 v39, v39
    v_exp_f32 v40, v40
    v_smfmac_f32_16x16x64_bf16 v[212:215], a[32:35], v[24:31], v224
    v_exp_f32 v41, v41
    v_smfmac_f32_32x32x32_bf16 v[96:111], a[16:19], v[32:39], v224
    v_exp_f32 v42, v42
    v_exp_f32 v43, v43
    v_exp_f32 v44, v44
    v_smfmac_f32_16x16x64_bf16 v[216:219], a[32:35], v[32:39], v224
    s_waitcnt lgkmcnt(5)
    v_exp_f32 v45, v45
    v_exp_f32 v46, v46
    v_exp_f32 v47, v47
    v_mfma_f32_32x32x16_bf16 v[0:15], a[8:11], v[128:131], 4.0
    s_waitcnt lgkmcnt(4)
    v_exp_f32 v48, v48
    v_exp_f32 v49, v49
    v_exp_f32 v50, v50
    v_mfma_f32_32x32x16_bf16 v[0:15], a[12:15], v[132:135], v[0:15]
    v_exp_f32 v51, v51
    v_exp_f32 v52, v52
    v_exp_f32 v53, v53
    v_smfmac_f32_32x32x32_bf16 v[96:111], a[20:23], v[40:47], v224
    v_exp_f32 v54, v54
    v_exp_f32 v55, v55
    v_exp_f32 v56, v56
    v_smfmac_f32_16x16x64_bf16 v[216:219], a[32:35], v[40:47], v224
    ds_read_b128 a[0:3], v225 offset:6144
    v_exp_f32 v57, v57
    v_smfmac_f32_32x32x32_bf16 v[112:127], a[16:19], v[48:55], v224
    v_exp_f32 v58, v58
    v_exp_f32 v59, v59
    v_exp_f32 v60, v60
    v_smfmac_f32_16x16x64_bf16 v[220:223], a[32:35], v[48:55], v224
    ds_read_b128 a[4:7], v225 offset:7168
    v_exp_f32 v61, v61
    v_exp_f32 v62, v62
    v_exp_f32 v63, v63
    v_mfma_f32_32x32x16_bf16 v[16:31], a[8:11], v[136:139], 4.0
    v_exp_f32 v0, v0
    v_exp_f32 v1, v1
    v_exp_f32 v2, v2
    v_mfma_f32_32x32x16_bf16 v[16:31], a[12:15], v[140:143], v[16:31]
    v_exp_f32 v3, v3
    v_exp_f32 v4, v4
    v_exp_f32 v5, v5
    v_smfmac_f32_32x32x32_bf16 v[112:127], a[20:23], v[56:63], v224
    v_exp_f32 v6, v6
    v_exp_f32 v7, v7
    v_exp_f32 v8, v8
    v_smfmac_f32_16x16x64_bf16 v[220:223], a[32:35], v[56:63], v224
    s_waitcnt lgkmcnt(4)
    ds_read_b64_tr_b16 a[16:17], v226 offset:6144
    v_exp_f32 v9, v9
    v_smfmac_f32_32x32x32_bf16 v[64:79], a[24:27], v[0:7], v224
    v_exp_f32 v10, v10
    v_exp_f32 v11, v11
    v_exp_f32 v12, v12
    v_smfmac_f32_16x16x64_bf16 v[208:211], a[32:35], v[0:7], v224
    ds_read_b64_tr_b16 a[18:19], v226 offset:6400
    v_exp_f32 v13, v13
    v_exp_f32 v14, v14
    v_exp_f32 v15, v15
    v_mfma_f32_32x32x16_bf16 v[32:47], a[8:11], v[144:147], 4.0
    v_exp_f32 v16, v16
    v_exp_f32 v17, v17
    v_exp_f32 v18, v18
    v_mfma_f32_32x32x16_bf16 v[32:47], a[12:15], v[148:151], v[32:47]
    s_waitcnt lgkmcnt(4)
    v_exp_f32 v19, v19
    v_exp_f32 v20, v20
    v_exp_f32 v21, v21
    v_smfmac_f32_32x32x32_bf16 v[64:79], a[28:31], v[8:15], v224
    v_exp_f32 v22, v22
    v_exp_f32 v23, v23
    v_exp_f32 v24, v24
    v_smfmac_f32_16x16x64_bf16 v[208:211], a[32:35], v[8:15], v224
    ds_read_b64_tr_b16 a[20:21], v226 offset:7168
    v_exp_f32 v25, v25
    v_smfmac_f32_32x32x32_bf16 v[80:95], a[24:27], v[16:23], v224
    v_exp_f32 v26, v26
    v_exp_f32 v27, v27
    v_exp_f32 v28, v28
    v_smfmac_f32_16x16x64_bf16 v[212:215], a[32:35], v[16:23], v224
    ds_read_b64_tr_b16 a[22:23], v226 offset:7424
    v_exp_f32 v29, v29
    v_exp_f32 v30, v30
    v_exp_f32 v31, v31
    v_mfma_f32_32x32x16_bf16 v[48:63], a[8:11], v[152:155], 4.0
    v_exp_f32 v32, v32
    v_exp_f32 v33, v33
    v_exp_f32 v34, v34
    v_mfma_f32_32x32x16_bf16 v[48:63], a[12:15], v[156:159], v[48:63]
    v_exp_f32 v35, v35
    v_exp_f32 v36, v36
    v_exp_f32 v37, v37
    v_smfmac_f32_32x32x32_bf16 v[80:95], a[28:31], v[24:31], v224
    v_exp_f32 v38, v38
    v_exp_f32 v39, v39
    v_exp_f32 v40, v40
    v_smfmac_f32_16x16x64_bf16 v[212:215], a[32:35], v[24:31], v224
    v_exp_f32 v41, v41
    v_smfmac_f32_32x32x32_bf16 v[96:111], a[24:27], v[32:39], v224
    v_exp_f32 v42, v42
    v_exp_f32 v43, v43
    v_exp_f32 v44, v44
    v_smfmac_f32_16x16x64_bf16 v[216:219], a[32:35], v[32:39], v224
    s_waitcnt lgkmcnt(5)
    v_exp_f32 v45, v45
    v_exp_f32 v46, v46
    v_exp_f32 v47, v47
    v_mfma_f32_32x32x16_bf16 v[0:15], a[0:3], v[128:131], 4.0
    s_waitcnt lgkmcnt(4)
    v_exp_f32 v48, v48
    v_exp_f32 v49, v49
    v_exp_f32 v50, v50
    v_mfma_f32_32x32x16_bf16 v[0:15], a[4:7], v[132:135], v[0:15]
    v_exp_f32 v51, v51
    v_exp_f32 v52, v52
    v_exp_f32 v53, v53
    v_smfmac_f32_32x32x32_bf16 v[96:111], a[28:31], v[40:47], v224
    v_exp_f32 v54, v54
    v_exp_f32 v55, v55
    v_exp_f32 v56, v56
    v_smfmac_f32_16x16x64_bf16 v[216:219], a[32:35], v[40:47], v224
    ds_read_b128 a[8:11], v225 offset:8192
    v_exp_f32 v57, v57
    v_smfmac_f32_32x32x32_bf16 v[112:127], a[24:27], v[48:55], v224
    v_exp_f32 v58, v58
    v_exp_f32 v59, v59
    v_exp_f32 v60, v60
    v_smfmac_f32_16x16x64_bf16 v[220:223], a[32:35], v[48:55], v224
    ds_read_b128 a[12:15], v225 offset:9216
    v_exp_f32 v61, v61
    v_exp_f32 v62, v62
    v_exp_f32 v63, v63
    v_mfma_f32_32x32x16_bf16 v[16:31], a[0:3], v[136:139], 4.0
    v_exp_f32 v0, v0
    v_exp_f32 v1, v1
    v_exp_f32 v2, v2
    v_mfma_f32_32x32x16_bf16 v[16:31], a[4:7], v[140:143], v[16:31]
    v_exp_f32 v3, v3
    v_exp_f32 v4, v4
    v_exp_f32 v5, v5
    v_smfmac_f32_32x32x32_bf16 v[112:127], a[28:31], v[56:63], v224
    v_exp_f32 v6, v6
    v_exp_f32 v7, v7
    v_exp_f32 v8, v8
    v_smfmac_f32_16x16x64_bf16 v[220:223], a[32:35], v[56:63], v224
    s_waitcnt lgkmcnt(4)
    ds_read_b64_tr_b16 a[24:25], v226 offset:8192
    ds_read_b64_tr_b16 a[26:27], v226 offset:8448
    v_exp_f32 v9, v9
    v_smfmac_f32_32x32x32_bf16 v[64:79], a[16:19], v[0:7], v224
    v_exp_f32 v10, v10
    v_exp_f32 v11, v11
    v_exp_f32 v12, v12
    v_smfmac_f32_16x16x64_bf16 v[208:211], a[32:35], v[0:7], v224
    s_waitcnt lgkmcnt(3)
    ds_read_b64_tr_b16 a[28:29], v226 offset:9216
    ds_read_b64_tr_b16 a[30:31], v226 offset:9472
    v_exp_f32 v13, v13
    v_exp_f32 v14, v14
    v_exp_f32 v15, v15
    v_mfma_f32_32x32x16_bf16 v[32:47], a[8:11], v[128:131], 4.0
    s_waitcnt lgkmcnt(4)
    v_exp_f32 v16, v16
    v_exp_f32 v17, v17
    v_exp_f32 v18, v18
    v_mfma_f32_32x32x16_bf16 v[32:47], a[12:15], v[132:135], v[32:47]
    v_exp_f32 v19, v19
    v_exp_f32 v20, v20
    v_exp_f32 v21, v21
    v_smfmac_f32_32x32x32_bf16 v[64:79], a[20:23], v[8:15], v224
    v_exp_f32 v22, v22
    v_exp_f32 v23, v23
    v_exp_f32 v24, v24
    v_smfmac_f32_16x16x64_bf16 v[208:211], a[32:35], v[8:15], v224
    ds_read_b128 a[0:3], v225 offset:10240
    v_exp_f32 v25, v25
    v_smfmac_f32_32x32x32_bf16 v[80:95], a[16:19], v[16:23], v224
    v_exp_f32 v26, v26
    v_exp_f32 v27, v27
    v_exp_f32 v28, v28
    v_smfmac_f32_16x16x64_bf16 v[212:215], a[32:35], v[16:23], v224
    ds_read_b128 a[4:7], v225 offset:11264
    v_exp_f32 v29, v29
    v_exp_f32 v30, v30
    v_exp_f32 v31, v31
    v_mfma_f32_32x32x16_bf16 v[48:63], a[8:11], v[136:139], 4.0
    v_exp_f32 v32, v32
    v_exp_f32 v33, v33
    v_exp_f32 v34, v34
    v_mfma_f32_32x32x16_bf16 v[48:63], a[12:15], v[140:143], v[48:63]
    v_exp_f32 v35, v35
    v_exp_f32 v36, v36
    v_exp_f32 v37, v37
    v_smfmac_f32_32x32x32_bf16 v[80:95], a[20:23], v[24:31], v224
    v_exp_f32 v38, v38
    v_exp_f32 v39, v39
    v_exp_f32 v40, v40
    v_smfmac_f32_16x16x64_bf16 v[212:215], a[32:35], v[24:31], v224
    s_waitcnt lgkmcnt(4)
    ds_read_b64_tr_b16 a[16:17], v226 offset:10240
    ds_read_b64_tr_b16 a[18:19], v226 offset:10496
    v_exp_f32 v41, v41
    v_smfmac_f32_32x32x32_bf16 v[64:79], a[24:27], v[32:39], v224
    v_exp_f32 v42, v42
    v_exp_f32 v43, v43
    v_exp_f32 v44, v44
    v_smfmac_f32_16x16x64_bf16 v[208:211], a[32:35], v[32:39], v224
    s_waitcnt lgkmcnt(3)
    ds_read_b64_tr_b16 a[20:21], v226 offset:11264
    ds_read_b64_tr_b16 a[22:23], v226 offset:11520
    v_exp_f32 v45, v45
    v_exp_f32 v46, v46
    v_exp_f32 v47, v47
    v_mfma_f32_32x32x16_bf16 v[0:15], a[0:3], v[128:131], 4.0
    s_waitcnt lgkmcnt(4)
    v_exp_f32 v48, v48
    v_exp_f32 v49, v49
    v_exp_f32 v50, v50
    v_mfma_f32_32x32x16_bf16 v[0:15], a[4:7], v[132:135], v[0:15]
    v_exp_f32 v51, v51
    v_exp_f32 v52, v52
    v_exp_f32 v53, v53
    v_smfmac_f32_32x32x32_bf16 v[64:79], a[28:31], v[40:47], v224
    v_exp_f32 v54, v54
    v_exp_f32 v55, v55
    v_exp_f32 v56, v56
    v_smfmac_f32_16x16x64_bf16 v[208:211], a[32:35], v[40:47], v224
    ds_read_b128 a[8:11], v225 offset:12288
    v_exp_f32 v57, v57
    v_smfmac_f32_32x32x32_bf16 v[80:95], a[24:27], v[48:55], v224
    v_exp_f32 v58, v58
    v_exp_f32 v59, v59
    v_exp_f32 v60, v60
    v_smfmac_f32_16x16x64_bf16 v[212:215], a[32:35], v[48:55], v224
    ds_read_b128 a[12:15], v225 offset:13312
    v_exp_f32 v61, v61
    v_exp_f32 v62, v62
    v_exp_f32 v63, v63
    v_mfma_f32_32x32x16_bf16 v[16:31], a[0:3], v[136:139], 4.0
    v_exp_f32 v0, v0
    v_exp_f32 v1, v1
    v_exp_f32 v2, v2
    v_mfma_f32_32x32x16_bf16 v[16:31], a[4:7], v[140:143], v[16:31]
    v_exp_f32 v3, v3
    v_exp_f32 v4, v4
    v_exp_f32 v5, v5
    v_smfmac_f32_32x32x32_bf16 v[80:95], a[28:31], v[56:63], v224
    v_exp_f32 v6, v6
    v_exp_f32 v7, v7
    v_exp_f32 v8, v8
    v_smfmac_f32_16x16x64_bf16 v[212:215], a[32:35], v[56:63], v224
    s_waitcnt lgkmcnt(4)
    ds_read_b64_tr_b16 a[24:25], v226 offset:12288
    ds_read_b64_tr_b16 a[26:27], v226 offset:12544
    v_exp_f32 v9, v9
    v_smfmac_f32_32x32x32_bf16 v[64:79], a[16:19], v[0:7], v224
    v_exp_f32 v10, v10
    v_exp_f32 v11, v11
    v_exp_f32 v12, v12
    v_smfmac_f32_16x16x64_bf16 v[208:211], a[32:35], v[0:7], v224
    s_waitcnt lgkmcnt(3)
    ds_read_b64_tr_b16 a[28:29], v226 offset:13312
    ds_read_b64_tr_b16 a[30:31], v226 offset:13568
    v_exp_f32 v13, v13
    v_exp_f32 v14, v14
    v_exp_f32 v15, v15
    v_mfma_f32_32x32x16_bf16 v[32:47], a[8:11], v[128:131], 4.0
    s_waitcnt lgkmcnt(4)
    v_exp_f32 v16, v16
    v_exp_f32 v17, v17
    v_exp_f32 v18, v18
    v_mfma_f32_32x32x16_bf16 v[32:47], a[12:15], v[132:135], v[32:47]
    v_exp_f32 v19, v19
    v_exp_f32 v20, v20
    v_exp_f32 v21, v21
    v_smfmac_f32_32x32x32_bf16 v[64:79], a[20:23], v[8:15], v224
    v_exp_f32 v22, v22
    v_exp_f32 v23, v23
    v_exp_f32 v24, v24
    v_smfmac_f32_16x16x64_bf16 v[208:211], a[32:35], v[8:15], v224
    ds_read_b128 a[0:3], v225 offset:6144
    v_exp_f32 v25, v25
    v_smfmac_f32_32x32x32_bf16 v[80:95], a[16:19], v[16:23], v224
    v_exp_f32 v26, v26
    v_exp_f32 v27, v27
    v_exp_f32 v28, v28
    v_smfmac_f32_16x16x64_bf16 v[212:215], a[32:35], v[16:23], v224
    ds_read_b128 a[4:7], v225 offset:7168
    v_exp_f32 v29, v29
    v_exp_f32 v30, v30
    v_exp_f32 v31, v31
    v_mfma_f32_32x32x16_bf16 v[48:63], a[8:11], v[136:139], 4.0
    v_exp_f32 v32, v32
    v_exp_f32 v33, v33
    v_exp_f32 v34, v34
    v_mfma_f32_32x32x16_bf16 v[48:63], a[12:15], v[140:143], v[48:63]
    v_exp_f32 v35, v35
    v_exp_f32 v36, v36
    v_exp_f32 v37, v37
    v_smfmac_f32_32x32x32_bf16 v[80:95], a[20:23], v[24:31], v224
    v_exp_f32 v38, v38
    v_exp_f32 v39, v39
    v_exp_f32 v40, v40
    v_smfmac_f32_16x16x64_bf16 v[212:215], a[32:35], v[24:31], v224
    s_waitcnt lgkmcnt(4)
    ds_read_b64_tr_b16 a[16:17], v226 offset:6144
    ds_read_b64_tr_b16 a[18:19], v226 offset:6400
    v_exp_f32 v41, v41
    v_smfmac_f32_32x32x32_bf16 v[64:79], a[24:27], v[32:39], v224
    v_exp_f32 v42, v42
    v_exp_f32 v43, v43
    v_exp_f32 v44, v44
    v_smfmac_f32_16x16x64_bf16 v[208:211], a[32:35], v[32:39], v224
    s_waitcnt lgkmcnt(3)
    ds_read_b64_tr_b16 a[20:21], v226 offset:7168
    ds_read_b64_tr_b16 a[22:23], v226 offset:7424
    v_exp_f32 v45, v45
    v_exp_f32 v46, v46
    v_exp_f32 v47, v47
    v_mfma_f32_32x32x16_bf16 v[0:15], a[0:3], v[144:147], 4.0
    s_waitcnt lgkmcnt(4)
    v_exp_f32 v48, v48
    v_exp_f32 v49, v49
    v_exp_f32 v50, v50
    v_mfma_f32_32x32x16_bf16 v[0:15], a[4:7], v[148:151], v[0:15]
    v_exp_f32 v51, v51
    v_exp_f32 v52, v52
    v_exp_f32 v53, v53
    v_smfmac_f32_32x32x32_bf16 v[64:79], a[28:31], v[40:47], v224
    v_exp_f32 v54, v54
    v_exp_f32 v55, v55
    v_exp_f32 v56, v56
    v_smfmac_f32_16x16x64_bf16 v[208:211], a[32:35], v[40:47], v224
    ds_read_b128 a[8:11], v225 offset:8192
    v_exp_f32 v57, v57
    v_smfmac_f32_32x32x32_bf16 v[80:95], a[24:27], v[48:55], v224
    v_exp_f32 v58, v58
    v_exp_f32 v59, v59
    v_exp_f32 v60, v60
    v_smfmac_f32_16x16x64_bf16 v[212:215], a[32:35], v[48:55], v224
    ds_read_b128 a[12:15], v225 offset:9216
    v_exp_f32 v61, v61
    v_exp_f32 v62, v62
    v_exp_f32 v63, v63
    v_mfma_f32_32x32x16_bf16 v[16:31], a[0:3], v[152:155], 4.0
    v_exp_f32 v0, v0
    v_exp_f32 v1, v1
    v_exp_f32 v2, v2
    v_mfma_f32_32x32x16_bf16 v[16:31], a[4:7], v[156:159], v[16:31]
    v_exp_f32 v3, v3
    v_exp_f32 v4, v4
    v_exp_f32 v5, v5
    v_smfmac_f32_32x32x32_bf16 v[80:95], a[28:31], v[56:63], v224
    v_exp_f32 v6, v6
    v_exp_f32 v7, v7
    v_exp_f32 v8, v8
    v_smfmac_f32_16x16x64_bf16 v[212:215], a[32:35], v[56:63], v224
    s_waitcnt lgkmcnt(4)
    ds_read_b64_tr_b16 a[24:25], v226 offset:8192
    ds_read_b64_tr_b16 a[26:27], v226 offset:8448
    v_exp_f32 v9, v9
    v_smfmac_f32_32x32x32_bf16 v[96:111], a[16:19], v[0:7], v224
    v_exp_f32 v10, v10
    v_exp_f32 v11, v11
    v_exp_f32 v12, v12
    v_smfmac_f32_16x16x64_bf16 v[216:219], a[32:35], v[0:7], v224
    s_waitcnt lgkmcnt(3)
    ds_read_b64_tr_b16 a[28:29], v226 offset:9216
    ds_read_b64_tr_b16 a[30:31], v226 offset:9472
    v_exp_f32 v13, v13
    v_exp_f32 v14, v14
    v_exp_f32 v15, v15
    v_mfma_f32_32x32x16_bf16 v[32:47], a[8:11], v[144:147], 4.0
    s_waitcnt lgkmcnt(4)
    v_exp_f32 v16, v16
    v_exp_f32 v17, v17
    v_exp_f32 v18, v18
    v_mfma_f32_32x32x16_bf16 v[32:47], a[12:15], v[148:151], v[32:47]
    v_exp_f32 v19, v19
    v_exp_f32 v20, v20
    v_exp_f32 v21, v21
    v_smfmac_f32_32x32x32_bf16 v[96:111], a[20:23], v[8:15], v224
    v_exp_f32 v22, v22
    v_exp_f32 v23, v23
    v_exp_f32 v24, v24
    v_smfmac_f32_16x16x64_bf16 v[216:219], a[32:35], v[8:15], v224
    ds_read_b128 a[0:3], v225 offset:10240
    v_exp_f32 v25, v25
    v_smfmac_f32_32x32x32_bf16 v[112:127], a[16:19], v[16:23], v224
    v_exp_f32 v26, v26
    v_exp_f32 v27, v27
    v_rcp_f32 v236, v208
    v_exp_f32 v28, v28
    v_smfmac_f32_16x16x64_bf16 v[220:223], a[32:35], v[16:23], v224
    ds_read_b128 a[4:7], v225 offset:11264
    v_exp_f32 v29, v29
    v_exp_f32 v30, v30
    v_exp_f32 v31, v31
    v_pk_mul_f32 v[64:65], v[64:65], v[236:237] op_sel_hi:[1,0]
    v_pk_mul_f32 v[66:67], v[66:67], v[236:237] op_sel_hi:[1,0]
    v_pk_mul_f32 v[68:69], v[68:69], v[236:237] op_sel_hi:[1,0]
    v_pk_mul_f32 v[70:71], v[70:71], v[236:237] op_sel_hi:[1,0]
    v_pk_mul_f32 v[72:73], v[72:73], v[236:237] op_sel_hi:[1,0]
    v_pk_mul_f32 v[74:75], v[74:75], v[236:237] op_sel_hi:[1,0]
    v_pk_mul_f32 v[76:77], v[76:77], v[236:237] op_sel_hi:[1,0]
    v_pk_mul_f32 v[78:79], v[78:79], v[236:237] op_sel_hi:[1,0]
    v_cvt_pk_bf16_f32 v160, v64, v65
    v_cvt_pk_bf16_f32 v164, v72, v73
    v_cvt_pk_bf16_f32 v161, v66, v67
    v_cvt_pk_bf16_f32 v165, v74, v75
    v_cvt_pk_bf16_f32 v162, v68, v69
    v_cvt_pk_bf16_f32 v166, v76, v77
    v_cvt_pk_bf16_f32 v163, v70, v71
    v_cvt_pk_bf16_f32 v167, v78, v79
    v_permlane16_swap_b32 v160, v164
    v_permlane16_swap_b32 v161, v165
    v_permlane16_swap_b32 v162, v166
    v_permlane16_swap_b32 v163, v167
    v_mfma_f32_32x32x16_bf16 v[48:63], a[8:11], v[152:155], 4.0
    v_exp_f32 v32, v32
    v_exp_f32 v33, v33
    v_exp_f32 v34, v34
    v_mfma_f32_32x32x16_bf16 v[48:63], a[12:15], v[156:159], v[48:63]
    v_exp_f32 v35, v35
    v_exp_f32 v36, v36
    v_exp_f32 v37, v37
    v_smfmac_f32_32x32x32_bf16 v[112:127], a[20:23], v[24:31], v224
    v_exp_f32 v38, v38
    v_exp_f32 v39, v39
    v_exp_f32 v40, v40
    v_smfmac_f32_16x16x64_bf16 v[220:223], a[32:35], v[24:31], v224
    s_waitcnt lgkmcnt(4)
    ds_read_b64_tr_b16 a[16:17], v226 offset:10240
    ds_read_b64_tr_b16 a[18:19], v226 offset:10496
    v_exp_f32 v41, v41
    v_smfmac_f32_32x32x32_bf16 v[96:111], a[24:27], v[32:39], v224
    v_exp_f32 v42, v42
    v_exp_f32 v43, v43
    v_exp_f32 v44, v44
    v_smfmac_f32_16x16x64_bf16 v[216:219], a[32:35], v[32:39], v224
    s_waitcnt lgkmcnt(3)
    ds_read_b64_tr_b16 a[20:21], v226 offset:11264
    ds_read_b64_tr_b16 a[22:23], v226 offset:11520
    v_exp_f32 v45, v45
    v_exp_f32 v46, v46
    v_exp_f32 v47, v47
    v_mfma_f32_32x32x16_bf16 v[0:15], a[0:3], v[144:147], 4.0
    s_waitcnt lgkmcnt(4)
    ds_read_b128 a[8:11], v225 offset:12288
    v_exp_f32 v48, v48
    v_exp_f32 v49, v49
    v_exp_f32 v50, v50
    v_mfma_f32_32x32x16_bf16 v[0:15], a[4:7], v[148:151], v[0:15]
    ds_read_b128 a[12:15], v225 offset:13312
    v_exp_f32 v51, v51
    v_exp_f32 v52, v52
    v_exp_f32 v53, v53
    v_smfmac_f32_32x32x32_bf16 v[96:111], a[28:31], v[40:47], v224
    v_exp_f32 v54, v54
    v_exp_f32 v55, v55
    v_exp_f32 v56, v56
    v_smfmac_f32_16x16x64_bf16 v[216:219], a[32:35], v[40:47], v224
    buffer_store_dwordx4 v[160:163], v229, s[28:31], s98 offen offset:0 sc1
    v_exp_f32 v57, v57
    v_smfmac_f32_32x32x32_bf16 v[112:127], a[24:27], v[48:55], v224
    v_exp_f32 v58, v58
    v_exp_f32 v59, v59
    v_rcp_f32 v236, v212
    v_exp_f32 v60, v60
    v_smfmac_f32_16x16x64_bf16 v[220:223], a[32:35], v[48:55], v224
    buffer_store_dwordx4 v[164:167], v229, s[28:31], s98 offen offset:1024 sc1
    v_exp_f32 v61, v61
    v_exp_f32 v62, v62
    v_exp_f32 v63, v63
    v_pk_mul_f32 v[80:81], v[80:81], v[236:237] op_sel_hi:[1,0]
    v_pk_mul_f32 v[82:83], v[82:83], v[236:237] op_sel_hi:[1,0]
    v_pk_mul_f32 v[84:85], v[84:85], v[236:237] op_sel_hi:[1,0]
    v_pk_mul_f32 v[86:87], v[86:87], v[236:237] op_sel_hi:[1,0]
    v_pk_mul_f32 v[88:89], v[88:89], v[236:237] op_sel_hi:[1,0]
    v_pk_mul_f32 v[90:91], v[90:91], v[236:237] op_sel_hi:[1,0]
    v_pk_mul_f32 v[92:93], v[92:93], v[236:237] op_sel_hi:[1,0]
    v_pk_mul_f32 v[94:95], v[94:95], v[236:237] op_sel_hi:[1,0]
    v_cvt_pk_bf16_f32 v168, v80, v81
    v_cvt_pk_bf16_f32 v172, v88, v89
    v_cvt_pk_bf16_f32 v169, v82, v83
    v_cvt_pk_bf16_f32 v173, v90, v91
    v_cvt_pk_bf16_f32 v170, v84, v85
    v_cvt_pk_bf16_f32 v174, v92, v93
    v_cvt_pk_bf16_f32 v171, v86, v87
    v_cvt_pk_bf16_f32 v175, v94, v95
    v_permlane16_swap_b32 v168, v172
    v_permlane16_swap_b32 v169, v173
    v_permlane16_swap_b32 v170, v174
    v_permlane16_swap_b32 v171, v175
    v_mfma_f32_32x32x16_bf16 v[16:31], a[0:3], v[152:155], 4.0
    v_exp_f32 v0, v0
    v_exp_f32 v1, v1
    v_exp_f32 v2, v2
    v_mfma_f32_32x32x16_bf16 v[16:31], a[4:7], v[156:159], v[16:31]
    v_exp_f32 v3, v3
    v_exp_f32 v4, v4
    v_exp_f32 v5, v5
    v_smfmac_f32_32x32x32_bf16 v[112:127], a[28:31], v[56:63], v224
    v_exp_f32 v6, v6
    v_exp_f32 v7, v7
    v_exp_f32 v8, v8
    v_smfmac_f32_16x16x64_bf16 v[220:223], a[32:35], v[56:63], v224
    s_waitcnt lgkmcnt(4)
    ds_read_b64_tr_b16 a[24:25], v226 offset:12288
    ds_read_b64_tr_b16 a[26:27], v226 offset:12544
    v_exp_f32 v9, v9
    v_smfmac_f32_32x32x32_bf16 v[96:111], a[16:19], v[0:7], v224
    v_exp_f32 v10, v10
    v_exp_f32 v11, v11
    v_exp_f32 v12, v12
    v_smfmac_f32_16x16x64_bf16 v[216:219], a[32:35], v[0:7], v224
    s_waitcnt lgkmcnt(3)
    ds_read_b64_tr_b16 a[28:29], v226 offset:13312
    ds_read_b64_tr_b16 a[30:31], v226 offset:13568
    v_exp_f32 v13, v13
    v_exp_f32 v14, v14
    v_exp_f32 v15, v15
    v_mfma_f32_32x32x16_bf16 v[32:47], a[8:11], v[144:147], 4.0
    s_waitcnt lgkmcnt(4)
    v_exp_f32 v16, v16
    v_exp_f32 v17, v17
    v_exp_f32 v18, v18
    v_mfma_f32_32x32x16_bf16 v[32:47], a[12:15], v[148:151], v[32:47]
    v_exp_f32 v19, v19
    v_exp_f32 v20, v20
    v_exp_f32 v21, v21
    v_smfmac_f32_32x32x32_bf16 v[96:111], a[20:23], v[8:15], v224
    v_exp_f32 v22, v22
    v_exp_f32 v23, v23
    v_exp_f32 v24, v24
    v_smfmac_f32_16x16x64_bf16 v[216:219], a[32:35], v[8:15], v224
    buffer_store_dwordx4 v[168:171], v229, s[28:31], s99 offen offset:0 sc1
    v_exp_f32 v25, v25
    v_smfmac_f32_32x32x32_bf16 v[112:127], a[16:19], v[16:23], v224
    v_exp_f32 v26, v26
    v_exp_f32 v27, v27
    v_exp_f32 v28, v28
    v_smfmac_f32_16x16x64_bf16 v[220:223], a[32:35], v[16:23], v224
    buffer_store_dwordx4 v[172:175], v229, s[28:31], s99 offen offset:1024 sc1
    v_exp_f32 v29, v29
    v_exp_f32 v30, v30
    v_exp_f32 v31, v31
    v_mfma_f32_32x32x16_bf16 v[48:63], a[8:11], v[152:155], 4.0
    v_exp_f32 v32, v32
    v_exp_f32 v33, v33
    v_exp_f32 v34, v34
    v_mfma_f32_32x32x16_bf16 v[48:63], a[12:15], v[156:159], v[48:63]
    v_exp_f32 v35, v35
    v_exp_f32 v36, v36
    v_exp_f32 v37, v37
    v_smfmac_f32_32x32x32_bf16 v[112:127], a[20:23], v[24:31], v224
    v_exp_f32 v38, v38
    v_exp_f32 v39, v39
    v_exp_f32 v40, v40
    v_smfmac_f32_16x16x64_bf16 v[220:223], a[32:35], v[24:31], v224
    s_waitcnt lgkmcnt(2)
    v_exp_f32 v41, v41
    v_smfmac_f32_32x32x32_bf16 v[96:111], a[24:27], v[32:39], v224
    v_exp_f32 v42, v42
    v_exp_f32 v43, v43
    v_exp_f32 v44, v44
    v_smfmac_f32_16x16x64_bf16 v[216:219], a[32:35], v[32:39], v224
    s_waitcnt lgkmcnt(0)
    v_exp_f32 v45, v45
    v_exp_f32 v46, v46
    v_exp_f32 v47, v47
    v_exp_f32 v48, v48
    v_exp_f32 v49, v49
    v_exp_f32 v50, v50
    v_exp_f32 v51, v51
    v_exp_f32 v52, v52
    v_exp_f32 v53, v53
    v_smfmac_f32_32x32x32_bf16 v[96:111], a[28:31], v[40:47], v224
    v_exp_f32 v54, v54
    v_exp_f32 v55, v55
    v_exp_f32 v56, v56
    v_smfmac_f32_16x16x64_bf16 v[216:219], a[32:35], v[40:47], v224
    v_exp_f32 v57, v57
    v_smfmac_f32_32x32x32_bf16 v[112:127], a[24:27], v[48:55], v224
    v_exp_f32 v58, v58
    v_exp_f32 v59, v59
    v_exp_f32 v60, v60
    v_smfmac_f32_16x16x64_bf16 v[220:223], a[32:35], v[48:55], v224
    v_exp_f32 v61, v61
    v_exp_f32 v62, v62
    v_rcp_f32 v236, v216
    v_exp_f32 v63, v63
    v_pk_mul_f32 v[96:97], v[96:97], v[236:237] op_sel_hi:[1,0]
    v_pk_mul_f32 v[98:99], v[98:99], v[236:237] op_sel_hi:[1,0]
    v_pk_mul_f32 v[100:101], v[100:101], v[236:237] op_sel_hi:[1,0]
    v_pk_mul_f32 v[102:103], v[102:103], v[236:237] op_sel_hi:[1,0]
    v_pk_mul_f32 v[104:105], v[104:105], v[236:237] op_sel_hi:[1,0]
    v_pk_mul_f32 v[106:107], v[106:107], v[236:237] op_sel_hi:[1,0]
    v_pk_mul_f32 v[108:109], v[108:109], v[236:237] op_sel_hi:[1,0]
    v_pk_mul_f32 v[110:111], v[110:111], v[236:237] op_sel_hi:[1,0]
    v_smfmac_f32_32x32x32_bf16 v[112:127], a[28:31], v[56:63], v224
    v_smfmac_f32_16x16x64_bf16 v[220:223], a[32:35], v[56:63], v224
    v_cvt_pk_bf16_f32 v176, v96, v97
    v_cvt_pk_bf16_f32 v180, v104, v105
    v_cvt_pk_bf16_f32 v177, v98, v99
    v_cvt_pk_bf16_f32 v181, v106, v107
    v_cvt_pk_bf16_f32 v178, v100, v101
    v_cvt_pk_bf16_f32 v182, v108, v109
    v_cvt_pk_bf16_f32 v179, v102, v103
    v_cvt_pk_bf16_f32 v183, v110, v111
    v_permlane16_swap_b32 v176, v180
    v_permlane16_swap_b32 v177, v181
    v_permlane16_swap_b32 v178, v182
    v_permlane16_swap_b32 v179, v183
    buffer_store_dwordx4 v[176:179], v229, s[28:31], s100 offen offset:0 sc1
    buffer_store_dwordx4 v[180:183], v229, s[28:31], s100 offen offset:1024 sc1
    v_rcp_f32 v236, v220
    s_nop 0
    v_pk_mul_f32 v[112:113], v[112:113], v[236:237] op_sel_hi:[1,0]
    v_pk_mul_f32 v[114:115], v[114:115], v[236:237] op_sel_hi:[1,0]
    v_pk_mul_f32 v[116:117], v[116:117], v[236:237] op_sel_hi:[1,0]
    v_pk_mul_f32 v[118:119], v[118:119], v[236:237] op_sel_hi:[1,0]
    v_pk_mul_f32 v[120:121], v[120:121], v[236:237] op_sel_hi:[1,0]
    v_pk_mul_f32 v[122:123], v[122:123], v[236:237] op_sel_hi:[1,0]
    v_pk_mul_f32 v[124:125], v[124:125], v[236:237] op_sel_hi:[1,0]
    v_pk_mul_f32 v[126:127], v[126:127], v[236:237] op_sel_hi:[1,0]
    v_cvt_pk_bf16_f32 v184, v112, v113
    v_cvt_pk_bf16_f32 v188, v120, v121
    v_cvt_pk_bf16_f32 v185, v114, v115
    v_cvt_pk_bf16_f32 v189, v122, v123
    v_cvt_pk_bf16_f32 v186, v116, v117
    v_cvt_pk_bf16_f32 v190, v124, v125
    v_cvt_pk_bf16_f32 v187, v118, v119
    v_cvt_pk_bf16_f32 v191, v126, v127
    v_permlane16_swap_b32 v184, v188
    v_permlane16_swap_b32 v185, v189
    v_permlane16_swap_b32 v186, v190
    v_permlane16_swap_b32 v187, v191
    buffer_store_dwordx4 v[184:187], v229, s[28:31], s101 offen offset:0 sc1
    buffer_store_dwordx4 v[188:191], v229, s[28:31], s101 offen offset:1024 sc1
    s_endpgm
L_end:
    s_endpgm
L_spin0F:
    s_movk_i32 s36, 128
L_spin0Fa:
    buffer_load_dword v239, v225, s[52:55], 0 offen offset:0 sc1
    s_waitcnt vmcnt(0)
    v_cmp_ne_u32 s[62:63], v239, v232
    s_nop 1
    s_cmp_eq_u32 s62, 15
    s_cbranch_scc1 L_back0F
    s_sub_u32 s36, s36, 1
    s_cmp_lg_u32 s36, 0
    s_cbranch_scc1 L_spin0Fa
    ds_write_b32 v235, v235
    s_waitcnt lgkmcnt(0)
    s_branch L_back0F
L_spin1F:
    s_movk_i32 s36, 128
L_spin1Fa:
    buffer_load_dword v239, v225, s[52:55], 0 offen offset:4 sc1
    s_waitcnt vmcnt(0)
    v_cmp_ne_u32 s[62:63], v239, v233
    s_nop 1
    s_cmp_eq_u32 s62, 15
    s_cbranch_scc1 L_back1F
    s_sub_u32 s36, s36, 1
    s_cmp_lg_u32 s36, 0
    s_cbranch_scc1 L_spin1Fa
    ds_write_b32 v235, v235
    s_waitcnt lgkmcnt(0)
    s_branch L_back1F
L_spin0B:
    s_movk_i32 s36, 128
L_spin0Ba:
    buffer_load_dword v239, v225, s[52:55], 0 offen offset:0 sc1
    s_waitcnt vmcnt(0)
    v_cmp_ne_u32 s[62:63], v239, v232
    s_nop 1
    s_cmp_eq_u32 s62, 15
    s_cbranch_scc1 L_back0B
    s_sub_u32 s36, s36, 1
    s_cmp_lg_u32 s36, 0
    s_cbranch_scc1 L_spin0Ba
    ds_write_b32 v235, v235
    s_waitcnt lgkmcnt(0)
    s_branch L_back0B
L_spin1B:
    s_movk_i32 s36, 128
L_spin1Ba:
    buffer_load_dword v239, v225, s[52:55], 0 offen offset:4 sc1
    s_waitcnt vmcnt(0)
    v_cmp_ne_u32 s[62:63], v239, v233
    s_nop 1
    s_cmp_eq_u32 s62, 15
    s_cbranch_scc1 L_back1B
    s_sub_u32 s36, s36, 1
    s_cmp_lg_u32 s36, 0
    s_cbranch_scc1 L_spin1Ba
    ds_write_b32 v235, v235
    s_waitcnt lgkmcnt(0)
    s_branch L_back1B
L_vbad:
    ds_write_b32 v235, v235
    s_waitcnt lgkmcnt(0)
    s_branch L_vback
L_slow:
    s_waitcnt vmcnt(0) lgkmcnt(0)
    s_nop 7
    s_nop 7
    v_mov_b32 v247, v225
    v_lshlrev_b32 v246, 2, v225
    v_mov_b32 v64, 0
    v_mov_b32 v65, 0
    v_mov_b32 v66, 0
    v_mov_b32 v67, 0
    v_mov_b32 v68, 0
    v_mov_b32 v69, 0
    v_mov_b32 v70, 0
    v_mov_b32 v71, 0
    v_mov_b32 v72, 0
    v_mov_b32 v73, 0
    v_mov_b32 v74, 0
    v_mov_b32 v75, 0
    v_mov_b32 v76, 0
    v_mov_b32 v77, 0
    v_mov_b32 v78, 0
    v_mov_b32 v79, 0
    v_mov_b32 v80, 0
    v_mov_b32 v81, 0
    v_mov_b32 v82, 0
    v_mov_b32 v83, 0
    v_mov_b32 v84, 0
    v_mov_b32 v85, 0
    v_mov_b32 v86, 0
    v_mov_b32 v87, 0
    v_mov_b32 v88, 0
    v_mov_b32 v89, 0
    v_mov_b32 v90, 0
    v_mov_b32 v91, 0
    v_mov_b32 v92, 0
    v_mov_b32 v93, 0
    v_mov_b32 v94, 0
    v_mov_b32 v95, 0
    v_mov_b32 v96, 0
    v_mov_b32 v97, 0
    v_mov_b32 v98, 0
    v_mov_b32 v99, 0
    v_mov_b32 v100, 0
    v_mov_b32 v101, 0
    v_mov_b32 v102, 0
    v_mov_b32 v103, 0
    v_mov_b32 v104, 0
    v_mov_b32 v105, 0
    v_mov_b32 v106, 0
    v_mov_b32 v107, 0
    v_mov_b32 v108, 0
    v_mov_b32 v109, 0
    v_mov_b32 v110, 0
    v_mov_b32 v111, 0
    v_mov_b32 v112, 0
    v_mov_b32 v113, 0
    v_mov_b32 v114, 0
    v_mov_b32 v115, 0
    v_mov_b32 v116, 0
    v_mov_b32 v117, 0
    v_mov_b32 v118, 0
    v_mov_b32 v119, 0
    v_mov_b32 v120, 0
    v_mov_b32 v121, 0
    v_mov_b32 v122, 0
    v_mov_b32 v123, 0
    v_mov_b32 v124, 0
    v_mov_b32 v125, 0
    v_mov_b32 v126, 0
    v_mov_b32 v127, 0
    v_lshrrev_b32 v39, 4, v225
    v_and_b32 v37, 32, v39
    v_lshlrev_b32 v226, 4, v37
    v_and_b32 v37, 12, v39
    v_lshl_add_u32 v226, v37, 4, v226
    v_and_b32 v37, 1, v39
    v_lshl_add_u32 v226, v37, 5, v226
    v_and_b32 v37, 16, v39
    v_add_u32 v226, v226, v37
    v_and_b32 v37, 2, v39
    v_lshl_add_u32 v226, v37, 2, v226
    v_and_b32 v37, 7, v39
    v_cmp_eq_u32 s[62:63], 0, v37
    v_add_u32 v226, 0x4000, v226
    v_mov_b32 v36, 0x3f803f80
    v_cndmask_b32 v38, 0, v36, s[62:63]
    v_cmp_eq_u32 s[62:63], 4, v37
    v_accvgpr_write_b32 a32, v38
    v_accvgpr_write_b32 a33, v38
    v_cndmask_b32 v38, 0, v36, s[62:63]
    v_mov_b32 v224, 0xdddddddd
    v_accvgpr_write_b32 a34, v38
    v_accvgpr_write_b32 a35, v38
    v_pk_mul_f32 v[208:209], 0, 0
    v_pk_mul_f32 v[210:211], 0, 0
    v_pk_mul_f32 v[212:213], 0, 0
    v_pk_mul_f32 v[214:215], 0, 0
    v_pk_mul_f32 v[216:217], 0, 0
    v_pk_mul_f32 v[218:219], 0, 0
    v_pk_mul_f32 v[220:221], 0, 0
    v_pk_mul_f32 v[222:223], 0, 0
    v_and_b32 v244, 0x7c0, v246
    v_lshrrev_b32 v245, 5, v225
    v_and_b32 v245, 16, v245
    v_or_b32 v244, v244, v245
    buffer_load_dwordx4 v[128:131], v244, s[16:19], s98 offen offset:0
    buffer_load_dwordx4 v[132:135], v244, s[16:19], s98 offen offset:32
    buffer_load_dwordx4 v[136:139], v244, s[16:19], s99 offen offset:0
    buffer_load_dwordx4 v[140:143], v244, s[16:19], s99 offen offset:32
    buffer_load_dwordx4 v[144:147], v244, s[16:19], s100 offen offset:0
    buffer_load_dwordx4 v[148:151], v244, s[16:19], s100 offen offset:32
    buffer_load_dwordx4 v[152:155], v244, s[16:19], s101 offen offset:0
    buffer_load_dwordx4 v[156:159], v244, s[16:19], s101 offen offset:32
    s_waitcnt vmcnt(0)
    v_pk_mul_f32 v[236:237], 0, 0
    v_dot2c_f32_bf16 v236, v128, v128
    v_dot2c_f32_bf16 v237, v136, v136
    v_dot2c_f32_bf16 v236, v129, v129
    v_dot2c_f32_bf16 v237, v137, v137
    v_dot2c_f32_bf16 v236, v130, v130
    v_dot2c_f32_bf16 v237, v138, v138
    v_dot2c_f32_bf16 v236, v131, v131
    v_dot2c_f32_bf16 v237, v139, v139
    v_dot2c_f32_bf16 v236, v132, v132
    v_dot2c_f32_bf16 v237, v140, v140
    v_dot2c_f32_bf16 v236, v133, v133
    v_dot2c_f32_bf16 v237, v141, v141
    v_dot2c_f32_bf16 v236, v134, v134
    v_dot2c_f32_bf16 v237, v142, v142
    v_dot2c_f32_bf16 v236, v135, v135
    v_dot2c_f32_bf16 v237, v143, v143
    v_mfma_f32_4x4x4_16b_bf16 v[160:163], v[230:231], v[128:129], 0
    v_mfma_f32_4x4x4_16b_bf16 v[164:167], v[230:231], v[130:131], 0
    v_mfma_f32_4x4x4_16b_bf16 v[168:171], v[230:231], v[132:133], 0
    v_permlane32_swap_b32 v236, v237
    v_add_f32 v236, v236, v237
    v_mfma_f32_4x4x4_16b_bf16 v[172:175], v[230:231], v[134:135], 0
    v_sqrt_f32 v236, v236
    v_mfma_f32_4x4x4_16b_bf16 v[176:179], v[230:231], v[136:137], 0
    v_add_f32 v236, 0x358637bd, v236
    v_rcp_f32 v236, v236
    v_mfma_f32_4x4x4_16b_bf16 v[180:183], v[230:231], v[138:139], 0
    v_mul_f32 v237, v238, v236
    v_mul_f32 v236, v238, v236
    v_mfma_f32_4x4x4_16b_bf16 v[184:187], v[230:231], v[140:141], 0
    v_mfma_f32_4x4x4_16b_bf16 v[188:191], v[230:231], v[142:143], 0
    v_permlane32_swap_b32 v236, v237
    v_pk_mul_f32 v[160:161], v[160:161], v[236:237] op_sel_hi:[1,0]
    v_pk_mul_f32 v[162:163], v[162:163], v[236:237] op_sel_hi:[1,0]
    v_pk_mul_f32 v[164:165], v[164:165], v[236:237] op_sel_hi:[1,0]
    v_pk_mul_f32 v[166:167], v[166:167], v[236:237] op_sel_hi:[1,0]
    v_pk_mul_f32 v[168:169], v[168:169], v[236:237] op_sel_hi:[1,0]
    v_pk_mul_f32 v[170:171], v[170:171], v[236:237] op_sel_hi:[1,0]
    v_pk_mul_f32 v[172:173], v[172:173], v[236:237] op_sel_hi:[1,0]
    v_pk_mul_f32 v[174:175], v[174:175], v[236:237] op_sel_hi:[1,0]
    v_pk_mul_f32 v[176:177], v[176:177], v[236:237] op_sel:[0,1]
    v_pk_mul_f32 v[178:179], v[178:179], v[236:237] op_sel:[0,1]
    v_pk_mul_f32 v[180:181], v[180:181], v[236:237] op_sel:[0,1]
    v_pk_mul_f32 v[182:183], v[182:183], v[236:237] op_sel:[0,1]
    v_pk_mul_f32 v[184:185], v[184:185], v[236:237] op_sel:[0,1]
    v_pk_mul_f32 v[186:187], v[186:187], v[236:237] op_sel:[0,1]
    v_pk_mul_f32 v[188:189], v[188:189], v[236:237] op_sel:[0,1]
    v_pk_mul_f32 v[190:191], v[190:191], v[236:237] op_sel:[0,1]
    v_cvt_pk_bf16_f32 v128, v160, v161
    v_cvt_pk_bf16_f32 v129, v162, v163
    v_cvt_pk_bf16_f32 v130, v164, v165
    v_cvt_pk_bf16_f32 v131, v166, v167
    v_cvt_pk_bf16_f32 v132, v168, v169
    v_cvt_pk_bf16_f32 v133, v170, v171
    v_cvt_pk_bf16_f32 v134, v172, v173
    v_cvt_pk_bf16_f32 v135, v174, v175
    v_cvt_pk_bf16_f32 v136, v176, v177
    v_cvt_pk_bf16_f32 v137, v178, v179
    v_cvt_pk_bf16_f32 v138, v180, v181
    v_cvt_pk_bf16_f32 v139, v182, v183
    v_cvt_pk_bf16_f32 v140, v184, v185
    v_cvt_pk_bf16_f32 v141, v186, v187
    v_cvt_pk_bf16_f32 v142, v188, v189
    v_cvt_pk_bf16_f32 v143, v190, v191
    v_pk_mul_f32 v[236:237], 0, 0
    v_dot2c_f32_bf16 v236, v144, v144
    v_dot2c_f32_bf16 v237, v152, v152
    v_dot2c_f32_bf16 v236, v145, v145
    v_dot2c_f32_bf16 v237, v153, v153
    v_dot2c_f32_bf16 v236, v146, v146
    v_dot2c_f32_bf16 v237, v154, v154
    v_dot2c_f32_bf16 v236, v147, v147
    v_dot2c_f32_bf16 v237, v155, v155
    v_dot2c_f32_bf16 v236, v148, v148
    v_dot2c_f32_bf16 v237, v156, v156
    v_dot2c_f32_bf16 v236, v149, v149
    v_dot2c_f32_bf16 v237, v157, v157
    v_dot2c_f32_bf16 v236, v150, v150
    v_dot2c_f32_bf16 v237, v158, v158
    v_dot2c_f32_bf16 v236, v151, v151
    v_dot2c_f32_bf16 v237, v159, v159
    v_mfma_f32_4x4x4_16b_bf16 v[160:163], v[230:231], v[144:145], 0
    v_mfma_f32_4x4x4_16b_bf16 v[164:167], v[230:231], v[146:147], 0
    v_mfma_f32_4x4x4_16b_bf16 v[168:171], v[230:231], v[148:149], 0
    v_permlane32_swap_b32 v236, v237
    v_add_f32 v236, v236, v237
    v_mfma_f32_4x4x4_16b_bf16 v[172:175], v[230:231], v[150:151], 0
    v_sqrt_f32 v236, v236
    v_mfma_f32_4x4x4_16b_bf16 v[176:179], v[230:231], v[152:153], 0
    v_add_f32 v236, 0x358637bd, v236
    v_rcp_f32 v236, v236
    v_mfma_f32_4x4x4_16b_bf16 v[180:183], v[230:231], v[154:155], 0
    v_mul_f32 v237, v238, v236
    v_mul_f32 v236, v238, v236
    v_mfma_f32_4x4x4_16b_bf16 v[184:187], v[230:231], v[156:157], 0
    v_mfma_f32_4x4x4_16b_bf16 v[188:191], v[230:231], v[158:159], 0
    v_permlane32_swap_b32 v236, v237
    v_pk_mul_f32 v[160:161], v[160:161], v[236:237] op_sel_hi:[1,0]
    v_pk_mul_f32 v[162:163], v[162:163], v[236:237] op_sel_hi:[1,0]
    v_pk_mul_f32 v[164:165], v[164:165], v[236:237] op_sel_hi:[1,0]
    v_pk_mul_f32 v[166:167], v[166:167], v[236:237] op_sel_hi:[1,0]
    v_pk_mul_f32 v[168:169], v[168:169], v[236:237] op_sel_hi:[1,0]
    v_pk_mul_f32 v[170:171], v[170:171], v[236:237] op_sel_hi:[1,0]
    v_pk_mul_f32 v[172:173], v[172:173], v[236:237] op_sel_hi:[1,0]
    v_pk_mul_f32 v[174:175], v[174:175], v[236:237] op_sel_hi:[1,0]
    v_pk_mul_f32 v[176:177], v[176:177], v[236:237] op_sel:[0,1]
    v_pk_mul_f32 v[178:179], v[178:179], v[236:237] op_sel:[0,1]
    v_pk_mul_f32 v[180:181], v[180:181], v[236:237] op_sel:[0,1]
    v_pk_mul_f32 v[182:183], v[182:183], v[236:237] op_sel:[0,1]
    v_pk_mul_f32 v[184:185], v[184:185], v[236:237] op_sel:[0,1]
    v_pk_mul_f32 v[186:187], v[186:187], v[236:237] op_sel:[0,1]
    v_pk_mul_f32 v[188:189], v[188:189], v[236:237] op_sel:[0,1]
    v_pk_mul_f32 v[190:191], v[190:191], v[236:237] op_sel:[0,1]
    v_cvt_pk_bf16_f32 v144, v160, v161
    v_cvt_pk_bf16_f32 v145, v162, v163
    v_cvt_pk_bf16_f32 v146, v164, v165
    v_cvt_pk_bf16_f32 v147, v166, v167
    v_cvt_pk_bf16_f32 v148, v168, v169
    v_cvt_pk_bf16_f32 v149, v170, v171
    v_cvt_pk_bf16_f32 v150, v172, v173
    v_cvt_pk_bf16_f32 v151, v174, v175
    v_cvt_pk_bf16_f32 v152, v176, v177
    v_cvt_pk_bf16_f32 v153, v178, v179
    v_cvt_pk_bf16_f32 v154, v180, v181
    v_cvt_pk_bf16_f32 v155, v182, v183
    v_cvt_pk_bf16_f32 v156, v184, v185
    v_cvt_pk_bf16_f32 v157, v186, v187
    v_cvt_pk_bf16_f32 v158, v188, v189
    v_cvt_pk_bf16_f32 v159, v190, v191
    v_mov_b32 v240, 0xff800000
    v_mov_b32 v241, 0xff800000
    v_mov_b32 v242, 0xff800000
    v_mov_b32 v243, 0xff800000
    s_waitcnt vmcnt(0) lgkmcnt(0)
    s_barrier
    s_nop 7
    s_nop 7
    s_mov_b32 s37, s44
    s_mov_b32 s38, s44
    s_mov_b32 s39, s56
    s_mov_b32 m0, s39
    s_mov_b32 s36, 0
    buffer_load_dwordx4 v[16:19], v246, s[20:23], s37 offen offset:0
    buffer_load_dwordx4 v[20:23], v246, s[20:23], s37 offen offset:16
    buffer_load_dwordx4 v[24:27], v246, s[20:23], s37 offen offset:32
    buffer_load_dwordx4 v[28:31], v246, s[20:23], s37 offen offset:48
    buffer_load_dwordx4 v247, s[24:27], s38 offen offset:0 lds
    buffer_load_dwordx4 v247, s[24:27], s38 offen offset:1024 lds
    buffer_load_dwordx4 v247, s[24:27], s38 offen offset:2048 lds
    buffer_load_dwordx4 v247, s[24:27], s38 offen offset:3072 lds
    s_add_u32 s37, s37, 0x4000
    buffer_load_dwordx4 v[192:195], v246, s[20:23], s37 offen offset:0
    buffer_load_dwordx4 v[196:199], v246, s[20:23], s37 offen offset:16
    buffer_load_dwordx4 v[200:203], v246, s[20:23], s37 offen offset:32
    buffer_load_dwordx4 v[204:207], v246, s[20:23], s37 offen offset:48
    s_waitcnt vmcnt(8)
    v_pk_mul_f32 v[236:237], 0, 0
    v_dot2c_f32_bf16 v236, v16, v16
    v_dot2c_f32_bf16 v237, v17, v17
    v_dot2c_f32_bf16 v236, v18, v18
    v_dot2c_f32_bf16 v237, v19, v19
    v_dot2c_f32_bf16 v236, v20, v20
    v_dot2c_f32_bf16 v237, v21, v21
    v_dot2c_f32_bf16 v236, v22, v22
    v_dot2c_f32_bf16 v237, v23, v23
    v_dot2c_f32_bf16 v236, v24, v24
    v_dot2c_f32_bf16 v237, v25, v25
    v_dot2c_f32_bf16 v236, v26, v26
    v_dot2c_f32_bf16 v237, v27, v27
    v_dot2c_f32_bf16 v236, v28, v28
    v_dot2c_f32_bf16 v237, v29, v29
    v_dot2c_f32_bf16 v236, v30, v30
    v_dot2c_f32_bf16 v237, v31, v31
    v_mfma_f32_4x4x4_16b_bf16 v[160:163], v[230:231], v[16:17], 0
    v_mfma_f32_4x4x4_16b_bf16 v[164:167], v[230:231], v[18:19], 0
    v_mfma_f32_4x4x4_16b_bf16 v[168:171], v[230:231], v[20:21], 0
    v_add_f32 v236, v236, v237
    v_mfma_f32_4x4x4_16b_bf16 v[172:175], v[230:231], v[22:23], 0
    v_sqrt_f32 v236, v236
    v_mfma_f32_4x4x4_16b_bf16 v[176:179], v[230:231], v[24:25], 0
    v_add_f32 v236, 0x358637bd, v236
    v_mfma_f32_4x4x4_16b_bf16 v[180:183], v[230:231], v[26:27], 0
    v_rcp_f32 v236, v236
    v_mfma_f32_4x4x4_16b_bf16 v[184:187], v[230:231], v[28:29], 0
    v_mfma_f32_4x4x4_16b_bf16 v[188:191], v[230:231], v[30:31], 0
    v_pk_mul_f32 v[160:161], v[160:161], v[236:237] op_sel_hi:[1,0]
    v_pk_mul_f32 v[162:163], v[162:163], v[236:237] op_sel_hi:[1,0]
    v_pk_mul_f32 v[164:165], v[164:165], v[236:237] op_sel_hi:[1,0]
    v_pk_mul_f32 v[166:167], v[166:167], v[236:237] op_sel_hi:[1,0]
    v_pk_mul_f32 v[168:169], v[168:169], v[236:237] op_sel_hi:[1,0]
    v_pk_mul_f32 v[170:171], v[170:171], v[236:237] op_sel_hi:[1,0]
    v_pk_mul_f32 v[172:173], v[172:173], v[236:237] op_sel_hi:[1,0]
    v_pk_mul_f32 v[174:175], v[174:175], v[236:237] op_sel_hi:[1,0]
    v_pk_mul_f32 v[176:177], v[176:177], v[236:237] op_sel_hi:[1,0]
    v_pk_mul_f32 v[178:179], v[178:179], v[236:237] op_sel_hi:[1,0]
    v_pk_mul_f32 v[180:181], v[180:181], v[236:237] op_sel_hi:[1,0]
    v_pk_mul_f32 v[182:183], v[182:183], v[236:237] op_sel_hi:[1,0]
    v_pk_mul_f32 v[184:185], v[184:185], v[236:237] op_sel_hi:[1,0]
    v_pk_mul_f32 v[186:187], v[186:187], v[236:237] op_sel_hi:[1,0]
    v_pk_mul_f32 v[188:189], v[188:189], v[236:237] op_sel_hi:[1,0]
    v_pk_mul_f32 v[190:191], v[190:191], v[236:237] op_sel_hi:[1,0]
    v_cvt_pk_bf16_f32 v16, v160, v161
    v_cvt_pk_bf16_f32 v17, v162, v163
    v_cvt_pk_bf16_f32 v18, v164, v165
    v_cvt_pk_bf16_f32 v19, v166, v167
    v_cvt_pk_bf16_f32 v20, v168, v169
    v_cvt_pk_bf16_f32 v21, v170, v171
    v_cvt_pk_bf16_f32 v22, v172, v173
    v_cvt_pk_bf16_f32 v23, v174, v175
    v_cvt_pk_bf16_f32 v24, v176, v177
    v_cvt_pk_bf16_f32 v25, v178, v179
    v_cvt_pk_bf16_f32 v26, v180, v181
    v_cvt_pk_bf16_f32 v27, v182, v183
    v_cvt_pk_bf16_f32 v28, v184, v185
    v_cvt_pk_bf16_f32 v29, v186, v187
    v_cvt_pk_bf16_f32 v30, v188, v189
    v_cvt_pk_bf16_f32 v31, v190, v191
    ds_write_b128 v227, v[16:19] offset:0
    ds_write_b128 v227, v[20:23] offset:512
    ds_write_b128 v227, v[24:27] offset:1024
    ds_write_b128 v227, v[28:31] offset:1536
    s_waitcnt vmcnt(4) lgkmcnt(0)
    s_barrier
    ds_read_b128 a[0:3], v225 offset:0
    ds_read_b128 a[4:7], v225 offset:1024
    ds_read_b64_tr_b16 a[16:17], v226 offset:0
    ds_read_b64_tr_b16 a[18:19], v226 offset:256
    ds_read_b64_tr_b16 a[20:21], v226 offset:1024
    ds_read_b64_tr_b16 a[22:23], v226 offset:1280
    v_xor_b32 v227, 0x8000, v227
    v_mov_b32 v56, 0
    v_mov_b32 v57, 0
    v_mov_b32 v58, 0
    v_mov_b32 v59, 0
    v_mov_b32 v60, 0
    v_mov_b32 v61, 0
    v_mov_b32 v62, 0
    v_mov_b32 v63, 0
    v_accvgpr_write_b32 a28, 0
    v_accvgpr_write_b32 a29, 0
    v_accvgpr_write_b32 a30, 0
    v_accvgpr_write_b32 a31, 0
    s_waitcnt lgkmcnt(0)
    v_mfma_f32_32x32x16_bf16 v[0:15], a[0:3], v[128:131], 0
    v_mfma_f32_32x32x16_bf16 v[0:15], a[4:7], v[132:135], v[0:15]
    s_nop 7
    s_nop 3
Lm_loop:
    v_mfma_f32_32x32x16_bf16 v[16:31], a[0:3], v[136:139], 0
    v_mfma_f32_32x32x16_bf16 v[16:31], a[4:7], v[140:143], v[16:31]
    v_max3_f32 v240, v0, v1, v240
    v_max3_f32 v240, v2, v3, v240
    v_max3_f32 v240, v4, v5, v240
    v_max3_f32 v240, v6, v7, v240
    v_max3_f32 v240, v8, v9, v240
    v_max3_f32 v240, v10, v11, v240
    v_max3_f32 v240, v12, v13, v240
    v_max3_f32 v240, v14, v15, v240
    s_waitcnt lgkmcnt(0)
    ds_read_b128 a[8:11], v225 offset:2048
    ds_read_b128 a[12:15], v225 offset:3072
    s_nop 3
    v_mfma_f32_32x32x16_bf16 v[32:47], a[0:3], v[144:147], 0
    v_mfma_f32_32x32x16_bf16 v[32:47], a[4:7], v[148:151], v[32:47]
    v_max3_f32 v241, v16, v17, v241
    v_max3_f32 v241, v18, v19, v241
    v_max3_f32 v241, v20, v21, v241
    v_max3_f32 v241, v22, v23, v241
    v_max3_f32 v241, v24, v25, v241
    v_max3_f32 v241, v26, v27, v241
    v_max3_f32 v241, v28, v29, v241
    v_max3_f32 v241, v30, v31, v241
    ds_read_b64_tr_b16 a[24:25], v226 offset:2048
    ds_read_b64_tr_b16 a[26:27], v226 offset:2304
    ds_read_b64_tr_b16 a[28:29], v226 offset:3072
    ds_read_b64_tr_b16 a[30:31], v226 offset:3328
    s_nop 3
    v_mfma_f32_32x32x16_bf16 v[48:63], a[0:3], v[152:155], 0
    v_mfma_f32_32x32x16_bf16 v[48:63], a[4:7], v[156:159], v[48:63]
    v_max3_f32 v242, v32, v33, v242
    v_max3_f32 v242, v34, v35, v242
    v_max3_f32 v242, v36, v37, v242
    v_max3_f32 v242, v38, v39, v242
    v_max3_f32 v242, v40, v41, v242
    v_max3_f32 v242, v42, v43, v242
    v_max3_f32 v242, v44, v45, v242
    v_max3_f32 v242, v46, v47, v242
    s_waitcnt lgkmcnt(0)
    s_nop 3
    v_mfma_f32_32x32x16_bf16 v[0:15], a[8:11], v[128:131], 0
    v_mfma_f32_32x32x16_bf16 v[0:15], a[12:15], v[132:135], v[0:15]
    v_max3_f32 v243, v48, v49, v243
    v_max3_f32 v243, v50, v51, v243
    v_max3_f32 v243, v52, v53, v243
    v_max3_f32 v243, v54, v55, v243
    v_max3_f32 v243, v56, v57, v243
    v_max3_f32 v243, v58, v59, v243
    v_max3_f32 v243, v60, v61, v243
    v_max3_f32 v243, v62, v63, v243
    s_xor_b32 s39, s39, 0x8000
    s_mov_b32 m0, s39
    s_add_u32 s38, s38, 0x4000
    buffer_load_dwordx4 v247, s[24:27], s38 offen offset:0 lds
    buffer_load_dwordx4 v247, s[24:27], s38 offen offset:1024 lds
    buffer_load_dwordx4 v247, s[24:27], s38 offen offset:2048 lds
    buffer_load_dwordx4 v247, s[24:27], s38 offen offset:3072 lds
    s_nop 3
    v_mfma_f32_32x32x16_bf16 v[16:31], a[8:11], v[136:139], 0
    v_mfma_f32_32x32x16_bf16 v[16:31], a[12:15], v[140:143], v[16:31]
    v_max3_f32 v240, v0, v1, v240
    v_max3_f32 v240, v2, v3, v240
    v_max3_f32 v240, v4, v5, v240
    v_max3_f32 v240, v6, v7, v240
    v_max3_f32 v240, v8, v9, v240
    v_max3_f32 v240, v10, v11, v240
    v_max3_f32 v240, v12, v13, v240
    v_max3_f32 v240, v14, v15, v240
    s_waitcnt lgkmcnt(0)
    ds_read_b128 a[0:3], v225 offset:4096
    ds_read_b128 a[4:7], v225 offset:5120
    s_nop 3
    v_mfma_f32_32x32x16_bf16 v[32:47], a[8:11], v[144:147], 0
    v_mfma_f32_32x32x16_bf16 v[32:47], a[12:15], v[148:151], v[32:47]
    v_max3_f32 v241, v16, v17, v241
    v_max3_f32 v241, v18, v19, v241
    v_max3_f32 v241, v20, v21, v241
    v_max3_f32 v241, v22, v23, v241
    v_max3_f32 v241, v24, v25, v241
    v_max3_f32 v241, v26, v27, v241
    v_max3_f32 v241, v28, v29, v241
    v_max3_f32 v241, v30, v31, v241
    ds_read_b64_tr_b16 a[16:17], v226 offset:4096
    ds_read_b64_tr_b16 a[18:19], v226 offset:4352
    ds_read_b64_tr_b16 a[20:21], v226 offset:5120
    ds_read_b64_tr_b16 a[22:23], v226 offset:5376
    s_nop 3
    v_mfma_f32_32x32x16_bf16 v[48:63], a[8:11], v[152:155], 0
    v_mfma_f32_32x32x16_bf16 v[48:63], a[12:15], v[156:159], v[48:63]
    v_max3_f32 v242, v32, v33, v242
    v_max3_f32 v242, v34, v35, v242
    v_max3_f32 v242, v36, v37, v242
    v_max3_f32 v242, v38, v39, v242
    v_max3_f32 v242, v40, v41, v242
    v_max3_f32 v242, v42, v43, v242
    v_max3_f32 v242, v44, v45, v242
    v_max3_f32 v242, v46, v47, v242
    s_waitcnt lgkmcnt(0)
    s_nop 3
    v_mfma_f32_32x32x16_bf16 v[0:15], a[0:3], v[128:131], 0
    v_mfma_f32_32x32x16_bf16 v[0:15], a[4:7], v[132:135], v[0:15]
    v_max3_f32 v243, v48, v49, v243
    v_max3_f32 v243, v50, v51, v243
    v_max3_f32 v243, v52, v53, v243
    v_max3_f32 v243, v54, v55, v243
    v_max3_f32 v243, v56, v57, v243
    v_max3_f32 v243, v58, v59, v243
    v_max3_f32 v243, v60, v61, v243
    v_max3_f32 v243, v62, v63, v243
    s_nop 3
    s_waitcnt vmcnt(4)
    v_pk_mul_f32 v[236:237], 0, 0
    v_dot2c_f32_bf16 v236, v192, v192
    v_dot2c_f32_bf16 v237, v193, v193
    v_dot2c_f32_bf16 v236, v194, v194
    v_dot2c_f32_bf16 v237, v195, v195
    v_dot2c_f32_bf16 v236, v196, v196
    v_dot2c_f32_bf16 v237, v197, v197
    v_dot2c_f32_bf16 v236, v198, v198
    v_dot2c_f32_bf16 v237, v199, v199
    v_dot2c_f32_bf16 v236, v200, v200
    v_dot2c_f32_bf16 v237, v201, v201
    v_dot2c_f32_bf16 v236, v202, v202
    v_dot2c_f32_bf16 v237, v203, v203
    v_dot2c_f32_bf16 v236, v204, v204
    v_dot2c_f32_bf16 v237, v205, v205
    v_dot2c_f32_bf16 v236, v206, v206
    v_dot2c_f32_bf16 v237, v207, v207
    v_mfma_f32_4x4x4_16b_bf16 v[160:163], v[230:231], v[192:193], 0
    v_mfma_f32_4x4x4_16b_bf16 v[164:167], v[230:231], v[194:195], 0
    v_mfma_f32_4x4x4_16b_bf16 v[168:171], v[230:231], v[196:197], 0
    v_add_f32 v236, v236, v237
    v_mfma_f32_4x4x4_16b_bf16 v[172:175], v[230:231], v[198:199], 0
    v_sqrt_f32 v236, v236
    v_mfma_f32_4x4x4_16b_bf16 v[176:179], v[230:231], v[200:201], 0
    v_add_f32 v236, 0x358637bd, v236
    v_mfma_f32_4x4x4_16b_bf16 v[180:183], v[230:231], v[202:203], 0
    v_rcp_f32 v236, v236
    v_mfma_f32_4x4x4_16b_bf16 v[184:187], v[230:231], v[204:205], 0
    v_mfma_f32_4x4x4_16b_bf16 v[188:191], v[230:231], v[206:207], 0
    v_pk_mul_f32 v[160:161], v[160:161], v[236:237] op_sel_hi:[1,0]
    v_pk_mul_f32 v[162:163], v[162:163], v[236:237] op_sel_hi:[1,0]
    v_pk_mul_f32 v[164:165], v[164:165], v[236:237] op_sel_hi:[1,0]
    v_pk_mul_f32 v[166:167], v[166:167], v[236:237] op_sel_hi:[1,0]
    v_pk_mul_f32 v[168:169], v[168:169], v[236:237] op_sel_hi:[1,0]
    v_pk_mul_f32 v[170:171], v[170:171], v[236:237] op_sel_hi:[1,0]
    v_pk_mul_f32 v[172:173], v[172:173], v[236:237] op_sel_hi:[1,0]
    v_pk_mul_f32 v[174:175], v[174:175], v[236:237] op_sel_hi:[1,0]
    v_pk_mul_f32 v[176:177], v[176:177], v[236:237] op_sel_hi:[1,0]
    v_pk_mul_f32 v[178:179], v[178:179], v[236:237] op_sel_hi:[1,0]
    v_pk_mul_f32 v[180:181], v[180:181], v[236:237] op_sel_hi:[1,0]
    v_pk_mul_f32 v[182:183], v[182:183], v[236:237] op_sel_hi:[1,0]
    v_pk_mul_f32 v[184:185], v[184:185], v[236:237] op_sel_hi:[1,0]
    v_pk_mul_f32 v[186:187], v[186:187], v[236:237] op_sel_hi:[1,0]
    v_pk_mul_f32 v[188:189], v[188:189], v[236:237] op_sel_hi:[1,0]
    v_pk_mul_f32 v[190:191], v[190:191], v[236:237] op_sel_hi:[1,0]
    v_cvt_pk_bf16_f32 v192, v160, v161
    v_cvt_pk_bf16_f32 v193, v162, v163
    v_cvt_pk_bf16_f32 v194, v164, v165
    v_cvt_pk_bf16_f32 v195, v166, v167
    v_cvt_pk_bf16_f32 v196, v168, v169
    v_cvt_pk_bf16_f32 v197, v170, v171
    v_cvt_pk_bf16_f32 v198, v172, v173
    v_cvt_pk_bf16_f32 v199, v174, v175
    v_cvt_pk_bf16_f32 v200, v176, v177
    v_cvt_pk_bf16_f32 v201, v178, v179
    v_cvt_pk_bf16_f32 v202, v180, v181
    v_cvt_pk_bf16_f32 v203, v182, v183
    v_cvt_pk_bf16_f32 v204, v184, v185
    v_cvt_pk_bf16_f32 v205, v186, v187
    v_cvt_pk_bf16_f32 v206, v188, v189
    v_cvt_pk_bf16_f32 v207, v190, v191
    ds_write_b128 v227, v[192:195] offset:0
    ds_write_b128 v227, v[196:199] offset:512
    ds_write_b128 v227, v[200:203] offset:1024
    ds_write_b128 v227, v[204:207] offset:1536
    v_mfma_f32_32x32x16_bf16 v[16:31], a[0:3], v[136:139], 0
    v_mfma_f32_32x32x16_bf16 v[16:31], a[4:7], v[140:143], v[16:31]
    v_max3_f32 v240, v0, v1, v240
    v_max3_f32 v240, v2, v3, v240
    v_max3_f32 v240, v4, v5, v240
    v_max3_f32 v240, v6, v7, v240
    v_max3_f32 v240, v8, v9, v240
    v_max3_f32 v240, v10, v11, v240
    v_max3_f32 v240, v12, v13, v240
    v_max3_f32 v240, v14, v15, v240
    s_waitcnt lgkmcnt(0)
    ds_read_b128 a[8:11], v225 offset:6144
    ds_read_b128 a[12:15], v225 offset:7168
    s_nop 3
    v_mfma_f32_32x32x16_bf16 v[32:47], a[0:3], v[144:147], 0
    v_mfma_f32_32x32x16_bf16 v[32:47], a[4:7], v[148:151], v[32:47]
    v_max3_f32 v241, v16, v17, v241
    v_max3_f32 v241, v18, v19, v241
    v_max3_f32 v241, v20, v21, v241
    v_max3_f32 v241, v22, v23, v241
    v_max3_f32 v241, v24, v25, v241
    v_max3_f32 v241, v26, v27, v241
    v_max3_f32 v241, v28, v29, v241
    v_max3_f32 v241, v30, v31, v241
    ds_read_b64_tr_b16 a[24:25], v226 offset:6144
    ds_read_b64_tr_b16 a[26:27], v226 offset:6400
    ds_read_b64_tr_b16 a[28:29], v226 offset:7168
    ds_read_b64_tr_b16 a[30:31], v226 offset:7424
    s_nop 3
    v_mfma_f32_32x32x16_bf16 v[48:63], a[0:3], v[152:155], 0
    v_mfma_f32_32x32x16_bf16 v[48:63], a[4:7], v[156:159], v[48:63]
    v_max3_f32 v242, v32, v33, v242
    v_max3_f32 v242, v34, v35, v242
    v_max3_f32 v242, v36, v37, v242
    v_max3_f32 v242, v38, v39, v242
    v_max3_f32 v242, v40, v41, v242
    v_max3_f32 v242, v42, v43, v242
    v_max3_f32 v242, v44, v45, v242
    v_max3_f32 v242, v46, v47, v242
    s_waitcnt lgkmcnt(0)
    s_nop 3
    v_mfma_f32_32x32x16_bf16 v[0:15], a[8:11], v[128:131], 0
    v_mfma_f32_32x32x16_bf16 v[0:15], a[12:15], v[132:135], v[0:15]
    v_max3_f32 v243, v48, v49, v243
    v_max3_f32 v243, v50, v51, v243
    v_max3_f32 v243, v52, v53, v243
    v_max3_f32 v243, v54, v55, v243
    v_max3_f32 v243, v56, v57, v243
    v_max3_f32 v243, v58, v59, v243
    v_max3_f32 v243, v60, v61, v243
    v_max3_f32 v243, v62, v63, v243
    s_nop 3
    v_mfma_f32_32x32x16_bf16 v[16:31], a[8:11], v[136:139], 0
    v_mfma_f32_32x32x16_bf16 v[16:31], a[12:15], v[140:143], v[16:31]
    v_max3_f32 v240, v0, v1, v240
    v_max3_f32 v240, v2, v3, v240
    v_max3_f32 v240, v4, v5, v240
    v_max3_f32 v240, v6, v7, v240
    v_max3_f32 v240, v8, v9, v240
    v_max3_f32 v240, v10, v11, v240
    v_max3_f32 v240, v12, v13, v240
    v_max3_f32 v240, v14, v15, v240
    s_waitcnt lgkmcnt(0)
    ds_read_b128 a[0:3], v225 offset:8192
    ds_read_b128 a[4:7], v225 offset:9216
    s_nop 3
    v_mfma_f32_32x32x16_bf16 v[32:47], a[8:11], v[144:147], 0
    v_mfma_f32_32x32x16_bf16 v[32:47], a[12:15], v[148:151], v[32:47]
    v_max3_f32 v241, v16, v17, v241
    v_max3_f32 v241, v18, v19, v241
    v_max3_f32 v241, v20, v21, v241
    v_max3_f32 v241, v22, v23, v241
    v_max3_f32 v241, v24, v25, v241
    v_max3_f32 v241, v26, v27, v241
    v_max3_f32 v241, v28, v29, v241
    v_max3_f32 v241, v30, v31, v241
    ds_read_b64_tr_b16 a[16:17], v226 offset:8192
    ds_read_b64_tr_b16 a[18:19], v226 offset:8448
    ds_read_b64_tr_b16 a[20:21], v226 offset:9216
    ds_read_b64_tr_b16 a[22:23], v226 offset:9472
    s_nop 3
    v_mfma_f32_32x32x16_bf16 v[48:63], a[8:11], v[152:155], 0
    v_mfma_f32_32x32x16_bf16 v[48:63], a[12:15], v[156:159], v[48:63]
    v_max3_f32 v242, v32, v33, v242
    v_max3_f32 v242, v34, v35, v242
    v_max3_f32 v242, v36, v37, v242
    v_max3_f32 v242, v38, v39, v242
    v_max3_f32 v242, v40, v41, v242
    v_max3_f32 v242, v42, v43, v242
    v_max3_f32 v242, v44, v45, v242
    v_max3_f32 v242, v46, v47, v242
    s_waitcnt lgkmcnt(0)
    s_nop 3
    v_mfma_f32_32x32x16_bf16 v[0:15], a[0:3], v[128:131], 0
    v_mfma_f32_32x32x16_bf16 v[0:15], a[4:7], v[132:135], v[0:15]
    v_max3_f32 v243, v48, v49, v243
    v_max3_f32 v243, v50, v51, v243
    v_max3_f32 v243, v52, v53, v243
    v_max3_f32 v243, v54, v55, v243
    v_max3_f32 v243, v56, v57, v243
    v_max3_f32 v243, v58, v59, v243
    v_max3_f32 v243, v60, v61, v243
    v_max3_f32 v243, v62, v63, v243
    s_nop 3
    v_mfma_f32_32x32x16_bf16 v[16:31], a[0:3], v[136:139], 0
    v_mfma_f32_32x32x16_bf16 v[16:31], a[4:7], v[140:143], v[16:31]
    v_max3_f32 v240, v0, v1, v240
    v_max3_f32 v240, v2, v3, v240
    v_max3_f32 v240, v4, v5, v240
    v_max3_f32 v240, v6, v7, v240
    v_max3_f32 v240, v8, v9, v240
    v_max3_f32 v240, v10, v11, v240
    v_max3_f32 v240, v12, v13, v240
    v_max3_f32 v240, v14, v15, v240
    s_waitcnt lgkmcnt(0)
    ds_read_b128 a[8:11], v225 offset:10240
    ds_read_b128 a[12:15], v225 offset:11264
    s_nop 3
    v_mfma_f32_32x32x16_bf16 v[32:47], a[0:3], v[144:147], 0
    v_mfma_f32_32x32x16_bf16 v[32:47], a[4:7], v[148:151], v[32:47]
    v_max3_f32 v241, v16, v17, v241
    v_max3_f32 v241, v18, v19, v241
    v_max3_f32 v241, v20, v21, v241
    v_max3_f32 v241, v22, v23, v241
    v_max3_f32 v241, v24, v25, v241
    v_max3_f32 v241, v26, v27, v241
    v_max3_f32 v241, v28, v29, v241
    v_max3_f32 v241, v30, v31, v241
    ds_read_b64_tr_b16 a[24:25], v226 offset:10240
    ds_read_b64_tr_b16 a[26:27], v226 offset:10496
    ds_read_b64_tr_b16 a[28:29], v226 offset:11264
    ds_read_b64_tr_b16 a[30:31], v226 offset:11520
    s_nop 3
    v_mfma_f32_32x32x16_bf16 v[48:63], a[0:3], v[152:155], 0
    v_mfma_f32_32x32x16_bf16 v[48:63], a[4:7], v[156:159], v[48:63]
    v_max3_f32 v242, v32, v33, v242
    v_max3_f32 v242, v34, v35, v242
    v_max3_f32 v242, v36, v37, v242
    v_max3_f32 v242, v38, v39, v242
    v_max3_f32 v242, v40, v41, v242
    v_max3_f32 v242, v42, v43, v242
    v_max3_f32 v242, v44, v45, v242
    v_max3_f32 v242, v46, v47, v242
    s_waitcnt lgkmcnt(0)
    s_nop 3
    v_mfma_f32_32x32x16_bf16 v[0:15], a[8:11], v[128:131], 0
    v_mfma_f32_32x32x16_bf16 v[0:15], a[12:15], v[132:135], v[0:15]
    v_max3_f32 v243, v48, v49, v243
    v_max3_f32 v243, v50, v51, v243
    v_max3_f32 v243, v52, v53, v243
    v_max3_f32 v243, v54, v55, v243
    v_max3_f32 v243, v56, v57, v243
    v_max3_f32 v243, v58, v59, v243
    v_max3_f32 v243, v60, v61, v243
    v_max3_f32 v243, v62, v63, v243
    s_add_u32 s37, s37, 0x4000
    buffer_load_dwordx4 v[192:195], v246, s[20:23], s37 offen offset:0
    buffer_load_dwordx4 v[196:199], v246, s[20:23], s37 offen offset:16
    buffer_load_dwordx4 v[200:203], v246, s[20:23], s37 offen offset:32
    buffer_load_dwordx4 v[204:207], v246, s[20:23], s37 offen offset:48
    s_nop 3
    v_mfma_f32_32x32x16_bf16 v[16:31], a[8:11], v[136:139], 0
    v_mfma_f32_32x32x16_bf16 v[16:31], a[12:15], v[140:143], v[16:31]
    v_max3_f32 v240, v0, v1, v240
    v_max3_f32 v240, v2, v3, v240
    v_max3_f32 v240, v4, v5, v240
    v_max3_f32 v240, v6, v7, v240
    v_max3_f32 v240, v8, v9, v240
    v_max3_f32 v240, v10, v11, v240
    v_max3_f32 v240, v12, v13, v240
    v_max3_f32 v240, v14, v15, v240
    s_waitcnt lgkmcnt(0)
    ds_read_b128 a[0:3], v225 offset:12288
    ds_read_b128 a[4:7], v225 offset:13312
    s_nop 3
    v_mfma_f32_32x32x16_bf16 v[32:47], a[8:11], v[144:147], 0
    v_mfma_f32_32x32x16_bf16 v[32:47], a[12:15], v[148:151], v[32:47]
    v_max3_f32 v241, v16, v17, v241
    v_max3_f32 v241, v18, v19, v241
    v_max3_f32 v241, v20, v21, v241
    v_max3_f32 v241, v22, v23, v241
    v_max3_f32 v241, v24, v25, v241
    v_max3_f32 v241, v26, v27, v241
    v_max3_f32 v241, v28, v29, v241
    v_max3_f32 v241, v30, v31, v241
    ds_read_b64_tr_b16 a[16:17], v226 offset:12288
    ds_read_b64_tr_b16 a[18:19], v226 offset:12544
    ds_read_b64_tr_b16 a[20:21], v226 offset:13312
    ds_read_b64_tr_b16 a[22:23], v226 offset:13568
    s_nop 3
    v_mfma_f32_32x32x16_bf16 v[48:63], a[8:11], v[152:155], 0
    v_mfma_f32_32x32x16_bf16 v[48:63], a[12:15], v[156:159], v[48:63]
    v_max3_f32 v242, v32, v33, v242
    v_max3_f32 v242, v34, v35, v242
    v_max3_f32 v242, v36, v37, v242
    v_max3_f32 v242, v38, v39, v242
    v_max3_f32 v242, v40, v41, v242
    v_max3_f32 v242, v42, v43, v242
    v_max3_f32 v242, v44, v45, v242
    v_max3_f32 v242, v46, v47, v242
    s_waitcnt lgkmcnt(0)
    s_nop 3
    v_mfma_f32_32x32x16_bf16 v[0:15], a[0:3], v[128:131], 0
    v_mfma_f32_32x32x16_bf16 v[0:15], a[4:7], v[132:135], v[0:15]
    v_max3_f32 v243, v48, v49, v243
    v_max3_f32 v243, v50, v51, v243
    v_max3_f32 v243, v52, v53, v243
    v_max3_f32 v243, v54, v55, v243
    v_max3_f32 v243, v56, v57, v243
    v_max3_f32 v243, v58, v59, v243
    v_max3_f32 v243, v60, v61, v243
    v_max3_f32 v243, v62, v63, v243
    s_nop 3
    v_mfma_f32_32x32x16_bf16 v[16:31], a[0:3], v[136:139], 0
    v_mfma_f32_32x32x16_bf16 v[16:31], a[4:7], v[140:143], v[16:31]
    v_max3_f32 v240, v0, v1, v240
    v_max3_f32 v240, v2, v3, v240
    v_max3_f32 v240, v4, v5, v240
    v_max3_f32 v240, v6, v7, v240
    v_max3_f32 v240, v8, v9, v240
    v_max3_f32 v240, v10, v11, v240
    v_max3_f32 v240, v12, v13, v240
    v_max3_f32 v240, v14, v15, v240
    s_waitcnt lgkmcnt(0)
    ds_read_b128 a[8:11], v225 offset:14336
    ds_read_b128 a[12:15], v225 offset:15360
    s_nop 3
    v_mfma_f32_32x32x16_bf16 v[32:47], a[0:3], v[144:147], 0
    v_mfma_f32_32x32x16_bf16 v[32:47], a[4:7], v[148:151], v[32:47]
    v_max3_f32 v241, v16, v17, v241
    v_max3_f32 v241, v18, v19, v241
    v_max3_f32 v241, v20, v21, v241
    v_max3_f32 v241, v22, v23, v241
    v_max3_f32 v241, v24, v25, v241
    v_max3_f32 v241, v26, v27, v241
    v_max3_f32 v241, v28, v29, v241
    v_max3_f32 v241, v30, v31, v241
    ds_read_b64_tr_b16 a[24:25], v226 offset:14336
    ds_read_b64_tr_b16 a[26:27], v226 offset:14592
    ds_read_b64_tr_b16 a[28:29], v226 offset:15360
    ds_read_b64_tr_b16 a[30:31], v226 offset:15616
    s_nop 3
    v_mfma_f32_32x32x16_bf16 v[48:63], a[0:3], v[152:155], 0
    v_mfma_f32_32x32x16_bf16 v[48:63], a[4:7], v[156:159], v[48:63]
    v_max3_f32 v242, v32, v33, v242
    v_max3_f32 v242, v34, v35, v242
    v_max3_f32 v242, v36, v37, v242
    v_max3_f32 v242, v38, v39, v242
    v_max3_f32 v242, v40, v41, v242
    v_max3_f32 v242, v42, v43, v242
    v_max3_f32 v242, v44, v45, v242
    v_max3_f32 v242, v46, v47, v242
    s_waitcnt lgkmcnt(0)
    s_nop 3
    v_mfma_f32_32x32x16_bf16 v[0:15], a[8:11], v[128:131], 0
    v_mfma_f32_32x32x16_bf16 v[0:15], a[12:15], v[132:135], v[0:15]
    v_max3_f32 v243, v48, v49, v243
    v_max3_f32 v243, v50, v51, v243
    v_max3_f32 v243, v52, v53, v243
    v_max3_f32 v243, v54, v55, v243
    v_max3_f32 v243, v56, v57, v243
    v_max3_f32 v243, v58, v59, v243
    v_max3_f32 v243, v60, v61, v243
    v_max3_f32 v243, v62, v63, v243
    v_xor_b32 v225, 0x8000, v225
    v_xor_b32 v226, 0x8000, v226
    v_xor_b32 v227, 0x8000, v227
    s_nop 3
    v_mfma_f32_32x32x16_bf16 v[16:31], a[8:11], v[136:139], 0
    v_mfma_f32_32x32x16_bf16 v[16:31], a[12:15], v[140:143], v[16:31]
    v_max3_f32 v240, v0, v1, v240
    v_max3_f32 v240, v2, v3, v240
    v_max3_f32 v240, v4, v5, v240
    v_max3_f32 v240, v6, v7, v240
    v_max3_f32 v240, v8, v9, v240
    v_max3_f32 v240, v10, v11, v240
    v_max3_f32 v240, v12, v13, v240
    v_max3_f32 v240, v14, v15, v240
    s_waitcnt vmcnt(4) lgkmcnt(0)
    s_barrier
    ds_read_b128 a[0:3], v225 offset:0
    ds_read_b128 a[4:7], v225 offset:1024
    s_nop 3
    v_mfma_f32_32x32x16_bf16 v[32:47], a[8:11], v[144:147], 0
    v_mfma_f32_32x32x16_bf16 v[32:47], a[12:15], v[148:151], v[32:47]
    v_max3_f32 v241, v16, v17, v241
    v_max3_f32 v241, v18, v19, v241
    v_max3_f32 v241, v20, v21, v241
    v_max3_f32 v241, v22, v23, v241
    v_max3_f32 v241, v24, v25, v241
    v_max3_f32 v241, v26, v27, v241
    v_max3_f32 v241, v28, v29, v241
    v_max3_f32 v241, v30, v31, v241
    ds_read_b64_tr_b16 a[16:17], v226 offset:0
    ds_read_b64_tr_b16 a[18:19], v226 offset:256
    ds_read_b64_tr_b16 a[20:21], v226 offset:1024
    ds_read_b64_tr_b16 a[22:23], v226 offset:1280
    s_nop 3
    v_mfma_f32_32x32x16_bf16 v[48:63], a[8:11], v[152:155], 0
    v_mfma_f32_32x32x16_bf16 v[48:63], a[12:15], v[156:159], v[48:63]
    v_max3_f32 v242, v32, v33, v242
    v_max3_f32 v242, v34, v35, v242
    v_max3_f32 v242, v36, v37, v242
    v_max3_f32 v242, v38, v39, v242
    v_max3_f32 v242, v40, v41, v242
    v_max3_f32 v242, v42, v43, v242
    v_max3_f32 v242, v44, v45, v242
    v_max3_f32 v242, v46, v47, v242
    s_waitcnt lgkmcnt(0)
    s_nop 3
    v_mfma_f32_32x32x16_bf16 v[0:15], a[0:3], v[128:131], 0
    v_mfma_f32_32x32x16_bf16 v[0:15], a[4:7], v[132:135], v[0:15]
    v_max3_f32 v243, v48, v49, v243
    v_max3_f32 v243, v50, v51, v243
    v_max3_f32 v243, v52, v53, v243
    v_max3_f32 v243, v54, v55, v243
    v_max3_f32 v243, v56, v57, v243
    v_max3_f32 v243, v58, v59, v243
    v_max3_f32 v243, v60, v61, v243
    v_max3_f32 v243, v62, v63, v243
    s_add_u32 s36, s36, 1
    s_cmp_lg_u32 s36, 8
    s_nop 3
    s_cbranch_scc1 Lm_loop
    v_mov_b32 v244, v240
    v_mov_b32 v245, v240
    s_nop 1
    v_permlane32_swap_b32 v244, v245
    s_nop 1
    v_max_f32 v240, v244, v245
    v_mov_b32 v244, v241
    v_mov_b32 v245, v241
    s_nop 1
    v_permlane32_swap_b32 v244, v245
    s_nop 1
    v_max_f32 v241, v244, v245
    v_mov_b32 v244, v242
    v_mov_b32 v245, v242
    s_nop 1
    v_permlane32_swap_b32 v244, v245
    s_nop 1
    v_max_f32 v242, v244, v245
    v_mov_b32 v244, v243
    v_mov_b32 v245, v243
    s_nop 1
    v_permlane32_swap_b32 v244, v245
    s_nop 1
    v_max_f32 v243, v244, v245
    v_xor_b32 v227, 0x8000, v227
    s_waitcnt vmcnt(0) lgkmcnt(0)
    s_barrier
    s_nop 7
    s_nop 7
    s_mov_b32 s37, s44
    s_mov_b32 s38, s44
    s_mov_b32 s39, s56
    s_mov_b32 m0, s39
    s_mov_b32 s36, 0
    buffer_load_dwordx4 v[16:19], v246, s[20:23], s37 offen offset:0
    buffer_load_dwordx4 v[20:23], v246, s[20:23], s37 offen offset:16
    buffer_load_dwordx4 v[24:27], v246, s[20:23], s37 offen offset:32
    buffer_load_dwordx4 v[28:31], v246, s[20:23], s37 offen offset:48
    buffer_load_dwordx4 v247, s[24:27], s38 offen offset:0 lds
    buffer_load_dwordx4 v247, s[24:27], s38 offen offset:1024 lds
    buffer_load_dwordx4 v247, s[24:27], s38 offen offset:2048 lds
    buffer_load_dwordx4 v247, s[24:27], s38 offen offset:3072 lds
    s_add_u32 s37, s37, 0x4000
    buffer_load_dwordx4 v[192:195], v246, s[20:23], s37 offen offset:0
    buffer_load_dwordx4 v[196:199], v246, s[20:23], s37 offen offset:16
    buffer_load_dwordx4 v[200:203], v246, s[20:23], s37 offen offset:32
    buffer_load_dwordx4 v[204:207], v246, s[20:23], s37 offen offset:48
    s_waitcnt vmcnt(8)
    v_pk_mul_f32 v[236:237], 0, 0
    v_dot2c_f32_bf16 v236, v16, v16
    v_dot2c_f32_bf16 v237, v17, v17
    v_dot2c_f32_bf16 v236, v18, v18
    v_dot2c_f32_bf16 v237, v19, v19
    v_dot2c_f32_bf16 v236, v20, v20
    v_dot2c_f32_bf16 v237, v21, v21
    v_dot2c_f32_bf16 v236, v22, v22
    v_dot2c_f32_bf16 v237, v23, v23
    v_dot2c_f32_bf16 v236, v24, v24
    v_dot2c_f32_bf16 v237, v25, v25
    v_dot2c_f32_bf16 v236, v26, v26
    v_dot2c_f32_bf16 v237, v27, v27
    v_dot2c_f32_bf16 v236, v28, v28
    v_dot2c_f32_bf16 v237, v29, v29
    v_dot2c_f32_bf16 v236, v30, v30
    v_dot2c_f32_bf16 v237, v31, v31
    v_mfma_f32_4x4x4_16b_bf16 v[160:163], v[230:231], v[16:17], 0
    v_mfma_f32_4x4x4_16b_bf16 v[164:167], v[230:231], v[18:19], 0
    v_mfma_f32_4x4x4_16b_bf16 v[168:171], v[230:231], v[20:21], 0
    v_add_f32 v236, v236, v237
    v_mfma_f32_4x4x4_16b_bf16 v[172:175], v[230:231], v[22:23], 0
    v_sqrt_f32 v236, v236
    v_mfma_f32_4x4x4_16b_bf16 v[176:179], v[230:231], v[24:25], 0
    v_add_f32 v236, 0x358637bd, v236
    v_mfma_f32_4x4x4_16b_bf16 v[180:183], v[230:231], v[26:27], 0
    v_rcp_f32 v236, v236
    v_mfma_f32_4x4x4_16b_bf16 v[184:187], v[230:231], v[28:29], 0
    v_mfma_f32_4x4x4_16b_bf16 v[188:191], v[230:231], v[30:31], 0
    v_pk_mul_f32 v[160:161], v[160:161], v[236:237] op_sel_hi:[1,0]
    v_pk_mul_f32 v[162:163], v[162:163], v[236:237] op_sel_hi:[1,0]
    v_pk_mul_f32 v[164:165], v[164:165], v[236:237] op_sel_hi:[1,0]
    v_pk_mul_f32 v[166:167], v[166:167], v[236:237] op_sel_hi:[1,0]
    v_pk_mul_f32 v[168:169], v[168:169], v[236:237] op_sel_hi:[1,0]
    v_pk_mul_f32 v[170:171], v[170:171], v[236:237] op_sel_hi:[1,0]
    v_pk_mul_f32 v[172:173], v[172:173], v[236:237] op_sel_hi:[1,0]
    v_pk_mul_f32 v[174:175], v[174:175], v[236:237] op_sel_hi:[1,0]
    v_pk_mul_f32 v[176:177], v[176:177], v[236:237] op_sel_hi:[1,0]
    v_pk_mul_f32 v[178:179], v[178:179], v[236:237] op_sel_hi:[1,0]
    v_pk_mul_f32 v[180:181], v[180:181], v[236:237] op_sel_hi:[1,0]
    v_pk_mul_f32 v[182:183], v[182:183], v[236:237] op_sel_hi:[1,0]
    v_pk_mul_f32 v[184:185], v[184:185], v[236:237] op_sel_hi:[1,0]
    v_pk_mul_f32 v[186:187], v[186:187], v[236:237] op_sel_hi:[1,0]
    v_pk_mul_f32 v[188:189], v[188:189], v[236:237] op_sel_hi:[1,0]
    v_pk_mul_f32 v[190:191], v[190:191], v[236:237] op_sel_hi:[1,0]
    v_cvt_pk_bf16_f32 v16, v160, v161
    v_cvt_pk_bf16_f32 v17, v162, v163
    v_cvt_pk_bf16_f32 v18, v164, v165
    v_cvt_pk_bf16_f32 v19, v166, v167
    v_cvt_pk_bf16_f32 v20, v168, v169
    v_cvt_pk_bf16_f32 v21, v170, v171
    v_cvt_pk_bf16_f32 v22, v172, v173
    v_cvt_pk_bf16_f32 v23, v174, v175
    v_cvt_pk_bf16_f32 v24, v176, v177
    v_cvt_pk_bf16_f32 v25, v178, v179
    v_cvt_pk_bf16_f32 v26, v180, v181
    v_cvt_pk_bf16_f32 v27, v182, v183
    v_cvt_pk_bf16_f32 v28, v184, v185
    v_cvt_pk_bf16_f32 v29, v186, v187
    v_cvt_pk_bf16_f32 v30, v188, v189
    v_cvt_pk_bf16_f32 v31, v190, v191
    ds_write_b128 v227, v[16:19] offset:0
    ds_write_b128 v227, v[20:23] offset:512
    ds_write_b128 v227, v[24:27] offset:1024
    ds_write_b128 v227, v[28:31] offset:1536
    s_waitcnt vmcnt(4) lgkmcnt(0)
    s_barrier
    ds_read_b128 a[0:3], v225 offset:0
    ds_read_b128 a[4:7], v225 offset:1024
    ds_read_b64_tr_b16 a[16:17], v226 offset:0
    ds_read_b64_tr_b16 a[18:19], v226 offset:256
    ds_read_b64_tr_b16 a[20:21], v226 offset:1024
    ds_read_b64_tr_b16 a[22:23], v226 offset:1280
    v_xor_b32 v227, 0x8000, v227
    v_mov_b32 v56, 0
    v_mov_b32 v57, 0
    v_mov_b32 v58, 0
    v_mov_b32 v59, 0
    v_mov_b32 v60, 0
    v_mov_b32 v61, 0
    v_mov_b32 v62, 0
    v_mov_b32 v63, 0
    v_accvgpr_write_b32 a28, 0
    v_accvgpr_write_b32 a29, 0
    v_accvgpr_write_b32 a30, 0
    v_accvgpr_write_b32 a31, 0
    s_waitcnt lgkmcnt(0)
    v_mfma_f32_32x32x16_bf16 v[0:15], a[0:3], v[128:131], 0
    v_mfma_f32_32x32x16_bf16 v[0:15], a[4:7], v[132:135], v[0:15]
    s_nop 7
    s_nop 3
Ls_loop:
    v_mfma_f32_32x32x16_bf16 v[16:31], a[0:3], v[136:139], 0
    v_sub_f32 v0, v0, v240
    v_exp_f32 v0, v0
    v_sub_f32 v1, v1, v240
    v_exp_f32 v1, v1
    v_sub_f32 v2, v2, v240
    v_exp_f32 v2, v2
    v_mfma_f32_32x32x16_bf16 v[16:31], a[4:7], v[140:143], v[16:31]
    v_sub_f32 v3, v3, v240
    v_exp_f32 v3, v3
    v_sub_f32 v4, v4, v240
    v_exp_f32 v4, v4
    v_sub_f32 v5, v5, v240
    v_exp_f32 v5, v5
    v_smfmac_f32_32x32x32_bf16 v[112:127], a[28:31], v[56:63], v224
    v_sub_f32 v6, v6, v240
    v_exp_f32 v6, v6
    v_sub_f32 v7, v7, v240
    v_exp_f32 v7, v7
    v_sub_f32 v8, v8, v240
    v_exp_f32 v8, v8
    v_smfmac_f32_16x16x64_bf16 v[220:223], a[32:35], v[56:63], v224
    s_waitcnt lgkmcnt(0)
    ds_read_b128 a[8:11], v225 offset:2048
    ds_read_b128 a[12:15], v225 offset:3072
    v_sub_f32 v9, v9, v240
    v_exp_f32 v9, v9
    v_smfmac_f32_32x32x32_bf16 v[64:79], a[16:19], v[0:7], v224
    v_sub_f32 v10, v10, v240
    v_exp_f32 v10, v10
    v_sub_f32 v11, v11, v240
    v_exp_f32 v11, v11
    v_sub_f32 v12, v12, v240
    v_exp_f32 v12, v12
    v_smfmac_f32_16x16x64_bf16 v[208:211], a[32:35], v[0:7], v224
    v_sub_f32 v13, v13, v240
    v_exp_f32 v13, v13
    v_sub_f32 v14, v14, v240
    v_exp_f32 v14, v14
    v_sub_f32 v15, v15, v240
    v_exp_f32 v15, v15
    v_mfma_f32_32x32x16_bf16 v[32:47], a[0:3], v[144:147], 0
    v_sub_f32 v16, v16, v241
    v_exp_f32 v16, v16
    v_sub_f32 v17, v17, v241
    v_exp_f32 v17, v17
    v_sub_f32 v18, v18, v241
    v_exp_f32 v18, v18
    v_mfma_f32_32x32x16_bf16 v[32:47], a[4:7], v[148:151], v[32:47]
    v_sub_f32 v19, v19, v241
    v_exp_f32 v19, v19
    v_sub_f32 v20, v20, v241
    v_exp_f32 v20, v20
    v_sub_f32 v21, v21, v241
    v_exp_f32 v21, v21
    v_smfmac_f32_32x32x32_bf16 v[64:79], a[20:23], v[8:15], v224
    v_sub_f32 v22, v22, v241
    v_exp_f32 v22, v22
    v_sub_f32 v23, v23, v241
    v_exp_f32 v23, v23
    v_sub_f32 v24, v24, v241
    v_exp_f32 v24, v24
    v_smfmac_f32_16x16x64_bf16 v[208:211], a[32:35], v[8:15], v224
    ds_read_b64_tr_b16 a[24:25], v226 offset:2048
    ds_read_b64_tr_b16 a[26:27], v226 offset:2304
    ds_read_b64_tr_b16 a[28:29], v226 offset:3072
    ds_read_b64_tr_b16 a[30:31], v226 offset:3328
    v_sub_f32 v25, v25, v241
    v_exp_f32 v25, v25
    v_smfmac_f32_32x32x32_bf16 v[80:95], a[16:19], v[16:23], v224
    v_sub_f32 v26, v26, v241
    v_exp_f32 v26, v26
    v_sub_f32 v27, v27, v241
    v_exp_f32 v27, v27
    v_sub_f32 v28, v28, v241
    v_exp_f32 v28, v28
    v_smfmac_f32_16x16x64_bf16 v[212:215], a[32:35], v[16:23], v224
    v_sub_f32 v29, v29, v241
    v_exp_f32 v29, v29
    v_sub_f32 v30, v30, v241
    v_exp_f32 v30, v30
    v_sub_f32 v31, v31, v241
    v_exp_f32 v31, v31
    v_mfma_f32_32x32x16_bf16 v[48:63], a[0:3], v[152:155], 0
    v_sub_f32 v32, v32, v242
    v_exp_f32 v32, v32
    v_sub_f32 v33, v33, v242
    v_exp_f32 v33, v33
    v_sub_f32 v34, v34, v242
    v_exp_f32 v34, v34
    v_mfma_f32_32x32x16_bf16 v[48:63], a[4:7], v[156:159], v[48:63]
    v_sub_f32 v35, v35, v242
    v_exp_f32 v35, v35
    v_sub_f32 v36, v36, v242
    v_exp_f32 v36, v36
    v_sub_f32 v37, v37, v242
    v_exp_f32 v37, v37
    v_smfmac_f32_32x32x32_bf16 v[80:95], a[20:23], v[24:31], v224
    v_sub_f32 v38, v38, v242
    v_exp_f32 v38, v38
    v_sub_f32 v39, v39, v242
    v_exp_f32 v39, v39
    v_sub_f32 v40, v40, v242
    v_exp_f32 v40, v40
    v_smfmac_f32_16x16x64_bf16 v[212:215], a[32:35], v[24:31], v224
    s_waitcnt lgkmcnt(0)
    v_sub_f32 v41, v41, v242
    v_exp_f32 v41, v41
    v_smfmac_f32_32x32x32_bf16 v[96:111], a[16:19], v[32:39], v224
    v_sub_f32 v42, v42, v242
    v_exp_f32 v42, v42
    v_sub_f32 v43, v43, v242
    v_exp_f32 v43, v43
    v_sub_f32 v44, v44, v242
    v_exp_f32 v44, v44
    v_smfmac_f32_16x16x64_bf16 v[216:219], a[32:35], v[32:39], v224
    v_sub_f32 v45, v45, v242
    v_exp_f32 v45, v45
    v_sub_f32 v46, v46, v242
    v_exp_f32 v46, v46
    v_sub_f32 v47, v47, v242
    v_exp_f32 v47, v47
    v_mfma_f32_32x32x16_bf16 v[0:15], a[8:11], v[128:131], 0
    v_sub_f32 v48, v48, v243
    v_exp_f32 v48, v48
    v_sub_f32 v49, v49, v243
    v_exp_f32 v49, v49
    v_sub_f32 v50, v50, v243
    v_exp_f32 v50, v50
    v_mfma_f32_32x32x16_bf16 v[0:15], a[12:15], v[132:135], v[0:15]
    v_sub_f32 v51, v51, v243
    v_exp_f32 v51, v51
    v_sub_f32 v52, v52, v243
    v_exp_f32 v52, v52
    v_sub_f32 v53, v53, v243
    v_exp_f32 v53, v53
    v_smfmac_f32_32x32x32_bf16 v[96:111], a[20:23], v[40:47], v224
    v_sub_f32 v54, v54, v243
    v_exp_f32 v54, v54
    v_sub_f32 v55, v55, v243
    v_exp_f32 v55, v55
    v_sub_f32 v56, v56, v243
    v_exp_f32 v56, v56
    v_smfmac_f32_16x16x64_bf16 v[216:219], a[32:35], v[40:47], v224
    s_xor_b32 s39, s39, 0x8000
    s_mov_b32 m0, s39
    s_add_u32 s38, s38, 0x4000
    buffer_load_dwordx4 v247, s[24:27], s38 offen offset:0 lds
    buffer_load_dwordx4 v247, s[24:27], s38 offen offset:1024 lds
    buffer_load_dwordx4 v247, s[24:27], s38 offen offset:2048 lds
    buffer_load_dwordx4 v247, s[24:27], s38 offen offset:3072 lds
    v_sub_f32 v57, v57, v243
    v_exp_f32 v57, v57
    v_smfmac_f32_32x32x32_bf16 v[112:127], a[16:19], v[48:55], v224
    v_sub_f32 v58, v58, v243
    v_exp_f32 v58, v58
    v_sub_f32 v59, v59, v243
    v_exp_f32 v59, v59
    v_sub_f32 v60, v60, v243
    v_exp_f32 v60, v60
    v_smfmac_f32_16x16x64_bf16 v[220:223], a[32:35], v[48:55], v224
    v_sub_f32 v61, v61, v243
    v_exp_f32 v61, v61
    v_sub_f32 v62, v62, v243
    v_exp_f32 v62, v62
    v_sub_f32 v63, v63, v243
    v_exp_f32 v63, v63
    v_mfma_f32_32x32x16_bf16 v[16:31], a[8:11], v[136:139], 0
    v_sub_f32 v0, v0, v240
    v_exp_f32 v0, v0
    v_sub_f32 v1, v1, v240
    v_exp_f32 v1, v1
    v_sub_f32 v2, v2, v240
    v_exp_f32 v2, v2
    v_mfma_f32_32x32x16_bf16 v[16:31], a[12:15], v[140:143], v[16:31]
    v_sub_f32 v3, v3, v240
    v_exp_f32 v3, v3
    v_sub_f32 v4, v4, v240
    v_exp_f32 v4, v4
    v_sub_f32 v5, v5, v240
    v_exp_f32 v5, v5
    v_smfmac_f32_32x32x32_bf16 v[112:127], a[20:23], v[56:63], v224
    v_sub_f32 v6, v6, v240
    v_exp_f32 v6, v6
    v_sub_f32 v7, v7, v240
    v_exp_f32 v7, v7
    v_sub_f32 v8, v8, v240
    v_exp_f32 v8, v8
    v_smfmac_f32_16x16x64_bf16 v[220:223], a[32:35], v[56:63], v224
    s_waitcnt lgkmcnt(0)
    ds_read_b128 a[0:3], v225 offset:4096
    ds_read_b128 a[4:7], v225 offset:5120
    v_sub_f32 v9, v9, v240
    v_exp_f32 v9, v9
    v_smfmac_f32_32x32x32_bf16 v[64:79], a[24:27], v[0:7], v224
    v_sub_f32 v10, v10, v240
    v_exp_f32 v10, v10
    v_sub_f32 v11, v11, v240
    v_exp_f32 v11, v11
    v_sub_f32 v12, v12, v240
    v_exp_f32 v12, v12
    v_smfmac_f32_16x16x64_bf16 v[208:211], a[32:35], v[0:7], v224
    v_sub_f32 v13, v13, v240
    v_exp_f32 v13, v13
    v_sub_f32 v14, v14, v240
    v_exp_f32 v14, v14
    v_sub_f32 v15, v15, v240
    v_exp_f32 v15, v15
    v_mfma_f32_32x32x16_bf16 v[32:47], a[8:11], v[144:147], 0
    v_sub_f32 v16, v16, v241
    v_exp_f32 v16, v16
    v_sub_f32 v17, v17, v241
    v_exp_f32 v17, v17
    v_sub_f32 v18, v18, v241
    v_exp_f32 v18, v18
    v_mfma_f32_32x32x16_bf16 v[32:47], a[12:15], v[148:151], v[32:47]
    v_sub_f32 v19, v19, v241
    v_exp_f32 v19, v19
    v_sub_f32 v20, v20, v241
    v_exp_f32 v20, v20
    v_sub_f32 v21, v21, v241
    v_exp_f32 v21, v21
    v_smfmac_f32_32x32x32_bf16 v[64:79], a[28:31], v[8:15], v224
    v_sub_f32 v22, v22, v241
    v_exp_f32 v22, v22
    v_sub_f32 v23, v23, v241
    v_exp_f32 v23, v23
    v_sub_f32 v24, v24, v241
    v_exp_f32 v24, v24
    v_smfmac_f32_16x16x64_bf16 v[208:211], a[32:35], v[8:15], v224
    ds_read_b64_tr_b16 a[16:17], v226 offset:4096
    ds_read_b64_tr_b16 a[18:19], v226 offset:4352
    ds_read_b64_tr_b16 a[20:21], v226 offset:5120
    ds_read_b64_tr_b16 a[22:23], v226 offset:5376
    v_sub_f32 v25, v25, v241
    v_exp_f32 v25, v25
    v_smfmac_f32_32x32x32_bf16 v[80:95], a[24:27], v[16:23], v224
    v_sub_f32 v26, v26, v241
    v_exp_f32 v26, v26
    v_sub_f32 v27, v27, v241
    v_exp_f32 v27, v27
    v_sub_f32 v28, v28, v241
    v_exp_f32 v28, v28
    v_smfmac_f32_16x16x64_bf16 v[212:215], a[32:35], v[16:23], v224
    v_sub_f32 v29, v29, v241
    v_exp_f32 v29, v29
    v_sub_f32 v30, v30, v241
    v_exp_f32 v30, v30
    v_sub_f32 v31, v31, v241
    v_exp_f32 v31, v31
    v_mfma_f32_32x32x16_bf16 v[48:63], a[8:11], v[152:155], 0
    v_sub_f32 v32, v32, v242
    v_exp_f32 v32, v32
    v_sub_f32 v33, v33, v242
    v_exp_f32 v33, v33
    v_sub_f32 v34, v34, v242
    v_exp_f32 v34, v34
    v_mfma_f32_32x32x16_bf16 v[48:63], a[12:15], v[156:159], v[48:63]
    v_sub_f32 v35, v35, v242
    v_exp_f32 v35, v35
    v_sub_f32 v36, v36, v242
    v_exp_f32 v36, v36
    v_sub_f32 v37, v37, v242
    v_exp_f32 v37, v37
    v_smfmac_f32_32x32x32_bf16 v[80:95], a[28:31], v[24:31], v224
    v_sub_f32 v38, v38, v242
    v_exp_f32 v38, v38
    v_sub_f32 v39, v39, v242
    v_exp_f32 v39, v39
    v_sub_f32 v40, v40, v242
    v_exp_f32 v40, v40
    v_smfmac_f32_16x16x64_bf16 v[212:215], a[32:35], v[24:31], v224
    s_waitcnt lgkmcnt(0)
    v_sub_f32 v41, v41, v242
    v_exp_f32 v41, v41
    v_smfmac_f32_32x32x32_bf16 v[96:111], a[24:27], v[32:39], v224
    v_sub_f32 v42, v42, v242
    v_exp_f32 v42, v42
    v_sub_f32 v43, v43, v242
    v_exp_f32 v43, v43
    v_sub_f32 v44, v44, v242
    v_exp_f32 v44, v44
    v_smfmac_f32_16x16x64_bf16 v[216:219], a[32:35], v[32:39], v224
    v_sub_f32 v45, v45, v242
    v_exp_f32 v45, v45
    v_sub_f32 v46, v46, v242
    v_exp_f32 v46, v46
    v_sub_f32 v47, v47, v242
    v_exp_f32 v47, v47
    v_mfma_f32_32x32x16_bf16 v[0:15], a[0:3], v[128:131], 0
    v_sub_f32 v48, v48, v243
    v_exp_f32 v48, v48
    v_sub_f32 v49, v49, v243
    v_exp_f32 v49, v49
    v_sub_f32 v50, v50, v243
    v_exp_f32 v50, v50
    v_mfma_f32_32x32x16_bf16 v[0:15], a[4:7], v[132:135], v[0:15]
    v_sub_f32 v51, v51, v243
    v_exp_f32 v51, v51
    v_sub_f32 v52, v52, v243
    v_exp_f32 v52, v52
    v_sub_f32 v53, v53, v243
    v_exp_f32 v53, v53
    v_smfmac_f32_32x32x32_bf16 v[96:111], a[28:31], v[40:47], v224
    v_sub_f32 v54, v54, v243
    v_exp_f32 v54, v54
    v_sub_f32 v55, v55, v243
    v_exp_f32 v55, v55
    v_sub_f32 v56, v56, v243
    v_exp_f32 v56, v56
    v_smfmac_f32_16x16x64_bf16 v[216:219], a[32:35], v[40:47], v224
    v_sub_f32 v57, v57, v243
    v_exp_f32 v57, v57
    v_smfmac_f32_32x32x32_bf16 v[112:127], a[24:27], v[48:55], v224
    v_sub_f32 v58, v58, v243
    v_exp_f32 v58, v58
    v_sub_f32 v59, v59, v243
    v_exp_f32 v59, v59
    v_sub_f32 v60, v60, v243
    v_exp_f32 v60, v60
    v_smfmac_f32_16x16x64_bf16 v[220:223], a[32:35], v[48:55], v224
    v_sub_f32 v61, v61, v243
    v_exp_f32 v61, v61
    v_sub_f32 v62, v62, v243
    v_exp_f32 v62, v62
    v_sub_f32 v63, v63, v243
    v_exp_f32 v63, v63
    s_waitcnt vmcnt(4)
    v_pk_mul_f32 v[236:237], 0, 0
    v_dot2c_f32_bf16 v236, v192, v192
    v_dot2c_f32_bf16 v237, v193, v193
    v_dot2c_f32_bf16 v236, v194, v194
    v_dot2c_f32_bf16 v237, v195, v195
    v_dot2c_f32_bf16 v236, v196, v196
    v_dot2c_f32_bf16 v237, v197, v197
    v_dot2c_f32_bf16 v236, v198, v198
    v_dot2c_f32_bf16 v237, v199, v199
    v_dot2c_f32_bf16 v236, v200, v200
    v_dot2c_f32_bf16 v237, v201, v201
    v_dot2c_f32_bf16 v236, v202, v202
    v_dot2c_f32_bf16 v237, v203, v203
    v_dot2c_f32_bf16 v236, v204, v204
    v_dot2c_f32_bf16 v237, v205, v205
    v_dot2c_f32_bf16 v236, v206, v206
    v_dot2c_f32_bf16 v237, v207, v207
    v_mfma_f32_4x4x4_16b_bf16 v[160:163], v[230:231], v[192:193], 0
    v_mfma_f32_4x4x4_16b_bf16 v[164:167], v[230:231], v[194:195], 0
    v_mfma_f32_4x4x4_16b_bf16 v[168:171], v[230:231], v[196:197], 0
    v_add_f32 v236, v236, v237
    v_mfma_f32_4x4x4_16b_bf16 v[172:175], v[230:231], v[198:199], 0
    v_sqrt_f32 v236, v236
    v_mfma_f32_4x4x4_16b_bf16 v[176:179], v[230:231], v[200:201], 0
    v_add_f32 v236, 0x358637bd, v236
    v_mfma_f32_4x4x4_16b_bf16 v[180:183], v[230:231], v[202:203], 0
    v_rcp_f32 v236, v236
    v_mfma_f32_4x4x4_16b_bf16 v[184:187], v[230:231], v[204:205], 0
    v_mfma_f32_4x4x4_16b_bf16 v[188:191], v[230:231], v[206:207], 0
    v_pk_mul_f32 v[160:161], v[160:161], v[236:237] op_sel_hi:[1,0]
    v_pk_mul_f32 v[162:163], v[162:163], v[236:237] op_sel_hi:[1,0]
    v_pk_mul_f32 v[164:165], v[164:165], v[236:237] op_sel_hi:[1,0]
    v_pk_mul_f32 v[166:167], v[166:167], v[236:237] op_sel_hi:[1,0]
    v_pk_mul_f32 v[168:169], v[168:169], v[236:237] op_sel_hi:[1,0]
    v_pk_mul_f32 v[170:171], v[170:171], v[236:237] op_sel_hi:[1,0]
    v_pk_mul_f32 v[172:173], v[172:173], v[236:237] op_sel_hi:[1,0]
    v_pk_mul_f32 v[174:175], v[174:175], v[236:237] op_sel_hi:[1,0]
    v_pk_mul_f32 v[176:177], v[176:177], v[236:237] op_sel_hi:[1,0]
    v_pk_mul_f32 v[178:179], v[178:179], v[236:237] op_sel_hi:[1,0]
    v_pk_mul_f32 v[180:181], v[180:181], v[236:237] op_sel_hi:[1,0]
    v_pk_mul_f32 v[182:183], v[182:183], v[236:237] op_sel_hi:[1,0]
    v_pk_mul_f32 v[184:185], v[184:185], v[236:237] op_sel_hi:[1,0]
    v_pk_mul_f32 v[186:187], v[186:187], v[236:237] op_sel_hi:[1,0]
    v_pk_mul_f32 v[188:189], v[188:189], v[236:237] op_sel_hi:[1,0]
    v_pk_mul_f32 v[190:191], v[190:191], v[236:237] op_sel_hi:[1,0]
    v_cvt_pk_bf16_f32 v192, v160, v161
    v_cvt_pk_bf16_f32 v193, v162, v163
    v_cvt_pk_bf16_f32 v194, v164, v165
    v_cvt_pk_bf16_f32 v195, v166, v167
    v_cvt_pk_bf16_f32 v196, v168, v169
    v_cvt_pk_bf16_f32 v197, v170, v171
    v_cvt_pk_bf16_f32 v198, v172, v173
    v_cvt_pk_bf16_f32 v199, v174, v175
    v_cvt_pk_bf16_f32 v200, v176, v177
    v_cvt_pk_bf16_f32 v201, v178, v179
    v_cvt_pk_bf16_f32 v202, v180, v181
    v_cvt_pk_bf16_f32 v203, v182, v183
    v_cvt_pk_bf16_f32 v204, v184, v185
    v_cvt_pk_bf16_f32 v205, v186, v187
    v_cvt_pk_bf16_f32 v206, v188, v189
    v_cvt_pk_bf16_f32 v207, v190, v191
    ds_write_b128 v227, v[192:195] offset:0
    ds_write_b128 v227, v[196:199] offset:512
    ds_write_b128 v227, v[200:203] offset:1024
    ds_write_b128 v227, v[204:207] offset:1536
    v_mfma_f32_32x32x16_bf16 v[16:31], a[0:3], v[136:139], 0
    v_sub_f32 v0, v0, v240
    v_exp_f32 v0, v0
    v_sub_f32 v1, v1, v240
    v_exp_f32 v1, v1
    v_sub_f32 v2, v2, v240
    v_exp_f32 v2, v2
    v_mfma_f32_32x32x16_bf16 v[16:31], a[4:7], v[140:143], v[16:31]
    v_sub_f32 v3, v3, v240
    v_exp_f32 v3, v3
    v_sub_f32 v4, v4, v240
    v_exp_f32 v4, v4
    v_sub_f32 v5, v5, v240
    v_exp_f32 v5, v5
    v_smfmac_f32_32x32x32_bf16 v[112:127], a[28:31], v[56:63], v224
    v_sub_f32 v6, v6, v240
    v_exp_f32 v6, v6
    v_sub_f32 v7, v7, v240
    v_exp_f32 v7, v7
    v_sub_f32 v8, v8, v240
    v_exp_f32 v8, v8
    v_smfmac_f32_16x16x64_bf16 v[220:223], a[32:35], v[56:63], v224
    s_waitcnt lgkmcnt(0)
    ds_read_b128 a[8:11], v225 offset:6144
    ds_read_b128 a[12:15], v225 offset:7168
    v_sub_f32 v9, v9, v240
    v_exp_f32 v9, v9
    v_smfmac_f32_32x32x32_bf16 v[64:79], a[16:19], v[0:7], v224
    v_sub_f32 v10, v10, v240
    v_exp_f32 v10, v10
    v_sub_f32 v11, v11, v240
    v_exp_f32 v11, v11
    v_sub_f32 v12, v12, v240
    v_exp_f32 v12, v12
    v_smfmac_f32_16x16x64_bf16 v[208:211], a[32:35], v[0:7], v224
    v_sub_f32 v13, v13, v240
    v_exp_f32 v13, v13
    v_sub_f32 v14, v14, v240
    v_exp_f32 v14, v14
    v_sub_f32 v15, v15, v240
    v_exp_f32 v15, v15
    v_mfma_f32_32x32x16_bf16 v[32:47], a[0:3], v[144:147], 0
    v_sub_f32 v16, v16, v241
    v_exp_f32 v16, v16
    v_sub_f32 v17, v17, v241
    v_exp_f32 v17, v17
    v_sub_f32 v18, v18, v241
    v_exp_f32 v18, v18
    v_mfma_f32_32x32x16_bf16 v[32:47], a[4:7], v[148:151], v[32:47]
    v_sub_f32 v19, v19, v241
    v_exp_f32 v19, v19
    v_sub_f32 v20, v20, v241
    v_exp_f32 v20, v20
    v_sub_f32 v21, v21, v241
    v_exp_f32 v21, v21
    v_smfmac_f32_32x32x32_bf16 v[64:79], a[20:23], v[8:15], v224
    v_sub_f32 v22, v22, v241
    v_exp_f32 v22, v22
    v_sub_f32 v23, v23, v241
    v_exp_f32 v23, v23
    v_sub_f32 v24, v24, v241
    v_exp_f32 v24, v24
    v_smfmac_f32_16x16x64_bf16 v[208:211], a[32:35], v[8:15], v224
    ds_read_b64_tr_b16 a[24:25], v226 offset:6144
    ds_read_b64_tr_b16 a[26:27], v226 offset:6400
    ds_read_b64_tr_b16 a[28:29], v226 offset:7168
    ds_read_b64_tr_b16 a[30:31], v226 offset:7424
    v_sub_f32 v25, v25, v241
    v_exp_f32 v25, v25
    v_smfmac_f32_32x32x32_bf16 v[80:95], a[16:19], v[16:23], v224
    v_sub_f32 v26, v26, v241
    v_exp_f32 v26, v26
    v_sub_f32 v27, v27, v241
    v_exp_f32 v27, v27
    v_sub_f32 v28, v28, v241
    v_exp_f32 v28, v28
    v_smfmac_f32_16x16x64_bf16 v[212:215], a[32:35], v[16:23], v224
    v_sub_f32 v29, v29, v241
    v_exp_f32 v29, v29
    v_sub_f32 v30, v30, v241
    v_exp_f32 v30, v30
    v_sub_f32 v31, v31, v241
    v_exp_f32 v31, v31
    v_mfma_f32_32x32x16_bf16 v[48:63], a[0:3], v[152:155], 0
    v_sub_f32 v32, v32, v242
    v_exp_f32 v32, v32
    v_sub_f32 v33, v33, v242
    v_exp_f32 v33, v33
    v_sub_f32 v34, v34, v242
    v_exp_f32 v34, v34
    v_mfma_f32_32x32x16_bf16 v[48:63], a[4:7], v[156:159], v[48:63]
    v_sub_f32 v35, v35, v242
    v_exp_f32 v35, v35
    v_sub_f32 v36, v36, v242
    v_exp_f32 v36, v36
    v_sub_f32 v37, v37, v242
    v_exp_f32 v37, v37
    v_smfmac_f32_32x32x32_bf16 v[80:95], a[20:23], v[24:31], v224
    v_sub_f32 v38, v38, v242
    v_exp_f32 v38, v38
    v_sub_f32 v39, v39, v242
    v_exp_f32 v39, v39
    v_sub_f32 v40, v40, v242
    v_exp_f32 v40, v40
    v_smfmac_f32_16x16x64_bf16 v[212:215], a[32:35], v[24:31], v224
    s_waitcnt lgkmcnt(0)
    v_sub_f32 v41, v41, v242
    v_exp_f32 v41, v41
    v_smfmac_f32_32x32x32_bf16 v[96:111], a[16:19], v[32:39], v224
    v_sub_f32 v42, v42, v242
    v_exp_f32 v42, v42
    v_sub_f32 v43, v43, v242
    v_exp_f32 v43, v43
    v_sub_f32 v44, v44, v242
    v_exp_f32 v44, v44
    v_smfmac_f32_16x16x64_bf16 v[216:219], a[32:35], v[32:39], v224
    v_sub_f32 v45, v45, v242
    v_exp_f32 v45, v45
    v_sub_f32 v46, v46, v242
    v_exp_f32 v46, v46
    v_sub_f32 v47, v47, v242
    v_exp_f32 v47, v47
    v_mfma_f32_32x32x16_bf16 v[0:15], a[8:11], v[128:131], 0
    v_sub_f32 v48, v48, v243
    v_exp_f32 v48, v48
    v_sub_f32 v49, v49, v243
    v_exp_f32 v49, v49
    v_sub_f32 v50, v50, v243
    v_exp_f32 v50, v50
    v_mfma_f32_32x32x16_bf16 v[0:15], a[12:15], v[132:135], v[0:15]
    v_sub_f32 v51, v51, v243
    v_exp_f32 v51, v51
    v_sub_f32 v52, v52, v243
    v_exp_f32 v52, v52
    v_sub_f32 v53, v53, v243
    v_exp_f32 v53, v53
    v_smfmac_f32_32x32x32_bf16 v[96:111], a[20:23], v[40:47], v224
    v_sub_f32 v54, v54, v243
    v_exp_f32 v54, v54
    v_sub_f32 v55, v55, v243
    v_exp_f32 v55, v55
    v_sub_f32 v56, v56, v243
    v_exp_f32 v56, v56
    v_smfmac_f32_16x16x64_bf16 v[216:219], a[32:35], v[40:47], v224
    v_sub_f32 v57, v57, v243
    v_exp_f32 v57, v57
    v_smfmac_f32_32x32x32_bf16 v[112:127], a[16:19], v[48:55], v224
    v_sub_f32 v58, v58, v243
    v_exp_f32 v58, v58
    v_sub_f32 v59, v59, v243
    v_exp_f32 v59, v59
    v_sub_f32 v60, v60, v243
    v_exp_f32 v60, v60
    v_smfmac_f32_16x16x64_bf16 v[220:223], a[32:35], v[48:55], v224
    v_sub_f32 v61, v61, v243
    v_exp_f32 v61, v61
    v_sub_f32 v62, v62, v243
    v_exp_f32 v62, v62
    v_sub_f32 v63, v63, v243
    v_exp_f32 v63, v63
    v_mfma_f32_32x32x16_bf16 v[16:31], a[8:11], v[136:139], 0
    v_sub_f32 v0, v0, v240
    v_exp_f32 v0, v0
    v_sub_f32 v1, v1, v240
    v_exp_f32 v1, v1
    v_sub_f32 v2, v2, v240
    v_exp_f32 v2, v2
    v_mfma_f32_32x32x16_bf16 v[16:31], a[12:15], v[140:143], v[16:31]
    v_sub_f32 v3, v3, v240
    v_exp_f32 v3, v3
    v_sub_f32 v4, v4, v240
    v_exp_f32 v4, v4
    v_sub_f32 v5, v5, v240
    v_exp_f32 v5, v5
    v_smfmac_f32_32x32x32_bf16 v[112:127], a[20:23], v[56:63], v224
    v_sub_f32 v6, v6, v240
    v_exp_f32 v6, v6
    v_sub_f32 v7, v7, v240
    v_exp_f32 v7, v7
    v_sub_f32 v8, v8, v240
    v_exp_f32 v8, v8
    v_smfmac_f32_16x16x64_bf16 v[220:223], a[32:35], v[56:63], v224
    s_waitcnt lgkmcnt(0)
    ds_read_b128 a[0:3], v225 offset:8192
    ds_read_b128 a[4:7], v225 offset:9216
    v_sub_f32 v9, v9, v240
    v_exp_f32 v9, v9
    v_smfmac_f32_32x32x32_bf16 v[64:79], a[24:27], v[0:7], v224
    v_sub_f32 v10, v10, v240
    v_exp_f32 v10, v10
    v_sub_f32 v11, v11, v240
    v_exp_f32 v11, v11
    v_sub_f32 v12, v12, v240
    v_exp_f32 v12, v12
    v_smfmac_f32_16x16x64_bf16 v[208:211], a[32:35], v[0:7], v224
    v_sub_f32 v13, v13, v240
    v_exp_f32 v13, v13
    v_sub_f32 v14, v14, v240
    v_exp_f32 v14, v14
    v_sub_f32 v15, v15, v240
    v_exp_f32 v15, v15
    v_mfma_f32_32x32x16_bf16 v[32:47], a[8:11], v[144:147], 0
    v_sub_f32 v16, v16, v241
    v_exp_f32 v16, v16
    v_sub_f32 v17, v17, v241
    v_exp_f32 v17, v17
    v_sub_f32 v18, v18, v241
    v_exp_f32 v18, v18
    v_mfma_f32_32x32x16_bf16 v[32:47], a[12:15], v[148:151], v[32:47]
    v_sub_f32 v19, v19, v241
    v_exp_f32 v19, v19
    v_sub_f32 v20, v20, v241
    v_exp_f32 v20, v20
    v_sub_f32 v21, v21, v241
    v_exp_f32 v21, v21
    v_smfmac_f32_32x32x32_bf16 v[64:79], a[28:31], v[8:15], v224
    v_sub_f32 v22, v22, v241
    v_exp_f32 v22, v22
    v_sub_f32 v23, v23, v241
    v_exp_f32 v23, v23
    v_sub_f32 v24, v24, v241
    v_exp_f32 v24, v24
    v_smfmac_f32_16x16x64_bf16 v[208:211], a[32:35], v[8:15], v224
    ds_read_b64_tr_b16 a[16:17], v226 offset:8192
    ds_read_b64_tr_b16 a[18:19], v226 offset:8448
    ds_read_b64_tr_b16 a[20:21], v226 offset:9216
    ds_read_b64_tr_b16 a[22:23], v226 offset:9472
    v_sub_f32 v25, v25, v241
    v_exp_f32 v25, v25
    v_smfmac_f32_32x32x32_bf16 v[80:95], a[24:27], v[16:23], v224
    v_sub_f32 v26, v26, v241
    v_exp_f32 v26, v26
    v_sub_f32 v27, v27, v241
    v_exp_f32 v27, v27
    v_sub_f32 v28, v28, v241
    v_exp_f32 v28, v28
    v_smfmac_f32_16x16x64_bf16 v[212:215], a[32:35], v[16:23], v224
    v_sub_f32 v29, v29, v241
    v_exp_f32 v29, v29
    v_sub_f32 v30, v30, v241
    v_exp_f32 v30, v30
    v_sub_f32 v31, v31, v241
    v_exp_f32 v31, v31
    v_mfma_f32_32x32x16_bf16 v[48:63], a[8:11], v[152:155], 0
    v_sub_f32 v32, v32, v242
    v_exp_f32 v32, v32
    v_sub_f32 v33, v33, v242
    v_exp_f32 v33, v33
    v_sub_f32 v34, v34, v242
    v_exp_f32 v34, v34
    v_mfma_f32_32x32x16_bf16 v[48:63], a[12:15], v[156:159], v[48:63]
    v_sub_f32 v35, v35, v242
    v_exp_f32 v35, v35
    v_sub_f32 v36, v36, v242
    v_exp_f32 v36, v36
    v_sub_f32 v37, v37, v242
    v_exp_f32 v37, v37
    v_smfmac_f32_32x32x32_bf16 v[80:95], a[28:31], v[24:31], v224
    v_sub_f32 v38, v38, v242
    v_exp_f32 v38, v38
    v_sub_f32 v39, v39, v242
    v_exp_f32 v39, v39
    v_sub_f32 v40, v40, v242
    v_exp_f32 v40, v40
    v_smfmac_f32_16x16x64_bf16 v[212:215], a[32:35], v[24:31], v224
    s_waitcnt lgkmcnt(0)
    v_sub_f32 v41, v41, v242
    v_exp_f32 v41, v41
    v_smfmac_f32_32x32x32_bf16 v[96:111], a[24:27], v[32:39], v224
    v_sub_f32 v42, v42, v242
    v_exp_f32 v42, v42
    v_sub_f32 v43, v43, v242
    v_exp_f32 v43, v43
    v_sub_f32 v44, v44, v242
    v_exp_f32 v44, v44
    v_smfmac_f32_16x16x64_bf16 v[216:219], a[32:35], v[32:39], v224
    v_sub_f32 v45, v45, v242
    v_exp_f32 v45, v45
    v_sub_f32 v46, v46, v242
    v_exp_f32 v46, v46
    v_sub_f32 v47, v47, v242
    v_exp_f32 v47, v47
    v_mfma_f32_32x32x16_bf16 v[0:15], a[0:3], v[128:131], 0
    v_sub_f32 v48, v48, v243
    v_exp_f32 v48, v48
    v_sub_f32 v49, v49, v243
    v_exp_f32 v49, v49
    v_sub_f32 v50, v50, v243
    v_exp_f32 v50, v50
    v_mfma_f32_32x32x16_bf16 v[0:15], a[4:7], v[132:135], v[0:15]
    v_sub_f32 v51, v51, v243
    v_exp_f32 v51, v51
    v_sub_f32 v52, v52, v243
    v_exp_f32 v52, v52
    v_sub_f32 v53, v53, v243
    v_exp_f32 v53, v53
    v_smfmac_f32_32x32x32_bf16 v[96:111], a[28:31], v[40:47], v224
    v_sub_f32 v54, v54, v243
    v_exp_f32 v54, v54
    v_sub_f32 v55, v55, v243
    v_exp_f32 v55, v55
    v_sub_f32 v56, v56, v243
    v_exp_f32 v56, v56
    v_smfmac_f32_16x16x64_bf16 v[216:219], a[32:35], v[40:47], v224
    v_sub_f32 v57, v57, v243
    v_exp_f32 v57, v57
    v_smfmac_f32_32x32x32_bf16 v[112:127], a[24:27], v[48:55], v224
    v_sub_f32 v58, v58, v243
    v_exp_f32 v58, v58
    v_sub_f32 v59, v59, v243
    v_exp_f32 v59, v59
    v_sub_f32 v60, v60, v243
    v_exp_f32 v60, v60
    v_smfmac_f32_16x16x64_bf16 v[220:223], a[32:35], v[48:55], v224
    v_sub_f32 v61, v61, v243
    v_exp_f32 v61, v61
    v_sub_f32 v62, v62, v243
    v_exp_f32 v62, v62
    v_sub_f32 v63, v63, v243
    v_exp_f32 v63, v63
    v_mfma_f32_32x32x16_bf16 v[16:31], a[0:3], v[136:139], 0
    v_sub_f32 v0, v0, v240
    v_exp_f32 v0, v0
    v_sub_f32 v1, v1, v240
    v_exp_f32 v1, v1
    v_sub_f32 v2, v2, v240
    v_exp_f32 v2, v2
    v_mfma_f32_32x32x16_bf16 v[16:31], a[4:7], v[140:143], v[16:31]
    v_sub_f32 v3, v3, v240
    v_exp_f32 v3, v3
    v_sub_f32 v4, v4, v240
    v_exp_f32 v4, v4
    v_sub_f32 v5, v5, v240
    v_exp_f32 v5, v5
    v_smfmac_f32_32x32x32_bf16 v[112:127], a[28:31], v[56:63], v224
    v_sub_f32 v6, v6, v240
    v_exp_f32 v6, v6
    v_sub_f32 v7, v7, v240
    v_exp_f32 v7, v7
    v_sub_f32 v8, v8, v240
    v_exp_f32 v8, v8
    v_smfmac_f32_16x16x64_bf16 v[220:223], a[32:35], v[56:63], v224
    s_waitcnt lgkmcnt(0)
    ds_read_b128 a[8:11], v225 offset:10240
    ds_read_b128 a[12:15], v225 offset:11264
    v_sub_f32 v9, v9, v240
    v_exp_f32 v9, v9
    v_smfmac_f32_32x32x32_bf16 v[64:79], a[16:19], v[0:7], v224
    v_sub_f32 v10, v10, v240
    v_exp_f32 v10, v10
    v_sub_f32 v11, v11, v240
    v_exp_f32 v11, v11
    v_sub_f32 v12, v12, v240
    v_exp_f32 v12, v12
    v_smfmac_f32_16x16x64_bf16 v[208:211], a[32:35], v[0:7], v224
    v_sub_f32 v13, v13, v240
    v_exp_f32 v13, v13
    v_sub_f32 v14, v14, v240
    v_exp_f32 v14, v14
    v_sub_f32 v15, v15, v240
    v_exp_f32 v15, v15
    v_mfma_f32_32x32x16_bf16 v[32:47], a[0:3], v[144:147], 0
    v_sub_f32 v16, v16, v241
    v_exp_f32 v16, v16
    v_sub_f32 v17, v17, v241
    v_exp_f32 v17, v17
    v_sub_f32 v18, v18, v241
    v_exp_f32 v18, v18
    v_mfma_f32_32x32x16_bf16 v[32:47], a[4:7], v[148:151], v[32:47]
    v_sub_f32 v19, v19, v241
    v_exp_f32 v19, v19
    v_sub_f32 v20, v20, v241
    v_exp_f32 v20, v20
    v_sub_f32 v21, v21, v241
    v_exp_f32 v21, v21
    v_smfmac_f32_32x32x32_bf16 v[64:79], a[20:23], v[8:15], v224
    v_sub_f32 v22, v22, v241
    v_exp_f32 v22, v22
    v_sub_f32 v23, v23, v241
    v_exp_f32 v23, v23
    v_sub_f32 v24, v24, v241
    v_exp_f32 v24, v24
    v_smfmac_f32_16x16x64_bf16 v[208:211], a[32:35], v[8:15], v224
    ds_read_b64_tr_b16 a[24:25], v226 offset:10240
    ds_read_b64_tr_b16 a[26:27], v226 offset:10496
    ds_read_b64_tr_b16 a[28:29], v226 offset:11264
    ds_read_b64_tr_b16 a[30:31], v226 offset:11520
    v_sub_f32 v25, v25, v241
    v_exp_f32 v25, v25
    v_smfmac_f32_32x32x32_bf16 v[80:95], a[16:19], v[16:23], v224
    v_sub_f32 v26, v26, v241
    v_exp_f32 v26, v26
    v_sub_f32 v27, v27, v241
    v_exp_f32 v27, v27
    v_sub_f32 v28, v28, v241
    v_exp_f32 v28, v28
    v_smfmac_f32_16x16x64_bf16 v[212:215], a[32:35], v[16:23], v224
    v_sub_f32 v29, v29, v241
    v_exp_f32 v29, v29
    v_sub_f32 v30, v30, v241
    v_exp_f32 v30, v30
    v_sub_f32 v31, v31, v241
    v_exp_f32 v31, v31
    v_mfma_f32_32x32x16_bf16 v[48:63], a[0:3], v[152:155], 0
    v_sub_f32 v32, v32, v242
    v_exp_f32 v32, v32
    v_sub_f32 v33, v33, v242
    v_exp_f32 v33, v33
    v_sub_f32 v34, v34, v242
    v_exp_f32 v34, v34
    v_mfma_f32_32x32x16_bf16 v[48:63], a[4:7], v[156:159], v[48:63]
    v_sub_f32 v35, v35, v242
    v_exp_f32 v35, v35
    v_sub_f32 v36, v36, v242
    v_exp_f32 v36, v36
    v_sub_f32 v37, v37, v242
    v_exp_f32 v37, v37
    v_smfmac_f32_32x32x32_bf16 v[80:95], a[20:23], v[24:31], v224
    v_sub_f32 v38, v38, v242
    v_exp_f32 v38, v38
    v_sub_f32 v39, v39, v242
    v_exp_f32 v39, v39
    v_sub_f32 v40, v40, v242
    v_exp_f32 v40, v40
    v_smfmac_f32_16x16x64_bf16 v[212:215], a[32:35], v[24:31], v224
    s_waitcnt lgkmcnt(0)
    v_sub_f32 v41, v41, v242
    v_exp_f32 v41, v41
    v_smfmac_f32_32x32x32_bf16 v[96:111], a[16:19], v[32:39], v224
    v_sub_f32 v42, v42, v242
    v_exp_f32 v42, v42
    v_sub_f32 v43, v43, v242
    v_exp_f32 v43, v43
    v_sub_f32 v44, v44, v242
    v_exp_f32 v44, v44
    v_smfmac_f32_16x16x64_bf16 v[216:219], a[32:35], v[32:39], v224
    v_sub_f32 v45, v45, v242
    v_exp_f32 v45, v45
    v_sub_f32 v46, v46, v242
    v_exp_f32 v46, v46
    v_sub_f32 v47, v47, v242
    v_exp_f32 v47, v47
    v_mfma_f32_32x32x16_bf16 v[0:15], a[8:11], v[128:131], 0
    v_sub_f32 v48, v48, v243
    v_exp_f32 v48, v48
    v_sub_f32 v49, v49, v243
    v_exp_f32 v49, v49
    v_sub_f32 v50, v50, v243
    v_exp_f32 v50, v50
    v_mfma_f32_32x32x16_bf16 v[0:15], a[12:15], v[132:135], v[0:15]
    v_sub_f32 v51, v51, v243
    v_exp_f32 v51, v51
    v_sub_f32 v52, v52, v243
    v_exp_f32 v52, v52
    v_sub_f32 v53, v53, v243
    v_exp_f32 v53, v53
    v_smfmac_f32_32x32x32_bf16 v[96:111], a[20:23], v[40:47], v224
    v_sub_f32 v54, v54, v243
    v_exp_f32 v54, v54
    v_sub_f32 v55, v55, v243
    v_exp_f32 v55, v55
    v_sub_f32 v56, v56, v243
    v_exp_f32 v56, v56
    v_smfmac_f32_16x16x64_bf16 v[216:219], a[32:35], v[40:47], v224
    s_add_u32 s37, s37, 0x4000
    buffer_load_dwordx4 v[192:195], v246, s[20:23], s37 offen offset:0
    buffer_load_dwordx4 v[196:199], v246, s[20:23], s37 offen offset:16
    buffer_load_dwordx4 v[200:203], v246, s[20:23], s37 offen offset:32
    buffer_load_dwordx4 v[204:207], v246, s[20:23], s37 offen offset:48
    v_sub_f32 v57, v57, v243
    v_exp_f32 v57, v57
    v_smfmac_f32_32x32x32_bf16 v[112:127], a[16:19], v[48:55], v224
    v_sub_f32 v58, v58, v243
    v_exp_f32 v58, v58
    v_sub_f32 v59, v59, v243
    v_exp_f32 v59, v59
    v_sub_f32 v60, v60, v243
    v_exp_f32 v60, v60
    v_smfmac_f32_16x16x64_bf16 v[220:223], a[32:35], v[48:55], v224
    v_sub_f32 v61, v61, v243
    v_exp_f32 v61, v61
    v_sub_f32 v62, v62, v243
    v_exp_f32 v62, v62
    v_sub_f32 v63, v63, v243
    v_exp_f32 v63, v63
    v_mfma_f32_32x32x16_bf16 v[16:31], a[8:11], v[136:139], 0
    v_sub_f32 v0, v0, v240
    v_exp_f32 v0, v0
    v_sub_f32 v1, v1, v240
    v_exp_f32 v1, v1
    v_sub_f32 v2, v2, v240
    v_exp_f32 v2, v2
    v_mfma_f32_32x32x16_bf16 v[16:31], a[12:15], v[140:143], v[16:31]
    v_sub_f32 v3, v3, v240
    v_exp_f32 v3, v3
    v_sub_f32 v4, v4, v240
    v_exp_f32 v4, v4
    v_sub_f32 v5, v5, v240
    v_exp_f32 v5, v5
    v_smfmac_f32_32x32x32_bf16 v[112:127], a[20:23], v[56:63], v224
    v_sub_f32 v6, v6, v240
    v_exp_f32 v6, v6
    v_sub_f32 v7, v7, v240
    v_exp_f32 v7, v7
    v_sub_f32 v8, v8, v240
    v_exp_f32 v8, v8
    v_smfmac_f32_16x16x64_bf16 v[220:223], a[32:35], v[56:63], v224
    s_waitcnt lgkmcnt(0)
    ds_read_b128 a[0:3], v225 offset:12288
    ds_read_b128 a[4:7], v225 offset:13312
    v_sub_f32 v9, v9, v240
    v_exp_f32 v9, v9
    v_smfmac_f32_32x32x32_bf16 v[64:79], a[24:27], v[0:7], v224
    v_sub_f32 v10, v10, v240
    v_exp_f32 v10, v10
    v_sub_f32 v11, v11, v240
    v_exp_f32 v11, v11
    v_sub_f32 v12, v12, v240
    v_exp_f32 v12, v12
    v_smfmac_f32_16x16x64_bf16 v[208:211], a[32:35], v[0:7], v224
    v_sub_f32 v13, v13, v240
    v_exp_f32 v13, v13
    v_sub_f32 v14, v14, v240
    v_exp_f32 v14, v14
    v_sub_f32 v15, v15, v240
    v_exp_f32 v15, v15
    v_mfma_f32_32x32x16_bf16 v[32:47], a[8:11], v[144:147], 0
    v_sub_f32 v16, v16, v241
    v_exp_f32 v16, v16
    v_sub_f32 v17, v17, v241
    v_exp_f32 v17, v17
    v_sub_f32 v18, v18, v241
    v_exp_f32 v18, v18
    v_mfma_f32_32x32x16_bf16 v[32:47], a[12:15], v[148:151], v[32:47]
    v_sub_f32 v19, v19, v241
    v_exp_f32 v19, v19
    v_sub_f32 v20, v20, v241
    v_exp_f32 v20, v20
    v_sub_f32 v21, v21, v241
    v_exp_f32 v21, v21
    v_smfmac_f32_32x32x32_bf16 v[64:79], a[28:31], v[8:15], v224
    v_sub_f32 v22, v22, v241
    v_exp_f32 v22, v22
    v_sub_f32 v23, v23, v241
    v_exp_f32 v23, v23
    v_sub_f32 v24, v24, v241
    v_exp_f32 v24, v24
    v_smfmac_f32_16x16x64_bf16 v[208:211], a[32:35], v[8:15], v224
    ds_read_b64_tr_b16 a[16:17], v226 offset:12288
    ds_read_b64_tr_b16 a[18:19], v226 offset:12544
    ds_read_b64_tr_b16 a[20:21], v226 offset:13312
    ds_read_b64_tr_b16 a[22:23], v226 offset:13568
    v_sub_f32 v25, v25, v241
    v_exp_f32 v25, v25
    v_smfmac_f32_32x32x32_bf16 v[80:95], a[24:27], v[16:23], v224
    v_sub_f32 v26, v26, v241
    v_exp_f32 v26, v26
    v_sub_f32 v27, v27, v241
    v_exp_f32 v27, v27
    v_sub_f32 v28, v28, v241
    v_exp_f32 v28, v28
    v_smfmac_f32_16x16x64_bf16 v[212:215], a[32:35], v[16:23], v224
    v_sub_f32 v29, v29, v241
    v_exp_f32 v29, v29
    v_sub_f32 v30, v30, v241
    v_exp_f32 v30, v30
    v_sub_f32 v31, v31, v241
    v_exp_f32 v31, v31
    v_mfma_f32_32x32x16_bf16 v[48:63], a[8:11], v[152:155], 0
    v_sub_f32 v32, v32, v242
    v_exp_f32 v32, v32
    v_sub_f32 v33, v33, v242
    v_exp_f32 v33, v33
    v_sub_f32 v34, v34, v242
    v_exp_f32 v34, v34
    v_mfma_f32_32x32x16_bf16 v[48:63], a[12:15], v[156:159], v[48:63]
    v_sub_f32 v35, v35, v242
    v_exp_f32 v35, v35
    v_sub_f32 v36, v36, v242
    v_exp_f32 v36, v36
    v_sub_f32 v37, v37, v242
    v_exp_f32 v37, v37
    v_smfmac_f32_32x32x32_bf16 v[80:95], a[28:31], v[24:31], v224
    v_sub_f32 v38, v38, v242
    v_exp_f32 v38, v38
    v_sub_f32 v39, v39, v242
    v_exp_f32 v39, v39
    v_sub_f32 v40, v40, v242
    v_exp_f32 v40, v40
    v_smfmac_f32_16x16x64_bf16 v[212:215], a[32:35], v[24:31], v224
    s_waitcnt lgkmcnt(0)
    v_sub_f32 v41, v41, v242
    v_exp_f32 v41, v41
    v_smfmac_f32_32x32x32_bf16 v[96:111], a[24:27], v[32:39], v224
    v_sub_f32 v42, v42, v242
    v_exp_f32 v42, v42
    v_sub_f32 v43, v43, v242
    v_exp_f32 v43, v43
    v_sub_f32 v44, v44, v242
    v_exp_f32 v44, v44
    v_smfmac_f32_16x16x64_bf16 v[216:219], a[32:35], v[32:39], v224
    v_sub_f32 v45, v45, v242
    v_exp_f32 v45, v45
    v_sub_f32 v46, v46, v242
    v_exp_f32 v46, v46
    v_sub_f32 v47, v47, v242
    v_exp_f32 v47, v47
    v_mfma_f32_32x32x16_bf16 v[0:15], a[0:3], v[128:131], 0
    v_sub_f32 v48, v48, v243
    v_exp_f32 v48, v48
    v_sub_f32 v49, v49, v243
    v_exp_f32 v49, v49
    v_sub_f32 v50, v50, v243
    v_exp_f32 v50, v50
    v_mfma_f32_32x32x16_bf16 v[0:15], a[4:7], v[132:135], v[0:15]
    v_sub_f32 v51, v51, v243
    v_exp_f32 v51, v51
    v_sub_f32 v52, v52, v243
    v_exp_f32 v52, v52
    v_sub_f32 v53, v53, v243
    v_exp_f32 v53, v53
    v_smfmac_f32_32x32x32_bf16 v[96:111], a[28:31], v[40:47], v224
    v_sub_f32 v54, v54, v243
    v_exp_f32 v54, v54
    v_sub_f32 v55, v55, v243
    v_exp_f32 v55, v55
    v_sub_f32 v56, v56, v243
    v_exp_f32 v56, v56
    v_smfmac_f32_16x16x64_bf16 v[216:219], a[32:35], v[40:47], v224
    v_sub_f32 v57, v57, v243
    v_exp_f32 v57, v57
    v_smfmac_f32_32x32x32_bf16 v[112:127], a[24:27], v[48:55], v224
    v_sub_f32 v58, v58, v243
    v_exp_f32 v58, v58
    v_sub_f32 v59, v59, v243
    v_exp_f32 v59, v59
    v_sub_f32 v60, v60, v243
    v_exp_f32 v60, v60
    v_smfmac_f32_16x16x64_bf16 v[220:223], a[32:35], v[48:55], v224
    v_sub_f32 v61, v61, v243
    v_exp_f32 v61, v61
    v_sub_f32 v62, v62, v243
    v_exp_f32 v62, v62
    v_sub_f32 v63, v63, v243
    v_exp_f32 v63, v63
    v_mfma_f32_32x32x16_bf16 v[16:31], a[0:3], v[136:139], 0
    v_sub_f32 v0, v0, v240
    v_exp_f32 v0, v0
    v_sub_f32 v1, v1, v240
    v_exp_f32 v1, v1
    v_sub_f32 v2, v2, v240
    v_exp_f32 v2, v2
    v_mfma_f32_32x32x16_bf16 v[16:31], a[4:7], v[140:143], v[16:31]
    v_sub_f32 v3, v3, v240
    v_exp_f32 v3, v3
    v_sub_f32 v4, v4, v240
    v_exp_f32 v4, v4
    v_sub_f32 v5, v5, v240
    v_exp_f32 v5, v5
    v_smfmac_f32_32x32x32_bf16 v[112:127], a[28:31], v[56:63], v224
    v_sub_f32 v6, v6, v240
    v_exp_f32 v6, v6
    v_sub_f32 v7, v7, v240
    v_exp_f32 v7, v7
    v_sub_f32 v8, v8, v240
    v_exp_f32 v8, v8
    v_smfmac_f32_16x16x64_bf16 v[220:223], a[32:35], v[56:63], v224
    s_waitcnt lgkmcnt(0)
    ds_read_b128 a[8:11], v225 offset:14336
    ds_read_b128 a[12:15], v225 offset:15360
    v_sub_f32 v9, v9, v240
    v_exp_f32 v9, v9
    v_smfmac_f32_32x32x32_bf16 v[64:79], a[16:19], v[0:7], v224
    v_sub_f32 v10, v10, v240
    v_exp_f32 v10, v10
    v_sub_f32 v11, v11, v240
    v_exp_f32 v11, v11
    v_sub_f32 v12, v12, v240
    v_exp_f32 v12, v12
    v_smfmac_f32_16x16x64_bf16 v[208:211], a[32:35], v[0:7], v224
    v_sub_f32 v13, v13, v240
    v_exp_f32 v13, v13
    v_sub_f32 v14, v14, v240
    v_exp_f32 v14, v14
    v_sub_f32 v15, v15, v240
    v_exp_f32 v15, v15
    v_mfma_f32_32x32x16_bf16 v[32:47], a[0:3], v[144:147], 0
    v_sub_f32 v16, v16, v241
    v_exp_f32 v16, v16
    v_sub_f32 v17, v17, v241
    v_exp_f32 v17, v17
    v_sub_f32 v18, v18, v241
    v_exp_f32 v18, v18
    v_mfma_f32_32x32x16_bf16 v[32:47], a[4:7], v[148:151], v[32:47]
    v_sub_f32 v19, v19, v241
    v_exp_f32 v19, v19
    v_sub_f32 v20, v20, v241
    v_exp_f32 v20, v20
    v_sub_f32 v21, v21, v241
    v_exp_f32 v21, v21
    v_smfmac_f32_32x32x32_bf16 v[64:79], a[20:23], v[8:15], v224
    v_sub_f32 v22, v22, v241
    v_exp_f32 v22, v22
    v_sub_f32 v23, v23, v241
    v_exp_f32 v23, v23
    v_sub_f32 v24, v24, v241
    v_exp_f32 v24, v24
    v_smfmac_f32_16x16x64_bf16 v[208:211], a[32:35], v[8:15], v224
    ds_read_b64_tr_b16 a[24:25], v226 offset:14336
    ds_read_b64_tr_b16 a[26:27], v226 offset:14592
    ds_read_b64_tr_b16 a[28:29], v226 offset:15360
    ds_read_b64_tr_b16 a[30:31], v226 offset:15616
    v_sub_f32 v25, v25, v241
    v_exp_f32 v25, v25
    v_smfmac_f32_32x32x32_bf16 v[80:95], a[16:19], v[16:23], v224
    v_sub_f32 v26, v26, v241
    v_exp_f32 v26, v26
    v_sub_f32 v27, v27, v241
    v_exp_f32 v27, v27
    v_sub_f32 v28, v28, v241
    v_exp_f32 v28, v28
    v_smfmac_f32_16x16x64_bf16 v[212:215], a[32:35], v[16:23], v224
    v_sub_f32 v29, v29, v241
    v_exp_f32 v29, v29
    v_sub_f32 v30, v30, v241
    v_exp_f32 v30, v30
    v_sub_f32 v31, v31, v241
    v_exp_f32 v31, v31
    v_mfma_f32_32x32x16_bf16 v[48:63], a[0:3], v[152:155], 0
    v_sub_f32 v32, v32, v242
    v_exp_f32 v32, v32
    v_sub_f32 v33, v33, v242
    v_exp_f32 v33, v33
    v_sub_f32 v34, v34, v242
    v_exp_f32 v34, v34
    v_mfma_f32_32x32x16_bf16 v[48:63], a[4:7], v[156:159], v[48:63]
    v_sub_f32 v35, v35, v242
    v_exp_f32 v35, v35
    v_sub_f32 v36, v36, v242
    v_exp_f32 v36, v36
    v_sub_f32 v37, v37, v242
    v_exp_f32 v37, v37
    v_smfmac_f32_32x32x32_bf16 v[80:95], a[20:23], v[24:31], v224
    v_sub_f32 v38, v38, v242
    v_exp_f32 v38, v38
    v_sub_f32 v39, v39, v242
    v_exp_f32 v39, v39
    v_sub_f32 v40, v40, v242
    v_exp_f32 v40, v40
    v_smfmac_f32_16x16x64_bf16 v[212:215], a[32:35], v[24:31], v224
    s_waitcnt lgkmcnt(0)
    v_sub_f32 v41, v41, v242
    v_exp_f32 v41, v41
    v_smfmac_f32_32x32x32_bf16 v[96:111], a[16:19], v[32:39], v224
    v_sub_f32 v42, v42, v242
    v_exp_f32 v42, v42
    v_sub_f32 v43, v43, v242
    v_exp_f32 v43, v43
    v_sub_f32 v44, v44, v242
    v_exp_f32 v44, v44
    v_smfmac_f32_16x16x64_bf16 v[216:219], a[32:35], v[32:39], v224
    v_sub_f32 v45, v45, v242
    v_exp_f32 v45, v45
    v_sub_f32 v46, v46, v242
    v_exp_f32 v46, v46
    v_sub_f32 v47, v47, v242
    v_exp_f32 v47, v47
    v_mfma_f32_32x32x16_bf16 v[0:15], a[8:11], v[128:131], 0
    v_sub_f32 v48, v48, v243
    v_exp_f32 v48, v48
    v_sub_f32 v49, v49, v243
    v_exp_f32 v49, v49
    v_sub_f32 v50, v50, v243
    v_exp_f32 v50, v50
    v_mfma_f32_32x32x16_bf16 v[0:15], a[12:15], v[132:135], v[0:15]
    v_sub_f32 v51, v51, v243
    v_exp_f32 v51, v51
    v_sub_f32 v52, v52, v243
    v_exp_f32 v52, v52
    v_sub_f32 v53, v53, v243
    v_exp_f32 v53, v53
    v_smfmac_f32_32x32x32_bf16 v[96:111], a[20:23], v[40:47], v224
    v_sub_f32 v54, v54, v243
    v_exp_f32 v54, v54
    v_sub_f32 v55, v55, v243
    v_exp_f32 v55, v55
    v_sub_f32 v56, v56, v243
    v_exp_f32 v56, v56
    v_smfmac_f32_16x16x64_bf16 v[216:219], a[32:35], v[40:47], v224
    v_xor_b32 v225, 0x8000, v225
    v_xor_b32 v226, 0x8000, v226
    v_xor_b32 v227, 0x8000, v227
    v_sub_f32 v57, v57, v243
    v_exp_f32 v57, v57
    v_smfmac_f32_32x32x32_bf16 v[112:127], a[16:19], v[48:55], v224
    v_sub_f32 v58, v58, v243
    v_exp_f32 v58, v58
    v_sub_f32 v59, v59, v243
    v_exp_f32 v59, v59
    v_sub_f32 v60, v60, v243
    v_exp_f32 v60, v60
    v_smfmac_f32_16x16x64_bf16 v[220:223], a[32:35], v[48:55], v224
    v_sub_f32 v61, v61, v243
    v_exp_f32 v61, v61
    v_sub_f32 v62, v62, v243
    v_exp_f32 v62, v62
    v_sub_f32 v63, v63, v243
    v_exp_f32 v63, v63
    v_mfma_f32_32x32x16_bf16 v[16:31], a[8:11], v[136:139], 0
    v_sub_f32 v0, v0, v240
    v_exp_f32 v0, v0
    v_sub_f32 v1, v1, v240
    v_exp_f32 v1, v1
    v_sub_f32 v2, v2, v240
    v_exp_f32 v2, v2
    v_mfma_f32_32x32x16_bf16 v[16:31], a[12:15], v[140:143], v[16:31]
    v_sub_f32 v3, v3, v240
    v_exp_f32 v3, v3
    v_sub_f32 v4, v4, v240
    v_exp_f32 v4, v4
    v_sub_f32 v5, v5, v240
    v_exp_f32 v5, v5
    v_smfmac_f32_32x32x32_bf16 v[112:127], a[20:23], v[56:63], v224
    v_sub_f32 v6, v6, v240
    v_exp_f32 v6, v6
    v_sub_f32 v7, v7, v240
    v_exp_f32 v7, v7
    v_sub_f32 v8, v8, v240
    v_exp_f32 v8, v8
    v_smfmac_f32_16x16x64_bf16 v[220:223], a[32:35], v[56:63], v224
    s_waitcnt vmcnt(4) lgkmcnt(0)
    s_barrier
    ds_read_b128 a[0:3], v225 offset:0
    ds_read_b128 a[4:7], v225 offset:1024
    v_sub_f32 v9, v9, v240
    v_exp_f32 v9, v9
    v_smfmac_f32_32x32x32_bf16 v[64:79], a[24:27], v[0:7], v224
    v_sub_f32 v10, v10, v240
    v_exp_f32 v10, v10
    v_sub_f32 v11, v11, v240
    v_exp_f32 v11, v11
    v_sub_f32 v12, v12, v240
    v_exp_f32 v12, v12
    v_smfmac_f32_16x16x64_bf16 v[208:211], a[32:35], v[0:7], v224
    v_sub_f32 v13, v13, v240
    v_exp_f32 v13, v13
    v_sub_f32 v14, v14, v240
    v_exp_f32 v14, v14
    v_sub_f32 v15, v15, v240
    v_exp_f32 v15, v15
    v_mfma_f32_32x32x16_bf16 v[32:47], a[8:11], v[144:147], 0
    v_sub_f32 v16, v16, v241
    v_exp_f32 v16, v16
    v_sub_f32 v17, v17, v241
    v_exp_f32 v17, v17
    v_sub_f32 v18, v18, v241
    v_exp_f32 v18, v18
    v_mfma_f32_32x32x16_bf16 v[32:47], a[12:15], v[148:151], v[32:47]
    v_sub_f32 v19, v19, v241
    v_exp_f32 v19, v19
    v_sub_f32 v20, v20, v241
    v_exp_f32 v20, v20
    v_sub_f32 v21, v21, v241
    v_exp_f32 v21, v21
    v_smfmac_f32_32x32x32_bf16 v[64:79], a[28:31], v[8:15], v224
    v_sub_f32 v22, v22, v241
    v_exp_f32 v22, v22
    v_sub_f32 v23, v23, v241
    v_exp_f32 v23, v23
    v_sub_f32 v24, v24, v241
    v_exp_f32 v24, v24
    v_smfmac_f32_16x16x64_bf16 v[208:211], a[32:35], v[8:15], v224
    ds_read_b64_tr_b16 a[16:17], v226 offset:0
    ds_read_b64_tr_b16 a[18:19], v226 offset:256
    ds_read_b64_tr_b16 a[20:21], v226 offset:1024
    ds_read_b64_tr_b16 a[22:23], v226 offset:1280
    v_sub_f32 v25, v25, v241
    v_exp_f32 v25, v25
    v_smfmac_f32_32x32x32_bf16 v[80:95], a[24:27], v[16:23], v224
    v_sub_f32 v26, v26, v241
    v_exp_f32 v26, v26
    v_sub_f32 v27, v27, v241
    v_exp_f32 v27, v27
    v_sub_f32 v28, v28, v241
    v_exp_f32 v28, v28
    v_smfmac_f32_16x16x64_bf16 v[212:215], a[32:35], v[16:23], v224
    v_sub_f32 v29, v29, v241
    v_exp_f32 v29, v29
    v_sub_f32 v30, v30, v241
    v_exp_f32 v30, v30
    v_sub_f32 v31, v31, v241
    v_exp_f32 v31, v31
    v_mfma_f32_32x32x16_bf16 v[48:63], a[8:11], v[152:155], 0
    v_sub_f32 v32, v32, v242
    v_exp_f32 v32, v32
    v_sub_f32 v33, v33, v242
    v_exp_f32 v33, v33
    v_sub_f32 v34, v34, v242
    v_exp_f32 v34, v34
    v_mfma_f32_32x32x16_bf16 v[48:63], a[12:15], v[156:159], v[48:63]
    v_sub_f32 v35, v35, v242
    v_exp_f32 v35, v35
    v_sub_f32 v36, v36, v242
    v_exp_f32 v36, v36
    v_sub_f32 v37, v37, v242
    v_exp_f32 v37, v37
    v_smfmac_f32_32x32x32_bf16 v[80:95], a[28:31], v[24:31], v224
    v_sub_f32 v38, v38, v242
    v_exp_f32 v38, v38
    v_sub_f32 v39, v39, v242
    v_exp_f32 v39, v39
    v_sub_f32 v40, v40, v242
    v_exp_f32 v40, v40
    v_smfmac_f32_16x16x64_bf16 v[212:215], a[32:35], v[24:31], v224
    s_waitcnt lgkmcnt(0)
    v_sub_f32 v41, v41, v242
    v_exp_f32 v41, v41
    v_smfmac_f32_32x32x32_bf16 v[96:111], a[24:27], v[32:39], v224
    v_sub_f32 v42, v42, v242
    v_exp_f32 v42, v42
    v_sub_f32 v43, v43, v242
    v_exp_f32 v43, v43
    v_sub_f32 v44, v44, v242
    v_exp_f32 v44, v44
    v_smfmac_f32_16x16x64_bf16 v[216:219], a[32:35], v[32:39], v224
    v_sub_f32 v45, v45, v242
    v_exp_f32 v45, v45
    v_sub_f32 v46, v46, v242
    v_exp_f32 v46, v46
    v_sub_f32 v47, v47, v242
    v_exp_f32 v47, v47
    v_mfma_f32_32x32x16_bf16 v[0:15], a[0:3], v[128:131], 0
    v_sub_f32 v48, v48, v243
    v_exp_f32 v48, v48
    v_sub_f32 v49, v49, v243
    v_exp_f32 v49, v49
    v_sub_f32 v50, v50, v243
    v_exp_f32 v50, v50
    v_mfma_f32_32x32x16_bf16 v[0:15], a[4:7], v[132:135], v[0:15]
    v_sub_f32 v51, v51, v243
    v_exp_f32 v51, v51
    v_sub_f32 v52, v52, v243
    v_exp_f32 v52, v52
    v_sub_f32 v53, v53, v243
    v_exp_f32 v53, v53
    v_smfmac_f32_32x32x32_bf16 v[96:111], a[28:31], v[40:47], v224
    v_sub_f32 v54, v54, v243
    v_exp_f32 v54, v54
    v_sub_f32 v55, v55, v243
    v_exp_f32 v55, v55
    v_sub_f32 v56, v56, v243
    v_exp_f32 v56, v56
    v_smfmac_f32_16x16x64_bf16 v[216:219], a[32:35], v[40:47], v224
    s_add_u32 s36, s36, 1
    s_cmp_lg_u32 s36, 8
    v_sub_f32 v57, v57, v243
    v_exp_f32 v57, v57
    v_smfmac_f32_32x32x32_bf16 v[112:127], a[24:27], v[48:55], v224
    v_sub_f32 v58, v58, v243
    v_exp_f32 v58, v58
    v_sub_f32 v59, v59, v243
    v_exp_f32 v59, v59
    v_sub_f32 v60, v60, v243
    v_exp_f32 v60, v60
    v_smfmac_f32_16x16x64_bf16 v[220:223], a[32:35], v[48:55], v224
    v_sub_f32 v61, v61, v243
    v_exp_f32 v61, v61
    v_sub_f32 v62, v62, v243
    v_exp_f32 v62, v62
    v_sub_f32 v63, v63, v243
    v_exp_f32 v63, v63
    s_cbranch_scc1 Ls_loop
    s_nop 1
    v_smfmac_f32_32x32x32_bf16 v[112:127], a[28:31], v[56:63], v224
    v_smfmac_f32_16x16x64_bf16 v[220:223], a[32:35], v[56:63], v224
    s_nop 7
    s_nop 7
    v_rcp_f32 v236, v208
    s_nop 0
    v_pk_mul_f32 v[64:65], v[64:65], v[236:237] op_sel_hi:[1,0]
    v_pk_mul_f32 v[66:67], v[66:67], v[236:237] op_sel_hi:[1,0]
    v_pk_mul_f32 v[68:69], v[68:69], v[236:237] op_sel_hi:[1,0]
    v_pk_mul_f32 v[70:71], v[70:71], v[236:237] op_sel_hi:[1,0]
    v_pk_mul_f32 v[72:73], v[72:73], v[236:237] op_sel_hi:[1,0]
    v_pk_mul_f32 v[74:75], v[74:75], v[236:237] op_sel_hi:[1,0]
    v_pk_mul_f32 v[76:77], v[76:77], v[236:237] op_sel_hi:[1,0]
    v_pk_mul_f32 v[78:79], v[78:79], v[236:237] op_sel_hi:[1,0]
    v_cvt_pk_bf16_f32 v160, v64, v65
    v_cvt_pk_bf16_f32 v164, v72, v73
    v_cvt_pk_bf16_f32 v161, v66, v67
    v_cvt_pk_bf16_f32 v165, v74, v75
    v_cvt_pk_bf16_f32 v162, v68, v69
    v_cvt_pk_bf16_f32 v166, v76, v77
    v_cvt_pk_bf16_f32 v163, v70, v71
    v_cvt_pk_bf16_f32 v167, v78, v79
    v_permlane16_swap_b32 v160, v164
    v_permlane16_swap_b32 v161, v165
    v_permlane16_swap_b32 v162, v166
    v_permlane16_swap_b32 v163, v167
    buffer_store_dwordx4 v[160:163], v229, s[28:31], s98 offen offset:0 sc1
    buffer_store_dwordx4 v[164:167], v229, s[28:31], s98 offen offset:1024 sc1
    v_rcp_f32 v236, v212
    s_nop 0
    v_pk_mul_f32 v[80:81], v[80:81], v[236:237] op_sel_hi:[1,0]
    v_pk_mul_f32 v[82:83], v[82:83], v[236:237] op_sel_hi:[1,0]
    v_pk_mul_f32 v[84:85], v[84:85], v[236:237] op_sel_hi:[1,0]
    v_pk_mul_f32 v[86:87], v[86:87], v[236:237] op_sel_hi:[1,0]
    v_pk_mul_f32 v[88:89], v[88:89], v[236:237] op_sel_hi:[1,0]
    v_pk_mul_f32 v[90:91], v[90:91], v[236:237] op_sel_hi:[1,0]
    v_pk_mul_f32 v[92:93], v[92:93], v[236:237] op_sel_hi:[1,0]
    v_pk_mul_f32 v[94:95], v[94:95], v[236:237] op_sel_hi:[1,0]
    v_cvt_pk_bf16_f32 v168, v80, v81
    v_cvt_pk_bf16_f32 v172, v88, v89
    v_cvt_pk_bf16_f32 v169, v82, v83
    v_cvt_pk_bf16_f32 v173, v90, v91
    v_cvt_pk_bf16_f32 v170, v84, v85
    v_cvt_pk_bf16_f32 v174, v92, v93
    v_cvt_pk_bf16_f32 v171, v86, v87
    v_cvt_pk_bf16_f32 v175, v94, v95
    v_permlane16_swap_b32 v168, v172
    v_permlane16_swap_b32 v169, v173
    v_permlane16_swap_b32 v170, v174
    v_permlane16_swap_b32 v171, v175
    buffer_store_dwordx4 v[168:171], v229, s[28:31], s99 offen offset:0 sc1
    buffer_store_dwordx4 v[172:175], v229, s[28:31], s99 offen offset:1024 sc1
    v_rcp_f32 v236, v216
    s_nop 0
    v_pk_mul_f32 v[96:97], v[96:97], v[236:237] op_sel_hi:[1,0]
    v_pk_mul_f32 v[98:99], v[98:99], v[236:237] op_sel_hi:[1,0]
    v_pk_mul_f32 v[100:101], v[100:101], v[236:237] op_sel_hi:[1,0]
    v_pk_mul_f32 v[102:103], v[102:103], v[236:237] op_sel_hi:[1,0]
    v_pk_mul_f32 v[104:105], v[104:105], v[236:237] op_sel_hi:[1,0]
    v_pk_mul_f32 v[106:107], v[106:107], v[236:237] op_sel_hi:[1,0]
    v_pk_mul_f32 v[108:109], v[108:109], v[236:237] op_sel_hi:[1,0]
    v_pk_mul_f32 v[110:111], v[110:111], v[236:237] op_sel_hi:[1,0]
    v_cvt_pk_bf16_f32 v176, v96, v97
    v_cvt_pk_bf16_f32 v180, v104, v105
    v_cvt_pk_bf16_f32 v177, v98, v99
    v_cvt_pk_bf16_f32 v181, v106, v107
    v_cvt_pk_bf16_f32 v178, v100, v101
    v_cvt_pk_bf16_f32 v182, v108, v109
    v_cvt_pk_bf16_f32 v179, v102, v103
    v_cvt_pk_bf16_f32 v183, v110, v111
    v_permlane16_swap_b32 v176, v180
    v_permlane16_swap_b32 v177, v181
    v_permlane16_swap_b32 v178, v182
    v_permlane16_swap_b32 v179, v183
    buffer_store_dwordx4 v[176:179], v229, s[28:31], s100 offen offset:0 sc1
    buffer_store_dwordx4 v[180:183], v229, s[28:31], s100 offen offset:1024 sc1
    v_rcp_f32 v236, v220
    s_nop 0
    v_pk_mul_f32 v[112:113], v[112:113], v[236:237] op_sel_hi:[1,0]
    v_pk_mul_f32 v[114:115], v[114:115], v[236:237] op_sel_hi:[1,0]
    v_pk_mul_f32 v[116:117], v[116:117], v[236:237] op_sel_hi:[1,0]
    v_pk_mul_f32 v[118:119], v[118:119], v[236:237] op_sel_hi:[1,0]
    v_pk_mul_f32 v[120:121], v[120:121], v[236:237] op_sel_hi:[1,0]
    v_pk_mul_f32 v[122:123], v[122:123], v[236:237] op_sel_hi:[1,0]
    v_pk_mul_f32 v[124:125], v[124:125], v[236:237] op_sel_hi:[1,0]
    v_pk_mul_f32 v[126:127], v[126:127], v[236:237] op_sel_hi:[1,0]
    v_cvt_pk_bf16_f32 v184, v112, v113
    v_cvt_pk_bf16_f32 v188, v120, v121
    v_cvt_pk_bf16_f32 v185, v114, v115
    v_cvt_pk_bf16_f32 v189, v122, v123
    v_cvt_pk_bf16_f32 v186, v116, v117
    v_cvt_pk_bf16_f32 v190, v124, v125
    v_cvt_pk_bf16_f32 v187, v118, v119
    v_cvt_pk_bf16_f32 v191, v126, v127
    v_permlane16_swap_b32 v184, v188
    v_permlane16_swap_b32 v185, v189
    v_permlane16_swap_b32 v186, v190
    v_permlane16_swap_b32 v187, v191
    buffer_store_dwordx4 v[184:187], v229, s[28:31], s101 offen offset:0 sc1
    buffer_store_dwordx4 v[188:191], v229, s[28:31], s101 offen offset:1024 sc1
    s_endpgm
.section .rodata,"a"
.p2align 6
.amdhsa_kernel standalone__qk_norm__prompt_kernel
  .amdhsa_next_free_vgpr 320
  .amdhsa_next_free_sgpr 102
  .amdhsa_accum_offset 256
  .amdhsa_group_segment_fixed_size 0
  .amdhsa_kernarg_size 56
  .amdhsa_user_sgpr_count 2
  .amdhsa_user_sgpr_kernarg_segment_ptr 1
  .amdhsa_system_sgpr_workgroup_id_x 1
  .amdhsa_float_denorm_mode_32 3
.end_amdhsa_kernel
```
